```python
import torch

def _softmax(x, axis=-1):
    return torch.softmax(x, dim=axis)
def _gelu(x):
    return torch.nn.functional.gelu(x, approximate="tanh")
def _silu(x):
    return torch.nn.functional.silu(x)
def _sigmoid(x):
    return torch.sigmoid(x)
def _layernorm(x, axis=-1, eps=1e-5):
    m = x.mean(dim=axis, keepdim=True)
    v = x.var(dim=axis, keepdim=True, unbiased=False)
    return (x - m) / torch.sqrt(v + eps)
def _scatter_add(tgt, idx, src, axis=0):
    return tgt.clone().index_add_(axis, idx, src)
def _segment_sum(src, seg, n):
    out = torch.zeros((n,) + src.shape[1:], dtype=src.dtype)
    return out.index_add_(0, seg, src)
def _pad(x, pw):
    flat = tuple(v for pair in reversed(pw) for v in pair)
    return torch.nn.functional.pad(x, flat)

kernel_name = 'concat_heads__sliding_local_dilated__compressed_kv_cla__prompt'

def setup_inputs():

    _w = (lambda a: (lambda t: t.to(torch.bfloat16) if t.is_floating_point() else t)(torch.as_tensor(a)))
    def _A_setup():
        B, S, D = 1, 2048, 448
        return {
            "x": _w((lambda *s: torch.randn(*s, dtype=torch.bfloat16) * 0.4)(B, S, D)),
            "wqkv": _w((lambda *s: torch.randn(*s, dtype=torch.bfloat16) * 0.4)(D, 3 * D)),
            "wo": _w((lambda *s: torch.randn(*s, dtype=torch.bfloat16) * 0.05)(D, D)),
        }
    _A_in = _A_setup()

    def _B_setup():
        B, H, Sq, Sk, D, M = 1, 16, 2048, 2048, 256, 448
        Dc = 4 * D
        return {
            "x": _w((lambda *s: torch.randn(*s, dtype=torch.bfloat16) * 0.2)(B, Sq, M)),
            "c_kv": _w((lambda *s: torch.randn(*s, dtype=torch.bfloat16) * 1.6)(B, Sk, Dc)),
            "w_q": _w((lambda *s: torch.randn(*s, dtype=torch.bfloat16) * 3.2)(M, H, D) * (M ** -0.5)),
            "w_uk": _w((lambda *s: torch.randn(*s, dtype=torch.bfloat16) * 3.2)(Dc, H, D) * (Dc ** -0.5)),
            "w_uv": _w((lambda *s: torch.randn(*s, dtype=torch.bfloat16) * 1.6)(Dc, H, D) * (Dc ** -0.5)),
            "w_o": _w((lambda *s: torch.randn(*s, dtype=torch.bfloat16) * 1.6)(H, D, M) * ((H * D) ** -0.5)),
        }
    _B_in = _B_setup()

    return {
        "A_x": _A_in["x"],
        "A_wqkv": _A_in["wqkv"],
        "A_wo": _A_in["wo"],
        "B_x": _B_in["x"],
        "B_c_kv": _B_in["c_kv"],
        "B_w_q": _B_in["w_q"],
        "B_w_uk": _B_in["w_uk"],
        "B_w_uv": _B_in["w_uv"],
        "B_w_o": _B_in["w_o"],
    }

def reference(A_x, A_wqkv, A_wo, B_x, B_c_kv, B_w_q, B_w_uk, B_w_uv, B_w_o):
    def _A_ref(x, wqkv, wo):
        B, S, D = x.shape
        H = 16; Dh = D // H
        W, dil = 8, 2
        qkv = (lambda x, *d: x.permute(*d))((x @ wqkv).reshape(B, S, 3, H, Dh), 2, 0, 3, 1, 4)
        q, k, v = qkv[0], qkv[1], qkv[2]
        scale = Dh ** -0.5
        pos = torch.arange(S)
        off = torch.arange(W) * dil
        idx = pos[:, None] - off[None, :]
        mask = idx >= 0
        idx_c = torch.where(mask, idx, 0).reshape(-1)
        kg = k[:, :, idx_c, :].reshape(B, H, S, W, Dh)
        vg = v[:, :, idx_c, :].reshape(B, H, S, W, Dh)
        logits = torch.einsum("bhsd,bhswd->bhsw", q, kg) * scale
        logits = torch.where(mask[None, None, :, :], logits, -1e9)
        attn = _softmax(logits, axis=-1)
        o = torch.einsum("bhsw,bhswd->bhsd", attn, vg)
        return (lambda x, *d: x.permute(*d))(o, 0, 2, 1, 3).reshape(B, S, D) @ wo

    def _B_ref(x, c_kv, w_q, w_uk, w_uv, w_o):
        B, Sq, M = x.shape[0], x.shape[1], x.shape[2]
        Sk = c_kv.shape[1]
        H, D = w_q.shape[1], w_q.shape[2]
        q = torch.einsum("bqm,mhd->bhqd", x, w_q)
        k = torch.einsum("bkc,chd->bhkd", c_kv, w_uk)
        v = torch.einsum("bkc,chd->bhkd", c_kv, w_uv)
        scores = torch.einsum("bhqd,bhkd->bhqk", q, k) * (D ** -0.5)
        off = Sk - Sq
        qi = torch.arange(Sq)[:, None]
        kj = torch.arange(Sk)[None, :]
        cmask = kj <= (qi + off)
        scores = torch.where(cmask[None, None], scores, -1e9)
        p = _softmax(scores, axis=-1)
        ctx = torch.einsum("bhqk,bhkd->bhqd", p, v)
        return torch.einsum("bhqd,hdm->bqm", ctx, w_o)

    a = _A_ref(A_x, A_wqkv, A_wo)
    b = _B_ref(B_x, B_c_kv, B_w_q, B_w_uk, B_w_uv, B_w_o)
    return torch.concatenate([a, b], axis=-1)
```

```asm
; @launch grid=(256,1,1) block=(256,1,1) lds=163840
.amdgcn_target "amdgcn-amd-amdhsa--gfx950"
.macro M aa,bb,cc,dd
v_mfma_f32_16x16x32_bf16 \aa,\bb,\cc,\dd
.endm
.macro CV aa,bb,cc
v_cvt_pk_bf16_f32 \aa,\bb,\cc
.endm
.macro AR aa,bb
v_accvgpr_read_b32 \aa,\bb
.endm
.macro AW aa,bb
v_accvgpr_write_b32 \aa,\bb
.endm
.text
.globl concat_heads__sliding_local_dilated__compressed_kv_cla__prompt_kernel
.p2align 8
.type concat_heads__sliding_local_dilated__compressed_kv_cla__prompt_kernel,@function
concat_heads__sliding_local_dilated__compressed_kv_cla__prompt_kernel:
s_cmp_ge_u32 s2,256
s_cbranch_scc0 K_START
s_endpgm
K_START:
s_load_dwordx16 s[80:95],s[0:1],0
s_load_dwordx2 s[40:41],s[0:1],88
s_load_dwordx2 s[68:69],s[0:1],80
v_lshrrev_b32_e64 v1,6,v0
s_and_b32 s58,s2,7
v_readfirstlane_b32 s20,v1
s_getpc_b64 s[64:65]
CPC_1:
s_sub_u32 s64,s64,CPC_1-concat_heads__sliding_local_dilated__compressed_kv_cla__prompt_kernel
s_subb_u32 s65,s65,0
s_mov_b32 s66,CODE_END-concat_heads__sliding_local_dilated__compressed_kv_cla__prompt_kernel
s_mov_b32 s67,0x20000
s_lshr_b32 s30,s2,3
s_lshl_b32 s30,s30,2
s_add_u32 s30,s30,s20
s_lshl_b32 s30,s30,7
v_and_b32 v37,63,v0
v_lshlrev_b32 v37,14,v37
v_add_u32 v37,s30,v37
buffer_load_dword v1,v37,s[64:67],0 offen
s_lshr_b32 s59,s2,3
s_lshr_b32 s27,s59,1
s_and_b32 s31,s59,1
s_lshl_b32 s35,s58,1
s_add_u32 s35,s35,s31
s_lshl_b32 s32,s35,9
s_sub_u32 s33,s59,26
s_mul_i32 s33,s33,448
s_movk_i32 s30,0x2000
s_cmp_ge_u32 s27,13
s_cselect_b32 s30,2688,s30
s_cselect_b32 s31,8,0
s_cselect_b32 s32,s33,s32
v_lshrrev_b32 v30,3,v0
v_and_b32 v30,24,v30
v_bfe_u32 v32,v0,5,1
v_and_b32 v33,8,v30
v_add_u32 v30,v30,v32
v_mul_u32_u24_e64 v30,s30,v30
v_lshl_or_b32 v32,v32,1,v33
v_and_b32 v31,31,v0
v_xor_b32 v31,v31,v32
s_lshl_b32 s25,s30,5
s_lshl_b32 s33,s30,1
s_sub_u32 s33,s33,1024
v_lshrrev_b32 v32,2,v31
v_mul_u32_u24 v32,s31,v32
v_lshl_add_u32 v33,v31,4,v30
v_sub_u32 v26,v33,v32
v_xor_b32 v31,4,v31
v_lshrrev_b32 v32,2,v31
v_mul_u32_u24 v32,s31,v32
v_lshl_add_u32 v33,v31,4,v30
v_sub_u32 v27,v33,v32
v_add_u32 v27,s33,v27
s_lshl_b32 s33,s33,1
v_add_u32 v28,s33,v26
v_add_u32 v29,s33,v27
s_mul_i32 s10,s30,448
s_sub_u32 s10,s10,s32
s_mov_b32 s11,0x20000
s_mov_b32 s24,0
s_lshl_b32 s21,s20,12
s_add_u32 m0,s21,131072
s_waitcnt lgkmcnt(0)
s_cmp_ge_u32 s27,4
s_cselect_b64 s[8:9],s[94:95],s[92:93]
s_cmp_ge_u32 s27,8
s_cselect_b64 s[8:9],s[90:91],s[8:9]
s_cmp_ge_u32 s27,13
s_cselect_b64 s[8:9],s[82:83],s[8:9]
s_add_u32 s8,s8,s32
s_addc_u32 s9,s9,0
buffer_load_dwordx4 v26,s[8:11],s24 offen sc1 lds
buffer_load_dwordx4 v27,s[8:11],s24 offen offset:1024 sc1 lds
buffer_load_dwordx4 v28,s[8:11],s24 offen offset:2048 sc1 lds
buffer_load_dwordx4 v29,s[8:11],s24 offen offset:3072 sc1 lds
s_add_u32 m0,s21,147456
s_mov_b32 s24,s25
buffer_load_dwordx4 v26,s[8:11],s24 offen sc1 lds
buffer_load_dwordx4 v27,s[8:11],s24 offen offset:1024 sc1 lds
buffer_load_dwordx4 v28,s[8:11],s24 offen offset:2048 sc1 lds
buffer_load_dwordx4 v29,s[8:11],s24 offen offset:3072 sc1 lds
s_lshl_b32 s24,s25,1
s_lshl_b32 s32,s27,2
s_mov_b32 s30,0xba983210
s_mov_b32 s31,0xfedc7654
s_lshr_b64 s[30:31],s[30:31],s32
s_and_b32 s34,s30,7
s_bfe_u32 s61,s30,0x10003
s_mov_b32 s30,0x210
s_mov_b32 s31,0x37654
s_lshr_b64 s[30:31],s[30:31],s32
s_and_b32 s28,s30,7
v_and_b32 v35,63,v0
s_mov_b32 s22,0
s_mov_b32 s7,0x20000
s_cmp_ge_u32 s27,8
s_cbranch_scc0 K1_LONG1
s_lshr_b32 s30,s20,1
s_lshl_b32 s30,s30,7
s_and_b32 s31,s20,1
s_lshl_b32 s31,s31,5
s_add_u32 s30,s30,s31
v_lshrrev_b32 v30,3,v35
v_add_u32_e64 v30,s30,v30
v_mul_u32_u24 v30,896,v30
v_and_b32 v31,7,v35
v_lshrrev_b32 v32,4,v35
v_xor_b32_e64 v31,v31,v32
v_lshl_add_u32 v22,v31,4,v30
v_xor_b32_e64 v31,4,v31
v_lshl_add_u32 v30,v31,4,v30
v_add_u32 v23,6144,v30
v_add_u32 v24,12288,v22
v_add_u32 v25,18432,v30
s_cmp_ge_u32 s27,13
s_cbranch_scc1 K1_DEC_A
s_mul_i32 s30,s28,229376
s_add_u32 s4,s86,s30
s_addc_u32 s5,s87,0
s_mov_b32 s6,229376
s_lshl_b32 s31,s35,9
s_add_u32 s8,s90,s31
s_addc_u32 s9,s91,0
s_sub_u32 s10,3670016,s31
s_mov_b32 s25,262144
s_mov_b32 s23,57344
s_mov_b32 s26,7
s_branch K1_ISSUE
K1_DEC_A:
s_mul_i32 s30,s58,229376
s_add_u32 s4,s80,s30
s_addc_u32 s5,s81,0
s_mov_b32 s6,229376
s_sub_u32 s31,s59,26
s_mul_i32 s31,s31,448
s_add_u32 s8,s82,s31
s_addc_u32 s9,s83,0
s_sub_u32 s10,1204224,s31
s_mov_b32 s25,86016
s_mov_b32 s23,57344
s_mov_b32 s26,7
s_branch K1_ISSUE
K1_LONG1:
s_lshr_b32 s30,s20,1
s_lshl_b32 s30,s30,7
s_and_b32 s31,s20,1
s_lshl_b32 s31,s31,5
s_add_u32 s30,s30,s31
v_lshrrev_b32 v30,3,v35
v_add_u32_e64 v30,s30,v30
v_mul_u32_u24 v30,2048,v30
v_and_b32 v31,7,v35
v_lshrrev_b32 v32,4,v35
v_xor_b32_e64 v31,v31,v32
v_lshl_add_u32 v22,v31,4,v30
v_xor_b32_e64 v31,4,v31
v_lshl_add_u32 v30,v31,4,v30
v_add_u32 v23,15360,v30
v_add_u32 v24,30720,v22
v_add_u32 v25,46080,v30
s_cmp_eq_u32 s61,1
s_cselect_b32 s38,s94,s92
s_cselect_b32 s39,s95,s93
s_lshl_b32 s30,s34,19
s_add_u32 s4,s88,s30
s_addc_u32 s5,s89,0
s_mov_b32 s6,524288
s_lshl_b32 s31,s35,9
s_add_u32 s8,s38,s31
s_addc_u32 s9,s39,0
s_sub_u32 s10,8388608,s31
s_mov_b32 s25,262144
s_mov_b32 s23,131072
s_mov_b32 s26,16
K1_ISSUE:
v_and_b32 v30,15,v35
v_lshrrev_b32 v31,4,v35
s_lshr_b32 s30,s20,1
s_lshl_b32 s30,s30,13
v_lshrrev_b32 v32,1,v30
v_xor_b32 v32,v32,v31
v_lshlrev_b32_e64 v32,4,v32
v_lshl_add_u32 v32,v30,7,v32
v_add_u32 v2,s30,v32
v_xor_b32 v3,64,v2
v_add_u32 v4,0x10000,v2
v_add_u32 v5,0x10000,v3
v_lshrrev_b32 v32,2,v30
v_and_b32 v33,1,v31
v_lshl_or_b32 v33,v33,2,v32
v_lshl_add_u32 v32,v31,3,v32
v_lshlrev_b32 v32,9,v32
v_and_b32 v34,3,v35
v_lshl_add_u32 v32,v34,3,v32
s_and_b32 s30,s20,1
s_lshl_b32 s30,s30,8
s_add_u32 s30,s30,16384
v_add_u32 v32,s30,v32
v_xor_b32 v34,0,v33
v_lshl_add_u32 v6,v34,5,v32
v_add_u32 v14,0x10000,v6
v_add_u32 v64,114688,v6
v_xor_b32_e64 v34,1,v33
v_lshl_add_u32 v7,v34,5,v32
v_add_u32 v15,0x10000,v7
v_add_u32 v65,114688,v7
v_xor_b32_e64 v34,2,v33
v_lshl_add_u32 v8,v34,5,v32
v_add_u32 v16,0x10000,v8
v_add_u32 v66,114688,v8
v_xor_b32_e64 v34,3,v33
v_lshl_add_u32 v9,v34,5,v32
v_add_u32 v17,0x10000,v9
v_add_u32 v67,114688,v9
v_xor_b32_e64 v34,4,v33
v_lshl_add_u32 v10,v34,5,v32
v_add_u32 v18,0x10000,v10
v_add_u32 v68,114688,v10
v_xor_b32_e64 v34,5,v33
v_lshl_add_u32 v11,v34,5,v32
v_add_u32 v19,0x10000,v11
v_add_u32 v69,114688,v11
v_xor_b32_e64 v34,6,v33
v_lshl_add_u32 v12,v34,5,v32
v_add_u32 v20,0x10000,v12
v_add_u32 v70,114688,v12
v_xor_b32_e64 v34,7,v33
v_lshl_add_u32 v13,v34,5,v32
v_add_u32 v21,0x10000,v13
v_add_u32 v71,114688,v13
s_add_u32 m0,s21,0
s_nop 0
buffer_load_dwordx4 v22,s[4:7],s22 offen sc1 lds
buffer_load_dwordx4 v23,s[4:7],s22 offen offset:1024 sc1 lds
buffer_load_dwordx4 v24,s[4:7],s22 offen offset:2048 sc1 lds
buffer_load_dwordx4 v25,s[4:7],s22 offen offset:3072 sc1 lds
s_add_u32 s22,s22,128
v_lshlrev_b32 v36,4,v35
v_lshlrev_b32 v40,2,v35
v_mov_b32 v38,0
v_mov_b32 v41,0
v_mov_b32 v39,0
s_mov_b32 s12,s40
s_mov_b32 s13,s41
s_mov_b32 s14,138412032
s_mov_b32 s15,0x20000
s_mov_b32 s70,4
s_mov_b32 s71,0x20000
s_mov_b32 s78,99
s_mov_b32 s43,0
s_lshl_b32 s32,s27,2
s_mov_b32 s30,0x16547238
s_mov_b32 s31,0xedcba9f
s_lshr_b64 s[30:31],s[30:31],s32
s_and_b32 s33,s30,15
s_and_b32 s72,s33,7
s_cmp_lt_u32 s33,8
s_cselect_b32 s73,1,0
s_cselect_b32 s75,8,0
s_add_u32 s74,s72,8
s_lshl_b32 s32,s72,2
s_lshr_b32 s76,0xeca86420,s32
s_and_b32 s76,s76,15
s_cmp_eq_u32 s33,0
s_cselect_b32 s75,0,s75
s_cselect_b32 s74,7,s74
s_cselect_b32 s73,2,s73
s_cmp_eq_u32 s33,8
s_cselect_b32 s73,2,s73
s_cmp_ge_u32 s27,8
s_cbranch_scc1 K1_P_LATE
s_lshr_b32 s30,s20,1
s_lshl_b32 s30,s30,7
s_and_b32 s31,s20,1
s_lshl_b32 s31,s31,5
s_add_u32 s30,s30,s31
v_lshrrev_b32 v30,3,v35
v_add_u32 v30,s30,v30
v_mul_u32_u24 v30,896,v30
v_and_b32 v31,7,v35
v_lshrrev_b32 v32,4,v35
v_xor_b32_e64 v31,v31,v32
v_lshl_add_u32 v96,v31,4,v30
v_xor_b32_e64 v31,4,v31
v_lshl_add_u32 v30,v31,4,v30
v_add_u32 v97,6144,v30
v_add_u32 v98,12288,v96
v_add_u32 v99,18432,v30
v_mov_b32 v100,v26
v_mov_b32 v101,v27
v_mov_b32 v102,v28
v_mov_b32 v103,v29
s_mul_i32 s30,s28,229376
s_add_u32 s46,s86,s30
s_addc_u32 s47,s87,0
s_mov_b32 s48,229376
s_lshl_b32 s31,s35,9
s_add_u32 s50,s90,s31
s_addc_u32 s51,s91,0
s_sub_u32 s49,3670016,s31
s_mov_b32 s52,262144
s_mov_b32 s16,57344
s_mov_b32 s17,7
s_lshr_b32 s32,s20,1
s_and_b32 s33,s20,1
s_lshl_b32 s54,s35,20
s_lshl_b32 s30,s34,17
s_add_u32 s54,s54,s30
s_lshl_b32 s30,s32,16
s_add_u32 s54,s54,s30
s_mov_b32 s19,s61
s_add_u32 s30,s19,12
s_lshl_b32 s30,s33,s30
s_add_u32 s54,s54,s30
s_lshl_b32 s30,s19,24
s_add_u32 s30,s30,16777216
s_add_u32 s54,s54,s30
s_lshl_b32 s55,s19,12
s_add_u32 s55,s55,8192
s_lshl_b32 s30,s19,3
s_add_u32 s30,s30,s34
s_lshl_b32 s30,s30,2
s_lshl_b32 s77,s35,7
s_add_u32 s77,s77,s30
s_add_u32 s77,s77,136314880
s_lshl_b32 s56,s35,20
s_lshl_b32 s30,s28,17
s_add_u32 s56,s56,s30
s_lshl_b32 s30,s32,16
s_add_u32 s56,s56,s30
s_lshl_b32 s30,s33,12
s_add_u32 s56,s56,s30
s_mov_b32 s57,8192
s_mov_b32 s53,2
s_lshl_b32 s30,s28,2
s_lshl_b32 s79,s35,7
s_add_u32 s79,s79,s30
s_add_u32 s79,s79,136314944
s_mov_b32 s18,0
s_sub_u32 s30,s27,3
s_cmp_lt_u32 s30,5
s_cbranch_scc0 K1_P_DONE
s_mov_b32 s53,3
s_mov_b32 s48,0
s_mov_b32 s49,0
s_mov_b32 s79,s77
s_cmp_eq_u32 s27,3
s_cselect_b32 s43,0,3
s_branch K1_P_DONE
K1_P_LATE:
s_lshl_b32 s30,s20,3
s_and_b32 s31,s20,1
s_lshl_b32 s31,s31,3
v_lshrrev_b32 v30,5,v35
v_lshlrev_b32 v32,1,v30
v_add_u32_e64 v30,s30,v30
v_mul_u32_u24 v30,8192,v30
v_and_b32 v31,31,v35
v_xor_b32 v31,v31,v32
v_xor_b32_e64 v31,s31,v31
v_lshl_add_u32 v32,v31,4,v30
v_add_u32_e64 v100,0,v32
v_add_u32 v102,30720,v32
v_xor_b32_e64 v31,4,v31
v_lshl_add_u32 v32,v31,4,v30
v_add_u32 v101,15360,v32
v_add_u32 v103,46080,v32
s_lshr_b32 s30,s20,1
s_lshl_b32 s30,s30,7
s_and_b32 s31,s20,1
s_lshl_b32 s31,s31,5
s_add_u32 s30,s30,s31
v_lshrrev_b32 v30,3,v35
v_add_u32_e64 v30,s30,v30
v_mul_u32_u24 v30,2048,v30
v_and_b32 v31,7,v35
v_lshrrev_b32 v32,4,v35
v_xor_b32_e64 v31,v31,v32
v_lshl_add_u32 v96,v31,4,v30
v_xor_b32_e64 v31,4,v31
v_lshl_add_u32 v30,v31,4,v30
v_add_u32 v97,15360,v30
v_add_u32 v98,30720,v96
v_add_u32 v99,46080,v30
s_cmp_eq_u32 s61,1
s_cselect_b32 s38,s94,s92
s_cselect_b32 s39,s95,s93
s_lshl_b32 s30,s34,19
s_add_u32 s46,s88,s30
s_addc_u32 s47,s89,0
s_mov_b32 s48,524288
s_lshl_b32 s31,s35,9
s_add_u32 s50,s38,s31
s_addc_u32 s51,s39,0
s_nop 0
s_sub_u32 s49,8388608,s31
s_mov_b32 s52,262144
s_mov_b32 s16,131072
s_mov_b32 s17,16
s_lshr_b32 s32,s20,1
s_and_b32 s33,s20,1
s_lshl_b32 s56,s35,20
s_lshl_b32 s30,s34,17
s_add_u32 s56,s56,s30
s_lshl_b32 s30,s32,16
s_add_u32 s56,s56,s30
s_mov_b32 s53,s61
s_add_u32 s30,s53,12
s_lshl_b32 s30,s33,s30
s_add_u32 s56,s56,s30
s_lshl_b32 s30,s53,24
s_add_u32 s30,s30,16777216
s_add_u32 s56,s56,s30
s_lshl_b32 s57,s53,12
s_add_u32 s57,s57,8192
s_lshl_b32 s30,s53,3
s_add_u32 s30,s30,s34
s_lshl_b32 s30,s30,2
s_lshl_b32 s79,s35,7
s_add_u32 s79,s79,s30
s_add_u32 s79,s79,136314880
s_mov_b32 s18,1
s_cmp_ge_u32 s27,13
s_cbranch_scc1 K1_P_A
s_lshl_b32 s54,s35,20
s_lshl_b32 s30,s28,17
s_add_u32 s54,s54,s30
s_lshl_b32 s30,s32,16
s_add_u32 s54,s54,s30
s_lshl_b32 s30,s33,12
s_add_u32 s54,s54,s30
s_mov_b32 s55,8192
s_mov_b32 s19,2
s_lshl_b32 s30,s28,2
s_lshl_b32 s77,s35,7
s_add_u32 s77,s77,s30
s_add_u32 s77,s77,136314944
s_branch K1_P_DONE
K1_P_A:
s_sub_u32 s31,s59,26
s_mul_i32 s77,s58,6
s_add_u32 s77,s77,s31
s_lshl_b32 s77,s77,2
s_add_u32 s77,s77,136318976
s_lshl_b32 s54,s58,18
s_lshl_b32 s30,s32,17
s_add_u32 s54,s54,s30
s_lshr_b32 s30,s31,1
s_lshl_b32 s30,s30,21
s_add_u32 s54,s54,s30
s_add_u32 s54,s54,67108864
s_and_b32 s30,s31,1
s_lshl_b32 s30,s30,1
s_add_u32 s30,s30,s33
s_cmp_ge_u32 s31,4
s_cselect_b32 s19,1,0
s_cselect_b32 s55,28672,s30
s_cselect_b32 s31,13,12
s_cbranch_scc1 K1_P_A2
s_mov_b32 s55,16384
K1_P_A2:
s_lshl_b32 s30,s30,s31
s_add_u32 s54,s54,s30
K1_P_DONE:
s_lshl_b32 s30,s2,2
s_add_u32 s30,s30,s20
s_cmp_eq_u32 s30,192
s_cbranch_scc0 K1_NOZ
v_mov_b32 v80,0
v_mov_b32 v81,0
v_mov_b32 v82,0
v_mov_b32_e64 v83,0
s_mov_b32 s30,136314880
s_mov_b32 s31,136318976
buffer_store_dwordx4 v[80:83],v36,s[12:15],s30 offen sc1
buffer_store_dwordx4 v[80:83],v36,s[12:15],s30 offen offset:1024 sc1
buffer_store_dwordx4 v[80:83],v36,s[12:15],s30 offen offset:2048 sc1
buffer_store_dwordx4 v[80:83],v36,s[12:15],s30 offen offset:3072 sc1
buffer_store_dwordx4 v[80:83],v36,s[12:15],s31 offen sc1
s_mov_b32 s30,136323072
buffer_store_dwordx4 v[80:83],v36,s[12:15],s30 offen sc1
buffer_store_dwordx4 v[80:83],v36,s[12:15],s30 offen offset:1024 sc1
buffer_store_dwordx4 v[80:83],v36,s[12:15],s30 offen offset:2048 sc1
buffer_store_dwordx4 v[80:83],v36,s[12:15],s30 offen offset:3072 sc1
s_mov_b32 s30,136327168
buffer_store_dwordx4 v[80:83],v36,s[12:15],s30 offen sc1
buffer_store_dwordx4 v[80:83],v36,s[12:15],s30 offen offset:1024 sc1
buffer_store_dwordx4 v[80:83],v36,s[12:15],s30 offen offset:2048 sc1
buffer_store_dwordx4 v[80:83],v36,s[12:15],s30 offen offset:3072 sc1
s_mov_b32 s30,136331264
buffer_store_dwordx4 v[80:83],v36,s[12:15],s30 offen sc1
buffer_store_dwordx4 v[80:83],v36,s[12:15],s30 offen offset:1024 sc1
buffer_store_dwordx4 v[80:83],v36,s[12:15],s30 offen offset:2048 sc1
buffer_store_dwordx4 v[80:83],v36,s[12:15],s30 offen offset:3072 sc1
s_mov_b32 s30,136335360
buffer_store_dwordx4 v[80:83],v36,s[12:15],s30 offen sc1
buffer_store_dwordx4 v[80:83],v36,s[12:15],s30 offen offset:1024 sc1
buffer_store_dwordx4 v[80:83],v36,s[12:15],s30 offen offset:2048 sc1
buffer_store_dwordx4 v[80:83],v36,s[12:15],s30 offen offset:3072 sc1
s_mov_b32 s30,136339456
buffer_store_dwordx4 v[80:83],v36,s[12:15],s30 offen sc1
buffer_store_dwordx4 v[80:83],v36,s[12:15],s30 offen offset:1024 sc1
buffer_store_dwordx4 v[80:83],v36,s[12:15],s30 offen offset:2048 sc1
buffer_store_dwordx4 v[80:83],v36,s[12:15],s30 offen offset:3072 sc1
s_mov_b32 s30,136343552
buffer_store_dwordx4 v[80:83],v36,s[12:15],s30 offen sc1
buffer_store_dwordx4 v[80:83],v36,s[12:15],s30 offen offset:1024 sc1
buffer_store_dwordx4 v[80:83],v36,s[12:15],s30 offen offset:2048 sc1
buffer_store_dwordx4 v[80:83],v36,s[12:15],s30 offen offset:3072 sc1
s_mov_b32 s30,136347648
buffer_store_dwordx4 v[80:83],v36,s[12:15],s30 offen sc1
buffer_store_dwordx4 v[80:83],v36,s[12:15],s30 offen offset:1024 sc1
buffer_store_dwordx4 v[80:83],v36,s[12:15],s30 offen offset:2048 sc1
buffer_store_dwordx4 v[80:83],v36,s[12:15],s30 offen offset:3072 sc1
s_mov_b32 s30,136351744
buffer_store_dwordx4 v[80:83],v36,s[12:15],s30 offen sc1
buffer_store_dwordx4 v[80:83],v36,s[12:15],s30 offen offset:1024 sc1
buffer_store_dwordx4 v[80:83],v36,s[12:15],s30 offen offset:2048 sc1
buffer_store_dwordx4 v[80:83],v36,s[12:15],s30 offen offset:3072 sc1
s_mov_b32 s30,136355840
buffer_store_dwordx4 v[80:83],v36,s[12:15],s30 offen sc1
buffer_store_dwordx4 v[80:83],v36,s[12:15],s30 offen offset:1024 sc1
buffer_store_dwordx4 v[80:83],v36,s[12:15],s30 offen offset:2048 sc1
buffer_store_dwordx4 v[80:83],v36,s[12:15],s30 offen offset:3072 sc1
s_mov_b32 s30,136359936
buffer_store_dwordx4 v[80:83],v36,s[12:15],s30 offen sc1
buffer_store_dwordx4 v[80:83],v36,s[12:15],s30 offen offset:1024 sc1
buffer_store_dwordx4 v[80:83],v36,s[12:15],s30 offen offset:2048 sc1
buffer_store_dwordx4 v[80:83],v36,s[12:15],s30 offen offset:3072 sc1
s_waitcnt vmcnt(0)
v_mov_b32 v30,1
buffer_store_dword v30,v40,s[68:71],0 offen sc1
K1_NOZ:
AW a192,v96
AW a193,v97
AW a194,v98
AW a195,v99
AW a196,v100
AW a197,v101
AW a198,v102
AW a199,v103
s_add_u32 m0,s21,16384
s_nop 0
s_nop 0
buffer_load_dwordx4 v26,s[8:11],s24 offen sc1 lds
buffer_load_dwordx4 v27,s[8:11],s24 offen offset:1024 sc1 lds
buffer_load_dwordx4 v28,s[8:11],s24 offen offset:2048 sc1 lds
buffer_load_dwordx4 v29,s[8:11],s24 offen offset:3072 sc1 lds
s_add_u32 s24,s24,s25
s_add_u32 m0,s21,32768
s_nop 0
buffer_load_dwordx4 v22,s[4:7],s23 offen sc1 lds
buffer_load_dwordx4 v23,s[4:7],s23 offen offset:1024 sc1 lds
buffer_load_dwordx4 v24,s[4:7],s23 offen offset:2048 sc1 lds
buffer_load_dwordx4 v25,s[4:7],s23 offen offset:3072 sc1 lds
s_add_u32 s23,s23,128
s_mov_b32 s29,0
s_lshl_b32 s30,s2,2
s_add_u32 s30,s30,s20
s_mov_b32 exec_lo,0xf
s_mov_b32 exec_hi,0x0
v_mov_b32 v42,s92
v_mov_b32 v43,s93
v_subrev_u32 v30,0,v35
s_mul_i32 s31,s30,512
s_add_u32 s31,s31,2359296
v_lshlrev_b32 v30,7,v30
v_add_u32 v44,s31,v30
v_mov_b32 v45,524288
v_mov_b32 v46,4194176
s_mov_b32 exec_lo,0xf0
s_mov_b32 exec_hi,0x0
v_mov_b32 v42,s94
v_mov_b32 v43,s95
v_subrev_u32 v30,4,v35
s_mul_i32 s31,s30,512
s_add_u32 s31,s31,2359296
v_lshlrev_b32 v30,7,v30
v_add_u32 v44,s31,v30
v_mov_b32 v45,524288
v_mov_b32 v46,4194176
s_mov_b32 exec_lo,0x700
s_mov_b32 exec_hi,0x0
v_mov_b32 v42,s90
v_mov_b32 v43,s91
v_subrev_u32 v30,8,v35
s_mul_i32 s31,s30,384
s_add_u32 s31,s31,2359296
v_lshlrev_b32 v30,7,v30
v_add_u32 v44,s31,v30
v_mov_b32 v45,393216
v_mov_b32 v46,3669888
s_mov_b32 exec_lo,0x1800
s_mov_b32 exec_hi,0x0
v_mov_b32 v42,s88
v_mov_b32 v43,s89
v_subrev_u32 v30,11,v35
s_mul_i32 s31,s30,1
s_add_u32 s31,s31,0
v_lshrrev_b32 v31,1,v30
v_add_u32 v31,s31,v31
v_min_u32 v31,1023,v31
v_mul_u32_u24 v31,2048,v31
v_add_u32 v46,1920,v31
v_and_b32_e64 v30,1,v30
v_lshl_add_u32 v31,v30,7,v31
v_add_u32 v44,384,v31
v_mov_b32 v45,256
s_mov_b32 exec_lo,0x6000
s_mov_b32 exec_hi,0x0
v_mov_b32 v42,s80
v_mov_b32 v43,s81
v_subrev_u32 v30,13,v35
s_mul_i32 s31,s30,2
s_add_u32 s31,s31,0
v_lshrrev_b32 v31,0,v30
v_add_u32 v31,s31,v31
v_min_u32 v31,2047,v31
v_mul_u32_u24 v31,896,v31
v_add_u32 v46,768,v31
v_and_b32_e64 v30,0,v30
v_lshl_add_u32 v31,v30,7,v31
v_add_u32 v44,384,v31
v_mov_b32 v45,128
s_mov_b32 exec_lo,0x18000
s_mov_b32 exec_hi,0x0
v_mov_b32 v42,s82
v_mov_b32 v43,s83
v_subrev_u32 v30,15,v35
s_mul_i32 s31,s30,256
s_add_u32 s31,s31,774144
v_lshlrev_b32 v30,7,v30
v_add_u32 v44,s31,v30
v_mov_b32 v45,262144
v_mov_b32 v46,1204096
s_mov_b32 exec_lo,0x60000
s_mov_b32 exec_hi,0x0
v_mov_b32 v42,s86
v_mov_b32_e64 v43,s87
v_subrev_u32 v30,17,v35
s_mul_i32 s31,s30,2
s_add_u32 s31,s31,768
v_lshrrev_b32 v31,0,v30
v_add_u32 v31,s31,v31
v_min_u32 v31,2047,v31
v_mul_u32_u24 v31,896,v31
v_add_u32 v46,768,v31
v_and_b32_e64 v30,0,v30
v_lshl_add_u32 v31,v30,7,v31
v_add_u32 v44,384,v31
v_mov_b32 v45,128
s_mov_b32 exec_lo,0x3f80000
s_mov_b32 exec_hi,0x0
v_mov_b32 v42,s92
v_mov_b32 v43,s93
v_subrev_u32 v30,19,v35
s_mul_i32 s31,s30,896
s_add_u32 s31,s31,4194304
v_lshlrev_b32 v30,7,v30
v_add_u32 v44,s31,v30
v_mov_b32 v45,917504
v_mov_b32 v46,8388480
s_mov_b32 exec_lo,0xfc000000
s_mov_b32 exec_hi,0x1
v_mov_b32 v42,s94
v_mov_b32 v43,s95
v_subrev_u32 v30,26,v35
s_mul_i32 s31,s30,896
s_add_u32 s31,s31,4194304
v_lshlrev_b32 v30,7,v30
v_add_u32 v44,s31,v30
v_mov_b32 v45,917504
v_mov_b32 v46,8388480
s_mov_b32 exec_lo,0x0
s_mov_b32 exec_hi,0x1e
v_mov_b32 v42,s88
v_mov_b32 v43,s89
v_subrev_u32_e64 v30,33,v35
s_mul_i32 s31,s30,512
s_add_u32 s31,s31,2097152
v_lshlrev_b32 v30,7,v30
v_add_u32 v44,s31,v30
v_mov_b32 v45,524288
v_mov_b32 v46,4194176
s_mov_b32 exec_lo,0x0
s_mov_b32 exec_hi,0x60
v_mov_b32 v42,s86
v_mov_b32 v43,s87
v_subrev_u32 v30,37,v35
s_mul_i32 s31,s30,256
s_add_u32 s31,s31,0
v_lshlrev_b32 v30,7,v30
v_add_u32_e64 v44,s31,v30
v_mov_b32 v45,262144
v_mov_b32 v46,688000
s_mov_b32 exec_lo,0x0
s_mov_b32 exec_hi,0x80
v_mov_b32 v42,s84
v_mov_b32 v43,s85
v_subrev_u32 v30,39,v35
s_mul_i32 s31,s30,128
s_add_u32 s31,s31,0
v_lshlrev_b32 v30,7,v30
v_add_u32_e64 v44,s31,v30
v_mov_b32 v45,131072
v_mov_b32 v46,401280
s_mov_b32 s88,0x7ffff
s_mov_b32 s89,0x0
s_mov_b64 exec,-1
s_mov_b32 s29,7
PF_SKIP:
s_mov_b32 s93,0x3db8aa3b
s_add_u32 m0,s21,49152
s_nop 0
buffer_load_dwordx4 v26,s[8:11],s24 offen sc1 lds
buffer_load_dwordx4 v27,s[8:11],s24 offen offset:1024 sc1 lds
buffer_load_dwordx4 v28,s[8:11],s24 offen offset:2048 sc1 lds
buffer_load_dwordx4 v29,s[8:11],s24 offen offset:3072 sc1 lds
s_add_u32 s24,s24,s25
s_waitcnt vmcnt(16)
s_barrier
s_nop 0
ds_read_b64_tr_b16 a[64:65],v64 offset:0
ds_read_b64_tr_b16 a[66:67],v64 offset:2048
ds_read_b64_tr_b16 a[72:73],v65 offset:0
ds_read_b64_tr_b16 a[74:75],v65 offset:2048
ds_read_b64_tr_b16 a[80:81],v66 offset:0
ds_read_b64_tr_b16 a[82:83],v66 offset:2048
ds_read_b64_tr_b16 a[88:89],v67 offset:0
ds_read_b64_tr_b16 a[90:91],v67 offset:2048
ds_read_b64_tr_b16 a[96:97],v68 offset:0
ds_read_b64_tr_b16 a[98:99],v68 offset:2048
ds_read_b64_tr_b16 a[104:105],v69 offset:0
ds_read_b64_tr_b16 a[106:107],v69 offset:2048
ds_read_b64_tr_b16 a[112:113],v70 offset:0
ds_read_b64_tr_b16 a[114:115],v70 offset:2048
ds_read_b64_tr_b16 a[120:121],v71 offset:0
ds_read_b64_tr_b16 a[122:123],v71 offset:2048
ds_read_b64_tr_b16 a[68:69],v64 offset:16384
ds_read_b64_tr_b16 a[70:71],v64 offset:18432
ds_read_b64_tr_b16 a[76:77],v65 offset:16384
ds_read_b64_tr_b16 a[78:79],v65 offset:18432
ds_read_b64_tr_b16 a[84:85],v66 offset:16384
ds_read_b64_tr_b16 a[86:87],v66 offset:18432
ds_read_b64_tr_b16 a[92:93],v67 offset:16384
ds_read_b64_tr_b16 a[94:95],v67 offset:18432
ds_read_b64_tr_b16 a[100:101],v68 offset:16384
ds_read_b64_tr_b16 a[102:103],v68 offset:18432
ds_read_b64_tr_b16 a[108:109],v69 offset:16384
ds_read_b64_tr_b16 a[110:111],v69 offset:18432
ds_read_b64_tr_b16 a[116:117],v70 offset:16384
ds_read_b64_tr_b16 a[118:119],v70 offset:18432
ds_read_b64_tr_b16 a[124:125],v71 offset:16384
ds_read_b64_tr_b16 a[126:127],v71 offset:18432
s_add_u32 m0,s21,65536
s_nop 0
buffer_load_dwordx4 v22,s[4:7],s22 offen sc1 lds
buffer_load_dwordx4 v23,s[4:7],s22 offen offset:1024 sc1 lds
buffer_load_dwordx4 v24,s[4:7],s22 offen offset:2048 sc1 lds
buffer_load_dwordx4 v25,s[4:7],s22 offen offset:3072 sc1 lds
s_add_u32 s22,s22,128
s_add_u32 m0,s21,81920
s_nop 0
buffer_load_dwordx4 v26,s[8:11],s24 offen sc1 lds
buffer_load_dwordx4 v27,s[8:11],s24 offen offset:1024 sc1 lds
buffer_load_dwordx4 v28,s[8:11],s24 offen offset:2048 sc1 lds
buffer_load_dwordx4 v29,s[8:11],s24 offen offset:3072 sc1 lds
s_add_u32 s24,s24,s25
buffer_load_dword v1,v37,s[64:67],0 offen
s_add_u32 m0,s21,98304
s_nop 0
buffer_load_dwordx4 v22,s[4:7],s23 offen sc1 lds
buffer_load_dwordx4 v23,s[4:7],s23 offen offset:1024 sc1 lds
s_waitcnt vmcnt(19)
s_barrier
ds_read_b128 a[48:51],v2 offset:0
ds_read_b128 a[52:55],v3 offset:0
s_cmp_eq_u32 s19,1
s_cbranch_scc1 K1_FS0V
s_waitcnt lgkmcnt(0)
M v[48:51],a[64:67],a[48:51],0
ds_read_b128 a[56:59],v2 offset:2048
M v[48:51],a[68:71],a[52:55],v[48:51]
ds_read_b128 a[60:63],v3 offset:2048
M v[52:55],a[76:79],a[52:55],0
ds_read_b64_tr_b16 a[128:129],v6 offset:0
M v[52:55],a[72:75],a[48:51],v[52:55]
buffer_load_dwordx4 v24,s[4:7],s23 offen offset:2048 sc1 lds
M v[56:59],a[80:83],a[48:51],0
ds_read_b64_tr_b16 a[130:131],v6 offset:2048
M v[56:59],a[84:87],a[52:55],v[56:59]
M v[60:63],a[92:95],a[52:55],0
ds_read_b64_tr_b16 a[136:137],v7 offset:0
M v[60:63],a[88:91],a[48:51],v[60:63]
M v[64:67],a[96:99],a[48:51],0
ds_read_b64_tr_b16 a[138:139],v7 offset:2048
M v[64:67],a[100:103],a[52:55],v[64:67]
M v[68:71],a[108:111],a[52:55],0
ds_read_b64_tr_b16 a[144:145],v8 offset:0
M v[68:71],a[104:107],a[48:51],v[68:71]
buffer_load_dwordx4 v25,s[4:7],s23 offen offset:3072 sc1 lds
M v[72:75],a[112:115],a[48:51],0
ds_read_b64_tr_b16 a[146:147],v8 offset:2048
M v[72:75],a[116:119],a[52:55],v[72:75]
s_add_u32 s23,s23,128
M v[76:79],a[124:127],a[52:55],0
M v[76:79],a[120:123],a[48:51],v[76:79]
s_waitcnt lgkmcnt(6)
M v[80:83],a[64:67],a[56:59],0
ds_read_b128 a[48:51],v2 offset:4096
M v[80:83],a[68:71],a[60:63],v[80:83]
ds_read_b128 a[52:55],v3 offset:4096
s_add_u32 m0,s21,114688
M v[84:87],a[76:79],a[60:63],0
ds_read_b64_tr_b16 a[152:153],v9 offset:0
M v[84:87],a[72:75],a[56:59],v[84:87]
buffer_load_dwordx4 v26,s[8:11],s24 offen sc1 lds
M v[88:91],a[80:83],a[56:59],0
ds_read_b64_tr_b16 a[154:155],v9 offset:2048
M v[88:91],a[84:87],a[60:63],v[88:91]
M v[92:95],a[92:95],a[60:63],0
ds_read_b64_tr_b16 a[160:161],v10 offset:0
M v[92:95],a[88:91],a[56:59],v[92:95]
M v[96:99],a[96:99],a[56:59],0
ds_read_b64_tr_b16 a[162:163],v10 offset:2048
M v[96:99],a[100:103],a[60:63],v[96:99]
M v[100:103],a[108:111],a[60:63],0
ds_read_b64_tr_b16 a[168:169],v11 offset:0
M v[100:103],a[104:107],a[56:59],v[100:103]
buffer_load_dwordx4 v27,s[8:11],s24 offen offset:1024 sc1 lds
M v[104:107],a[112:115],a[56:59],0
ds_read_b64_tr_b16 a[170:171],v11 offset:2048
M v[104:107],a[116:119],a[60:63],v[104:107]
M v[108:111],a[124:127],a[60:63],0
M v[108:111],a[120:123],a[56:59],v[108:111]
s_waitcnt lgkmcnt(6)
M v[112:115],a[64:67],a[48:51],0
ds_read_b128 a[56:59],v2 offset:6144
M v[112:115],a[68:71],a[52:55],v[112:115]
ds_read_b128 a[60:63],v3 offset:6144
M v[116:119],a[76:79],a[52:55],0
ds_read_b64_tr_b16 a[176:177],v12 offset:0
M v[116:119],a[72:75],a[48:51],v[116:119]
buffer_load_dwordx4 v28,s[8:11],s24 offen offset:2048 sc1 lds
M v[120:123],a[80:83],a[48:51],0
ds_read_b64_tr_b16 a[178:179],v12 offset:2048
M v[120:123],a[84:87],a[52:55],v[120:123]
M v[124:127],a[92:95],a[52:55],0
ds_read_b64_tr_b16 a[184:185],v13 offset:0
M v[124:127],a[88:91],a[48:51],v[124:127]
M v[128:131],a[96:99],a[48:51],0
ds_read_b64_tr_b16 a[186:187],v13 offset:2048
M v[128:131],a[100:103],a[52:55],v[128:131]
M v[132:135],a[108:111],a[52:55],0
M v[132:135],a[104:107],a[48:51],v[132:135]
buffer_load_dwordx4 v29,s[8:11],s24 offen offset:3072 sc1 lds
M v[136:139],a[112:115],a[48:51],0
s_add_u32 s24,s24,s25
M v[136:139],a[116:119],a[52:55],v[136:139]
M v[140:143],a[124:127],a[52:55],0
M v[140:143],a[120:123],a[48:51],v[140:143]
s_waitcnt vmcnt(17) lgkmcnt(0)
s_barrier
M v[144:147],a[64:67],a[56:59],0
ds_read_b128 a[48:51],v2 offset:32768
M v[144:147],a[68:71],a[60:63],v[144:147]
ds_read_b128 a[52:55],v3 offset:32768
s_add_u32 m0,s21,0
M v[148:151],a[76:79],a[60:63],0
ds_read_b64_tr_b16 a[132:133],v6 offset:32768
M v[148:151],a[72:75],a[56:59],v[148:151]
buffer_load_dwordx4 v22,s[4:7],s22 offen sc1 lds
M v[152:155],a[80:83],a[56:59],0
ds_read_b64_tr_b16 a[134:135],v6 offset:34816
M v[152:155],a[84:87],a[60:63],v[152:155]
M v[156:159],a[92:95],a[60:63],0
ds_read_b64_tr_b16 a[140:141],v7 offset:32768
M v[156:159],a[88:91],a[56:59],v[156:159]
M v[160:163],a[96:99],a[56:59],0
ds_read_b64_tr_b16 a[142:143],v7 offset:34816
M v[160:163],a[100:103],a[60:63],v[160:163]
M v[164:167],a[108:111],a[60:63],0
ds_read_b64_tr_b16 a[148:149],v8 offset:32768
M v[164:167],a[104:107],a[56:59],v[164:167]
buffer_load_dwordx4 v23,s[4:7],s22 offen offset:1024 sc1 lds
M v[168:171],a[112:115],a[56:59],0
M v[168:171],a[116:119],a[60:63],v[168:171]
M v[172:175],a[124:127],a[60:63],0
M v[172:175],a[120:123],a[56:59],v[172:175]
s_waitcnt lgkmcnt(5)
M v[176:179],a[64:67],a[48:51],0
ds_read_b128 a[56:59],v2 offset:34816
M v[176:179],a[68:71],a[52:55],v[176:179]
ds_read_b128 a[60:63],v3 offset:34816
M v[180:183],a[76:79],a[52:55],0
ds_read_b64_tr_b16 a[150:151],v8 offset:34816
M v[180:183],a[72:75],a[48:51],v[180:183]
buffer_load_dwordx4 v24,s[4:7],s22 offen offset:2048 sc1 lds
M v[184:187],a[80:83],a[48:51],0
ds_read_b64_tr_b16 a[156:157],v9 offset:32768
M v[184:187],a[84:87],a[52:55],v[184:187]
M v[188:191],a[92:95],a[52:55],0
ds_read_b64_tr_b16 a[158:159],v9 offset:34816
M v[188:191],a[88:91],a[48:51],v[188:191]
M v[192:195],a[96:99],a[48:51],0
ds_read_b64_tr_b16 a[164:165],v10 offset:32768
M v[192:195],a[100:103],a[52:55],v[192:195]
M v[196:199],a[108:111],a[52:55],0
ds_read_b64_tr_b16 a[166:167],v10 offset:34816
M v[196:199],a[104:107],a[48:51],v[196:199]
buffer_load_dwordx4 v25,s[4:7],s22 offen offset:3072 sc1 lds
M v[200:203],a[112:115],a[48:51],0
s_add_u32 s22,s22,128
M v[200:203],a[116:119],a[52:55],v[200:203]
M v[204:207],a[124:127],a[52:55],0
M v[204:207],a[120:123],a[48:51],v[204:207]
s_waitcnt lgkmcnt(5)
M v[208:211],a[64:67],a[56:59],0
ds_read_b128 a[48:51],v2 offset:36864
M v[208:211],a[68:71],a[60:63],v[208:211]
ds_read_b128 a[52:55],v3 offset:36864
s_add_u32 m0,s21,16384
M v[212:215],a[76:79],a[60:63],0
ds_read_b64_tr_b16 a[172:173],v11 offset:32768
M v[212:215],a[72:75],a[56:59],v[212:215]
buffer_load_dwordx4 v26,s[8:11],s24 offen sc1 lds
M v[216:219],a[80:83],a[56:59],0
ds_read_b64_tr_b16 a[174:175],v11 offset:34816
M v[216:219],a[84:87],a[60:63],v[216:219]
M v[220:223],a[92:95],a[60:63],0
ds_read_b64_tr_b16 a[180:181],v12 offset:32768
M v[220:223],a[88:91],a[56:59],v[220:223]
M v[224:227],a[96:99],a[56:59],0
ds_read_b64_tr_b16 a[182:183],v12 offset:34816
M v[224:227],a[100:103],a[60:63],v[224:227]
M v[228:231],a[108:111],a[60:63],0
M v[228:231],a[104:107],a[56:59],v[228:231]
buffer_load_dwordx4 v27,s[8:11],s24 offen offset:1024 sc1 lds
M v[232:235],a[112:115],a[56:59],0
M v[232:235],a[116:119],a[60:63],v[232:235]
s_cmp_lg_u32 s29,0
M v[236:239],a[124:127],a[60:63],0
buffer_load_dword v1,v37,s[64:67],0 offen
s_cbranch_scc1 HSUB_PF_F0K0
HSUB_PF_F0K0_R:
M v[236:239],a[120:123],a[56:59],v[236:239]
s_waitcnt lgkmcnt(4)
M v[240:243],a[64:67],a[48:51],0
ds_read_b128 a[56:59],v2 offset:38912
M v[240:243],a[68:71],a[52:55],v[240:243]
ds_read_b128 a[60:63],v3 offset:38912
M v[244:247],a[76:79],a[52:55],0
ds_read_b64_tr_b16 a[188:189],v13 offset:32768
M v[244:247],a[72:75],a[48:51],v[244:247]
buffer_load_dwordx4 v28,s[8:11],s24 offen offset:2048 sc1 lds
M v[248:251],a[80:83],a[48:51],0
ds_read_b64_tr_b16 a[190:191],v13 offset:34816
M v[248:251],a[84:87],a[52:55],v[248:251]
M v[252:255],a[92:95],a[52:55],0
M v[252:255],a[88:91],a[48:51],v[252:255]
M a[0:3],a[96:99],a[48:51],0
M a[0:3],a[100:103],a[52:55],a[0:3]
M a[4:7],a[108:111],a[52:55],0
M a[4:7],a[104:107],a[48:51],a[4:7]
buffer_load_dwordx4 v29,s[8:11],s24 offen offset:3072 sc1 lds
M a[8:11],a[112:115],a[48:51],0
s_add_u32 s24,s24,s25
M a[8:11],a[116:119],a[52:55],a[8:11]
M a[12:15],a[124:127],a[52:55],0
M a[12:15],a[120:123],a[48:51],a[12:15]
s_waitcnt vmcnt(17) lgkmcnt(0)
s_barrier
M a[16:19],a[64:67],a[56:59],0
ds_read_b128 a[48:51],v4 offset:0
M a[16:19],a[68:71],a[60:63],a[16:19]
ds_read_b128 a[52:55],v5 offset:0
M a[20:23],a[76:79],a[60:63],0
s_add_u32 m0,s21,32768
M a[20:23],a[72:75],a[56:59],a[20:23]
buffer_load_dwordx4 v22,s[4:7],s23 offen sc1 lds
M a[24:27],a[80:83],a[56:59],0
M a[24:27],a[84:87],a[60:63],a[24:27]
M a[28:31],a[92:95],a[60:63],0
M a[28:31],a[88:91],a[56:59],a[28:31]
M a[32:35],a[96:99],a[56:59],0
M a[32:35],a[100:103],a[60:63],a[32:35]
M a[36:39],a[108:111],a[60:63],0
M a[36:39],a[104:107],a[56:59],a[36:39]
buffer_load_dwordx4 v23,s[4:7],s23 offen offset:1024 sc1 lds
M a[40:43],a[112:115],a[56:59],0
M a[40:43],a[116:119],a[60:63],a[40:43]
s_sub_u32 s26,s26,1
M a[44:47],a[124:127],a[60:63],0
s_cmp_eq_u32 s26,s43
M a[44:47],a[120:123],a[56:59],a[44:47]
s_branch K1_LOOP1_KQ
K1_XK0:
s_cmp_ge_u32 s27,13
s_cbranch_scc1 K1_FS_AV
s_cmp_eq_u32 s27,12
s_cbranch_scc1 K1_FS_QV
s_mov_b32 s94,s54
s_mov_b32 s95,s55
s_mov_b32 s92,s54
s_mov_b32 s19,s53
s_mov_b32 s53,4
s_mov_b32 s54,s56
s_mov_b32 s55,s57
s_mov_b32 s26,s17
s_mov_b32 s43,3
s_cmp_eq_u32 s20,0
s_cselect_b32 s78,12,99
v_mul_f32 v48,s93,v48
v_mul_f32 v49,s93,v49
v_mul_f32 v50,s93,v50
v_mul_f32 v51,s93,v51
CV v48,v48,v49
CV v49,v50,v51
v_mul_f32 v52,s93,v52
v_mul_f32 v53,s93,v53
v_mul_f32 v54,s93,v54
v_mul_f32 v55,s93,v55
CV v50,v52,v53
CV v51,v54,v55
buffer_store_dwordx4 v[48:51],v36,s[12:15],s94 offen sc1
s_nop 0
s_waitcnt lgkmcnt(0)
M v[48:51],a[128:131],a[48:51],0
ds_read_b128 a[56:59],v4 offset:2048
v_mul_f32 v56,s93,v56
v_mul_f32 v57,s93,v57
v_mul_f32 v58,s93,v58
v_mul_f32 v59,s93,v59
CV v56,v56,v57
M v[48:51],a[132:135],a[52:55],v[48:51]
ds_read_b128 a[60:63],v5 offset:2048
CV v57,v58,v59
v_mul_f32 v60,s93,v60
v_mul_f32 v61,s93,v61
v_mul_f32 v62,s93,v62
M v[52:55],a[140:143],a[52:55],0
ds_read_b64_tr_b16 a[64:65],v14 offset:0
v_mul_f32 v63,s93,v63
CV v58,v60,v61
CV v59,v62,v63
AW a192,v56
AW a193,v57
M v[52:55],a[136:139],a[48:51],v[52:55]
buffer_load_dwordx4 v24,s[4:7],s23 offen offset:2048 sc1 lds
AW a194,v58
AW a195,v59
M v[56:59],a[144:147],a[48:51],0
ds_read_b64_tr_b16 a[66:67],v14 offset:2048
v_mul_f32 v64,s93,v64
v_mul_f32 v65,s93,v65
v_mul_f32 v66,s93,v66
v_mul_f32 v67,s93,v67
M v[56:59],a[148:151],a[52:55],v[56:59]
CV v64,v64,v65
CV v65,v66,v67
v_mul_f32 v68,s93,v68
v_mul_f32 v69,s93,v69
M v[60:63],a[156:159],a[52:55],0
ds_read_b64_tr_b16 a[72:73],v15 offset:0
v_mul_f32 v70,s93,v70
v_mul_f32 v71,s93,v71
CV v66,v68,v69
CV v67,v70,v71
M v[60:63],a[152:155],a[48:51],v[60:63]
buffer_store_dwordx4 v[64:67],v36,s[12:15],s94 offen offset:2048 sc1
s_nop 0
M v[64:67],a[160:163],a[48:51],0
ds_read_b64_tr_b16 a[74:75],v15 offset:2048
v_mul_f32 v72,s93,v72
v_mul_f32 v73,s93,v73
v_mul_f32 v74,s93,v74
v_mul_f32 v75,s93,v75
CV v72,v72,v73
M v[64:67],a[164:167],a[52:55],v[64:67]
CV v73,v74,v75
v_mul_f32 v76,s93,v76
v_mul_f32 v77,s93,v77
v_mul_f32 v78,s93,v78
v_mul_f32 v79,s93,v79
M v[68:71],a[172:175],a[52:55],0
ds_read_b64_tr_b16 a[80:81],v16 offset:0
CV v74,v76,v77
CV v75,v78,v79
AW a196,v72
AW a197,v73
AW a198,v74
M v[68:71],a[168:171],a[48:51],v[68:71]
buffer_load_dwordx4 v25,s[4:7],s23 offen offset:3072 sc1 lds
AW a199,v75
s_add_u32 s94,s94,s95
M v[72:75],a[176:179],a[48:51],0
ds_read_b64_tr_b16 a[82:83],v16 offset:2048
v_mul_f32 v80,s93,v80
v_mul_f32 v81,s93,v81
v_mul_f32 v82,s93,v82
v_mul_f32 v83,s93,v83
M v[72:75],a[180:183],a[52:55],v[72:75]
s_add_u32 s23,s23,128
CV v80,v80,v81
CV v81,v82,v83
v_mul_f32 v84,s93,v84
v_mul_f32 v85,s93,v85
M v[76:79],a[188:191],a[52:55],0
v_mul_f32 v86,s93,v86
v_mul_f32 v87,s93,v87
CV v82,v84,v85
CV v83,v86,v87
M v[76:79],a[184:187],a[48:51],v[76:79]
buffer_store_dwordx4 v[80:83],v36,s[12:15],s94 offen sc1
s_nop 0
s_waitcnt lgkmcnt(6)
M v[80:83],a[128:131],a[56:59],0
ds_read_b128 a[48:51],v4 offset:4096
v_mul_f32 v88,s93,v88
v_mul_f32 v89,s93,v89
v_mul_f32 v90,s93,v90
v_mul_f32 v91,s93,v91
CV v88,v88,v89
M v[80:83],a[132:135],a[60:63],v[80:83]
ds_read_b128 a[52:55],v5 offset:4096
s_add_u32 m0,s21,49152
CV v89,v90,v91
v_mul_f32 v92,s93,v92
v_mul_f32 v93,s93,v93
v_mul_f32 v94,s93,v94
M v[84:87],a[140:143],a[60:63],0
ds_read_b64_tr_b16 a[88:89],v17 offset:0
v_mul_f32 v95,s93,v95
CV v90,v92,v93
CV v91,v94,v95
AW a200,v88
M v[84:87],a[136:139],a[56:59],v[84:87]
buffer_load_dwordx4 v26,s[8:11],s24 offen sc1 lds
AW a201,v89
AW a202,v90
AW a203,v91
M v[88:91],a[144:147],a[56:59],0
ds_read_b64_tr_b16 a[90:91],v17 offset:2048
v_mul_f32 v96,s93,v96
v_mul_f32 v97,s93,v97
v_mul_f32 v98,s93,v98
v_mul_f32 v99,s93,v99
M v[88:91],a[148:151],a[60:63],v[88:91]
CV v96,v96,v97
CV v97,v98,v99
v_mul_f32 v100,s93,v100
v_mul_f32 v101,s93,v101
M v[92:95],a[156:159],a[60:63],0
ds_read_b64_tr_b16 a[96:97],v18 offset:0
v_mul_f32 v102,s93,v102
v_mul_f32 v103,s93,v103
CV v98,v100,v101
CV v99,v102,v103
M v[92:95],a[152:155],a[56:59],v[92:95]
buffer_store_dwordx4 v[96:99],v36,s[12:15],s94 offen offset:2048 sc1
s_nop 0
M v[96:99],a[160:163],a[56:59],0
ds_read_b64_tr_b16 a[98:99],v18 offset:2048
v_mul_f32 v104,s93,v104
v_mul_f32 v105,s93,v105
v_mul_f32 v106,s93,v106
v_mul_f32 v107,s93,v107
CV v104,v104,v105
M v[96:99],a[164:167],a[60:63],v[96:99]
CV v105,v106,v107
v_mul_f32 v108,s93,v108
v_mul_f32 v109,s93,v109
v_mul_f32 v110,s93,v110
v_mul_f32 v111,s93,v111
M v[100:103],a[172:175],a[60:63],0
ds_read_b64_tr_b16 a[104:105],v19 offset:0
CV v106,v108,v109
CV v107,v110,v111
AW a204,v104
AW a205,v105
AW a206,v106
M v[100:103],a[168:171],a[56:59],v[100:103]
buffer_load_dwordx4 v27,s[8:11],s24 offen offset:1024 sc1 lds
AW a207,v107
s_add_u32 s94,s94,s95
M v[104:107],a[176:179],a[56:59],0
ds_read_b64_tr_b16 a[106:107],v19 offset:2048
v_mul_f32 v112,s93,v112
v_mul_f32 v113,s93,v113
v_mul_f32 v114,s93,v114
v_mul_f32 v115,s93,v115
M v[104:107],a[180:183],a[60:63],v[104:107]
CV v112,v112,v113
CV v113,v114,v115
v_mul_f32 v116,s93,v116
v_mul_f32 v117,s93,v117
M v[108:111],a[188:191],a[60:63],0
v_mul_f32 v118,s93,v118
v_mul_f32 v119,s93,v119
CV v114,v116,v117
CV v115,v118,v119
M v[108:111],a[184:187],a[56:59],v[108:111]
buffer_store_dwordx4 v[112:115],v36,s[12:15],s94 offen sc1
s_nop 0
s_waitcnt lgkmcnt(6)
M v[112:115],a[128:131],a[48:51],0
ds_read_b128 a[56:59],v4 offset:6144
v_mul_f32 v120,s93,v120
v_mul_f32 v121,s93,v121
v_mul_f32 v122,s93,v122
v_mul_f32 v123,s93,v123
CV v120,v120,v121
M v[112:115],a[132:135],a[52:55],v[112:115]
ds_read_b128 a[60:63],v5 offset:6144
CV v121,v122,v123
v_mul_f32 v124,s93,v124
v_mul_f32 v125,s93,v125
v_mul_f32 v126,s93,v126
M v[116:119],a[140:143],a[52:55],0
ds_read_b64_tr_b16 a[112:113],v20 offset:0
v_mul_f32 v127,s93,v127
CV v122,v124,v125
CV v123,v126,v127
AW a208,v120
AW a209,v121
M v[116:119],a[136:139],a[48:51],v[116:119]
buffer_load_dwordx4 v28,s[8:11],s24 offen offset:2048 sc1 lds
AW a210,v122
AW a211,v123
M v[120:123],a[144:147],a[48:51],0
ds_read_b64_tr_b16 a[114:115],v20 offset:2048
v_mul_f32 v128,s93,v128
v_mul_f32 v129,s93,v129
v_mul_f32 v130,s93,v130
v_mul_f32 v131,s93,v131
M v[120:123],a[148:151],a[52:55],v[120:123]
CV v128,v128,v129
CV v129,v130,v131
v_mul_f32 v132,s93,v132
v_mul_f32 v133,s93,v133
M v[124:127],a[156:159],a[52:55],0
ds_read_b64_tr_b16 a[120:121],v21 offset:0
v_mul_f32 v134,s93,v134
v_mul_f32 v135,s93,v135
CV v130,v132,v133
CV v131,v134,v135
M v[124:127],a[152:155],a[48:51],v[124:127]
buffer_store_dwordx4 v[128:131],v36,s[12:15],s94 offen offset:2048 sc1
s_nop 0
M v[128:131],a[160:163],a[48:51],0
ds_read_b64_tr_b16 a[122:123],v21 offset:2048
v_mul_f32 v136,s93,v136
v_mul_f32 v137,s93,v137
v_mul_f32 v138,s93,v138
v_mul_f32 v139,s93,v139
M v[128:131],a[164:167],a[52:55],v[128:131]
CV v136,v136,v137
CV v137,v138,v139
v_mul_f32 v140,s93,v140
v_mul_f32 v141,s93,v141
v_mul_f32 v142,s93,v142
v_mul_f32 v143,s93,v143
M v[132:135],a[172:175],a[52:55],0
CV v138,v140,v141
CV v139,v142,v143
AW a212,v136
AW a213,v137
AW a214,v138
M v[132:135],a[168:171],a[48:51],v[132:135]
buffer_load_dwordx4 v29,s[8:11],s24 offen offset:3072 sc1 lds
AW a215,v139
s_add_u32 s94,s94,s95
M v[136:139],a[176:179],a[48:51],0
s_add_u32 s24,s24,s25
v_mul_f32 v144,s93,v144
v_mul_f32 v145,s93,v145
v_mul_f32 v146,s93,v146
v_mul_f32 v147,s93,v147
M v[136:139],a[180:183],a[52:55],v[136:139]
CV v144,v144,v145
CV v145,v146,v147
v_mul_f32 v148,s93,v148
v_mul_f32 v149,s93,v149
M v[140:143],a[188:191],a[52:55],0
v_mul_f32 v150,s93,v150
v_mul_f32 v151,s93,v151
CV v146,v148,v149
CV v147,v150,v151
M v[140:143],a[184:187],a[48:51],v[140:143]
buffer_store_dwordx4 v[144:147],v36,s[12:15],s94 offen sc1
s_nop 0
s_waitcnt vmcnt(24) lgkmcnt(0)
s_barrier
M v[144:147],a[128:131],a[56:59],0
ds_read_b128 a[48:51],v4 offset:32768
v_mul_f32 v152,s93,v152
v_mul_f32 v153,s93,v153
v_mul_f32 v154,s93,v154
v_mul_f32 v155,s93,v155
CV v152,v152,v153
M v[144:147],a[132:135],a[60:63],v[144:147]
ds_read_b128 a[52:55],v5 offset:32768
s_add_u32 m0,s21,65536
CV v153,v154,v155
v_mul_f32 v156,s93,v156
v_mul_f32 v157,s93,v157
v_mul_f32 v158,s93,v158
M v[148:151],a[140:143],a[60:63],0
ds_read_b64_tr_b16 a[68:69],v14 offset:32768
v_mul_f32 v159,s93,v159
CV v154,v156,v157
CV v155,v158,v159
AW a216,v152
M v[148:151],a[136:139],a[56:59],v[148:151]
buffer_load_dwordx4 v22,s[4:7],s22 offen sc1 lds
AW a217,v153
AW a218,v154
AW a219,v155
M v[152:155],a[144:147],a[56:59],0
ds_read_b64_tr_b16 a[70:71],v14 offset:34816
v_mul_f32 v160,s93,v160
v_mul_f32 v161,s93,v161
v_mul_f32 v162,s93,v162
v_mul_f32 v163,s93,v163
M v[152:155],a[148:151],a[60:63],v[152:155]
CV v160,v160,v161
CV v161,v162,v163
v_mul_f32 v164,s93,v164
v_mul_f32 v165,s93,v165
M v[156:159],a[156:159],a[60:63],0
ds_read_b64_tr_b16 a[76:77],v15 offset:32768
v_mul_f32 v166,s93,v166
v_mul_f32 v167,s93,v167
CV v162,v164,v165
CV v163,v166,v167
M v[156:159],a[152:155],a[56:59],v[156:159]
buffer_store_dwordx4 v[160:163],v36,s[12:15],s94 offen offset:2048 sc1
s_nop 0
M v[160:163],a[160:163],a[56:59],0
ds_read_b64_tr_b16 a[78:79],v15 offset:34816
v_mul_f32 v168,s93,v168
v_mul_f32 v169,s93,v169
v_mul_f32 v170,s93,v170
v_mul_f32 v171,s93,v171
CV v168,v168,v169
M v[160:163],a[164:167],a[60:63],v[160:163]
CV v169,v170,v171
v_mul_f32 v172,s93,v172
v_mul_f32 v173,s93,v173
v_mul_f32 v174,s93,v174
v_mul_f32 v175,s93,v175
M v[164:167],a[172:175],a[60:63],0
ds_read_b64_tr_b16 a[84:85],v16 offset:32768
CV v170,v172,v173
CV v171,v174,v175
AW a220,v168
AW a221,v169
AW a222,v170
M v[164:167],a[168:171],a[56:59],v[164:167]
buffer_load_dwordx4 v23,s[4:7],s22 offen offset:1024 sc1 lds
AW a223,v171
s_add_u32 s94,s94,s95
M v[168:171],a[176:179],a[56:59],0
v_mul_f32 v176,s93,v176
v_mul_f32 v177,s93,v177
v_mul_f32 v178,s93,v178
v_mul_f32 v179,s93,v179
M v[168:171],a[180:183],a[60:63],v[168:171]
CV v176,v176,v177
CV v177,v178,v179
v_mul_f32 v180,s93,v180
v_mul_f32 v181,s93,v181
v_mul_f32 v182,s93,v182
M v[172:175],a[188:191],a[60:63],0
v_mul_f32 v183,s93,v183
CV v178,v180,v181
CV v179,v182,v183
M v[172:175],a[184:187],a[56:59],v[172:175]
buffer_store_dwordx4 v[176:179],v36,s[12:15],s94 offen sc1
s_nop 0
s_waitcnt lgkmcnt(5)
M v[176:179],a[128:131],a[48:51],0
ds_read_b128 a[56:59],v4 offset:34816
v_mul_f32 v184,s93,v184
v_mul_f32 v185,s93,v185
v_mul_f32 v186,s93,v186
v_mul_f32 v187,s93,v187
CV v184,v184,v185
M v[176:179],a[132:135],a[52:55],v[176:179]
ds_read_b128 a[60:63],v5 offset:34816
CV v185,v186,v187
v_mul_f32 v188,s93,v188
v_mul_f32 v189,s93,v189
v_mul_f32 v190,s93,v190
M v[180:183],a[140:143],a[52:55],0
ds_read_b64_tr_b16 a[86:87],v16 offset:34816
v_mul_f32 v191,s93,v191
CV v186,v188,v189
CV v187,v190,v191
AW a224,v184
AW a225,v185
M v[180:183],a[136:139],a[48:51],v[180:183]
buffer_load_dwordx4 v24,s[4:7],s22 offen offset:2048 sc1 lds
AW a226,v186
AW a227,v187
M v[184:187],a[144:147],a[48:51],0
ds_read_b64_tr_b16 a[92:93],v17 offset:32768
v_mul_f32 v192,s93,v192
v_mul_f32 v193,s93,v193
v_mul_f32 v194,s93,v194
v_mul_f32 v195,s93,v195
M v[184:187],a[148:151],a[52:55],v[184:187]
CV v192,v192,v193
CV v193,v194,v195
v_mul_f32 v196,s93,v196
v_mul_f32 v197,s93,v197
M v[188:191],a[156:159],a[52:55],0
ds_read_b64_tr_b16 a[94:95],v17 offset:34816
v_mul_f32 v198,s93,v198
v_mul_f32 v199,s93,v199
CV v194,v196,v197
CV v195,v198,v199
M v[188:191],a[152:155],a[48:51],v[188:191]
buffer_store_dwordx4 v[192:195],v36,s[12:15],s94 offen offset:2048 sc1
s_nop 0
M v[192:195],a[160:163],a[48:51],0
ds_read_b64_tr_b16 a[100:101],v18 offset:32768
v_mul_f32 v200,s93,v200
v_mul_f32 v201,s93,v201
v_mul_f32 v202,s93,v202
v_mul_f32 v203,s93,v203
CV v200,v200,v201
M v[192:195],a[164:167],a[52:55],v[192:195]
CV v201,v202,v203
v_mul_f32 v204,s93,v204
v_mul_f32 v205,s93,v205
v_mul_f32 v206,s93,v206
v_mul_f32 v207,s93,v207
M v[196:199],a[172:175],a[52:55],0
ds_read_b64_tr_b16 a[102:103],v18 offset:34816
CV v202,v204,v205
CV v203,v206,v207
AW a228,v200
AW a229,v201
AW a230,v202
M v[196:199],a[168:171],a[48:51],v[196:199]
buffer_load_dwordx4 v25,s[4:7],s22 offen offset:3072 sc1 lds
AW a231,v203
s_add_u32 s94,s94,s95
M v[200:203],a[176:179],a[48:51],0
s_add_u32 s22,s22,128
v_mul_f32 v208,s93,v208
v_mul_f32 v209,s93,v209
v_mul_f32 v210,s93,v210
v_mul_f32 v211,s93,v211
M v[200:203],a[180:183],a[52:55],v[200:203]
CV v208,v208,v209
CV v209,v210,v211
v_mul_f32 v212,s93,v212
v_mul_f32 v213,s93,v213
M v[204:207],a[188:191],a[52:55],0
v_mul_f32 v214,s93,v214
v_mul_f32 v215,s93,v215
CV v210,v212,v213
CV v211,v214,v215
M v[204:207],a[184:187],a[48:51],v[204:207]
buffer_store_dwordx4 v[208:211],v36,s[12:15],s94 offen sc1
s_nop 0
s_waitcnt lgkmcnt(5)
M v[208:211],a[128:131],a[56:59],0
ds_read_b128 a[48:51],v4 offset:36864
v_mul_f32 v216,s93,v216
v_mul_f32 v217,s93,v217
v_mul_f32 v218,s93,v218
v_mul_f32 v219,s93,v219
CV v216,v216,v217
M v[208:211],a[132:135],a[60:63],v[208:211]
ds_read_b128 a[52:55],v5 offset:36864
s_add_u32 m0,s21,81920
CV v217,v218,v219
v_mul_f32 v220,s93,v220
v_mul_f32 v221,s93,v221
v_mul_f32 v222,s93,v222
M v[212:215],a[140:143],a[60:63],0
ds_read_b64_tr_b16 a[108:109],v19 offset:32768
v_mul_f32 v223,s93,v223
CV v218,v220,v221
CV v219,v222,v223
AW a232,v216
M v[212:215],a[136:139],a[56:59],v[212:215]
buffer_load_dwordx4 v26,s[8:11],s24 offen sc1 lds
AW a233,v217
AW a234,v218
AW a235,v219
M v[216:219],a[144:147],a[56:59],0
ds_read_b64_tr_b16 a[110:111],v19 offset:34816
v_mul_f32 v224,s93,v224
v_mul_f32 v225,s93,v225
v_mul_f32 v226,s93,v226
v_mul_f32 v227,s93,v227
M v[216:219],a[148:151],a[60:63],v[216:219]
CV v224,v224,v225
CV v225,v226,v227
v_mul_f32 v228,s93,v228
v_mul_f32 v229,s93,v229
M v[220:223],a[156:159],a[60:63],0
ds_read_b64_tr_b16 a[116:117],v20 offset:32768
v_mul_f32 v230,s93,v230
v_mul_f32 v231,s93,v231
CV v226,v228,v229
CV v227,v230,v231
M v[220:223],a[152:155],a[56:59],v[220:223]
buffer_store_dwordx4 v[224:227],v36,s[12:15],s94 offen offset:2048 sc1
s_nop 0
M v[224:227],a[160:163],a[56:59],0
ds_read_b64_tr_b16 a[118:119],v20 offset:34816
v_mul_f32 v232,s93,v232
v_mul_f32 v233,s93,v233
v_mul_f32 v234,s93,v234
v_mul_f32 v235,s93,v235
M v[224:227],a[164:167],a[60:63],v[224:227]
CV v232,v232,v233
CV v233,v234,v235
v_mul_f32 v236,s93,v236
v_mul_f32 v237,s93,v237
v_mul_f32 v238,s93,v238
v_mul_f32 v239,s93,v239
M v[228:231],a[172:175],a[60:63],0
CV v234,v236,v237
CV v235,v238,v239
AW a236,v232
AW a237,v233
AW a238,v234
M v[228:231],a[168:171],a[56:59],v[228:231]
buffer_load_dwordx4 v27,s[8:11],s24 offen offset:1024 sc1 lds
AW a239,v235
s_add_u32 s94,s94,s95
M v[232:235],a[176:179],a[56:59],0
v_mul_f32 v240,s93,v240
v_mul_f32 v241,s93,v241
v_mul_f32 v242,s93,v242
v_mul_f32 v243,s93,v243
CV v240,v240,v241
M v[232:235],a[180:183],a[60:63],v[232:235]
CV v241,v242,v243
v_mul_f32 v244,s93,v244
v_mul_f32 v245,s93,v245
v_mul_f32 v246,s93,v246
v_mul_f32 v247,s93,v247
M v[236:239],a[188:191],a[60:63],0
buffer_load_dword v1,v37,s[64:67],0 offen
CV v242,v244,v245
CV v243,v246,v247
M v[236:239],a[184:187],a[56:59],v[236:239]
buffer_store_dwordx4 v[240:243],v36,s[12:15],s94 offen sc1
s_nop 0
s_waitcnt lgkmcnt(4)
M v[240:243],a[128:131],a[48:51],0
ds_read_b128 a[56:59],v4 offset:38912
v_mul_f32 v248,s93,v248
v_mul_f32 v249,s93,v249
v_mul_f32 v250,s93,v250
v_mul_f32 v251,s93,v251
CV v248,v248,v249
M v[240:243],a[132:135],a[52:55],v[240:243]
ds_read_b128 a[60:63],v5 offset:38912
CV v249,v250,v251
v_mul_f32 v252,s93,v252
v_mul_f32 v253,s93,v253
v_mul_f32 v254,s93,v254
M v[244:247],a[140:143],a[52:55],0
ds_read_b64_tr_b16 a[124:125],v21 offset:32768
v_mul_f32 v255,s93,v255
CV v250,v252,v253
CV v251,v254,v255
AW a240,v248
AW a241,v249
M v[244:247],a[136:139],a[48:51],v[244:247]
buffer_load_dwordx4 v28,s[8:11],s24 offen offset:2048 sc1 lds
AW a242,v250
AW a243,v251
M v[248:251],a[144:147],a[48:51],0
ds_read_b64_tr_b16 a[126:127],v21 offset:34816
AR v42,a0
AR v43,a1
AR v44,a2
AR v45,a3
v_mul_f32 v42,s93,v42
M v[248:251],a[148:151],a[52:55],v[248:251]
v_mul_f32 v43,s93,v43
v_mul_f32 v44,s93,v44
v_mul_f32 v45,s93,v45
CV v30,v42,v43
CV v31,v44,v45
AR v42,a4
AR v43,a5
M v[252:255],a[156:159],a[52:55],0
AR v44,a6
AR v45,a7
v_mul_f32 v42,s93,v42
v_mul_f32 v43,s93,v43
v_mul_f32_e64 v44,s93,v44
v_mul_f32 v45,s93,v45
M v[252:255],a[152:155],a[48:51],v[252:255]
CV v32,v42,v43
CV v33,v44,v45
buffer_store_dwordx4 v[30:33],v36,s[12:15],s94 offen offset:2048 sc1
s_nop 0
M a[0:3],a[160:163],a[48:51],0
AR v42,a8
AR v43,a9
AR v44,a10
AR v45,a11
v_mul_f32 v42,s93,v42
v_mul_f32 v43,s93,v43
v_mul_f32 v44,s93,v44
M a[0:3],a[164:167],a[52:55],a[0:3]
v_mul_f32 v45,s93,v45
CV v30,v42,v43
CV v31,v44,v45
AR v42,a12
AR v43,a13
AR v44,a14
AR v45,a15
M a[4:7],a[172:175],a[52:55],0
v_mul_f32 v42,s93,v42
v_mul_f32 v43,s93,v43
v_mul_f32 v44,s93,v44
v_mul_f32 v45,s93,v45
CV v32,v42,v43
CV v33,v44,v45
AW a244,v30
M a[4:7],a[168:171],a[48:51],a[4:7]
buffer_load_dwordx4 v29,s[8:11],s24 offen offset:3072 sc1 lds
AW a245,v31
AW a246,v32
AW a247,v33
s_add_u32 s94,s94,s95
M a[8:11],a[176:179],a[48:51],0
s_add_u32 s24,s24,s25
AR v42,a16
AR v43,a17
AR v44,a18
AR v45,a19
v_mul_f32 v42,s93,v42
v_mul_f32 v43,s93,v43
M a[8:11],a[180:183],a[52:55],a[8:11]
v_mul_f32 v44,s93,v44
v_mul_f32 v45,s93,v45
CV v30,v42,v43
CV v31,v44,v45
AR v42,a20
AR v43,a21
M a[12:15],a[188:191],a[52:55],0
AR v44,a22
AR v45,a23
v_mul_f32 v42,s93,v42
v_mul_f32 v43,s93,v43
v_mul_f32_e64 v44,s93,v44
v_mul_f32 v45,s93,v45
CV v32,v42,v43
M a[12:15],a[184:187],a[48:51],a[12:15]
CV v33,v44,v45
buffer_store_dwordx4 v[30:33],v36,s[12:15],s94 offen sc1
s_nop 0
s_waitcnt vmcnt(32) lgkmcnt(0)
s_barrier
M a[16:19],a[128:131],a[56:59],0
ds_read_b128 a[48:51],v2 offset:0
AR v42,a24
AR v43,a25
AR v44,a26
AR v45,a27
v_mul_f32 v42,s93,v42
v_mul_f32 v43,s93,v43
v_mul_f32 v44,s93,v44
M a[16:19],a[132:135],a[60:63],a[16:19]
ds_read_b128 a[52:55],v3 offset:0
v_mul_f32 v45,s93,v45
CV v30,v42,v43
CV v31,v44,v45
AR v42,a28
AR v43,a29
AR v44,a30
M a[20:23],a[140:143],a[60:63],0
s_add_u32 m0,s21,98304
AR v45,a31
v_mul_f32 v42,s93,v42
v_mul_f32 v43,s93,v43
v_mul_f32 v44,s93,v44
v_mul_f32 v45,s93,v45
CV v32,v42,v43
CV v33,v44,v45
M a[20:23],a[136:139],a[56:59],a[20:23]
buffer_load_dwordx4 v22,s[4:7],s23 offen sc1 lds
AW a248,v30
AW a249,v31
AW a250,v32
AW a251,v33
M a[24:27],a[144:147],a[56:59],0
AR v42,a32
AR v43,a33
AR v44,a34
AR v45,a35
v_mul_f32 v42,s93,v42
v_mul_f32 v43,s93,v43
M a[24:27],a[148:151],a[60:63],a[24:27]
v_mul_f32 v44,s93,v44
v_mul_f32 v45,s93,v45
CV v30,v42,v43
CV v31,v44,v45
AR v42,a36
AR v43,a37
M a[28:31],a[156:159],a[60:63],0
AR v44,a38
AR v45,a39
v_mul_f32 v42,s93,v42
v_mul_f32 v43,s93,v43
v_mul_f32_e64 v44,s93,v44
v_mul_f32 v45,s93,v45
M a[28:31],a[152:155],a[56:59],a[28:31]
CV v32,v42,v43
CV v33,v44,v45
buffer_store_dwordx4 v[30:33],v36,s[12:15],s94 offen offset:2048 sc1
s_nop 0
M a[32:35],a[160:163],a[56:59],0
AR v42,a40
AR v43,a41
AR v44,a42
AR v45,a43
v_mul_f32 v42,s93,v42
v_mul_f32 v43,s93,v43
v_mul_f32 v44,s93,v44
M a[32:35],a[164:167],a[60:63],a[32:35]
v_mul_f32 v45,s93,v45
CV v30,v42,v43
CV v31,v44,v45
AR v42,a44
AR v43,a45
AR v44,a46
AR v45,a47
M a[36:39],a[172:175],a[60:63],0
v_mul_f32 v42,s93,v42
v_mul_f32 v43,s93,v43
v_mul_f32 v44,s93,v44
v_mul_f32 v45,s93,v45
CV v32,v42,v43
CV v33,v44,v45
AW a252,v30
M a[36:39],a[168:171],a[56:59],a[36:39]
buffer_load_dwordx4 v23,s[4:7],s23 offen offset:1024 sc1 lds
AW a253,v31
AW a254,v32
AW a255,v33
s_add_u32 s94,s94,s95
M a[40:43],a[176:179],a[56:59],0
M a[40:43],a[180:183],a[60:63],a[40:43]
s_sub_u32 s26,s26,1
M a[44:47],a[188:191],a[60:63],0
s_cmp_eq_u32 s26,s43
M a[44:47],a[184:187],a[56:59],a[44:47]
s_waitcnt lgkmcnt(0)
M v[48:51],a[64:67],a[48:51],v[48:51]
ds_read_b128 a[56:59],v2 offset:2048
M v[48:51],a[68:71],a[52:55],v[48:51]
ds_read_b128 a[60:63],v3 offset:2048
M v[52:55],a[76:79],a[52:55],v[52:55]
ds_read_b64_tr_b16 a[128:129],v6 offset:0
M v[52:55],a[72:75],a[48:51],v[52:55]
buffer_load_dwordx4 v24,s[4:7],s23 offen offset:2048 sc1 lds
M v[56:59],a[80:83],a[48:51],v[56:59]
ds_read_b64_tr_b16 a[130:131],v6 offset:2048
M v[56:59],a[84:87],a[52:55],v[56:59]
M v[60:63],a[92:95],a[52:55],v[60:63]
ds_read_b64_tr_b16 a[136:137],v7 offset:0
M v[60:63],a[88:91],a[48:51],v[60:63]
buffer_store_dwordx4 a[192:195],v36,s[12:15],s92 offen offset:1024 sc1
M v[64:67],a[96:99],a[48:51],v[64:67]
ds_read_b64_tr_b16 a[138:139],v7 offset:2048
M v[64:67],a[100:103],a[52:55],v[64:67]
M v[68:71],a[108:111],a[52:55],v[68:71]
ds_read_b64_tr_b16 a[144:145],v8 offset:0
M v[68:71],a[104:107],a[48:51],v[68:71]
buffer_load_dwordx4 v25,s[4:7],s23 offen offset:3072 sc1 lds
M v[72:75],a[112:115],a[48:51],v[72:75]
ds_read_b64_tr_b16 a[146:147],v8 offset:2048
M v[72:75],a[116:119],a[52:55],v[72:75]
s_add_u32 s23,s23,128
M v[76:79],a[124:127],a[52:55],v[76:79]
M v[76:79],a[120:123],a[48:51],v[76:79]
s_waitcnt lgkmcnt(6)
M v[80:83],a[64:67],a[56:59],v[80:83]
ds_read_b128 a[48:51],v2 offset:4096
M v[80:83],a[68:71],a[60:63],v[80:83]
ds_read_b128 a[52:55],v3 offset:4096
s_add_u32 m0,s21,114688
M v[84:87],a[76:79],a[60:63],v[84:87]
ds_read_b64_tr_b16 a[152:153],v9 offset:0
M v[84:87],a[72:75],a[56:59],v[84:87]
buffer_load_dwordx4 v26,s[8:11],s24 offen sc1 lds
M v[88:91],a[80:83],a[56:59],v[88:91]
ds_read_b64_tr_b16 a[154:155],v9 offset:2048
M v[88:91],a[84:87],a[60:63],v[88:91]
M v[92:95],a[92:95],a[60:63],v[92:95]
ds_read_b64_tr_b16 a[160:161],v10 offset:0
M v[92:95],a[88:91],a[56:59],v[92:95]
buffer_store_dwordx4 a[196:199],v36,s[12:15],s92 offen offset:3072 sc1
M v[96:99],a[96:99],a[56:59],v[96:99]
ds_read_b64_tr_b16 a[162:163],v10 offset:2048
M v[96:99],a[100:103],a[60:63],v[96:99]
s_add_u32 s92,s92,s95
M v[100:103],a[108:111],a[60:63],v[100:103]
ds_read_b64_tr_b16 a[168:169],v11 offset:0
M v[100:103],a[104:107],a[56:59],v[100:103]
buffer_load_dwordx4 v27,s[8:11],s24 offen offset:1024 sc1 lds
M v[104:107],a[112:115],a[56:59],v[104:107]
ds_read_b64_tr_b16 a[170:171],v11 offset:2048
M v[104:107],a[116:119],a[60:63],v[104:107]
M v[108:111],a[124:127],a[60:63],v[108:111]
M v[108:111],a[120:123],a[56:59],v[108:111]
s_waitcnt lgkmcnt(6)
M v[112:115],a[64:67],a[48:51],v[112:115]
ds_read_b128 a[56:59],v2 offset:6144
M v[112:115],a[68:71],a[52:55],v[112:115]
ds_read_b128 a[60:63],v3 offset:6144
M v[116:119],a[76:79],a[52:55],v[116:119]
ds_read_b64_tr_b16 a[176:177],v12 offset:0
M v[116:119],a[72:75],a[48:51],v[116:119]
buffer_load_dwordx4 v28,s[8:11],s24 offen offset:2048 sc1 lds
M v[120:123],a[80:83],a[48:51],v[120:123]
ds_read_b64_tr_b16 a[178:179],v12 offset:2048
M v[120:123],a[84:87],a[52:55],v[120:123]
M v[124:127],a[92:95],a[52:55],v[124:127]
ds_read_b64_tr_b16 a[184:185],v13 offset:0
M v[124:127],a[88:91],a[48:51],v[124:127]
buffer_store_dwordx4 a[200:203],v36,s[12:15],s92 offen offset:1024 sc1
M v[128:131],a[96:99],a[48:51],v[128:131]
ds_read_b64_tr_b16 a[186:187],v13 offset:2048
M v[128:131],a[100:103],a[52:55],v[128:131]
M v[132:135],a[108:111],a[52:55],v[132:135]
M v[132:135],a[104:107],a[48:51],v[132:135]
buffer_load_dwordx4 v29,s[8:11],s24 offen offset:3072 sc1 lds
M v[136:139],a[112:115],a[48:51],v[136:139]
s_add_u32 s24,s24,s25
M v[136:139],a[116:119],a[52:55],v[136:139]
M v[140:143],a[124:127],a[52:55],v[140:143]
M v[140:143],a[120:123],a[48:51],v[140:143]
s_waitcnt vmcnt(30) lgkmcnt(0)
s_barrier
M v[144:147],a[64:67],a[56:59],v[144:147]
ds_read_b128 a[48:51],v2 offset:32768
M v[144:147],a[68:71],a[60:63],v[144:147]
ds_read_b128 a[52:55],v3 offset:32768
s_add_u32 m0,s21,0
M v[148:151],a[76:79],a[60:63],v[148:151]
ds_read_b64_tr_b16 a[132:133],v6 offset:32768
M v[148:151],a[72:75],a[56:59],v[148:151]
buffer_load_dwordx4 v22,s[4:7],s22 offen sc1 lds
M v[152:155],a[80:83],a[56:59],v[152:155]
ds_read_b64_tr_b16 a[134:135],v6 offset:34816
M v[152:155],a[84:87],a[60:63],v[152:155]
M v[156:159],a[92:95],a[60:63],v[156:159]
ds_read_b64_tr_b16 a[140:141],v7 offset:32768
M v[156:159],a[88:91],a[56:59],v[156:159]
buffer_store_dwordx4 a[204:207],v36,s[12:15],s92 offen offset:3072 sc1
M v[160:163],a[96:99],a[56:59],v[160:163]
ds_read_b64_tr_b16 a[142:143],v7 offset:34816
M v[160:163],a[100:103],a[60:63],v[160:163]
s_add_u32 s92,s92,s95
M v[164:167],a[108:111],a[60:63],v[164:167]
ds_read_b64_tr_b16 a[148:149],v8 offset:32768
M v[164:167],a[104:107],a[56:59],v[164:167]
buffer_load_dwordx4 v23,s[4:7],s22 offen offset:1024 sc1 lds
M v[168:171],a[112:115],a[56:59],v[168:171]
M v[168:171],a[116:119],a[60:63],v[168:171]
M v[172:175],a[124:127],a[60:63],v[172:175]
M v[172:175],a[120:123],a[56:59],v[172:175]
s_waitcnt lgkmcnt(5)
M v[176:179],a[64:67],a[48:51],v[176:179]
ds_read_b128 a[56:59],v2 offset:34816
M v[176:179],a[68:71],a[52:55],v[176:179]
ds_read_b128 a[60:63],v3 offset:34816
M v[180:183],a[76:79],a[52:55],v[180:183]
ds_read_b64_tr_b16 a[150:151],v8 offset:34816
M v[180:183],a[72:75],a[48:51],v[180:183]
buffer_load_dwordx4 v24,s[4:7],s22 offen offset:2048 sc1 lds
M v[184:187],a[80:83],a[48:51],v[184:187]
ds_read_b64_tr_b16 a[156:157],v9 offset:32768
M v[184:187],a[84:87],a[52:55],v[184:187]
M v[188:191],a[92:95],a[52:55],v[188:191]
ds_read_b64_tr_b16 a[158:159],v9 offset:34816
M v[188:191],a[88:91],a[48:51],v[188:191]
buffer_store_dwordx4 a[208:211],v36,s[12:15],s92 offen offset:1024 sc1
M v[192:195],a[96:99],a[48:51],v[192:195]
ds_read_b64_tr_b16 a[164:165],v10 offset:32768
M v[192:195],a[100:103],a[52:55],v[192:195]
M v[196:199],a[108:111],a[52:55],v[196:199]
ds_read_b64_tr_b16 a[166:167],v10 offset:34816
M v[196:199],a[104:107],a[48:51],v[196:199]
buffer_load_dwordx4 v25,s[4:7],s22 offen offset:3072 sc1 lds
M v[200:203],a[112:115],a[48:51],v[200:203]
s_add_u32 s22,s22,128
M v[200:203],a[116:119],a[52:55],v[200:203]
M v[204:207],a[124:127],a[52:55],v[204:207]
M v[204:207],a[120:123],a[48:51],v[204:207]
s_waitcnt lgkmcnt(5)
M v[208:211],a[64:67],a[56:59],v[208:211]
ds_read_b128 a[48:51],v2 offset:36864
M v[208:211],a[68:71],a[60:63],v[208:211]
ds_read_b128 a[52:55],v3 offset:36864
s_add_u32 m0,s21,16384
M v[212:215],a[76:79],a[60:63],v[212:215]
ds_read_b64_tr_b16 a[172:173],v11 offset:32768
M v[212:215],a[72:75],a[56:59],v[212:215]
buffer_load_dwordx4 v26,s[8:11],s24 offen sc1 lds
M v[216:219],a[80:83],a[56:59],v[216:219]
ds_read_b64_tr_b16 a[174:175],v11 offset:34816
M v[216:219],a[84:87],a[60:63],v[216:219]
M v[220:223],a[92:95],a[60:63],v[220:223]
ds_read_b64_tr_b16 a[180:181],v12 offset:32768
M v[220:223],a[88:91],a[56:59],v[220:223]
buffer_store_dwordx4 a[212:215],v36,s[12:15],s92 offen offset:3072 sc1
M v[224:227],a[96:99],a[56:59],v[224:227]
ds_read_b64_tr_b16 a[182:183],v12 offset:34816
M v[224:227],a[100:103],a[60:63],v[224:227]
s_add_u32 s92,s92,s95
M v[228:231],a[108:111],a[60:63],v[228:231]
M v[228:231],a[104:107],a[56:59],v[228:231]
buffer_load_dwordx4 v27,s[8:11],s24 offen offset:1024 sc1 lds
M v[232:235],a[112:115],a[56:59],v[232:235]
M v[232:235],a[116:119],a[60:63],v[232:235]
M v[236:239],a[124:127],a[60:63],v[236:239]
buffer_load_dword v1,v37,s[64:67],0 offen
M v[236:239],a[120:123],a[56:59],v[236:239]
s_waitcnt lgkmcnt(4)
M v[240:243],a[64:67],a[48:51],v[240:243]
ds_read_b128 a[56:59],v2 offset:38912
M v[240:243],a[68:71],a[52:55],v[240:243]
ds_read_b128 a[60:63],v3 offset:38912
M v[244:247],a[76:79],a[52:55],v[244:247]
ds_read_b64_tr_b16 a[188:189],v13 offset:32768
M v[244:247],a[72:75],a[48:51],v[244:247]
buffer_load_dwordx4 v28,s[8:11],s24 offen offset:2048 sc1 lds
M v[248:251],a[80:83],a[48:51],v[248:251]
ds_read_b64_tr_b16 a[190:191],v13 offset:34816
M v[248:251],a[84:87],a[52:55],v[248:251]
M v[252:255],a[92:95],a[52:55],v[252:255]
M v[252:255],a[88:91],a[48:51],v[252:255]
buffer_store_dwordx4 a[216:219],v36,s[12:15],s92 offen offset:1024 sc1
M a[0:3],a[96:99],a[48:51],a[0:3]
M a[0:3],a[100:103],a[52:55],a[0:3]
M a[4:7],a[108:111],a[52:55],a[4:7]
M a[4:7],a[104:107],a[48:51],a[4:7]
buffer_load_dwordx4 v29,s[8:11],s24 offen offset:3072 sc1 lds
M a[8:11],a[112:115],a[48:51],a[8:11]
s_add_u32 s24,s24,s25
M a[8:11],a[116:119],a[52:55],a[8:11]
M a[12:15],a[124:127],a[52:55],a[12:15]
M a[12:15],a[120:123],a[48:51],a[12:15]
s_waitcnt vmcnt(26) lgkmcnt(0)
s_barrier
M a[16:19],a[64:67],a[56:59],a[16:19]
ds_read_b128 a[48:51],v4 offset:0
M a[16:19],a[68:71],a[60:63],a[16:19]
ds_read_b128 a[52:55],v5 offset:0
M a[20:23],a[76:79],a[60:63],a[20:23]
s_add_u32 m0,s21,32768
M a[20:23],a[72:75],a[56:59],a[20:23]
buffer_load_dwordx4 v22,s[4:7],s23 offen sc1 lds
M a[24:27],a[80:83],a[56:59],a[24:27]
M a[24:27],a[84:87],a[60:63],a[24:27]
M a[28:31],a[92:95],a[60:63],a[28:31]
M a[28:31],a[88:91],a[56:59],a[28:31]
buffer_store_dwordx4 a[220:223],v36,s[12:15],s92 offen offset:3072 sc1
M a[32:35],a[96:99],a[56:59],a[32:35]
M a[32:35],a[100:103],a[60:63],a[32:35]
s_add_u32 s92,s92,s95
M a[36:39],a[108:111],a[60:63],a[36:39]
M a[36:39],a[104:107],a[56:59],a[36:39]
buffer_load_dwordx4 v23,s[4:7],s23 offen offset:1024 sc1 lds
M a[40:43],a[112:115],a[56:59],a[40:43]
M a[40:43],a[116:119],a[60:63],a[40:43]
s_sub_u32 s26,s26,1
M a[44:47],a[124:127],a[60:63],a[44:47]
s_cmp_eq_u32 s26,s43
M a[44:47],a[120:123],a[56:59],a[44:47]
s_waitcnt lgkmcnt(0)
M v[48:51],a[128:131],a[48:51],v[48:51]
ds_read_b128 a[56:59],v4 offset:2048
M v[48:51],a[132:135],a[52:55],v[48:51]
ds_read_b128 a[60:63],v5 offset:2048
M v[52:55],a[140:143],a[52:55],v[52:55]
ds_read_b64_tr_b16 a[64:65],v14 offset:0
M v[52:55],a[136:139],a[48:51],v[52:55]
buffer_load_dwordx4 v24,s[4:7],s23 offen offset:2048 sc1 lds
M v[56:59],a[144:147],a[48:51],v[56:59]
ds_read_b64_tr_b16 a[66:67],v14 offset:2048
M v[56:59],a[148:151],a[52:55],v[56:59]
M v[60:63],a[156:159],a[52:55],v[60:63]
ds_read_b64_tr_b16 a[72:73],v15 offset:0
M v[60:63],a[152:155],a[48:51],v[60:63]
buffer_store_dwordx4 a[224:227],v36,s[12:15],s92 offen offset:1024 sc1
M v[64:67],a[160:163],a[48:51],v[64:67]
ds_read_b64_tr_b16 a[74:75],v15 offset:2048
M v[64:67],a[164:167],a[52:55],v[64:67]
M v[68:71],a[172:175],a[52:55],v[68:71]
ds_read_b64_tr_b16 a[80:81],v16 offset:0
M v[68:71],a[168:171],a[48:51],v[68:71]
buffer_load_dwordx4 v25,s[4:7],s23 offen offset:3072 sc1 lds
M v[72:75],a[176:179],a[48:51],v[72:75]
ds_read_b64_tr_b16 a[82:83],v16 offset:2048
M v[72:75],a[180:183],a[52:55],v[72:75]
s_add_u32 s23,s23,128
M v[76:79],a[188:191],a[52:55],v[76:79]
M v[76:79],a[184:187],a[48:51],v[76:79]
s_waitcnt lgkmcnt(6)
M v[80:83],a[128:131],a[56:59],v[80:83]
ds_read_b128 a[48:51],v4 offset:4096
M v[80:83],a[132:135],a[60:63],v[80:83]
ds_read_b128 a[52:55],v5 offset:4096
s_add_u32 m0,s21,49152
M v[84:87],a[140:143],a[60:63],v[84:87]
ds_read_b64_tr_b16 a[88:89],v17 offset:0
M v[84:87],a[136:139],a[56:59],v[84:87]
buffer_load_dwordx4 v26,s[8:11],s24 offen sc1 lds
M v[88:91],a[144:147],a[56:59],v[88:91]
ds_read_b64_tr_b16 a[90:91],v17 offset:2048
M v[88:91],a[148:151],a[60:63],v[88:91]
M v[92:95],a[156:159],a[60:63],v[92:95]
ds_read_b64_tr_b16 a[96:97],v18 offset:0
M v[92:95],a[152:155],a[56:59],v[92:95]
buffer_store_dwordx4 a[228:231],v36,s[12:15],s92 offen offset:3072 sc1
M v[96:99],a[160:163],a[56:59],v[96:99]
ds_read_b64_tr_b16 a[98:99],v18 offset:2048
M v[96:99],a[164:167],a[60:63],v[96:99]
s_add_u32 s92,s92,s95
M v[100:103],a[172:175],a[60:63],v[100:103]
ds_read_b64_tr_b16 a[104:105],v19 offset:0
M v[100:103],a[168:171],a[56:59],v[100:103]
buffer_load_dwordx4 v27,s[8:11],s24 offen offset:1024 sc1 lds
M v[104:107],a[176:179],a[56:59],v[104:107]
ds_read_b64_tr_b16 a[106:107],v19 offset:2048
M v[104:107],a[180:183],a[60:63],v[104:107]
M v[108:111],a[188:191],a[60:63],v[108:111]
M v[108:111],a[184:187],a[56:59],v[108:111]
s_waitcnt lgkmcnt(6)
M v[112:115],a[128:131],a[48:51],v[112:115]
ds_read_b128 a[56:59],v4 offset:6144
M v[112:115],a[132:135],a[52:55],v[112:115]
ds_read_b128 a[60:63],v5 offset:6144
M v[116:119],a[140:143],a[52:55],v[116:119]
ds_read_b64_tr_b16 a[112:113],v20 offset:0
M v[116:119],a[136:139],a[48:51],v[116:119]
buffer_load_dwordx4 v28,s[8:11],s24 offen offset:2048 sc1 lds
M v[120:123],a[144:147],a[48:51],v[120:123]
ds_read_b64_tr_b16 a[114:115],v20 offset:2048
M v[120:123],a[148:151],a[52:55],v[120:123]
M v[124:127],a[156:159],a[52:55],v[124:127]
ds_read_b64_tr_b16 a[120:121],v21 offset:0
M v[124:127],a[152:155],a[48:51],v[124:127]
buffer_store_dwordx4 a[232:235],v36,s[12:15],s92 offen offset:1024 sc1
M v[128:131],a[160:163],a[48:51],v[128:131]
ds_read_b64_tr_b16 a[122:123],v21 offset:2048
M v[128:131],a[164:167],a[52:55],v[128:131]
M v[132:135],a[172:175],a[52:55],v[132:135]
M v[132:135],a[168:171],a[48:51],v[132:135]
buffer_load_dwordx4 v29,s[8:11],s24 offen offset:3072 sc1 lds
M v[136:139],a[176:179],a[48:51],v[136:139]
s_add_u32 s24,s24,s25
M v[136:139],a[180:183],a[52:55],v[136:139]
M v[140:143],a[188:191],a[52:55],v[140:143]
M v[140:143],a[184:187],a[48:51],v[140:143]
s_waitcnt vmcnt(25) lgkmcnt(0)
s_barrier
M v[144:147],a[128:131],a[56:59],v[144:147]
ds_read_b128 a[48:51],v4 offset:32768
M v[144:147],a[132:135],a[60:63],v[144:147]
ds_read_b128 a[52:55],v5 offset:32768
s_add_u32 m0,s21,65536
M v[148:151],a[140:143],a[60:63],v[148:151]
ds_read_b64_tr_b16 a[68:69],v14 offset:32768
M v[148:151],a[136:139],a[56:59],v[148:151]
buffer_load_dwordx4 v22,s[4:7],s22 offen sc1 lds
M v[152:155],a[144:147],a[56:59],v[152:155]
ds_read_b64_tr_b16 a[70:71],v14 offset:34816
M v[152:155],a[148:151],a[60:63],v[152:155]
M v[156:159],a[156:159],a[60:63],v[156:159]
ds_read_b64_tr_b16 a[76:77],v15 offset:32768
M v[156:159],a[152:155],a[56:59],v[156:159]
buffer_store_dwordx4 a[236:239],v36,s[12:15],s92 offen offset:3072 sc1
M v[160:163],a[160:163],a[56:59],v[160:163]
ds_read_b64_tr_b16 a[78:79],v15 offset:34816
M v[160:163],a[164:167],a[60:63],v[160:163]
s_add_u32 s92,s92,s95
M v[164:167],a[172:175],a[60:63],v[164:167]
ds_read_b64_tr_b16 a[84:85],v16 offset:32768
M v[164:167],a[168:171],a[56:59],v[164:167]
buffer_load_dwordx4 v23,s[4:7],s22 offen offset:1024 sc1 lds
M v[168:171],a[176:179],a[56:59],v[168:171]
M v[168:171],a[180:183],a[60:63],v[168:171]
M v[172:175],a[188:191],a[60:63],v[172:175]
M v[172:175],a[184:187],a[56:59],v[172:175]
s_waitcnt lgkmcnt(5)
M v[176:179],a[128:131],a[48:51],v[176:179]
ds_read_b128 a[56:59],v4 offset:34816
M v[176:179],a[132:135],a[52:55],v[176:179]
ds_read_b128 a[60:63],v5 offset:34816
M v[180:183],a[140:143],a[52:55],v[180:183]
ds_read_b64_tr_b16 a[86:87],v16 offset:34816
M v[180:183],a[136:139],a[48:51],v[180:183]
buffer_load_dwordx4 v24,s[4:7],s22 offen offset:2048 sc1 lds
M v[184:187],a[144:147],a[48:51],v[184:187]
ds_read_b64_tr_b16 a[92:93],v17 offset:32768
M v[184:187],a[148:151],a[52:55],v[184:187]
M v[188:191],a[156:159],a[52:55],v[188:191]
ds_read_b64_tr_b16 a[94:95],v17 offset:34816
M v[188:191],a[152:155],a[48:51],v[188:191]
buffer_store_dwordx4 a[240:243],v36,s[12:15],s92 offen offset:1024 sc1
M v[192:195],a[160:163],a[48:51],v[192:195]
ds_read_b64_tr_b16 a[100:101],v18 offset:32768
M v[192:195],a[164:167],a[52:55],v[192:195]
M v[196:199],a[172:175],a[52:55],v[196:199]
ds_read_b64_tr_b16 a[102:103],v18 offset:34816
M v[196:199],a[168:171],a[48:51],v[196:199]
buffer_load_dwordx4 v25,s[4:7],s22 offen offset:3072 sc1 lds
M v[200:203],a[176:179],a[48:51],v[200:203]
s_add_u32 s22,s22,128
M v[200:203],a[180:183],a[52:55],v[200:203]
M v[204:207],a[188:191],a[52:55],v[204:207]
M v[204:207],a[184:187],a[48:51],v[204:207]
s_waitcnt lgkmcnt(5)
M v[208:211],a[128:131],a[56:59],v[208:211]
ds_read_b128 a[48:51],v4 offset:36864
M v[208:211],a[132:135],a[60:63],v[208:211]
ds_read_b128 a[52:55],v5 offset:36864
s_add_u32 m0,s21,81920
M v[212:215],a[140:143],a[60:63],v[212:215]
ds_read_b64_tr_b16 a[108:109],v19 offset:32768
M v[212:215],a[136:139],a[56:59],v[212:215]
buffer_load_dwordx4 v26,s[8:11],s24 offen sc1 lds
M v[216:219],a[144:147],a[56:59],v[216:219]
ds_read_b64_tr_b16 a[110:111],v19 offset:34816
M v[216:219],a[148:151],a[60:63],v[216:219]
M v[220:223],a[156:159],a[60:63],v[220:223]
ds_read_b64_tr_b16 a[116:117],v20 offset:32768
M v[220:223],a[152:155],a[56:59],v[220:223]
buffer_store_dwordx4 a[244:247],v36,s[12:15],s92 offen offset:3072 sc1
M v[224:227],a[160:163],a[56:59],v[224:227]
ds_read_b64_tr_b16 a[118:119],v20 offset:34816
M v[224:227],a[164:167],a[60:63],v[224:227]
s_add_u32 s92,s92,s95
M v[228:231],a[172:175],a[60:63],v[228:231]
M v[228:231],a[168:171],a[56:59],v[228:231]
buffer_load_dwordx4 v27,s[8:11],s24 offen offset:1024 sc1 lds
M v[232:235],a[176:179],a[56:59],v[232:235]
M v[232:235],a[180:183],a[60:63],v[232:235]
M v[236:239],a[188:191],a[60:63],v[236:239]
buffer_load_dword v1,v37,s[64:67],0 offen
M v[236:239],a[184:187],a[56:59],v[236:239]
s_waitcnt lgkmcnt(4)
M v[240:243],a[128:131],a[48:51],v[240:243]
ds_read_b128 a[56:59],v4 offset:38912
M v[240:243],a[132:135],a[52:55],v[240:243]
ds_read_b128 a[60:63],v5 offset:38912
M v[244:247],a[140:143],a[52:55],v[244:247]
ds_read_b64_tr_b16 a[124:125],v21 offset:32768
M v[244:247],a[136:139],a[48:51],v[244:247]
buffer_load_dwordx4 v28,s[8:11],s24 offen offset:2048 sc1 lds
M v[248:251],a[144:147],a[48:51],v[248:251]
ds_read_b64_tr_b16 a[126:127],v21 offset:34816
M v[248:251],a[148:151],a[52:55],v[248:251]
M v[252:255],a[156:159],a[52:55],v[252:255]
M v[252:255],a[152:155],a[48:51],v[252:255]
buffer_store_dwordx4 a[248:251],v36,s[12:15],s92 offen offset:1024 sc1
M a[0:3],a[160:163],a[48:51],a[0:3]
M a[0:3],a[164:167],a[52:55],a[0:3]
M a[4:7],a[172:175],a[52:55],a[4:7]
M a[4:7],a[168:171],a[48:51],a[4:7]
buffer_load_dwordx4 v29,s[8:11],s24 offen offset:3072 sc1 lds
M a[8:11],a[176:179],a[48:51],a[8:11]
s_add_u32 s24,s24,s25
M a[8:11],a[180:183],a[52:55],a[8:11]
M a[12:15],a[188:191],a[52:55],a[12:15]
M a[12:15],a[184:187],a[48:51],a[12:15]
s_waitcnt vmcnt(25) lgkmcnt(0)
s_barrier
M a[16:19],a[128:131],a[56:59],a[16:19]
ds_read_b128 a[48:51],v2 offset:0
M a[16:19],a[132:135],a[60:63],a[16:19]
ds_read_b128 a[52:55],v3 offset:0
M a[20:23],a[140:143],a[60:63],a[20:23]
s_add_u32 m0,s21,98304
M a[20:23],a[136:139],a[56:59],a[20:23]
buffer_load_dwordx4 v22,s[4:7],s23 offen sc1 lds
M a[24:27],a[144:147],a[56:59],a[24:27]
M a[24:27],a[148:151],a[60:63],a[24:27]
M a[28:31],a[156:159],a[60:63],a[28:31]
M a[28:31],a[152:155],a[56:59],a[28:31]
buffer_store_dwordx4 a[252:255],v36,s[12:15],s92 offen offset:3072 sc1
M a[32:35],a[160:163],a[56:59],a[32:35]
M a[32:35],a[164:167],a[60:63],a[32:35]
s_add_u32 s92,s92,s95
M a[36:39],a[172:175],a[60:63],a[36:39]
M a[36:39],a[168:171],a[56:59],a[36:39]
buffer_load_dwordx4 v23,s[4:7],s23 offen offset:1024 sc1 lds
M a[40:43],a[176:179],a[56:59],a[40:43]
M a[40:43],a[180:183],a[60:63],a[40:43]
s_sub_u32 s26,s26,1
M a[44:47],a[188:191],a[60:63],a[44:47]
s_cmp_eq_u32 s26,s43
M a[44:47],a[184:187],a[56:59],a[44:47]
.p2align 6
K1_LOOP_KQ:
s_waitcnt lgkmcnt(0)
M v[48:51],a[64:67],a[48:51],v[48:51]
ds_read_b128 a[56:59],v2 offset:2048
M v[48:51],a[68:71],a[52:55],v[48:51]
ds_read_b128 a[60:63],v3 offset:2048
M v[52:55],a[76:79],a[52:55],v[52:55]
ds_read_b64_tr_b16 a[128:129],v6 offset:0
M v[52:55],a[72:75],a[48:51],v[52:55]
buffer_load_dwordx4 v24,s[4:7],s23 offen offset:2048 sc1 lds
M v[56:59],a[80:83],a[48:51],v[56:59]
ds_read_b64_tr_b16 a[130:131],v6 offset:2048
M v[56:59],a[84:87],a[52:55],v[56:59]
M v[60:63],a[92:95],a[52:55],v[60:63]
ds_read_b64_tr_b16 a[136:137],v7 offset:0
M v[60:63],a[88:91],a[48:51],v[60:63]
M v[64:67],a[96:99],a[48:51],v[64:67]
ds_read_b64_tr_b16 a[138:139],v7 offset:2048
M v[64:67],a[100:103],a[52:55],v[64:67]
M v[68:71],a[108:111],a[52:55],v[68:71]
ds_read_b64_tr_b16 a[144:145],v8 offset:0
M v[68:71],a[104:107],a[48:51],v[68:71]
buffer_load_dwordx4 v25,s[4:7],s23 offen offset:3072 sc1 lds
M v[72:75],a[112:115],a[48:51],v[72:75]
ds_read_b64_tr_b16 a[146:147],v8 offset:2048
M v[72:75],a[116:119],a[52:55],v[72:75]
s_add_u32 s23,s23,128
M v[76:79],a[124:127],a[52:55],v[76:79]
M v[76:79],a[120:123],a[48:51],v[76:79]
s_waitcnt lgkmcnt(6)
M v[80:83],a[64:67],a[56:59],v[80:83]
ds_read_b128 a[48:51],v2 offset:4096
M v[80:83],a[68:71],a[60:63],v[80:83]
ds_read_b128 a[52:55],v3 offset:4096
s_add_u32 m0,s21,114688
M v[84:87],a[76:79],a[60:63],v[84:87]
ds_read_b64_tr_b16 a[152:153],v9 offset:0
M v[84:87],a[72:75],a[56:59],v[84:87]
buffer_load_dwordx4 v26,s[8:11],s24 offen sc1 lds
M v[88:91],a[80:83],a[56:59],v[88:91]
ds_read_b64_tr_b16 a[154:155],v9 offset:2048
M v[88:91],a[84:87],a[60:63],v[88:91]
M v[92:95],a[92:95],a[60:63],v[92:95]
ds_read_b64_tr_b16 a[160:161],v10 offset:0
M v[92:95],a[88:91],a[56:59],v[92:95]
M v[96:99],a[96:99],a[56:59],v[96:99]
ds_read_b64_tr_b16 a[162:163],v10 offset:2048
M v[96:99],a[100:103],a[60:63],v[96:99]
M v[100:103],a[108:111],a[60:63],v[100:103]
ds_read_b64_tr_b16 a[168:169],v11 offset:0
M v[100:103],a[104:107],a[56:59],v[100:103]
buffer_load_dwordx4 v27,s[8:11],s24 offen offset:1024 sc1 lds
M v[104:107],a[112:115],a[56:59],v[104:107]
ds_read_b64_tr_b16 a[170:171],v11 offset:2048
M v[104:107],a[116:119],a[60:63],v[104:107]
M v[108:111],a[124:127],a[60:63],v[108:111]
M v[108:111],a[120:123],a[56:59],v[108:111]
s_waitcnt lgkmcnt(6)
M v[112:115],a[64:67],a[48:51],v[112:115]
ds_read_b128 a[56:59],v2 offset:6144
M v[112:115],a[68:71],a[52:55],v[112:115]
ds_read_b128 a[60:63],v3 offset:6144
M v[116:119],a[76:79],a[52:55],v[116:119]
ds_read_b64_tr_b16 a[176:177],v12 offset:0
M v[116:119],a[72:75],a[48:51],v[116:119]
buffer_load_dwordx4 v28,s[8:11],s24 offen offset:2048 sc1 lds
M v[120:123],a[80:83],a[48:51],v[120:123]
ds_read_b64_tr_b16 a[178:179],v12 offset:2048
M v[120:123],a[84:87],a[52:55],v[120:123]
M v[124:127],a[92:95],a[52:55],v[124:127]
ds_read_b64_tr_b16 a[184:185],v13 offset:0
M v[124:127],a[88:91],a[48:51],v[124:127]
M v[128:131],a[96:99],a[48:51],v[128:131]
ds_read_b64_tr_b16 a[186:187],v13 offset:2048
M v[128:131],a[100:103],a[52:55],v[128:131]
M v[132:135],a[108:111],a[52:55],v[132:135]
M v[132:135],a[104:107],a[48:51],v[132:135]
buffer_load_dwordx4 v29,s[8:11],s24 offen offset:3072 sc1 lds
M v[136:139],a[112:115],a[48:51],v[136:139]
s_add_u32 s24,s24,s25
M v[136:139],a[116:119],a[52:55],v[136:139]
s_cmp_eq_u32 s26,2
M v[140:143],a[124:127],a[52:55],v[140:143]
s_cbranch_scc1 HSUB_X_KQ0
HSUB_X_KQ0_R:
M v[140:143],a[120:123],a[48:51],v[140:143]
s_waitcnt vmcnt(17) lgkmcnt(0)
s_barrier
M v[144:147],a[64:67],a[56:59],v[144:147]
ds_read_b128 a[48:51],v2 offset:32768
M v[144:147],a[68:71],a[60:63],v[144:147]
ds_read_b128 a[52:55],v3 offset:32768
s_add_u32 m0,s21,0
M v[148:151],a[76:79],a[60:63],v[148:151]
ds_read_b64_tr_b16 a[132:133],v6 offset:32768
M v[148:151],a[72:75],a[56:59],v[148:151]
buffer_load_dwordx4 v22,s[4:7],s22 offen sc1 lds
M v[152:155],a[80:83],a[56:59],v[152:155]
ds_read_b64_tr_b16 a[134:135],v6 offset:34816
M v[152:155],a[84:87],a[60:63],v[152:155]
M v[156:159],a[92:95],a[60:63],v[156:159]
ds_read_b64_tr_b16 a[140:141],v7 offset:32768
M v[156:159],a[88:91],a[56:59],v[156:159]
M v[160:163],a[96:99],a[56:59],v[160:163]
ds_read_b64_tr_b16 a[142:143],v7 offset:34816
M v[160:163],a[100:103],a[60:63],v[160:163]
M v[164:167],a[108:111],a[60:63],v[164:167]
ds_read_b64_tr_b16 a[148:149],v8 offset:32768
M v[164:167],a[104:107],a[56:59],v[164:167]
buffer_load_dwordx4 v23,s[4:7],s22 offen offset:1024 sc1 lds
M v[168:171],a[112:115],a[56:59],v[168:171]
M v[168:171],a[116:119],a[60:63],v[168:171]
s_cmp_eq_u32 s26,s78
M v[172:175],a[124:127],a[60:63],v[172:175]
s_cbranch_scc1 HSUB_S_KQ0
HSUB_S_KQ0_R:
M v[172:175],a[120:123],a[56:59],v[172:175]
s_waitcnt lgkmcnt(5)
M v[176:179],a[64:67],a[48:51],v[176:179]
ds_read_b128 a[56:59],v2 offset:34816
M v[176:179],a[68:71],a[52:55],v[176:179]
ds_read_b128 a[60:63],v3 offset:34816
M v[180:183],a[76:79],a[52:55],v[180:183]
ds_read_b64_tr_b16 a[150:151],v8 offset:34816
M v[180:183],a[72:75],a[48:51],v[180:183]
buffer_load_dwordx4 v24,s[4:7],s22 offen offset:2048 sc1 lds
M v[184:187],a[80:83],a[48:51],v[184:187]
ds_read_b64_tr_b16 a[156:157],v9 offset:32768
M v[184:187],a[84:87],a[52:55],v[184:187]
M v[188:191],a[92:95],a[52:55],v[188:191]
ds_read_b64_tr_b16 a[158:159],v9 offset:34816
M v[188:191],a[88:91],a[48:51],v[188:191]
M v[192:195],a[96:99],a[48:51],v[192:195]
ds_read_b64_tr_b16 a[164:165],v10 offset:32768
M v[192:195],a[100:103],a[52:55],v[192:195]
M v[196:199],a[108:111],a[52:55],v[196:199]
ds_read_b64_tr_b16 a[166:167],v10 offset:34816
M v[196:199],a[104:107],a[48:51],v[196:199]
buffer_load_dwordx4 v25,s[4:7],s22 offen offset:3072 sc1 lds
M v[200:203],a[112:115],a[48:51],v[200:203]
s_add_u32 s22,s22,128
M v[200:203],a[116:119],a[52:55],v[200:203]
s_cmp_eq_u32 s26,3
M v[204:207],a[124:127],a[52:55],v[204:207]
s_cbranch_scc1 HSUB_W_KQ0
HSUB_W_KQ0_R:
M v[204:207],a[120:123],a[48:51],v[204:207]
s_waitcnt lgkmcnt(5)
M v[208:211],a[64:67],a[56:59],v[208:211]
ds_read_b128 a[48:51],v2 offset:36864
M v[208:211],a[68:71],a[60:63],v[208:211]
ds_read_b128 a[52:55],v3 offset:36864
s_add_u32 m0,s21,16384
M v[212:215],a[76:79],a[60:63],v[212:215]
ds_read_b64_tr_b16 a[172:173],v11 offset:32768
M v[212:215],a[72:75],a[56:59],v[212:215]
buffer_load_dwordx4 v26,s[8:11],s24 offen sc1 lds
M v[216:219],a[80:83],a[56:59],v[216:219]
ds_read_b64_tr_b16 a[174:175],v11 offset:34816
M v[216:219],a[84:87],a[60:63],v[216:219]
M v[220:223],a[92:95],a[60:63],v[220:223]
ds_read_b64_tr_b16 a[180:181],v12 offset:32768
M v[220:223],a[88:91],a[56:59],v[220:223]
M v[224:227],a[96:99],a[56:59],v[224:227]
ds_read_b64_tr_b16 a[182:183],v12 offset:34816
M v[224:227],a[100:103],a[60:63],v[224:227]
M v[228:231],a[108:111],a[60:63],v[228:231]
M v[228:231],a[104:107],a[56:59],v[228:231]
buffer_load_dwordx4 v27,s[8:11],s24 offen offset:1024 sc1 lds
M v[232:235],a[112:115],a[56:59],v[232:235]
M v[232:235],a[116:119],a[60:63],v[232:235]
s_cmp_lg_u32 s29,0
M v[236:239],a[124:127],a[60:63],v[236:239]
buffer_load_dword v1,v37,s[64:67],0 offen
s_cbranch_scc1 HSUB_PF_KQ0
HSUB_PF_KQ0_R:
M v[236:239],a[120:123],a[56:59],v[236:239]
s_waitcnt lgkmcnt(4)
M v[240:243],a[64:67],a[48:51],v[240:243]
ds_read_b128 a[56:59],v2 offset:38912
M v[240:243],a[68:71],a[52:55],v[240:243]
ds_read_b128 a[60:63],v3 offset:38912
M v[244:247],a[76:79],a[52:55],v[244:247]
ds_read_b64_tr_b16 a[188:189],v13 offset:32768
M v[244:247],a[72:75],a[48:51],v[244:247]
buffer_load_dwordx4 v28,s[8:11],s24 offen offset:2048 sc1 lds
M v[248:251],a[80:83],a[48:51],v[248:251]
ds_read_b64_tr_b16 a[190:191],v13 offset:34816
M v[248:251],a[84:87],a[52:55],v[248:251]
M v[252:255],a[92:95],a[52:55],v[252:255]
M v[252:255],a[88:91],a[48:51],v[252:255]
M a[0:3],a[96:99],a[48:51],a[0:3]
M a[0:3],a[100:103],a[52:55],a[0:3]
M a[4:7],a[108:111],a[52:55],a[4:7]
M a[4:7],a[104:107],a[48:51],a[4:7]
buffer_load_dwordx4 v29,s[8:11],s24 offen offset:3072 sc1 lds
M a[8:11],a[112:115],a[48:51],a[8:11]
s_add_u32 s24,s24,s25
M a[8:11],a[116:119],a[52:55],a[8:11]
M a[12:15],a[124:127],a[52:55],a[12:15]
M a[12:15],a[120:123],a[48:51],a[12:15]
s_waitcnt vmcnt(17) lgkmcnt(0)
s_barrier
M a[16:19],a[64:67],a[56:59],a[16:19]
ds_read_b128 a[48:51],v4 offset:0
M a[16:19],a[68:71],a[60:63],a[16:19]
ds_read_b128 a[52:55],v5 offset:0
M a[20:23],a[76:79],a[60:63],a[20:23]
s_add_u32 m0,s21,32768
M a[20:23],a[72:75],a[56:59],a[20:23]
buffer_load_dwordx4 v22,s[4:7],s23 offen sc1 lds
M a[24:27],a[80:83],a[56:59],a[24:27]
M a[24:27],a[84:87],a[60:63],a[24:27]
M a[28:31],a[92:95],a[60:63],a[28:31]
M a[28:31],a[88:91],a[56:59],a[28:31]
M a[32:35],a[96:99],a[56:59],a[32:35]
M a[32:35],a[100:103],a[60:63],a[32:35]
M a[36:39],a[108:111],a[60:63],a[36:39]
M a[36:39],a[104:107],a[56:59],a[36:39]
buffer_load_dwordx4 v23,s[4:7],s23 offen offset:1024 sc1 lds
M a[40:43],a[112:115],a[56:59],a[40:43]
M a[40:43],a[116:119],a[60:63],a[40:43]
s_sub_u32 s26,s26,1
M a[44:47],a[124:127],a[60:63],a[44:47]
s_cmp_eq_u32 s26,s43
M a[44:47],a[120:123],a[56:59],a[44:47]
s_cbranch_scc1 K1_XK0
K1_LOOP1_KQ:
s_waitcnt lgkmcnt(0)
M v[48:51],a[128:131],a[48:51],v[48:51]
ds_read_b128 a[56:59],v4 offset:2048
M v[48:51],a[132:135],a[52:55],v[48:51]
ds_read_b128 a[60:63],v5 offset:2048
M v[52:55],a[140:143],a[52:55],v[52:55]
ds_read_b64_tr_b16 a[64:65],v14 offset:0
M v[52:55],a[136:139],a[48:51],v[52:55]
buffer_load_dwordx4 v24,s[4:7],s23 offen offset:2048 sc1 lds
M v[56:59],a[144:147],a[48:51],v[56:59]
ds_read_b64_tr_b16 a[66:67],v14 offset:2048
M v[56:59],a[148:151],a[52:55],v[56:59]
M v[60:63],a[156:159],a[52:55],v[60:63]
ds_read_b64_tr_b16 a[72:73],v15 offset:0
M v[60:63],a[152:155],a[48:51],v[60:63]
M v[64:67],a[160:163],a[48:51],v[64:67]
ds_read_b64_tr_b16 a[74:75],v15 offset:2048
M v[64:67],a[164:167],a[52:55],v[64:67]
M v[68:71],a[172:175],a[52:55],v[68:71]
ds_read_b64_tr_b16 a[80:81],v16 offset:0
M v[68:71],a[168:171],a[48:51],v[68:71]
buffer_load_dwordx4 v25,s[4:7],s23 offen offset:3072 sc1 lds
M v[72:75],a[176:179],a[48:51],v[72:75]
ds_read_b64_tr_b16 a[82:83],v16 offset:2048
M v[72:75],a[180:183],a[52:55],v[72:75]
s_add_u32 s23,s23,128
M v[76:79],a[188:191],a[52:55],v[76:79]
M v[76:79],a[184:187],a[48:51],v[76:79]
s_waitcnt lgkmcnt(6)
M v[80:83],a[128:131],a[56:59],v[80:83]
ds_read_b128 a[48:51],v4 offset:4096
M v[80:83],a[132:135],a[60:63],v[80:83]
ds_read_b128 a[52:55],v5 offset:4096
s_add_u32 m0,s21,49152
M v[84:87],a[140:143],a[60:63],v[84:87]
ds_read_b64_tr_b16 a[88:89],v17 offset:0
M v[84:87],a[136:139],a[56:59],v[84:87]
buffer_load_dwordx4 v26,s[8:11],s24 offen sc1 lds
M v[88:91],a[144:147],a[56:59],v[88:91]
ds_read_b64_tr_b16 a[90:91],v17 offset:2048
M v[88:91],a[148:151],a[60:63],v[88:91]
M v[92:95],a[156:159],a[60:63],v[92:95]
ds_read_b64_tr_b16 a[96:97],v18 offset:0
M v[92:95],a[152:155],a[56:59],v[92:95]
M v[96:99],a[160:163],a[56:59],v[96:99]
ds_read_b64_tr_b16 a[98:99],v18 offset:2048
M v[96:99],a[164:167],a[60:63],v[96:99]
M v[100:103],a[172:175],a[60:63],v[100:103]
ds_read_b64_tr_b16 a[104:105],v19 offset:0
M v[100:103],a[168:171],a[56:59],v[100:103]
buffer_load_dwordx4 v27,s[8:11],s24 offen offset:1024 sc1 lds
M v[104:107],a[176:179],a[56:59],v[104:107]
ds_read_b64_tr_b16 a[106:107],v19 offset:2048
M v[104:107],a[180:183],a[60:63],v[104:107]
M v[108:111],a[188:191],a[60:63],v[108:111]
M v[108:111],a[184:187],a[56:59],v[108:111]
s_waitcnt lgkmcnt(6)
M v[112:115],a[128:131],a[48:51],v[112:115]
ds_read_b128 a[56:59],v4 offset:6144
M v[112:115],a[132:135],a[52:55],v[112:115]
ds_read_b128 a[60:63],v5 offset:6144
M v[116:119],a[140:143],a[52:55],v[116:119]
ds_read_b64_tr_b16 a[112:113],v20 offset:0
M v[116:119],a[136:139],a[48:51],v[116:119]
buffer_load_dwordx4 v28,s[8:11],s24 offen offset:2048 sc1 lds
M v[120:123],a[144:147],a[48:51],v[120:123]
ds_read_b64_tr_b16 a[114:115],v20 offset:2048
M v[120:123],a[148:151],a[52:55],v[120:123]
M v[124:127],a[156:159],a[52:55],v[124:127]
ds_read_b64_tr_b16 a[120:121],v21 offset:0
M v[124:127],a[152:155],a[48:51],v[124:127]
M v[128:131],a[160:163],a[48:51],v[128:131]
ds_read_b64_tr_b16 a[122:123],v21 offset:2048
M v[128:131],a[164:167],a[52:55],v[128:131]
M v[132:135],a[172:175],a[52:55],v[132:135]
M v[132:135],a[168:171],a[48:51],v[132:135]
buffer_load_dwordx4 v29,s[8:11],s24 offen offset:3072 sc1 lds
M v[136:139],a[176:179],a[48:51],v[136:139]
s_add_u32 s24,s24,s25
M v[136:139],a[180:183],a[52:55],v[136:139]
s_cmp_eq_u32 s26,2
M v[140:143],a[188:191],a[52:55],v[140:143]
s_cbranch_scc1 HSUB_X_KQ1
HSUB_X_KQ1_R:
M v[140:143],a[184:187],a[48:51],v[140:143]
s_waitcnt vmcnt(17) lgkmcnt(0)
s_barrier
M v[144:147],a[128:131],a[56:59],v[144:147]
ds_read_b128 a[48:51],v4 offset:32768
M v[144:147],a[132:135],a[60:63],v[144:147]
ds_read_b128 a[52:55],v5 offset:32768
s_add_u32 m0,s21,65536
M v[148:151],a[140:143],a[60:63],v[148:151]
ds_read_b64_tr_b16 a[68:69],v14 offset:32768
M v[148:151],a[136:139],a[56:59],v[148:151]
buffer_load_dwordx4 v22,s[4:7],s22 offen sc1 lds
M v[152:155],a[144:147],a[56:59],v[152:155]
ds_read_b64_tr_b16 a[70:71],v14 offset:34816
M v[152:155],a[148:151],a[60:63],v[152:155]
M v[156:159],a[156:159],a[60:63],v[156:159]
ds_read_b64_tr_b16 a[76:77],v15 offset:32768
M v[156:159],a[152:155],a[56:59],v[156:159]
M v[160:163],a[160:163],a[56:59],v[160:163]
ds_read_b64_tr_b16 a[78:79],v15 offset:34816
M v[160:163],a[164:167],a[60:63],v[160:163]
M v[164:167],a[172:175],a[60:63],v[164:167]
ds_read_b64_tr_b16 a[84:85],v16 offset:32768
M v[164:167],a[168:171],a[56:59],v[164:167]
buffer_load_dwordx4 v23,s[4:7],s22 offen offset:1024 sc1 lds
M v[168:171],a[176:179],a[56:59],v[168:171]
M v[168:171],a[180:183],a[60:63],v[168:171]
s_cmp_eq_u32 s26,s78
M v[172:175],a[188:191],a[60:63],v[172:175]
s_cbranch_scc1 HSUB_S_KQ1
HSUB_S_KQ1_R:
M v[172:175],a[184:187],a[56:59],v[172:175]
s_waitcnt lgkmcnt(5)
M v[176:179],a[128:131],a[48:51],v[176:179]
ds_read_b128 a[56:59],v4 offset:34816
M v[176:179],a[132:135],a[52:55],v[176:179]
ds_read_b128 a[60:63],v5 offset:34816
M v[180:183],a[140:143],a[52:55],v[180:183]
ds_read_b64_tr_b16 a[86:87],v16 offset:34816
M v[180:183],a[136:139],a[48:51],v[180:183]
buffer_load_dwordx4 v24,s[4:7],s22 offen offset:2048 sc1 lds
M v[184:187],a[144:147],a[48:51],v[184:187]
ds_read_b64_tr_b16 a[92:93],v17 offset:32768
M v[184:187],a[148:151],a[52:55],v[184:187]
M v[188:191],a[156:159],a[52:55],v[188:191]
ds_read_b64_tr_b16 a[94:95],v17 offset:34816
M v[188:191],a[152:155],a[48:51],v[188:191]
M v[192:195],a[160:163],a[48:51],v[192:195]
ds_read_b64_tr_b16 a[100:101],v18 offset:32768
M v[192:195],a[164:167],a[52:55],v[192:195]
M v[196:199],a[172:175],a[52:55],v[196:199]
ds_read_b64_tr_b16 a[102:103],v18 offset:34816
M v[196:199],a[168:171],a[48:51],v[196:199]
buffer_load_dwordx4 v25,s[4:7],s22 offen offset:3072 sc1 lds
M v[200:203],a[176:179],a[48:51],v[200:203]
s_add_u32 s22,s22,128
M v[200:203],a[180:183],a[52:55],v[200:203]
s_cmp_eq_u32 s26,3
M v[204:207],a[188:191],a[52:55],v[204:207]
s_cbranch_scc1 HSUB_W_KQ1
HSUB_W_KQ1_R:
M v[204:207],a[184:187],a[48:51],v[204:207]
s_waitcnt lgkmcnt(5)
M v[208:211],a[128:131],a[56:59],v[208:211]
ds_read_b128 a[48:51],v4 offset:36864
M v[208:211],a[132:135],a[60:63],v[208:211]
ds_read_b128 a[52:55],v5 offset:36864
s_add_u32 m0,s21,81920
M v[212:215],a[140:143],a[60:63],v[212:215]
ds_read_b64_tr_b16 a[108:109],v19 offset:32768
M v[212:215],a[136:139],a[56:59],v[212:215]
buffer_load_dwordx4 v26,s[8:11],s24 offen sc1 lds
M v[216:219],a[144:147],a[56:59],v[216:219]
ds_read_b64_tr_b16 a[110:111],v19 offset:34816
M v[216:219],a[148:151],a[60:63],v[216:219]
M v[220:223],a[156:159],a[60:63],v[220:223]
ds_read_b64_tr_b16 a[116:117],v20 offset:32768
M v[220:223],a[152:155],a[56:59],v[220:223]
M v[224:227],a[160:163],a[56:59],v[224:227]
ds_read_b64_tr_b16 a[118:119],v20 offset:34816
M v[224:227],a[164:167],a[60:63],v[224:227]
M v[228:231],a[172:175],a[60:63],v[228:231]
M v[228:231],a[168:171],a[56:59],v[228:231]
buffer_load_dwordx4 v27,s[8:11],s24 offen offset:1024 sc1 lds
M v[232:235],a[176:179],a[56:59],v[232:235]
M v[232:235],a[180:183],a[60:63],v[232:235]
s_cmp_lg_u32 s29,0
M v[236:239],a[188:191],a[60:63],v[236:239]
buffer_load_dword v1,v37,s[64:67],0 offen
s_cbranch_scc1 HSUB_PF_KQ1
HSUB_PF_KQ1_R:
M v[236:239],a[184:187],a[56:59],v[236:239]
s_waitcnt lgkmcnt(4)
M v[240:243],a[128:131],a[48:51],v[240:243]
ds_read_b128 a[56:59],v4 offset:38912
M v[240:243],a[132:135],a[52:55],v[240:243]
ds_read_b128 a[60:63],v5 offset:38912
M v[244:247],a[140:143],a[52:55],v[244:247]
ds_read_b64_tr_b16 a[124:125],v21 offset:32768
M v[244:247],a[136:139],a[48:51],v[244:247]
buffer_load_dwordx4 v28,s[8:11],s24 offen offset:2048 sc1 lds
M v[248:251],a[144:147],a[48:51],v[248:251]
ds_read_b64_tr_b16 a[126:127],v21 offset:34816
M v[248:251],a[148:151],a[52:55],v[248:251]
M v[252:255],a[156:159],a[52:55],v[252:255]
M v[252:255],a[152:155],a[48:51],v[252:255]
M a[0:3],a[160:163],a[48:51],a[0:3]
M a[0:3],a[164:167],a[52:55],a[0:3]
M a[4:7],a[172:175],a[52:55],a[4:7]
M a[4:7],a[168:171],a[48:51],a[4:7]
buffer_load_dwordx4 v29,s[8:11],s24 offen offset:3072 sc1 lds
M a[8:11],a[176:179],a[48:51],a[8:11]
s_add_u32 s24,s24,s25
M a[8:11],a[180:183],a[52:55],a[8:11]
M a[12:15],a[188:191],a[52:55],a[12:15]
M a[12:15],a[184:187],a[48:51],a[12:15]
s_waitcnt vmcnt(17) lgkmcnt(0)
s_barrier
M a[16:19],a[128:131],a[56:59],a[16:19]
ds_read_b128 a[48:51],v2 offset:0
M a[16:19],a[132:135],a[60:63],a[16:19]
ds_read_b128 a[52:55],v3 offset:0
M a[20:23],a[140:143],a[60:63],a[20:23]
s_add_u32 m0,s21,98304
M a[20:23],a[136:139],a[56:59],a[20:23]
buffer_load_dwordx4 v22,s[4:7],s23 offen sc1 lds
M a[24:27],a[144:147],a[56:59],a[24:27]
M a[24:27],a[148:151],a[60:63],a[24:27]
M a[28:31],a[156:159],a[60:63],a[28:31]
M a[28:31],a[152:155],a[56:59],a[28:31]
M a[32:35],a[160:163],a[56:59],a[32:35]
M a[32:35],a[164:167],a[60:63],a[32:35]
M a[36:39],a[172:175],a[60:63],a[36:39]
M a[36:39],a[168:171],a[56:59],a[36:39]
buffer_load_dwordx4 v23,s[4:7],s23 offen offset:1024 sc1 lds
M a[40:43],a[176:179],a[56:59],a[40:43]
M a[40:43],a[180:183],a[60:63],a[40:43]
s_sub_u32 s26,s26,1
M a[44:47],a[188:191],a[60:63],a[44:47]
s_cmp_eq_u32 s26,s43
M a[44:47],a[184:187],a[56:59],a[44:47]
s_cbranch_scc0 K1_LOOP_KQ
s_cmp_eq_u32 s53,4
s_cbranch_scc0 K1_XK1
s_waitcnt lgkmcnt(0)
M v[48:51],a[64:67],a[48:51],v[48:51]
ds_read_b128 a[56:59],v2 offset:2048
M v[48:51],a[68:71],a[52:55],v[48:51]
ds_read_b128 a[60:63],v3 offset:2048
M v[52:55],a[76:79],a[52:55],v[52:55]
ds_read_b64_tr_b16 a[128:129],v6 offset:0
M v[52:55],a[72:75],a[48:51],v[52:55]
buffer_load_dwordx4 v24,s[4:7],s23 offen offset:2048 sc1 lds
M v[56:59],a[80:83],a[48:51],v[56:59]
ds_read_b64_tr_b16 a[130:131],v6 offset:2048
M v[56:59],a[84:87],a[52:55],v[56:59]
s_lshl_b32 s31,s35,7
s_add_u32 s31,s31,136314880
M v[60:63],a[92:95],a[52:55],v[60:63]
ds_read_b64_tr_b16 a[136:137],v7 offset:0
M v[60:63],a[88:91],a[48:51],v[60:63]
buffer_load_dword v41,v40,s[12:15],s31 offen sc1
M v[64:67],a[96:99],a[48:51],v[64:67]
ds_read_b64_tr_b16 a[138:139],v7 offset:2048
M v[64:67],a[100:103],a[52:55],v[64:67]
M v[68:71],a[108:111],a[52:55],v[68:71]
ds_read_b64_tr_b16 a[144:145],v8 offset:0
M v[68:71],a[104:107],a[48:51],v[68:71]
buffer_load_dwordx4 v25,s[4:7],s23 offen offset:3072 sc1 lds
M v[72:75],a[112:115],a[48:51],v[72:75]
ds_read_b64_tr_b16 a[146:147],v8 offset:2048
M v[72:75],a[116:119],a[52:55],v[72:75]
s_add_u32 s23,s23,128
M v[76:79],a[124:127],a[52:55],v[76:79]
M v[76:79],a[120:123],a[48:51],v[76:79]
s_waitcnt lgkmcnt(6)
M v[80:83],a[64:67],a[56:59],v[80:83]
ds_read_b128 a[48:51],v2 offset:4096
M v[80:83],a[68:71],a[60:63],v[80:83]
ds_read_b128 a[52:55],v3 offset:4096
s_add_u32 m0,s21,114688
M v[84:87],a[76:79],a[60:63],v[84:87]
ds_read_b64_tr_b16 a[152:153],v9 offset:0
M v[84:87],a[72:75],a[56:59],v[84:87]
buffer_load_dwordx4 v26,s[8:11],s24 offen sc1 lds
M v[88:91],a[80:83],a[56:59],v[88:91]
ds_read_b64_tr_b16 a[154:155],v9 offset:2048
M v[88:91],a[84:87],a[60:63],v[88:91]
M v[92:95],a[92:95],a[60:63],v[92:95]
ds_read_b64_tr_b16 a[160:161],v10 offset:0
M v[92:95],a[88:91],a[56:59],v[92:95]
M v[96:99],a[96:99],a[56:59],v[96:99]
ds_read_b64_tr_b16 a[162:163],v10 offset:2048
M v[96:99],a[100:103],a[60:63],v[96:99]
M v[100:103],a[108:111],a[60:63],v[100:103]
ds_read_b64_tr_b16 a[168:169],v11 offset:0
M v[100:103],a[104:107],a[56:59],v[100:103]
buffer_load_dwordx4 v27,s[8:11],s24 offen offset:1024 sc1 lds
M v[104:107],a[112:115],a[56:59],v[104:107]
ds_read_b64_tr_b16 a[170:171],v11 offset:2048
M v[104:107],a[116:119],a[60:63],v[104:107]
M v[108:111],a[124:127],a[60:63],v[108:111]
M v[108:111],a[120:123],a[56:59],v[108:111]
s_waitcnt lgkmcnt(6)
M v[112:115],a[64:67],a[48:51],v[112:115]
ds_read_b128 a[56:59],v2 offset:6144
M v[112:115],a[68:71],a[52:55],v[112:115]
ds_read_b128 a[60:63],v3 offset:6144
M v[116:119],a[76:79],a[52:55],v[116:119]
ds_read_b64_tr_b16 a[176:177],v12 offset:0
M v[116:119],a[72:75],a[48:51],v[116:119]
buffer_load_dwordx4 v28,s[8:11],s24 offen offset:2048 sc1 lds
M v[120:123],a[80:83],a[48:51],v[120:123]
ds_read_b64_tr_b16 a[178:179],v12 offset:2048
M v[120:123],a[84:87],a[52:55],v[120:123]
M v[124:127],a[92:95],a[52:55],v[124:127]
ds_read_b64_tr_b16 a[184:185],v13 offset:0
M v[124:127],a[88:91],a[48:51],v[124:127]
M v[128:131],a[96:99],a[48:51],v[128:131]
ds_read_b64_tr_b16 a[186:187],v13 offset:2048
M v[128:131],a[100:103],a[52:55],v[128:131]
M v[132:135],a[108:111],a[52:55],v[132:135]
M v[132:135],a[104:107],a[48:51],v[132:135]
buffer_load_dwordx4 v29,s[8:11],s24 offen offset:3072 sc1 lds
M v[136:139],a[112:115],a[48:51],v[136:139]
s_add_u32 s24,s24,s25
M v[136:139],a[116:119],a[52:55],v[136:139]
M v[140:143],a[124:127],a[52:55],v[140:143]
M v[140:143],a[120:123],a[48:51],v[140:143]
s_waitcnt vmcnt(18) lgkmcnt(0)
s_barrier
M v[144:147],a[64:67],a[56:59],v[144:147]
ds_read_b128 a[48:51],v2 offset:32768
M v[144:147],a[68:71],a[60:63],v[144:147]
ds_read_b128 a[52:55],v3 offset:32768
s_add_u32 m0,s21,0
M v[148:151],a[76:79],a[60:63],v[148:151]
ds_read_b64_tr_b16 a[132:133],v6 offset:32768
M v[148:151],a[72:75],a[56:59],v[148:151]
buffer_load_dwordx4 v22,s[4:7],s22 offen sc1 lds
M v[152:155],a[80:83],a[56:59],v[152:155]
ds_read_b64_tr_b16 a[134:135],v6 offset:34816
M v[152:155],a[84:87],a[60:63],v[152:155]
M v[156:159],a[92:95],a[60:63],v[156:159]
ds_read_b64_tr_b16 a[140:141],v7 offset:32768
M v[156:159],a[88:91],a[56:59],v[156:159]
M v[160:163],a[96:99],a[56:59],v[160:163]
ds_read_b64_tr_b16 a[142:143],v7 offset:34816
M v[160:163],a[100:103],a[60:63],v[160:163]
M v[164:167],a[108:111],a[60:63],v[164:167]
ds_read_b64_tr_b16 a[148:149],v8 offset:32768
M v[164:167],a[104:107],a[56:59],v[164:167]
buffer_load_dwordx4 v23,s[4:7],s22 offen offset:1024 sc1 lds
M v[168:171],a[112:115],a[56:59],v[168:171]
M v[168:171],a[116:119],a[60:63],v[168:171]
M v[172:175],a[124:127],a[60:63],v[172:175]
M v[172:175],a[120:123],a[56:59],v[172:175]
s_waitcnt lgkmcnt(5)
M v[176:179],a[64:67],a[48:51],v[176:179]
ds_read_b128 a[56:59],v2 offset:34816
M v[176:179],a[68:71],a[52:55],v[176:179]
ds_read_b128 a[60:63],v3 offset:34816
M v[180:183],a[76:79],a[52:55],v[180:183]
ds_read_b64_tr_b16 a[150:151],v8 offset:34816
M v[180:183],a[72:75],a[48:51],v[180:183]
buffer_load_dwordx4 v24,s[4:7],s22 offen offset:2048 sc1 lds
M v[184:187],a[80:83],a[48:51],v[184:187]
ds_read_b64_tr_b16 a[156:157],v9 offset:32768
M v[184:187],a[84:87],a[52:55],v[184:187]
M v[188:191],a[92:95],a[52:55],v[188:191]
ds_read_b64_tr_b16 a[158:159],v9 offset:34816
M v[188:191],a[88:91],a[48:51],v[188:191]
M v[192:195],a[96:99],a[48:51],v[192:195]
ds_read_b64_tr_b16 a[164:165],v10 offset:32768
M v[192:195],a[100:103],a[52:55],v[192:195]
M v[196:199],a[108:111],a[52:55],v[196:199]
ds_read_b64_tr_b16 a[166:167],v10 offset:34816
M v[196:199],a[104:107],a[48:51],v[196:199]
buffer_load_dwordx4 v25,s[4:7],s22 offen offset:3072 sc1 lds
M v[200:203],a[112:115],a[48:51],v[200:203]
s_add_u32 s22,s22,128
M v[200:203],a[116:119],a[52:55],v[200:203]
M v[204:207],a[124:127],a[52:55],v[204:207]
M v[204:207],a[120:123],a[48:51],v[204:207]
s_waitcnt lgkmcnt(5)
M v[208:211],a[64:67],a[56:59],v[208:211]
ds_read_b128 a[48:51],v2 offset:36864
M v[208:211],a[68:71],a[60:63],v[208:211]
ds_read_b128 a[52:55],v3 offset:36864
s_add_u32 m0,s21,16384
M v[212:215],a[76:79],a[60:63],v[212:215]
ds_read_b64_tr_b16 a[172:173],v11 offset:32768
M v[212:215],a[72:75],a[56:59],v[212:215]
M v[216:219],a[80:83],a[56:59],v[216:219]
ds_read_b64_tr_b16 a[174:175],v11 offset:34816
M v[216:219],a[84:87],a[60:63],v[216:219]
M v[220:223],a[92:95],a[60:63],v[220:223]
ds_read_b64_tr_b16 a[180:181],v12 offset:32768
M v[220:223],a[88:91],a[56:59],v[220:223]
M v[224:227],a[96:99],a[56:59],v[224:227]
ds_read_b64_tr_b16 a[182:183],v12 offset:34816
M v[224:227],a[100:103],a[60:63],v[224:227]
s_lshl_b32 s30,s35,20
s_lshl_b32 s31,s75,15
M v[228:231],a[108:111],a[60:63],v[228:231]
s_add_u32 s44,s30,s31
s_lshl_b32 s30,s35,7
M v[228:231],a[104:107],a[56:59],v[228:231]
s_lshl_b32 s31,s74,3
s_add_u32 s30,s30,s31
M v[232:235],a[112:115],a[56:59],v[232:235]
s_add_u32 s30,s30,s20
s_lshl_b32 s62,s30,13
M v[232:235],a[116:119],a[60:63],v[232:235]
M v[236:239],a[124:127],a[60:63],v[236:239]
buffer_load_dword v1,v37,s[64:67],0 offen
M v[236:239],a[120:123],a[56:59],v[236:239]
s_waitcnt lgkmcnt(4)
M v[240:243],a[64:67],a[48:51],v[240:243]
ds_read_b128 a[56:59],v2 offset:38912
M v[240:243],a[68:71],a[52:55],v[240:243]
ds_read_b128 a[60:63],v3 offset:38912
M v[244:247],a[76:79],a[52:55],v[244:247]
ds_read_b64_tr_b16 a[188:189],v13 offset:32768
M v[244:247],a[72:75],a[48:51],v[244:247]
M v[248:251],a[80:83],a[48:51],v[248:251]
ds_read_b64_tr_b16 a[190:191],v13 offset:34816
M v[248:251],a[84:87],a[52:55],v[248:251]
M v[252:255],a[92:95],a[52:55],v[252:255]
M v[252:255],a[88:91],a[48:51],v[252:255]
M a[0:3],a[96:99],a[48:51],a[0:3]
M a[0:3],a[100:103],a[52:55],a[0:3]
M a[4:7],a[108:111],a[52:55],a[4:7]
M a[4:7],a[104:107],a[48:51],a[4:7]
M a[8:11],a[112:115],a[48:51],a[8:11]
s_add_u32 s24,s24,s25
M a[8:11],a[116:119],a[52:55],a[8:11]
M a[12:15],a[124:127],a[52:55],a[12:15]
M a[12:15],a[120:123],a[48:51],a[12:15]
s_waitcnt vmcnt(10) lgkmcnt(0)
s_barrier
M a[16:19],a[64:67],a[56:59],a[16:19]
ds_read_b128 a[48:51],v4 offset:0
M a[16:19],a[68:71],a[60:63],a[16:19]
ds_read_b128 a[52:55],v5 offset:0
M a[20:23],a[76:79],a[60:63],a[20:23]
s_add_u32 m0,s21,32768
M a[20:23],a[72:75],a[56:59],a[20:23]
buffer_load_dwordx4 v22,s[4:7],s23 offen sc1 lds
M a[24:27],a[80:83],a[56:59],a[24:27]
M a[24:27],a[84:87],a[60:63],a[24:27]
v_cmp_ne_u32 vcc,0,v41
s_mov_b32 s33,0xf80f0f
M a[28:31],a[92:95],a[60:63],a[28:31]
M a[28:31],a[88:91],a[56:59],a[28:31]
s_and_b32 s30,vcc_lo,s33
M a[32:35],a[96:99],a[56:59],a[32:35]
s_cmp_eq_u32 s30,s33
s_cbranch_scc0 TLC_KQ
TLC_KQR:
M a[32:35],a[100:103],a[60:63],a[32:35]
M a[36:39],a[108:111],a[60:63],a[36:39]
M a[36:39],a[104:107],a[56:59],a[36:39]
buffer_load_dwordx4 v23,s[4:7],s23 offen offset:1024 sc1 lds
M a[40:43],a[112:115],a[56:59],a[40:43]
M a[40:43],a[116:119],a[60:63],a[40:43]
s_sub_u32 s26,s26,1
s_add_u32 s31,s62,0
M a[44:47],a[124:127],a[60:63],a[44:47]
s_cmp_eq_u32 s26,s43
buffer_load_dwordx4 a[192:195],v36,s[12:15],s31 offen sc1
M a[44:47],a[120:123],a[56:59],a[44:47]
s_waitcnt lgkmcnt(0)
M v[48:51],a[128:131],a[48:51],v[48:51]
ds_read_b128 a[56:59],v4 offset:2048
M v[48:51],a[132:135],a[52:55],v[48:51]
ds_read_b128 a[60:63],v5 offset:2048
M v[52:55],a[140:143],a[52:55],v[52:55]
ds_read_b64_tr_b16 a[64:65],v14 offset:0
M v[52:55],a[136:139],a[48:51],v[52:55]
buffer_load_dwordx4 v24,s[4:7],s23 offen offset:2048 sc1 lds
M v[56:59],a[144:147],a[48:51],v[56:59]
ds_read_b64_tr_b16 a[66:67],v14 offset:2048
M v[56:59],a[148:151],a[52:55],v[56:59]
M v[60:63],a[156:159],a[52:55],v[60:63]
ds_read_b64_tr_b16 a[72:73],v15 offset:0
M v[60:63],a[152:155],a[48:51],v[60:63]
buffer_load_dwordx4 a[196:199],v36,s[12:15],s31 offen offset:1024 sc1
M v[64:67],a[160:163],a[48:51],v[64:67]
ds_read_b64_tr_b16 a[74:75],v15 offset:2048
M v[64:67],a[164:167],a[52:55],v[64:67]
M v[68:71],a[172:175],a[52:55],v[68:71]
ds_read_b64_tr_b16 a[80:81],v16 offset:0
M v[68:71],a[168:171],a[48:51],v[68:71]
buffer_load_dwordx4 v25,s[4:7],s23 offen offset:3072 sc1 lds
M v[72:75],a[176:179],a[48:51],v[72:75]
ds_read_b64_tr_b16 a[82:83],v16 offset:2048
M v[72:75],a[180:183],a[52:55],v[72:75]
s_add_u32 s23,s23,128
M v[76:79],a[188:191],a[52:55],v[76:79]
M v[76:79],a[184:187],a[48:51],v[76:79]
s_waitcnt lgkmcnt(6)
M v[80:83],a[128:131],a[56:59],v[80:83]
ds_read_b128 a[48:51],v4 offset:4096
M v[80:83],a[132:135],a[60:63],v[80:83]
ds_read_b128 a[52:55],v5 offset:4096
s_add_u32 m0,s21,49152
M v[84:87],a[140:143],a[60:63],v[84:87]
ds_read_b64_tr_b16 a[88:89],v17 offset:0
M v[84:87],a[136:139],a[56:59],v[84:87]
buffer_load_dwordx4 a[200:203],v36,s[12:15],s31 offen offset:2048 sc1
M v[88:91],a[144:147],a[56:59],v[88:91]
ds_read_b64_tr_b16 a[90:91],v17 offset:2048
M v[88:91],a[148:151],a[60:63],v[88:91]
M v[92:95],a[156:159],a[60:63],v[92:95]
ds_read_b64_tr_b16 a[96:97],v18 offset:0
M v[92:95],a[152:155],a[56:59],v[92:95]
M v[96:99],a[160:163],a[56:59],v[96:99]
ds_read_b64_tr_b16 a[98:99],v18 offset:2048
buffer_load_dwordx4 a[204:207],v36,s[12:15],s31 offen offset:3072 sc1
M v[96:99],a[164:167],a[60:63],v[96:99]
M v[100:103],a[172:175],a[60:63],v[100:103]
ds_read_b64_tr_b16 a[104:105],v19 offset:0
M v[100:103],a[168:171],a[56:59],v[100:103]
M v[104:107],a[176:179],a[56:59],v[104:107]
ds_read_b64_tr_b16 a[106:107],v19 offset:2048
s_mov_b64 s[8:9],s[12:13]
s_mov_b32 s10,138412032
s_add_u32 s31,s62,4096
M v[104:107],a[180:183],a[60:63],v[104:107]
s_mov_b32 s25,32768
v_add_u32 v26,s21,v36
buffer_load_dwordx4 a[208:211],v36,s[12:15],s31 offen sc1
M v[108:111],a[188:191],a[60:63],v[108:111]
v_add_u32 v27,s21,v36
v_add_u32 v28,s21,v36
M v[108:111],a[184:187],a[56:59],v[108:111]
v_add_u32 v29,s21,v36
s_waitcnt lgkmcnt(6)
M v[112:115],a[128:131],a[48:51],v[112:115]
ds_read_b128 a[56:59],v4 offset:6144
M v[112:115],a[132:135],a[52:55],v[112:115]
ds_read_b128 a[60:63],v5 offset:6144
M v[116:119],a[140:143],a[52:55],v[116:119]
ds_read_b64_tr_b16 a[112:113],v20 offset:0
M v[116:119],a[136:139],a[48:51],v[116:119]
buffer_load_dwordx4 a[212:215],v36,s[12:15],s31 offen offset:1024 sc1
M v[120:123],a[144:147],a[48:51],v[120:123]
ds_read_b64_tr_b16 a[114:115],v20 offset:2048
M v[120:123],a[148:151],a[52:55],v[120:123]
M v[124:127],a[156:159],a[52:55],v[124:127]
ds_read_b64_tr_b16 a[120:121],v21 offset:0
M v[124:127],a[152:155],a[48:51],v[124:127]
M v[128:131],a[160:163],a[48:51],v[128:131]
ds_read_b64_tr_b16 a[122:123],v21 offset:2048
buffer_load_dwordx4 a[216:219],v36,s[12:15],s31 offen offset:2048 sc1
M v[128:131],a[164:167],a[52:55],v[128:131]
s_mov_b64 s[4:5],s[12:13]
s_mov_b32 s6,138412032
M v[132:135],a[172:175],a[52:55],v[132:135]
v_add_u32 v22,s21,v36
v_add_u32 v23,s21,v36
M v[132:135],a[168:171],a[48:51],v[132:135]
v_add_u32 v24,s21,v36
v_add_u32_e64 v25,s21,v36
M v[136:139],a[176:179],a[48:51],v[136:139]
s_add_u32 s24,s24,s25
M v[136:139],a[180:183],a[52:55],v[136:139]
s_add_u32 s22,s44,16777216
s_add_u32 s23,s44,16809984
M v[140:143],a[188:191],a[52:55],v[140:143]
s_add_u32 s24,s44,16793600
buffer_load_dwordx4 a[220:223],v36,s[12:15],s31 offen offset:3072 sc1
M v[140:143],a[184:187],a[48:51],v[140:143]
s_waitcnt vmcnt(17) lgkmcnt(0)
s_barrier
M v[144:147],a[128:131],a[56:59],v[144:147]
ds_read_b128 a[48:51],v4 offset:32768
M v[144:147],a[132:135],a[60:63],v[144:147]
ds_read_b128 a[52:55],v5 offset:32768
s_add_u32 m0,s21,65536
M v[148:151],a[140:143],a[60:63],v[148:151]
ds_read_b64_tr_b16 a[68:69],v14 offset:32768
M v[148:151],a[136:139],a[56:59],v[148:151]
buffer_load_dwordx4 v22,s[4:7],s22 offen sc1 lds
M v[152:155],a[144:147],a[56:59],v[152:155]
ds_read_b64_tr_b16 a[70:71],v14 offset:34816
M v[152:155],a[148:151],a[60:63],v[152:155]
M v[156:159],a[156:159],a[60:63],v[156:159]
ds_read_b64_tr_b16 a[76:77],v15 offset:32768
s_add_u32 s31,s62,32768
M v[156:159],a[152:155],a[56:59],v[156:159]
buffer_load_dwordx4 a[224:227],v36,s[12:15],s31 offen sc1
M v[160:163],a[160:163],a[56:59],v[160:163]
ds_read_b64_tr_b16 a[78:79],v15 offset:34816
M v[160:163],a[164:167],a[60:63],v[160:163]
M v[164:167],a[172:175],a[60:63],v[164:167]
ds_read_b64_tr_b16 a[84:85],v16 offset:32768
M v[164:167],a[168:171],a[56:59],v[164:167]
buffer_load_dwordx4 v23,s[4:7],s22 offen offset:1024 sc1 lds
M v[168:171],a[176:179],a[56:59],v[168:171]
M v[168:171],a[180:183],a[60:63],v[168:171]
M v[172:175],a[188:191],a[60:63],v[172:175]
M v[172:175],a[184:187],a[56:59],v[172:175]
s_waitcnt lgkmcnt(5)
M v[176:179],a[128:131],a[48:51],v[176:179]
ds_read_b128 a[56:59],v4 offset:34816
M v[176:179],a[132:135],a[52:55],v[176:179]
ds_read_b128 a[60:63],v5 offset:34816
M v[180:183],a[140:143],a[52:55],v[180:183]
ds_read_b64_tr_b16 a[86:87],v16 offset:34816
M v[180:183],a[136:139],a[48:51],v[180:183]
buffer_load_dwordx4 v24,s[4:7],s22 offen offset:2048 sc1 lds
M v[184:187],a[144:147],a[48:51],v[184:187]
ds_read_b64_tr_b16 a[92:93],v17 offset:32768
M v[184:187],a[148:151],a[52:55],v[184:187]
M v[188:191],a[156:159],a[52:55],v[188:191]
ds_read_b64_tr_b16 a[94:95],v17 offset:34816
M v[188:191],a[152:155],a[48:51],v[188:191]
buffer_load_dwordx4 a[228:231],v36,s[12:15],s31 offen offset:1024 sc1
M v[192:195],a[160:163],a[48:51],v[192:195]
ds_read_b64_tr_b16 a[100:101],v18 offset:32768
M v[192:195],a[164:167],a[52:55],v[192:195]
M v[196:199],a[172:175],a[52:55],v[196:199]
ds_read_b64_tr_b16 a[102:103],v18 offset:34816
M v[196:199],a[168:171],a[48:51],v[196:199]
buffer_load_dwordx4 v25,s[4:7],s22 offen offset:3072 sc1 lds
M v[200:203],a[176:179],a[48:51],v[200:203]
s_add_u32 s22,s22,128
M v[200:203],a[180:183],a[52:55],v[200:203]
M v[204:207],a[188:191],a[52:55],v[204:207]
M v[204:207],a[184:187],a[48:51],v[204:207]
s_waitcnt lgkmcnt(5)
M v[208:211],a[128:131],a[56:59],v[208:211]
ds_read_b128 a[48:51],v4 offset:36864
M v[208:211],a[132:135],a[60:63],v[208:211]
ds_read_b128 a[52:55],v5 offset:36864
s_add_u32 m0,s21,81920
M v[212:215],a[140:143],a[60:63],v[212:215]
ds_read_b64_tr_b16 a[108:109],v19 offset:32768
M v[212:215],a[136:139],a[56:59],v[212:215]
buffer_load_dwordx4 v26,s[8:11],s24 offen sc1 lds
M v[216:219],a[144:147],a[56:59],v[216:219]
ds_read_b64_tr_b16 a[110:111],v19 offset:34816
M v[216:219],a[148:151],a[60:63],v[216:219]
M v[220:223],a[156:159],a[60:63],v[220:223]
ds_read_b64_tr_b16 a[116:117],v20 offset:32768
M v[220:223],a[152:155],a[56:59],v[220:223]
buffer_load_dwordx4 a[232:235],v36,s[12:15],s31 offen offset:2048 sc1
M v[224:227],a[160:163],a[56:59],v[224:227]
ds_read_b64_tr_b16 a[118:119],v20 offset:34816
M v[224:227],a[164:167],a[60:63],v[224:227]
M v[228:231],a[172:175],a[60:63],v[228:231]
M v[228:231],a[168:171],a[56:59],v[228:231]
buffer_load_dwordx4 v27,s[8:11],s24 offen offset:1024 sc1 lds
M v[232:235],a[176:179],a[56:59],v[232:235]
M v[232:235],a[180:183],a[60:63],v[232:235]
M v[236:239],a[188:191],a[60:63],v[236:239]
buffer_load_dword v1,v37,s[64:67],0 offen
M v[236:239],a[184:187],a[56:59],v[236:239]
s_waitcnt lgkmcnt(4)
M v[240:243],a[128:131],a[48:51],v[240:243]
ds_read_b128 a[56:59],v4 offset:38912
M v[240:243],a[132:135],a[52:55],v[240:243]
ds_read_b128 a[60:63],v5 offset:38912
M v[244:247],a[140:143],a[52:55],v[244:247]
ds_read_b64_tr_b16 a[124:125],v21 offset:32768
M v[244:247],a[136:139],a[48:51],v[244:247]
buffer_load_dwordx4 v28,s[8:11],s24 offen offset:2048 sc1 lds
M v[248:251],a[144:147],a[48:51],v[248:251]
ds_read_b64_tr_b16 a[126:127],v21 offset:34816
M v[248:251],a[148:151],a[52:55],v[248:251]
M v[252:255],a[156:159],a[52:55],v[252:255]
M v[252:255],a[152:155],a[48:51],v[252:255]
buffer_load_dwordx4 a[236:239],v36,s[12:15],s31 offen offset:3072 sc1
M a[0:3],a[160:163],a[48:51],a[0:3]
M a[0:3],a[164:167],a[52:55],a[0:3]
M a[4:7],a[172:175],a[52:55],a[4:7]
M a[4:7],a[168:171],a[48:51],a[4:7]
buffer_load_dwordx4 v29,s[8:11],s24 offen offset:3072 sc1 lds
M a[8:11],a[176:179],a[48:51],a[8:11]
s_add_u32 s24,s24,s25
M a[8:11],a[180:183],a[52:55],a[8:11]
M a[12:15],a[188:191],a[52:55],a[12:15]
M a[12:15],a[184:187],a[48:51],a[12:15]
s_waitcnt vmcnt(26) lgkmcnt(0)
s_barrier
M a[16:19],a[128:131],a[56:59],a[16:19]
ds_read_b128 a[48:51],v2 offset:0
M a[16:19],a[132:135],a[60:63],a[16:19]
ds_read_b128 a[52:55],v3 offset:0
M a[20:23],a[140:143],a[60:63],a[20:23]
s_add_u32 m0,s21,98304
M a[20:23],a[136:139],a[56:59],a[20:23]
buffer_load_dwordx4 v22,s[4:7],s23 offen sc1 lds
M a[24:27],a[144:147],a[56:59],a[24:27]
M a[24:27],a[148:151],a[60:63],a[24:27]
M a[28:31],a[156:159],a[60:63],a[28:31]
s_add_u32 s31,s62,36864
M a[28:31],a[152:155],a[56:59],a[28:31]
buffer_load_dwordx4 a[240:243],v36,s[12:15],s31 offen sc1
M a[32:35],a[160:163],a[56:59],a[32:35]
M a[32:35],a[164:167],a[60:63],a[32:35]
M a[36:39],a[172:175],a[60:63],a[36:39]
M a[36:39],a[168:171],a[56:59],a[36:39]
buffer_load_dwordx4 v23,s[4:7],s23 offen offset:1024 sc1 lds
M a[40:43],a[176:179],a[56:59],a[40:43]
M a[40:43],a[180:183],a[60:63],a[40:43]
s_sub_u32 s26,s26,1
M a[44:47],a[188:191],a[60:63],a[44:47]
s_cmp_eq_u32 s26,s43
M a[44:47],a[184:187],a[56:59],a[44:47]
s_cmp_eq_u32 s19,2
s_cbranch_scc1 K1_TLQ
s_waitcnt lgkmcnt(0)
M v[48:51],a[64:67],a[48:51],v[48:51]
ds_read_b128 a[56:59],v2 offset:2048
M v[48:51],a[68:71],a[52:55],v[48:51]
ds_read_b128 a[60:63],v3 offset:2048
M v[52:55],a[76:79],a[52:55],v[52:55]
M v[52:55],a[72:75],a[48:51],v[52:55]
buffer_load_dwordx4 v24,s[4:7],s23 offen offset:2048 sc1 lds
M v[56:59],a[80:83],a[48:51],v[56:59]
M v[56:59],a[84:87],a[52:55],v[56:59]
M v[60:63],a[92:95],a[52:55],v[60:63]
M v[60:63],a[88:91],a[48:51],v[60:63]
buffer_load_dwordx4 a[244:247],v36,s[12:15],s31 offen offset:1024 sc1
M v[64:67],a[96:99],a[48:51],v[64:67]
s_mov_b32 s84,s54
CV v48,v48,v49
M v[64:67],a[100:103],a[52:55],v[64:67]
CV v49,v50,v51
CV v50,v52,v53
M v[68:71],a[108:111],a[52:55],v[68:71]
CV v51,v54,v55
M v[68:71],a[104:107],a[48:51],v[68:71]
buffer_load_dwordx4 v25,s[4:7],s23 offen offset:3072 sc1 lds
M v[72:75],a[112:115],a[48:51],v[72:75]
CV v52,v56,v57
CV v53,v58,v59
M v[72:75],a[116:119],a[52:55],v[72:75]
s_add_u32 s23,s23,128
M v[76:79],a[124:127],a[52:55],v[76:79]
CV v54,v60,v61
CV v55,v62,v63
M v[76:79],a[120:123],a[48:51],v[76:79]
s_waitcnt lgkmcnt(0)
M v[80:83],a[64:67],a[56:59],v[80:83]
ds_read_b128 a[48:51],v2 offset:4096
CV v56,v64,v65
CV v57,v66,v67
M v[80:83],a[68:71],a[60:63],v[80:83]
ds_read_b128 a[52:55],v3 offset:4096
s_add_u32 m0,s21,114688
M v[84:87],a[76:79],a[60:63],v[84:87]
CV v58,v68,v69
CV v59,v70,v71
M v[84:87],a[72:75],a[56:59],v[84:87]
buffer_load_dwordx4 v26,s[8:11],s24 offen sc1 lds
M v[88:91],a[80:83],a[56:59],v[88:91]
CV v72,v72,v73
CV v73,v74,v75
CV v74,v76,v77
M v[88:91],a[84:87],a[60:63],v[88:91]
CV v75,v78,v79
buffer_store_dwordx4 v[72:75],v36,s[12:15],s54 offen offset:3072 sc1
M v[92:95],a[92:95],a[60:63],v[92:95]
s_add_u32 s54,s54,s55
M v[92:95],a[88:91],a[56:59],v[92:95]
buffer_load_dwordx4 a[248:251],v36,s[12:15],s31 offen offset:2048 sc1
M v[96:99],a[96:99],a[56:59],v[96:99]
s_mov_b32 s85,s54
CV v60,v80,v81
M v[96:99],a[100:103],a[60:63],v[96:99]
CV v61,v82,v83
CV v62,v84,v85
M v[100:103],a[108:111],a[60:63],v[100:103]
CV v63,v86,v87
M v[100:103],a[104:107],a[56:59],v[100:103]
buffer_load_dwordx4 v27,s[8:11],s24 offen offset:1024 sc1 lds
M v[104:107],a[112:115],a[56:59],v[104:107]
CV v64,v88,v89
M v[104:107],a[116:119],a[60:63],v[104:107]
CV v65,v90,v91
CV v66,v92,v93
M v[108:111],a[124:127],a[60:63],v[108:111]
CV v67,v94,v95
M v[108:111],a[120:123],a[56:59],v[108:111]
s_waitcnt lgkmcnt(0)
M v[112:115],a[64:67],a[48:51],v[112:115]
ds_read_b128 a[56:59],v2 offset:6144
CV v68,v96,v97
M v[112:115],a[68:71],a[52:55],v[112:115]
ds_read_b128 a[60:63],v3 offset:6144
CV v69,v98,v99
CV v70,v100,v101
M v[116:119],a[76:79],a[52:55],v[116:119]
CV v71,v102,v103
M v[116:119],a[72:75],a[48:51],v[116:119]
buffer_load_dwordx4 v28,s[8:11],s24 offen offset:2048 sc1 lds
M v[120:123],a[80:83],a[48:51],v[120:123]
CV v104,v104,v105
CV v105,v106,v107
CV v106,v108,v109
M v[120:123],a[84:87],a[52:55],v[120:123]
CV v107,v110,v111
buffer_store_dwordx4 v[104:107],v36,s[12:15],s54 offen offset:3072 sc1
M v[124:127],a[92:95],a[52:55],v[124:127]
s_add_u32 s54,s54,s55
M v[124:127],a[88:91],a[48:51],v[124:127]
buffer_load_dwordx4 a[252:255],v36,s[12:15],s31 offen offset:3072 sc1
M v[128:131],a[96:99],a[48:51],v[128:131]
s_mov_b32 s86,s54
CV v72,v112,v113
M v[128:131],a[100:103],a[52:55],v[128:131]
CV v73,v114,v115
CV v74,v116,v117
M v[132:135],a[108:111],a[52:55],v[132:135]
CV v75,v118,v119
M v[132:135],a[104:107],a[48:51],v[132:135]
buffer_load_dwordx4 v29,s[8:11],s24 offen offset:3072 sc1 lds
M v[136:139],a[112:115],a[48:51],v[136:139]
s_add_u32 s24,s24,s25
CV v76,v120,v121
M v[136:139],a[116:119],a[52:55],v[136:139]
s_add_u32 s22,s44,33554432
CV v77,v122,v123
M v[140:143],a[124:127],a[52:55],v[140:143]
s_add_u32 s24,s44,33570816
CV v78,v124,v125
M v[140:143],a[120:123],a[48:51],v[140:143]
CV v79,v126,v127
s_waitcnt vmcnt(33) lgkmcnt(0)
s_barrier
M v[144:147],a[64:67],a[56:59],v[144:147]
ds_read_b128 a[48:51],v2 offset:32768
CV v80,v128,v129
CV v81,v130,v131
M v[144:147],a[68:71],a[60:63],v[144:147]
ds_read_b128 a[52:55],v3 offset:32768
s_add_u32 m0,s21,0
M v[148:151],a[76:79],a[60:63],v[148:151]
CV v82,v132,v133
CV v83,v134,v135
M v[148:151],a[72:75],a[56:59],v[148:151]
buffer_load_dwordx4 v22,s[4:7],s22 offen sc1 lds
M v[152:155],a[80:83],a[56:59],v[152:155]
CV v136,v136,v137
CV v137,v138,v139
M v[152:155],a[84:87],a[60:63],v[152:155]
CV v138,v140,v141
CV v139,v142,v143
M v[156:159],a[92:95],a[60:63],v[156:159]
buffer_store_dwordx4 v[136:139],v36,s[12:15],s54 offen offset:3072 sc1
M v[156:159],a[88:91],a[56:59],v[156:159]
s_add_u32 s54,s54,s55
M v[160:163],a[96:99],a[56:59],v[160:163]
s_mov_b32 s87,s54
CV v84,v144,v145
M v[160:163],a[100:103],a[60:63],v[160:163]
CV v85,v146,v147
CV v86,v148,v149
M v[164:167],a[108:111],a[60:63],v[164:167]
CV v87,v150,v151
M v[164:167],a[104:107],a[56:59],v[164:167]
buffer_load_dwordx4 v23,s[4:7],s22 offen offset:1024 sc1 lds
M v[168:171],a[112:115],a[56:59],v[168:171]
CV v88,v152,v153
M v[168:171],a[116:119],a[60:63],v[168:171]
CV v89,v154,v155
CV v90,v156,v157
M v[172:175],a[124:127],a[60:63],v[172:175]
CV v91,v158,v159
M v[172:175],a[120:123],a[56:59],v[172:175]
s_waitcnt lgkmcnt(0)
M v[176:179],a[64:67],a[48:51],v[176:179]
ds_read_b128 a[56:59],v2 offset:34816
CV v92,v160,v161
M v[176:179],a[68:71],a[52:55],v[176:179]
ds_read_b128 a[60:63],v3 offset:34816
CV v93,v162,v163
CV v94,v164,v165
M v[180:183],a[76:79],a[52:55],v[180:183]
CV v95,v166,v167
M v[180:183],a[72:75],a[48:51],v[180:183]
buffer_load_dwordx4 v24,s[4:7],s22 offen offset:2048 sc1 lds
M v[184:187],a[80:83],a[48:51],v[184:187]
CV v168,v168,v169
CV v169,v170,v171
M v[184:187],a[84:87],a[52:55],v[184:187]
CV v170,v172,v173
CV v171,v174,v175
M v[188:191],a[92:95],a[52:55],v[188:191]
buffer_store_dwordx4 v[168:171],v36,s[12:15],s54 offen offset:3072 sc1
M v[188:191],a[88:91],a[48:51],v[188:191]
s_add_u32 s54,s54,s55
M v[192:195],a[96:99],a[48:51],v[192:195]
s_mov_b32 s88,s54
CV v96,v176,v177
M v[192:195],a[100:103],a[52:55],v[192:195]
CV v97,v178,v179
CV v98,v180,v181
M v[196:199],a[108:111],a[52:55],v[196:199]
CV v99,v182,v183
M v[196:199],a[104:107],a[48:51],v[196:199]
buffer_load_dwordx4 v25,s[4:7],s22 offen offset:3072 sc1 lds
M v[200:203],a[112:115],a[48:51],v[200:203]
s_add_u32 s22,s22,128
CV v100,v184,v185
M v[200:203],a[116:119],a[52:55],v[200:203]
CV v101,v186,v187
M v[204:207],a[124:127],a[52:55],v[204:207]
CV v102,v188,v189
CV v103,v190,v191
M v[204:207],a[120:123],a[48:51],v[204:207]
s_waitcnt lgkmcnt(0)
M v[208:211],a[64:67],a[56:59],v[208:211]
ds_read_b128 a[48:51],v2 offset:36864
CV v104,v192,v193
CV v105,v194,v195
M v[208:211],a[68:71],a[60:63],v[208:211]
ds_read_b128 a[52:55],v3 offset:36864
s_add_u32 m0,s21,16384
M v[212:215],a[76:79],a[60:63],v[212:215]
CV v106,v196,v197
CV v107,v198,v199
M v[212:215],a[72:75],a[56:59],v[212:215]
buffer_load_dwordx4 v26,s[8:11],s24 offen sc1 lds
M v[216:219],a[80:83],a[56:59],v[216:219]
CV v200,v200,v201
CV v201,v202,v203
M v[216:219],a[84:87],a[60:63],v[216:219]
CV v202,v204,v205
CV v203,v206,v207
M v[220:223],a[92:95],a[60:63],v[220:223]
buffer_store_dwordx4 v[200:203],v36,s[12:15],s54 offen offset:3072 sc1
M v[220:223],a[88:91],a[56:59],v[220:223]
s_add_u32 s54,s54,s55
M v[224:227],a[96:99],a[56:59],v[224:227]
s_mov_b32 s89,s54
CV v208,v208,v209
CV v209,v210,v211
M v[224:227],a[100:103],a[60:63],v[224:227]
CV v210,v212,v213
CV v211,v214,v215
AW a128,v208
M v[228:231],a[108:111],a[60:63],v[228:231]
AW a129,v209
AW a130,v210
AW a131,v211
M v[228:231],a[104:107],a[56:59],v[228:231]
buffer_load_dwordx4 v27,s[8:11],s24 offen offset:1024 sc1 lds
M v[232:235],a[112:115],a[56:59],v[232:235]
CV v216,v216,v217
CV v217,v218,v219
CV v218,v220,v221
M v[232:235],a[116:119],a[60:63],v[232:235]
CV v219,v222,v223
AW a132,v216
AW a133,v217
M v[236:239],a[124:127],a[60:63],v[236:239]
buffer_load_dword v1,v37,s[64:67],0 offen
M v[236:239],a[120:123],a[56:59],v[236:239]
AW a134,v218
AW a135,v219
s_waitcnt lgkmcnt(0)
M v[240:243],a[64:67],a[48:51],v[240:243]
ds_read_b128 a[56:59],v2 offset:38912
CV v224,v224,v225
CV v225,v226,v227
M v[240:243],a[68:71],a[52:55],v[240:243]
ds_read_b128 a[60:63],v3 offset:38912
CV v226,v228,v229
CV v227,v230,v231
AW a136,v224
M v[244:247],a[76:79],a[52:55],v[244:247]
AW a137,v225
AW a138,v226
AW a139,v227
M v[244:247],a[72:75],a[48:51],v[244:247]
buffer_load_dwordx4 v28,s[8:11],s24 offen offset:2048 sc1 lds
M v[248:251],a[80:83],a[48:51],v[248:251]
CV v232,v232,v233
CV v233,v234,v235
M v[248:251],a[84:87],a[52:55],v[248:251]
CV v234,v236,v237
CV v235,v238,v239
M v[252:255],a[92:95],a[52:55],v[252:255]
buffer_store_dwordx4 v[232:235],v36,s[12:15],s54 offen offset:3072 sc1
M v[252:255],a[88:91],a[48:51],v[252:255]
s_add_u32 s54,s54,s55
M a[0:3],a[96:99],a[48:51],a[0:3]
s_mov_b32 s90,s54
CV v240,v240,v241
CV v241,v242,v243
M a[0:3],a[100:103],a[52:55],a[0:3]
CV v242,v244,v245
CV v243,v246,v247
AW a140,v240
M a[4:7],a[108:111],a[52:55],a[4:7]
AW a141,v241
AW a142,v242
AW a143,v243
M a[4:7],a[104:107],a[48:51],a[4:7]
buffer_load_dwordx4 v29,s[8:11],s24 offen offset:3072 sc1 lds
M a[8:11],a[112:115],a[48:51],a[8:11]
s_add_u32 s24,s24,s25
CV v248,v248,v249
CV v249,v250,v251
M a[8:11],a[116:119],a[52:55],a[8:11]
CV v250,v252,v253
CV v251,v254,v255
M a[12:15],a[124:127],a[52:55],a[12:15]
AW a144,v248
AW a145,v249
AW a146,v250
M a[12:15],a[120:123],a[48:51],a[12:15]
AW a147,v251
s_waitcnt lgkmcnt(0)
s_barrier
M a[16:19],a[64:67],a[56:59],a[16:19]
AR v42,a0
AR v43,a1
AR v44,a2
AR v45,a3
M a[16:19],a[68:71],a[60:63],a[16:19]
CV v30,v42,v43
CV v31,v44,v45
AR v42,a4
AR v43,a5
AR v44,a6
M a[20:23],a[76:79],a[60:63],a[20:23]
s_add_u32 m0,s21,32768
AR v45,a7
CV v32,v42,v43
CV v33,v44,v45
M a[20:23],a[72:75],a[56:59],a[20:23]
AW a148,v30
AW a149,v31
AW a150,v32
AW a151,v33
M a[24:27],a[80:83],a[56:59],a[24:27]
AR v42,a8
AR v43,a9
AR v44,a10
AR v45,a11
M a[24:27],a[84:87],a[60:63],a[24:27]
CV v30,v42,v43
CV v31,v44,v45
AR v42,a12
AR v43,a13
M a[28:31],a[92:95],a[60:63],a[28:31]
AR v44,a14
AR v45,a15
CV v32,v42,v43
CV v33,v44,v45
M a[28:31],a[88:91],a[56:59],a[28:31]
buffer_store_dwordx4 v[30:33],v36,s[12:15],s54 offen offset:3072 sc1
s_add_u32 s54,s54,s55
M a[32:35],a[96:99],a[56:59],a[32:35]
s_mov_b32 s91,s54
AR v42,a16
AR v43,a17
AR v44,a18
M a[32:35],a[100:103],a[60:63],a[32:35]
AR v45,a19
CV v30,v42,v43
CV v31,v44,v45
AR v42,a20
AR v43,a21
M a[36:39],a[108:111],a[60:63],a[36:39]
AR v44,a22
AR v45,a23
CV v32,v42,v43
CV v33,v44,v45
M a[36:39],a[104:107],a[56:59],a[36:39]
AW a152,v30
AW a153,v31
AW a154,v32
AW a155,v33
M a[40:43],a[112:115],a[56:59],a[40:43]
AR v42,a24
AR v43,a25
AR v44,a26
AR v45,a27
CV v30,v42,v43
M a[40:43],a[116:119],a[60:63],a[40:43]
s_sub_u32 s26,s26,1
CV v31,v44,v45
AR v42,a28
AR v43,a29
AR v44,a30
M a[44:47],a[124:127],a[60:63],a[44:47]
s_cmp_eq_u32 s26,s43
AR v45,a31
CV v32,v42,v43
CV v33,v44,v45
M a[44:47],a[120:123],a[56:59],a[44:47]
AW a156,v30
AW a157,v31
AW a158,v32
AW a159,v33
s_nop 7
AR v42,a32
AR v43,a33
AR v44,a34
AR v45,a35
CV v30,v42,v43
CV v31,v44,v45
AR v42,a36
AR v43,a37
AR v44,a38
AR v45,a39
CV v32,v42,v43
CV v33,v44,v45
AW a160,v30
AW a161,v31
AW a162,v32
AW a163,v33
AR v42,a40
AR v43,a41
AR v44,a42
AR v45,a43
CV v30,v42,v43
CV v31,v44,v45
AR v42,a44
AR v43,a45
AR v44,a46
AR v45,a47
CV v32,v42,v43
CV v33,v44,v45
buffer_store_dwordx4 v[30:33],v36,s[12:15],s54 offen offset:3072 sc1
s_branch K2_FASTX
K1_TLQ:
s_waitcnt lgkmcnt(0)
M v[48:51],a[64:67],a[48:51],v[48:51]
ds_read_b128 a[56:59],v2 offset:2048
M v[48:51],a[68:71],a[52:55],v[48:51]
ds_read_b128 a[60:63],v3 offset:2048
M v[52:55],a[76:79],a[52:55],v[52:55]
M v[52:55],a[72:75],a[48:51],v[52:55]
buffer_load_dwordx4 v24,s[4:7],s23 offen offset:2048 sc1 lds
M v[56:59],a[80:83],a[48:51],v[56:59]
M v[56:59],a[84:87],a[52:55],v[56:59]
M v[60:63],a[92:95],a[52:55],v[60:63]
M v[60:63],a[88:91],a[48:51],v[60:63]
buffer_load_dwordx4 a[244:247],v36,s[12:15],s31 offen offset:1024 sc1
M v[64:67],a[96:99],a[48:51],v[64:67]
s_mov_b32 s84,s54
v_mul_f32 v48,s93,v48
v_mul_f32 v49,s93,v49
v_mul_f32 v50,s93,v50
M v[64:67],a[100:103],a[52:55],v[64:67]
v_mul_f32 v51,s93,v51
CV v48,v48,v49
CV v49,v50,v51
v_mul_f32 v52,s93,v52
M v[68:71],a[108:111],a[52:55],v[68:71]
v_mul_f32 v53,s93,v53
v_mul_f32 v54,s93,v54
v_mul_f32 v55,s93,v55
CV v50,v52,v53
M v[68:71],a[104:107],a[48:51],v[68:71]
buffer_load_dwordx4 v25,s[4:7],s23 offen offset:3072 sc1 lds
CV v51,v54,v55
M v[72:75],a[112:115],a[48:51],v[72:75]
v_mul_f32 v56,s93,v56
v_mul_f32 v57,s93,v57
v_mul_f32 v58,s93,v58
v_mul_f32 v59,s93,v59
M v[72:75],a[116:119],a[52:55],v[72:75]
s_add_u32 s23,s23,128
CV v52,v56,v57
CV v53,v58,v59
M v[76:79],a[124:127],a[52:55],v[76:79]
v_mul_f32 v60,s93,v60
v_mul_f32 v61,s93,v61
v_mul_f32 v62,s93,v62
v_mul_f32 v63,s93,v63
M v[76:79],a[120:123],a[48:51],v[76:79]
CV v54,v60,v61
CV v55,v62,v63
s_waitcnt lgkmcnt(0)
M v[80:83],a[64:67],a[56:59],v[80:83]
ds_read_b128 a[48:51],v2 offset:4096
v_mul_f32 v64,s93,v64
v_mul_f32 v65,s93,v65
v_mul_f32 v66,s93,v66
v_mul_f32 v67,s93,v67
M v[80:83],a[68:71],a[60:63],v[80:83]
ds_read_b128 a[52:55],v3 offset:4096
s_add_u32 m0,s21,114688
CV v56,v64,v65
CV v57,v66,v67
M v[84:87],a[76:79],a[60:63],v[84:87]
v_mul_f32 v68,s93,v68
v_mul_f32 v69,s93,v69
v_mul_f32 v70,s93,v70
v_mul_f32 v71,s93,v71
CV v58,v68,v69
M v[84:87],a[72:75],a[56:59],v[84:87]
buffer_load_dwordx4 v26,s[8:11],s24 offen sc1 lds
CV v59,v70,v71
M v[88:91],a[80:83],a[56:59],v[88:91]
v_mul_f32 v72,s93,v72
v_mul_f32 v73,s93,v73
v_mul_f32 v74,s93,v74
v_mul_f32 v75,s93,v75
CV v72,v72,v73
M v[88:91],a[84:87],a[60:63],v[88:91]
CV v73,v74,v75
v_mul_f32 v76,s93,v76
v_mul_f32 v77,s93,v77
v_mul_f32 v78,s93,v78
v_mul_f32 v79,s93,v79
M v[92:95],a[92:95],a[60:63],v[92:95]
CV v74,v76,v77
CV v75,v78,v79
buffer_store_dwordx4 v[72:75],v36,s[12:15],s54 offen offset:3072 sc1
M v[92:95],a[88:91],a[56:59],v[92:95]
buffer_load_dwordx4 a[248:251],v36,s[12:15],s31 offen offset:2048 sc1
s_add_u32 s54,s54,s55
M v[96:99],a[96:99],a[56:59],v[96:99]
s_mov_b32 s85,s54
v_mul_f32 v80,s93,v80
v_mul_f32 v81,s93,v81
v_mul_f32 v82,s93,v82
M v[96:99],a[100:103],a[60:63],v[96:99]
v_mul_f32 v83,s93,v83
CV v60,v80,v81
CV v61,v82,v83
v_mul_f32 v84,s93,v84
M v[100:103],a[108:111],a[60:63],v[100:103]
v_mul_f32 v85,s93,v85
v_mul_f32 v86,s93,v86
v_mul_f32 v87,s93,v87
CV v62,v84,v85
M v[100:103],a[104:107],a[56:59],v[100:103]
buffer_load_dwordx4 v27,s[8:11],s24 offen offset:1024 sc1 lds
CV v63,v86,v87
M v[104:107],a[112:115],a[56:59],v[104:107]
v_mul_f32 v88,s93,v88
v_mul_f32 v89,s93,v89
v_mul_f32 v90,s93,v90
M v[104:107],a[116:119],a[60:63],v[104:107]
v_mul_f32 v91,s93,v91
CV v64,v88,v89
CV v65,v90,v91
v_mul_f32 v92,s93,v92
M v[108:111],a[124:127],a[60:63],v[108:111]
v_mul_f32 v93,s93,v93
v_mul_f32 v94,s93,v94
v_mul_f32 v95,s93,v95
M v[108:111],a[120:123],a[56:59],v[108:111]
CV v66,v92,v93
CV v67,v94,v95
s_waitcnt lgkmcnt(0)
M v[112:115],a[64:67],a[48:51],v[112:115]
ds_read_b128 a[56:59],v2 offset:6144
v_mul_f32 v96,s93,v96
v_mul_f32 v97,s93,v97
v_mul_f32 v98,s93,v98
M v[112:115],a[68:71],a[52:55],v[112:115]
ds_read_b128 a[60:63],v3 offset:6144
v_mul_f32 v99,s93,v99
CV v68,v96,v97
CV v69,v98,v99
v_mul_f32 v100,s93,v100
M v[116:119],a[76:79],a[52:55],v[116:119]
v_mul_f32 v101,s93,v101
v_mul_f32 v102,s93,v102
v_mul_f32 v103,s93,v103
CV v70,v100,v101
M v[116:119],a[72:75],a[48:51],v[116:119]
buffer_load_dwordx4 v28,s[8:11],s24 offen offset:2048 sc1 lds
CV v71,v102,v103
M v[120:123],a[80:83],a[48:51],v[120:123]
v_mul_f32 v104,s93,v104
v_mul_f32 v105,s93,v105
v_mul_f32 v106,s93,v106
v_mul_f32 v107,s93,v107
CV v104,v104,v105
M v[120:123],a[84:87],a[52:55],v[120:123]
CV v105,v106,v107
v_mul_f32 v108,s93,v108
v_mul_f32 v109,s93,v109
v_mul_f32 v110,s93,v110
v_mul_f32 v111,s93,v111
M v[124:127],a[92:95],a[52:55],v[124:127]
CV v106,v108,v109
CV v107,v110,v111
buffer_store_dwordx4 v[104:107],v36,s[12:15],s54 offen offset:3072 sc1
M v[124:127],a[88:91],a[48:51],v[124:127]
buffer_load_dwordx4 a[252:255],v36,s[12:15],s31 offen offset:3072 sc1
s_add_u32 s54,s54,s55
M v[128:131],a[96:99],a[48:51],v[128:131]
s_mov_b32 s86,s54
v_mul_f32 v112,s93,v112
v_mul_f32 v113,s93,v113
v_mul_f32 v114,s93,v114
M v[128:131],a[100:103],a[52:55],v[128:131]
v_mul_f32 v115,s93,v115
CV v72,v112,v113
CV v73,v114,v115
v_mul_f32 v116,s93,v116
M v[132:135],a[108:111],a[52:55],v[132:135]
v_mul_f32 v117,s93,v117
v_mul_f32 v118,s93,v118
v_mul_f32 v119,s93,v119
CV v74,v116,v117
M v[132:135],a[104:107],a[48:51],v[132:135]
buffer_load_dwordx4 v29,s[8:11],s24 offen offset:3072 sc1 lds
CV v75,v118,v119
M v[136:139],a[112:115],a[48:51],v[136:139]
s_add_u32 s24,s24,s25
v_mul_f32 v120,s93,v120
v_mul_f32 v121,s93,v121
v_mul_f32 v122,s93,v122
M v[136:139],a[116:119],a[52:55],v[136:139]
s_add_u32 s22,s44,33554432
v_mul_f32 v123,s93,v123
CV v76,v120,v121
CV v77,v122,v123
M v[140:143],a[124:127],a[52:55],v[140:143]
s_add_u32 s24,s44,33570816
v_mul_f32 v124,s93,v124
v_mul_f32 v125,s93,v125
v_mul_f32 v126,s93,v126
M v[140:143],a[120:123],a[48:51],v[140:143]
v_mul_f32 v127,s93,v127
CV v78,v124,v125
CV v79,v126,v127
s_waitcnt vmcnt(33) lgkmcnt(0)
s_barrier
M v[144:147],a[64:67],a[56:59],v[144:147]
ds_read_b128 a[48:51],v2 offset:32768
v_mul_f32 v128,s93,v128
v_mul_f32 v129,s93,v129
v_mul_f32 v130,s93,v130
v_mul_f32 v131,s93,v131
M v[144:147],a[68:71],a[60:63],v[144:147]
ds_read_b128 a[52:55],v3 offset:32768
s_add_u32 m0,s21,0
CV v80,v128,v129
CV v81,v130,v131
M v[148:151],a[76:79],a[60:63],v[148:151]
v_mul_f32 v132,s93,v132
v_mul_f32 v133,s93,v133
v_mul_f32 v134,s93,v134
v_mul_f32 v135,s93,v135
CV v82,v132,v133
M v[148:151],a[72:75],a[56:59],v[148:151]
buffer_load_dwordx4 v22,s[4:7],s22 offen sc1 lds
CV v83,v134,v135
M v[152:155],a[80:83],a[56:59],v[152:155]
v_mul_f32 v136,s93,v136
v_mul_f32 v137,s93,v137
v_mul_f32 v138,s93,v138
v_mul_f32 v139,s93,v139
M v[152:155],a[84:87],a[60:63],v[152:155]
CV v136,v136,v137
CV v137,v138,v139
v_mul_f32 v140,s93,v140
v_mul_f32 v141,s93,v141
M v[156:159],a[92:95],a[60:63],v[156:159]
v_mul_f32 v142,s93,v142
v_mul_f32 v143,s93,v143
CV v138,v140,v141
CV v139,v142,v143
M v[156:159],a[88:91],a[56:59],v[156:159]
buffer_store_dwordx4 v[136:139],v36,s[12:15],s54 offen offset:3072 sc1
s_add_u32 s54,s54,s55
M v[160:163],a[96:99],a[56:59],v[160:163]
s_mov_b32 s87,s54
v_mul_f32 v144,s93,v144
v_mul_f32 v145,s93,v145
v_mul_f32 v146,s93,v146
M v[160:163],a[100:103],a[60:63],v[160:163]
v_mul_f32 v147,s93,v147
CV v84,v144,v145
CV v85,v146,v147
v_mul_f32 v148,s93,v148
M v[164:167],a[108:111],a[60:63],v[164:167]
v_mul_f32 v149,s93,v149
v_mul_f32 v150,s93,v150
v_mul_f32 v151,s93,v151
CV v86,v148,v149
M v[164:167],a[104:107],a[56:59],v[164:167]
buffer_load_dwordx4 v23,s[4:7],s22 offen offset:1024 sc1 lds
CV v87,v150,v151
M v[168:171],a[112:115],a[56:59],v[168:171]
v_mul_f32 v152,s93,v152
v_mul_f32 v153,s93,v153
v_mul_f32 v154,s93,v154
M v[168:171],a[116:119],a[60:63],v[168:171]
v_mul_f32 v155,s93,v155
CV v88,v152,v153
CV v89,v154,v155
v_mul_f32 v156,s93,v156
M v[172:175],a[124:127],a[60:63],v[172:175]
v_mul_f32 v157,s93,v157
v_mul_f32 v158,s93,v158
v_mul_f32 v159,s93,v159
M v[172:175],a[120:123],a[56:59],v[172:175]
CV v90,v156,v157
CV v91,v158,v159
s_waitcnt lgkmcnt(0)
M v[176:179],a[64:67],a[48:51],v[176:179]
ds_read_b128 a[56:59],v2 offset:34816
v_mul_f32 v160,s93,v160
v_mul_f32 v161,s93,v161
v_mul_f32 v162,s93,v162
M v[176:179],a[68:71],a[52:55],v[176:179]
ds_read_b128 a[60:63],v3 offset:34816
v_mul_f32 v163,s93,v163
CV v92,v160,v161
CV v93,v162,v163
v_mul_f32 v164,s93,v164
M v[180:183],a[76:79],a[52:55],v[180:183]
v_mul_f32 v165,s93,v165
v_mul_f32 v166,s93,v166
v_mul_f32 v167,s93,v167
CV v94,v164,v165
M v[180:183],a[72:75],a[48:51],v[180:183]
buffer_load_dwordx4 v24,s[4:7],s22 offen offset:2048 sc1 lds
CV v95,v166,v167
M v[184:187],a[80:83],a[48:51],v[184:187]
v_mul_f32 v168,s93,v168
v_mul_f32 v169,s93,v169
v_mul_f32 v170,s93,v170
v_mul_f32 v171,s93,v171
M v[184:187],a[84:87],a[52:55],v[184:187]
CV v168,v168,v169
CV v169,v170,v171
v_mul_f32 v172,s93,v172
v_mul_f32 v173,s93,v173
M v[188:191],a[92:95],a[52:55],v[188:191]
v_mul_f32 v174,s93,v174
v_mul_f32 v175,s93,v175
CV v170,v172,v173
CV v171,v174,v175
M v[188:191],a[88:91],a[48:51],v[188:191]
buffer_store_dwordx4 v[168:171],v36,s[12:15],s54 offen offset:3072 sc1
s_add_u32 s54,s54,s55
M v[192:195],a[96:99],a[48:51],v[192:195]
s_mov_b32 s88,s54
v_mul_f32 v176,s93,v176
v_mul_f32 v177,s93,v177
v_mul_f32 v178,s93,v178
M v[192:195],a[100:103],a[52:55],v[192:195]
v_mul_f32 v179,s93,v179
CV v96,v176,v177
CV v97,v178,v179
v_mul_f32 v180,s93,v180
M v[196:199],a[108:111],a[52:55],v[196:199]
v_mul_f32 v181,s93,v181
v_mul_f32 v182,s93,v182
v_mul_f32 v183,s93,v183
CV v98,v180,v181
M v[196:199],a[104:107],a[48:51],v[196:199]
buffer_load_dwordx4 v25,s[4:7],s22 offen offset:3072 sc1 lds
CV v99,v182,v183
M v[200:203],a[112:115],a[48:51],v[200:203]
s_add_u32 s22,s22,128
v_mul_f32 v184,s93,v184
v_mul_f32 v185,s93,v185
v_mul_f32 v186,s93,v186
M v[200:203],a[116:119],a[52:55],v[200:203]
v_mul_f32 v187,s93,v187
CV v100,v184,v185
CV v101,v186,v187
M v[204:207],a[124:127],a[52:55],v[204:207]
v_mul_f32 v188,s93,v188
v_mul_f32 v189,s93,v189
v_mul_f32 v190,s93,v190
v_mul_f32 v191,s93,v191
M v[204:207],a[120:123],a[48:51],v[204:207]
CV v102,v188,v189
CV v103,v190,v191
s_waitcnt lgkmcnt(0)
M v[208:211],a[64:67],a[56:59],v[208:211]
ds_read_b128 a[48:51],v2 offset:36864
v_mul_f32 v192,s93,v192
v_mul_f32 v193,s93,v193
v_mul_f32 v194,s93,v194
v_mul_f32 v195,s93,v195
M v[208:211],a[68:71],a[60:63],v[208:211]
ds_read_b128 a[52:55],v3 offset:36864
s_add_u32 m0,s21,16384
CV v104,v192,v193
CV v105,v194,v195
M v[212:215],a[76:79],a[60:63],v[212:215]
v_mul_f32 v196,s93,v196
v_mul_f32 v197,s93,v197
v_mul_f32 v198,s93,v198
v_mul_f32 v199,s93,v199
CV v106,v196,v197
M v[212:215],a[72:75],a[56:59],v[212:215]
buffer_load_dwordx4 v26,s[8:11],s24 offen sc1 lds
CV v107,v198,v199
M v[216:219],a[80:83],a[56:59],v[216:219]
v_mul_f32 v200,s93,v200
v_mul_f32 v201,s93,v201
v_mul_f32 v202,s93,v202
v_mul_f32 v203,s93,v203
M v[216:219],a[84:87],a[60:63],v[216:219]
CV v200,v200,v201
CV v201,v202,v203
v_mul_f32 v204,s93,v204
v_mul_f32 v205,s93,v205
M v[220:223],a[92:95],a[60:63],v[220:223]
v_mul_f32 v206,s93,v206
v_mul_f32 v207,s93,v207
CV v202,v204,v205
CV v203,v206,v207
M v[220:223],a[88:91],a[56:59],v[220:223]
buffer_store_dwordx4 v[200:203],v36,s[12:15],s54 offen offset:3072 sc1
s_add_u32 s54,s54,s55
M v[224:227],a[96:99],a[56:59],v[224:227]
s_mov_b32 s89,s54
v_mul_f32 v208,s93,v208
v_mul_f32 v209,s93,v209
v_mul_f32 v210,s93,v210
v_mul_f32 v211,s93,v211
M v[224:227],a[100:103],a[60:63],v[224:227]
CV v208,v208,v209
CV v209,v210,v211
v_mul_f32 v212,s93,v212
v_mul_f32 v213,s93,v213
v_mul_f32 v214,s93,v214
M v[228:231],a[108:111],a[60:63],v[228:231]
v_mul_f32 v215,s93,v215
CV v210,v212,v213
CV v211,v214,v215
AW a128,v208
AW a129,v209
M v[228:231],a[104:107],a[56:59],v[228:231]
buffer_load_dwordx4 v27,s[8:11],s24 offen offset:1024 sc1 lds
AW a130,v210
AW a131,v211
M v[232:235],a[112:115],a[56:59],v[232:235]
v_mul_f32 v216,s93,v216
v_mul_f32 v217,s93,v217
v_mul_f32 v218,s93,v218
v_mul_f32 v219,s93,v219
CV v216,v216,v217
M v[232:235],a[116:119],a[60:63],v[232:235]
CV v217,v218,v219
v_mul_f32 v220,s93,v220
v_mul_f32 v221,s93,v221
v_mul_f32 v222,s93,v222
v_mul_f32 v223,s93,v223
M v[236:239],a[124:127],a[60:63],v[236:239]
buffer_load_dword v1,v37,s[64:67],0 offen
CV v218,v220,v221
CV v219,v222,v223
M v[236:239],a[120:123],a[56:59],v[236:239]
AW a132,v216
AW a133,v217
AW a134,v218
AW a135,v219
s_waitcnt lgkmcnt(0)
M v[240:243],a[64:67],a[48:51],v[240:243]
ds_read_b128 a[56:59],v2 offset:38912
v_mul_f32 v224,s93,v224
v_mul_f32 v225,s93,v225
v_mul_f32 v226,s93,v226
v_mul_f32 v227,s93,v227
M v[240:243],a[68:71],a[52:55],v[240:243]
ds_read_b128 a[60:63],v3 offset:38912
CV v224,v224,v225
CV v225,v226,v227
v_mul_f32 v228,s93,v228
v_mul_f32 v229,s93,v229
v_mul_f32 v230,s93,v230
M v[244:247],a[76:79],a[52:55],v[244:247]
v_mul_f32 v231,s93,v231
CV v226,v228,v229
CV v227,v230,v231
AW a136,v224
AW a137,v225
M v[244:247],a[72:75],a[48:51],v[244:247]
buffer_load_dwordx4 v28,s[8:11],s24 offen offset:2048 sc1 lds
AW a138,v226
AW a139,v227
M v[248:251],a[80:83],a[48:51],v[248:251]
v_mul_f32 v232,s93,v232
v_mul_f32 v233,s93,v233
v_mul_f32 v234,s93,v234
v_mul_f32 v235,s93,v235
M v[248:251],a[84:87],a[52:55],v[248:251]
CV v232,v232,v233
CV v233,v234,v235
v_mul_f32 v236,s93,v236
v_mul_f32 v237,s93,v237
M v[252:255],a[92:95],a[52:55],v[252:255]
v_mul_f32 v238,s93,v238
v_mul_f32 v239,s93,v239
CV v234,v236,v237
CV v235,v238,v239
M v[252:255],a[88:91],a[48:51],v[252:255]
buffer_store_dwordx4 v[232:235],v36,s[12:15],s54 offen offset:3072 sc1
s_add_u32 s54,s54,s55
M a[0:3],a[96:99],a[48:51],a[0:3]
s_mov_b32 s90,s54
v_mul_f32 v240,s93,v240
v_mul_f32 v241,s93,v241
v_mul_f32 v242,s93,v242
v_mul_f32 v243,s93,v243
M a[0:3],a[100:103],a[52:55],a[0:3]
CV v240,v240,v241
CV v241,v242,v243
v_mul_f32 v244,s93,v244
v_mul_f32 v245,s93,v245
v_mul_f32 v246,s93,v246
M a[4:7],a[108:111],a[52:55],a[4:7]
v_mul_f32 v247,s93,v247
CV v242,v244,v245
CV v243,v246,v247
AW a140,v240
AW a141,v241
M a[4:7],a[104:107],a[48:51],a[4:7]
buffer_load_dwordx4 v29,s[8:11],s24 offen offset:3072 sc1 lds
AW a142,v242
AW a143,v243
M a[8:11],a[112:115],a[48:51],a[8:11]
s_add_u32 s24,s24,s25
v_mul_f32 v248,s93,v248
v_mul_f32 v249,s93,v249
v_mul_f32 v250,s93,v250
v_mul_f32 v251,s93,v251
M a[8:11],a[116:119],a[52:55],a[8:11]
CV v248,v248,v249
CV v249,v250,v251
v_mul_f32 v252,s93,v252
v_mul_f32 v253,s93,v253
M a[12:15],a[124:127],a[52:55],a[12:15]
v_mul_f32 v254,s93,v254
v_mul_f32 v255,s93,v255
CV v250,v252,v253
CV v251,v254,v255
AW a144,v248
M a[12:15],a[120:123],a[48:51],a[12:15]
AW a145,v249
AW a146,v250
AW a147,v251
s_waitcnt lgkmcnt(0)
s_barrier
M a[16:19],a[64:67],a[56:59],a[16:19]
AR v42,a0
AR v43,a1
AR v44,a2
AR v45,a3
v_mul_f32 v42,s93,v42
v_mul_f32 v43,s93,v43
M a[16:19],a[68:71],a[60:63],a[16:19]
v_mul_f32 v44,s93,v44
v_mul_f32_e64 v45,s93,v45
CV v30,v42,v43
CV v31,v44,v45
AR v42,a4
AR v43,a5
AR v44,a6
M a[20:23],a[76:79],a[60:63],a[20:23]
s_add_u32 m0,s21,32768
AR v45,a7
v_mul_f32 v42,s93,v42
v_mul_f32 v43,s93,v43
v_mul_f32 v44,s93,v44
v_mul_f32 v45,s93,v45
M a[20:23],a[72:75],a[56:59],a[20:23]
CV v32,v42,v43
CV v33,v44,v45
AW a148,v30
AW a149,v31
AW a150,v32
AW a151,v33
M a[24:27],a[80:83],a[56:59],a[24:27]
AR v42,a8
AR v43,a9
AR v44,a10
AR v45,a11
v_mul_f32 v42,s93,v42
v_mul_f32 v43,s93,v43
M a[24:27],a[84:87],a[60:63],a[24:27]
v_mul_f32 v44,s93,v44
v_mul_f32 v45,s93,v45
CV v30,v42,v43
CV v31,v44,v45
AR v42,a12
AR v43,a13
M a[28:31],a[92:95],a[60:63],a[28:31]
AR v44,a14
AR v45,a15
v_mul_f32 v42,s93,v42
v_mul_f32 v43,s93,v43
v_mul_f32 v44,s93,v44
v_mul_f32 v45,s93,v45
M a[28:31],a[88:91],a[56:59],a[28:31]
CV v32,v42,v43
CV v33,v44,v45
buffer_store_dwordx4 v[30:33],v36,s[12:15],s54 offen offset:3072 sc1
s_add_u32 s54,s54,s55
M a[32:35],a[96:99],a[56:59],a[32:35]
s_mov_b32 s91,s54
AR v42,a16
AR v43,a17
AR v44,a18
AR v45,a19
v_mul_f32 v42,s93,v42
M a[32:35],a[100:103],a[60:63],a[32:35]
v_mul_f32 v43,s93,v43
v_mul_f32 v44,s93,v44
v_mul_f32 v45,s93,v45
CV v30,v42,v43
CV v31,v44,v45
AR v42,a20
AR v43,a21
M a[36:39],a[108:111],a[60:63],a[36:39]
AR v44,a22
AR v45,a23
v_mul_f32 v42,s93,v42
v_mul_f32 v43,s93,v43
v_mul_f32 v44,s93,v44
v_mul_f32 v45,s93,v45
M a[36:39],a[104:107],a[56:59],a[36:39]
CV v32,v42,v43
CV v33,v44,v45
AW a152,v30
AW a153,v31
AW a154,v32
AW a155,v33
M a[40:43],a[112:115],a[56:59],a[40:43]
AR v42,a24
AR v43,a25
AR v44,a26
AR v45,a27
v_mul_f32 v42,s93,v42
v_mul_f32 v43,s93,v43
v_mul_f32 v44,s93,v44
M a[40:43],a[116:119],a[60:63],a[40:43]
s_sub_u32 s26,s26,1
v_mul_f32_e64 v45,s93,v45
CV v30,v42,v43
CV v31,v44,v45
AR v42,a28
AR v43,a29
AR v44,a30
M a[44:47],a[124:127],a[60:63],a[44:47]
s_cmp_eq_u32 s26,s43
AR v45,a31
v_mul_f32 v42,s93,v42
v_mul_f32 v43,s93,v43
v_mul_f32 v44,s93,v44
v_mul_f32 v45,s93,v45
M a[44:47],a[120:123],a[56:59],a[44:47]
CV v32,v42,v43
CV v33,v44,v45
AW a156,v30
AW a157,v31
AW a158,v32
AW a159,v33
s_nop 7
AR v42,a32
AR v43,a33
AR v44,a34
AR v45,a35
v_pk_mul_f32 v[42:43],v[42:43],s[92:93] op_sel:[0,1] op_sel_hi:[1,1]
v_pk_mul_f32 v[44:45],v[44:45],s[92:93] op_sel:[0,1] op_sel_hi:[1,1]
CV v30,v42,v43
CV v31,v44,v45
AR v42,a36
AR v43,a37
AR v44,a38
AR v45,a39
v_pk_mul_f32 v[42:43],v[42:43],s[92:93] op_sel:[0,1] op_sel_hi:[1,1]
v_pk_mul_f32 v[44:45],v[44:45],s[92:93] op_sel:[0,1] op_sel_hi:[1,1]
CV v32,v42,v43
CV v33,v44,v45
AW a160,v30
AW a161,v31
AW a162,v32
AW a163,v33
AR v42,a40
AR v43,a41
AR v44,a42
AR v45,a43
v_pk_mul_f32 v[42:43],v[42:43],s[92:93] op_sel:[0,1] op_sel_hi:[1,1]
v_pk_mul_f32 v[44:45],v[44:45],s[92:93] op_sel:[0,1] op_sel_hi:[1,1]
CV v30,v42,v43
CV v31,v44,v45
AR v42,a44
AR v43,a45
AR v44,a46
AR v45,a47
v_pk_mul_f32 v[42:43],v[42:43],s[92:93] op_sel:[0,1] op_sel_hi:[1,1]
v_pk_mul_f32 v[44:45],v[44:45],s[92:93] op_sel:[0,1] op_sel_hi:[1,1]
CV v32,v42,v43
CV v33,v44,v45
buffer_store_dwordx4 v[30:33],v36,s[12:15],s54 offen offset:3072 sc1
s_branch K2_FASTX
K1_XK1:
s_cmp_eq_u32 s53,3
s_cbranch_scc1 K1_IDLE
s_mov_b32 s94,s54
s_mov_b32 s95,s55
s_mov_b32 s92,s54
s_mov_b32 s19,s53
s_mov_b32 s53,4
s_mov_b32 s54,s56
s_mov_b32 s55,s57
s_mov_b32 s26,s17
s_mov_b32 s43,3
s_cmp_eq_u32 s20,0
s_nop 0
s_cselect_b32 s78,5,99
CV v48,v48,v49
CV v49,v50,v51
CV v50,v52,v53
CV v51,v54,v55
buffer_store_dwordx4 v[48:51],v36,s[12:15],s94 offen sc1
s_nop 0
s_waitcnt lgkmcnt(0)
M v[48:51],a[64:67],a[48:51],0
ds_read_b128 a[56:59],v2 offset:2048
CV v56,v56,v57
CV v57,v58,v59
CV v58,v60,v61
M v[48:51],a[68:71],a[52:55],v[48:51]
ds_read_b128 a[60:63],v3 offset:2048
CV v59,v62,v63
M v[52:55],a[76:79],a[52:55],0
ds_read_b64_tr_b16 a[128:129],v6 offset:0
buffer_store_dwordx4 v[56:59],v36,s[12:15],s94 offen offset:1024 sc1
s_nop 0
M v[52:55],a[72:75],a[48:51],v[52:55]
buffer_load_dwordx4 v24,s[4:7],s23 offen offset:2048 sc1 lds
M v[56:59],a[80:83],a[48:51],0
ds_read_b64_tr_b16 a[130:131],v6 offset:2048
CV v64,v64,v65
CV v65,v66,v67
M v[56:59],a[84:87],a[52:55],v[56:59]
CV v66,v68,v69
CV v67,v70,v71
M v[60:63],a[92:95],a[52:55],0
ds_read_b64_tr_b16 a[136:137],v7 offset:0
buffer_store_dwordx4 v[64:67],v36,s[12:15],s94 offen offset:2048 sc1
M v[60:63],a[88:91],a[48:51],v[60:63]
s_nop 0
M v[64:67],a[96:99],a[48:51],0
ds_read_b64_tr_b16 a[138:139],v7 offset:2048
CV v72,v72,v73
CV v73,v74,v75
M v[64:67],a[100:103],a[52:55],v[64:67]
CV v74,v76,v77
CV v75,v78,v79
buffer_store_dwordx4 v[72:75],v36,s[12:15],s94 offen offset:3072 sc1
M v[68:71],a[108:111],a[52:55],0
ds_read_b64_tr_b16 a[144:145],v8 offset:0
s_add_u32 s94,s94,s95
M v[68:71],a[104:107],a[48:51],v[68:71]
buffer_load_dwordx4 v25,s[4:7],s23 offen offset:3072 sc1 lds
M v[72:75],a[112:115],a[48:51],0
ds_read_b64_tr_b16 a[146:147],v8 offset:2048
CV v80,v80,v81
CV v81,v82,v83
M v[72:75],a[116:119],a[52:55],v[72:75]
s_add_u32 s23,s23,128
CV v82,v84,v85
CV v83,v86,v87
M v[76:79],a[124:127],a[52:55],0
buffer_store_dwordx4 v[80:83],v36,s[12:15],s94 offen sc1
M v[76:79],a[120:123],a[48:51],v[76:79]
s_nop 0
s_waitcnt lgkmcnt(6)
M v[80:83],a[64:67],a[56:59],0
ds_read_b128 a[48:51],v2 offset:4096
CV v88,v88,v89
CV v89,v90,v91
CV v90,v92,v93
M v[80:83],a[68:71],a[60:63],v[80:83]
ds_read_b128 a[52:55],v3 offset:4096
s_add_u32 m0,s21,114688
CV v91,v94,v95
M v[84:87],a[76:79],a[60:63],0
ds_read_b64_tr_b16 a[152:153],v9 offset:0
buffer_store_dwordx4 v[88:91],v36,s[12:15],s94 offen offset:1024 sc1
M v[84:87],a[72:75],a[56:59],v[84:87]
buffer_load_dwordx4 v26,s[8:11],s24 offen sc1 lds
s_nop 0
M v[88:91],a[80:83],a[56:59],0
ds_read_b64_tr_b16 a[154:155],v9 offset:2048
CV v96,v96,v97
CV v97,v98,v99
M v[88:91],a[84:87],a[60:63],v[88:91]
CV v98,v100,v101
CV v99,v102,v103
M v[92:95],a[92:95],a[60:63],0
ds_read_b64_tr_b16 a[160:161],v10 offset:0
buffer_store_dwordx4 v[96:99],v36,s[12:15],s94 offen offset:2048 sc1
M v[92:95],a[88:91],a[56:59],v[92:95]
s_nop 0
M v[96:99],a[96:99],a[56:59],0
ds_read_b64_tr_b16 a[162:163],v10 offset:2048
CV v104,v104,v105
CV v105,v106,v107
M v[96:99],a[100:103],a[60:63],v[96:99]
CV v106,v108,v109
CV v107,v110,v111
buffer_store_dwordx4 v[104:107],v36,s[12:15],s94 offen offset:3072 sc1
M v[100:103],a[108:111],a[60:63],0
ds_read_b64_tr_b16 a[168:169],v11 offset:0
s_add_u32 s94,s94,s95
M v[100:103],a[104:107],a[56:59],v[100:103]
buffer_load_dwordx4 v27,s[8:11],s24 offen offset:1024 sc1 lds
M v[104:107],a[112:115],a[56:59],0
ds_read_b64_tr_b16 a[170:171],v11 offset:2048
CV v112,v112,v113
CV v113,v114,v115
M v[104:107],a[116:119],a[60:63],v[104:107]
CV v114,v116,v117
CV v115,v118,v119
M v[108:111],a[124:127],a[60:63],0
buffer_store_dwordx4 v[112:115],v36,s[12:15],s94 offen sc1
M v[108:111],a[120:123],a[56:59],v[108:111]
s_nop 0
s_waitcnt lgkmcnt(6)
M v[112:115],a[64:67],a[48:51],0
ds_read_b128 a[56:59],v2 offset:6144
CV v120,v120,v121
CV v121,v122,v123
CV v122,v124,v125
M v[112:115],a[68:71],a[52:55],v[112:115]
ds_read_b128 a[60:63],v3 offset:6144
CV v123,v126,v127
M v[116:119],a[76:79],a[52:55],0
ds_read_b64_tr_b16 a[176:177],v12 offset:0
buffer_store_dwordx4 v[120:123],v36,s[12:15],s94 offen offset:1024 sc1
s_nop 0
M v[116:119],a[72:75],a[48:51],v[116:119]
buffer_load_dwordx4 v28,s[8:11],s24 offen offset:2048 sc1 lds
M v[120:123],a[80:83],a[48:51],0
ds_read_b64_tr_b16 a[178:179],v12 offset:2048
CV v128,v128,v129
CV v129,v130,v131
M v[120:123],a[84:87],a[52:55],v[120:123]
CV v130,v132,v133
CV v131,v134,v135
M v[124:127],a[92:95],a[52:55],0
ds_read_b64_tr_b16 a[184:185],v13 offset:0
buffer_store_dwordx4 v[128:131],v36,s[12:15],s94 offen offset:2048 sc1
M v[124:127],a[88:91],a[48:51],v[124:127]
s_nop 0
M v[128:131],a[96:99],a[48:51],0
ds_read_b64_tr_b16 a[186:187],v13 offset:2048
CV v136,v136,v137
CV v137,v138,v139
M v[128:131],a[100:103],a[52:55],v[128:131]
CV v138,v140,v141
CV v139,v142,v143
M v[132:135],a[108:111],a[52:55],0
buffer_store_dwordx4 v[136:139],v36,s[12:15],s94 offen offset:3072 sc1
s_add_u32 s94,s94,s95
M v[132:135],a[104:107],a[48:51],v[132:135]
buffer_load_dwordx4 v29,s[8:11],s24 offen offset:3072 sc1 lds
M v[136:139],a[112:115],a[48:51],0
s_add_u32 s24,s24,s25
CV v144,v144,v145
CV v145,v146,v147
M v[136:139],a[116:119],a[52:55],v[136:139]
CV v146,v148,v149
CV v147,v150,v151
M v[140:143],a[124:127],a[52:55],0
buffer_store_dwordx4 v[144:147],v36,s[12:15],s94 offen sc1
M v[140:143],a[120:123],a[48:51],v[140:143]
s_nop 0
s_waitcnt vmcnt(30) lgkmcnt(0)
s_barrier
M v[144:147],a[64:67],a[56:59],0
ds_read_b128 a[48:51],v2 offset:32768
CV v152,v152,v153
CV v153,v154,v155
CV v154,v156,v157
M v[144:147],a[68:71],a[60:63],v[144:147]
ds_read_b128 a[52:55],v3 offset:32768
s_add_u32 m0,s21,0
CV v155,v158,v159
M v[148:151],a[76:79],a[60:63],0
ds_read_b64_tr_b16 a[132:133],v6 offset:32768
buffer_store_dwordx4 v[152:155],v36,s[12:15],s94 offen offset:1024 sc1
M v[148:151],a[72:75],a[56:59],v[148:151]
buffer_load_dwordx4 v22,s[4:7],s22 offen sc1 lds
s_nop 0
M v[152:155],a[80:83],a[56:59],0
ds_read_b64_tr_b16 a[134:135],v6 offset:34816
CV v160,v160,v161
CV v161,v162,v163
M v[152:155],a[84:87],a[60:63],v[152:155]
CV v162,v164,v165
CV v163,v166,v167
M v[156:159],a[92:95],a[60:63],0
ds_read_b64_tr_b16 a[140:141],v7 offset:32768
buffer_store_dwordx4 v[160:163],v36,s[12:15],s94 offen offset:2048 sc1
M v[156:159],a[88:91],a[56:59],v[156:159]
s_nop 0
M v[160:163],a[96:99],a[56:59],0
ds_read_b64_tr_b16 a[142:143],v7 offset:34816
CV v168,v168,v169
CV v169,v170,v171
M v[160:163],a[100:103],a[60:63],v[160:163]
CV v170,v172,v173
CV v171,v174,v175
buffer_store_dwordx4 v[168:171],v36,s[12:15],s94 offen offset:3072 sc1
M v[164:167],a[108:111],a[60:63],0
ds_read_b64_tr_b16 a[148:149],v8 offset:32768
s_add_u32 s94,s94,s95
M v[164:167],a[104:107],a[56:59],v[164:167]
buffer_load_dwordx4 v23,s[4:7],s22 offen offset:1024 sc1 lds
M v[168:171],a[112:115],a[56:59],0
CV v176,v176,v177
CV v177,v178,v179
M v[168:171],a[116:119],a[60:63],v[168:171]
CV v178,v180,v181
CV v179,v182,v183
M v[172:175],a[124:127],a[60:63],0
buffer_store_dwordx4 v[176:179],v36,s[12:15],s94 offen sc1
M v[172:175],a[120:123],a[56:59],v[172:175]
s_nop 0
s_waitcnt lgkmcnt(5)
M v[176:179],a[64:67],a[48:51],0
ds_read_b128 a[56:59],v2 offset:34816
CV v184,v184,v185
CV v185,v186,v187
CV v186,v188,v189
M v[176:179],a[68:71],a[52:55],v[176:179]
ds_read_b128 a[60:63],v3 offset:34816
CV v187,v190,v191
M v[180:183],a[76:79],a[52:55],0
ds_read_b64_tr_b16 a[150:151],v8 offset:34816
buffer_store_dwordx4 v[184:187],v36,s[12:15],s94 offen offset:1024 sc1
s_nop 0
M v[180:183],a[72:75],a[48:51],v[180:183]
buffer_load_dwordx4 v24,s[4:7],s22 offen offset:2048 sc1 lds
M v[184:187],a[80:83],a[48:51],0
ds_read_b64_tr_b16 a[156:157],v9 offset:32768
CV v192,v192,v193
CV v193,v194,v195
M v[184:187],a[84:87],a[52:55],v[184:187]
CV v194,v196,v197
CV v195,v198,v199
M v[188:191],a[92:95],a[52:55],0
ds_read_b64_tr_b16 a[158:159],v9 offset:34816
buffer_store_dwordx4 v[192:195],v36,s[12:15],s94 offen offset:2048 sc1
M v[188:191],a[88:91],a[48:51],v[188:191]
s_nop 0
M v[192:195],a[96:99],a[48:51],0
ds_read_b64_tr_b16 a[164:165],v10 offset:32768
CV v200,v200,v201
CV v201,v202,v203
M v[192:195],a[100:103],a[52:55],v[192:195]
CV v202,v204,v205
CV v203,v206,v207
buffer_store_dwordx4 v[200:203],v36,s[12:15],s94 offen offset:3072 sc1
M v[196:199],a[108:111],a[52:55],0
ds_read_b64_tr_b16 a[166:167],v10 offset:34816
s_add_u32 s94,s94,s95
M v[196:199],a[104:107],a[48:51],v[196:199]
buffer_load_dwordx4 v25,s[4:7],s22 offen offset:3072 sc1 lds
M v[200:203],a[112:115],a[48:51],0
s_add_u32 s22,s22,128
CV v208,v208,v209
CV v209,v210,v211
M v[200:203],a[116:119],a[52:55],v[200:203]
CV v210,v212,v213
CV v211,v214,v215
M v[204:207],a[124:127],a[52:55],0
buffer_store_dwordx4 v[208:211],v36,s[12:15],s94 offen sc1
M v[204:207],a[120:123],a[48:51],v[204:207]
s_nop 0
s_waitcnt lgkmcnt(5)
M v[208:211],a[64:67],a[56:59],0
ds_read_b128 a[48:51],v2 offset:36864
CV v216,v216,v217
CV v217,v218,v219
CV v218,v220,v221
M v[208:211],a[68:71],a[60:63],v[208:211]
ds_read_b128 a[52:55],v3 offset:36864
s_add_u32 m0,s21,16384
CV v219,v222,v223
M v[212:215],a[76:79],a[60:63],0
ds_read_b64_tr_b16 a[172:173],v11 offset:32768
buffer_store_dwordx4 v[216:219],v36,s[12:15],s94 offen offset:1024 sc1
M v[212:215],a[72:75],a[56:59],v[212:215]
buffer_load_dwordx4 v26,s[8:11],s24 offen sc1 lds
s_nop 0
M v[216:219],a[80:83],a[56:59],0
ds_read_b64_tr_b16 a[174:175],v11 offset:34816
CV v224,v224,v225
CV v225,v226,v227
M v[216:219],a[84:87],a[60:63],v[216:219]
CV v226,v228,v229
CV v227,v230,v231
M v[220:223],a[92:95],a[60:63],0
ds_read_b64_tr_b16 a[180:181],v12 offset:32768
buffer_store_dwordx4 v[224:227],v36,s[12:15],s94 offen offset:2048 sc1
M v[220:223],a[88:91],a[56:59],v[220:223]
s_nop 0
M v[224:227],a[96:99],a[56:59],0
ds_read_b64_tr_b16 a[182:183],v12 offset:34816
CV v232,v232,v233
CV v233,v234,v235
M v[224:227],a[100:103],a[60:63],v[224:227]
CV v234,v236,v237
CV v235,v238,v239
M v[228:231],a[108:111],a[60:63],0
buffer_store_dwordx4 v[232:235],v36,s[12:15],s94 offen offset:3072 sc1
s_add_u32 s94,s94,s95
M v[228:231],a[104:107],a[56:59],v[228:231]
buffer_load_dwordx4 v27,s[8:11],s24 offen offset:1024 sc1 lds
M v[232:235],a[112:115],a[56:59],0
CV v240,v240,v241
CV v241,v242,v243
CV v242,v244,v245
M v[232:235],a[116:119],a[60:63],v[232:235]
CV v243,v246,v247
buffer_store_dwordx4 v[240:243],v36,s[12:15],s94 offen sc1
M v[236:239],a[124:127],a[60:63],0
buffer_load_dword v1,v37,s[64:67],0 offen
M v[236:239],a[120:123],a[56:59],v[236:239]
s_nop 0
s_waitcnt lgkmcnt(4)
M v[240:243],a[64:67],a[48:51],0
ds_read_b128 a[56:59],v2 offset:38912
CV v248,v248,v249
CV v249,v250,v251
CV v250,v252,v253
M v[240:243],a[68:71],a[52:55],v[240:243]
ds_read_b128 a[60:63],v3 offset:38912
CV v251,v254,v255
M v[244:247],a[76:79],a[52:55],0
ds_read_b64_tr_b16 a[188:189],v13 offset:32768
buffer_store_dwordx4 v[248:251],v36,s[12:15],s94 offen offset:1024 sc1
s_nop 0
M v[244:247],a[72:75],a[48:51],v[244:247]
buffer_load_dwordx4 v28,s[8:11],s24 offen offset:2048 sc1 lds
M v[248:251],a[80:83],a[48:51],0
ds_read_b64_tr_b16 a[190:191],v13 offset:34816
AR v42,a0
AR v43,a1
AR v44,a2
M v[248:251],a[84:87],a[52:55],v[248:251]
AR v45,a3
CV v30,v42,v43
CV v31,v44,v45
AR v42,a4
AR v43,a5
M v[252:255],a[92:95],a[52:55],0
AR v44,a6
AR v45,a7
CV v32,v42,v43
CV v33,v44,v45
M v[252:255],a[88:91],a[48:51],v[252:255]
buffer_store_dwordx4 v[30:33],v36,s[12:15],s94 offen offset:2048 sc1
s_nop 0
M a[0:3],a[96:99],a[48:51],0
AR v42,a8
AR v43,a9
AR v44,a10
AR v45,a11
CV v30,v42,v43
M a[0:3],a[100:103],a[52:55],a[0:3]
CV v31,v44,v45
AR v42,a12
AR v43,a13
AR v44,a14
AR v45,a15
M a[4:7],a[108:111],a[52:55],0
CV v32,v42,v43
CV v33,v44,v45
buffer_store_dwordx4 v[30:33],v36,s[12:15],s94 offen offset:3072 sc1
M a[4:7],a[104:107],a[48:51],a[4:7]
buffer_load_dwordx4 v29,s[8:11],s24 offen offset:3072 sc1 lds
s_add_u32 s94,s94,s95
M a[8:11],a[112:115],a[48:51],0
s_add_u32 s24,s24,s25
AR v42,a16
AR v43,a17
AR v44,a18
AR v45,a19
M a[8:11],a[116:119],a[52:55],a[8:11]
CV v30,v42,v43
CV v31,v44,v45
AR v42,a20
AR v43,a21
M a[12:15],a[124:127],a[52:55],0
AR v44,a22
AR v45,a23
CV v32,v42,v43
CV v33,v44,v45
M a[12:15],a[120:123],a[48:51],a[12:15]
buffer_store_dwordx4 v[30:33],v36,s[12:15],s94 offen sc1
s_nop 0
s_waitcnt vmcnt(46) lgkmcnt(0)
s_barrier
M a[16:19],a[64:67],a[56:59],0
ds_read_b128 a[48:51],v4 offset:0
AR v42,a24
AR v43,a25
AR v44,a26
AR v45,a27
CV v30,v42,v43
M a[16:19],a[68:71],a[60:63],a[16:19]
ds_read_b128 a[52:55],v5 offset:0
CV v31,v44,v45
AR v42,a28
AR v43,a29
AR v44,a30
M a[20:23],a[76:79],a[60:63],0
s_add_u32 m0,s21,32768
AR v45,a31
CV v32,v42,v43
CV v33,v44,v45
buffer_store_dwordx4 v[30:33],v36,s[12:15],s94 offen offset:1024 sc1
M a[20:23],a[72:75],a[56:59],a[20:23]
buffer_load_dwordx4 v22,s[4:7],s23 offen sc1 lds
s_nop 0
M a[24:27],a[80:83],a[56:59],0
AR v42,a32
AR v43,a33
AR v44,a34
AR v45,a35
M a[24:27],a[84:87],a[60:63],a[24:27]
CV v30,v42,v43
CV v31,v44,v45
AR v42,a36
AR v43,a37
M a[28:31],a[92:95],a[60:63],0
AR v44,a38
AR v45,a39
CV v32,v42,v43
CV v33,v44,v45
M a[28:31],a[88:91],a[56:59],a[28:31]
buffer_store_dwordx4 v[30:33],v36,s[12:15],s94 offen offset:2048 sc1
s_nop 0
M a[32:35],a[96:99],a[56:59],0
AR v42,a40
AR v43,a41
AR v44,a42
AR v45,a43
CV v30,v42,v43
M a[32:35],a[100:103],a[60:63],a[32:35]
CV v31,v44,v45
AR v42,a44
AR v43,a45
AR v44,a46
AR v45,a47
M a[36:39],a[108:111],a[60:63],0
CV v32,v42,v43
CV v33,v44,v45
buffer_store_dwordx4 v[30:33],v36,s[12:15],s94 offen offset:3072 sc1
M a[36:39],a[104:107],a[56:59],a[36:39]
buffer_load_dwordx4 v23,s[4:7],s23 offen offset:1024 sc1 lds
s_add_u32 s94,s94,s95
M a[40:43],a[112:115],a[56:59],0
M a[40:43],a[116:119],a[60:63],a[40:43]
s_sub_u32 s26,s26,1
M a[44:47],a[124:127],a[60:63],0
s_cmp_eq_u32 s26,s43
M a[44:47],a[120:123],a[56:59],a[44:47]
s_branch K1_LOOP1_KQ
HSUB_PF_F0K0:
s_call_b64 s[100:101],SUB_PF
s_branch HSUB_PF_F0K0_R
HSUB_X_KQ0:
s_mov_b64 s[4:5],s[46:47]
s_mov_b32 s6,s48
s_mov_b32 s22,0
s_mov_b32 s23,s16
AR v22,a192
AR v23,a193
AR v24,a194
AR v25,a195
s_branch HSUB_X_KQ0_R
HSUB_S_KQ0:
s_call_b64 s[100:101],SUB_S
s_branch HSUB_S_KQ0_R
HSUB_W_KQ0:
s_mov_b64 s[8:9],s[50:51]
s_mov_b32 s10,s49
s_mov_b32 s24,0
s_mov_b32 s25,s52
AR v26,a196
AR v27,a197
AR v28,a198
AR v29,a199
v_readfirstlane_b32 s30,v38
s_nop 0
s_cmp_lg_u32 s30,0
s_cbranch_scc1 HSUB_W_KQ0_R
s_cmp_eq_u32 s20,0
s_cbranch_scc0 HSUB_W_KQ0_R
s_call_b64 s[100:101],SUB_W
s_branch HSUB_W_KQ0_R
HSUB_PF_KQ0:
s_call_b64 s[100:101],SUB_PF
s_branch HSUB_PF_KQ0_R
HSUB_X_KQ1:
s_mov_b64 s[4:5],s[46:47]
s_mov_b32 s6,s48
s_mov_b32 s22,0
s_mov_b32 s23,s16
AR v22,a192
AR v23,a193
AR v24,a194
AR v25,a195
s_branch HSUB_X_KQ1_R
HSUB_S_KQ1:
s_call_b64 s[100:101],SUB_S
s_branch HSUB_S_KQ1_R
HSUB_W_KQ1:
s_mov_b64 s[8:9],s[50:51]
s_mov_b32 s10,s49
s_mov_b32 s24,0
s_mov_b32 s25,s52
AR v26,a196
AR v27,a197
AR v28,a198
AR v29,a199
v_readfirstlane_b32 s30,v38
s_nop 0
s_cmp_lg_u32 s30,0
s_cbranch_scc1 HSUB_W_KQ1_R
s_cmp_eq_u32 s20,0
s_cbranch_scc0 HSUB_W_KQ1_R
s_call_b64 s[100:101],SUB_W
s_branch HSUB_W_KQ1_R
HSUB_PF_KQ1:
s_call_b64 s[100:101],SUB_PF
s_branch HSUB_PF_KQ1_R
TLC_KQ:
s_call_b64 s[100:101],SUB_CHK
s_branch TLC_KQR
SUB_PF:
s_mov_b64 exec,s[88:89]
v_min_u32 v44,v44,v46
v_add_co_u32 v30,vcc,v42,v44
s_nop 1
v_addc_co_u32 v31,vcc,0,v43,vcc
v_add_u32 v44,v44,v45
global_load_dword v1,v[30:31],off
s_mov_b64 exec,-1
s_sub_u32 s29,s29,1
s_cmp_eq_u32 s29,5
s_cselect_b32 s88,0xffffffff,s88
s_cselect_b32 s89,0xff,s89
s_lshl_b32 s30,s20,4
s_add_u32 s30,s30,s29
s_cmp_eq_u32 s30,4
s_cbranch_scc0 SUB_RET
buffer_load_dword v38,v40,s[68:71],0 offen sc1
SUB_RET:
s_setpc_b64 s[100:101]
SUB_S:
v_mov_b32 v30,1
v_mov_b32 v31,0
s_mov_b64 exec,1
buffer_store_dword v30,v31,s[12:15],s77 offen sc1
s_mov_b64 exec,-1
s_setpc_b64 s[100:101]
SUB_W:
s_mov_b32 s32,0x80000
SUB_W3B:
buffer_load_dword v38,v40,s[68:71],0 offen sc1
s_waitcnt vmcnt(0)
v_readfirstlane_b32 s30,v38
s_sub_u32 s32,s32,1
s_cbranch_scc1 SUB_RET
s_cmp_lg_u32 s30,0
s_cbranch_scc1 SUB_RET
s_sleep 2
s_branch SUB_W3B
SUB_CHK:
v_cmp_ne_u32_e64 vcc,0,v41
s_nop 1
s_and_b32 s30,vcc_lo,s33
s_cmp_eq_u32 s30,s33
s_cbranch_scc1 SUB_RET
SUB_POLL:
s_mov_b32 s32,0x80000
s_lshl_b32 s31,s35,7
s_add_u32 s31,s31,136314880
SUB_POLL2:
buffer_load_dword v41,v40,s[12:15],s31 offen sc1
s_waitcnt vmcnt(0)
v_cmp_ne_u32 vcc,0,v41
s_sub_u32 s32,s32,1
s_cbranch_scc1 SUB_RET
s_and_b32 s30,vcc_lo,s33
s_cmp_eq_u32 s30,s33
s_cbranch_scc1 SUB_RET
s_sleep 2
s_branch SUB_POLL2
K1_IDLE:
s_load_dwordx2 s[4:5],s[0:1],64
CV v48,v48,v49
CV v49,v50,v51
CV v50,v52,v53
CV v51,v54,v55
buffer_store_dwordx4 v[48:51],v36,s[12:15],s54 offen sc1
s_nop 0
CV v56,v56,v57
CV v57,v58,v59
CV v58,v60,v61
CV v59,v62,v63
buffer_store_dwordx4 v[56:59],v36,s[12:15],s54 offen offset:1024 sc1
s_nop 0
CV v64,v64,v65
CV v65,v66,v67
CV v66,v68,v69
CV v67,v70,v71
buffer_store_dwordx4 v[64:67],v36,s[12:15],s54 offen offset:2048 sc1
s_nop 0
CV v72,v72,v73
CV v73,v74,v75
CV v74,v76,v77
CV v75,v78,v79
buffer_store_dwordx4 v[72:75],v36,s[12:15],s54 offen offset:3072 sc1
s_add_u32 s54,s54,s55
CV v80,v80,v81
CV v81,v82,v83
CV v82,v84,v85
CV v83,v86,v87
buffer_store_dwordx4 v[80:83],v36,s[12:15],s54 offen sc1
s_nop 0
CV v88,v88,v89
CV v89,v90,v91
CV v90,v92,v93
CV v91,v94,v95
buffer_store_dwordx4 v[88:91],v36,s[12:15],s54 offen offset:1024 sc1
s_nop 0
CV v96,v96,v97
CV v97,v98,v99
CV v98,v100,v101
CV v99,v102,v103
buffer_store_dwordx4 v[96:99],v36,s[12:15],s54 offen offset:2048 sc1
s_nop 0
CV v104,v104,v105
CV v105,v106,v107
CV v106,v108,v109
CV v107,v110,v111
buffer_store_dwordx4 v[104:107],v36,s[12:15],s54 offen offset:3072 sc1
s_add_u32 s54,s54,s55
CV v112,v112,v113
CV v113,v114,v115
CV v114,v116,v117
CV v115,v118,v119
buffer_store_dwordx4 v[112:115],v36,s[12:15],s54 offen sc1
s_nop 0
CV v120,v120,v121
CV v121,v122,v123
CV v122,v124,v125
CV v123,v126,v127
buffer_store_dwordx4 v[120:123],v36,s[12:15],s54 offen offset:1024 sc1
s_nop 0
CV v128,v128,v129
CV v129,v130,v131
CV v130,v132,v133
CV v131,v134,v135
buffer_store_dwordx4 v[128:131],v36,s[12:15],s54 offen offset:2048 sc1
s_nop 0
CV v136,v136,v137
CV v137,v138,v139
CV v138,v140,v141
CV v139,v142,v143
buffer_store_dwordx4 v[136:139],v36,s[12:15],s54 offen offset:3072 sc1
s_add_u32 s54,s54,s55
CV v144,v144,v145
CV v145,v146,v147
CV v146,v148,v149
CV v147,v150,v151
buffer_store_dwordx4 v[144:147],v36,s[12:15],s54 offen sc1
s_nop 0
CV v152,v152,v153
CV v153,v154,v155
CV v154,v156,v157
CV v155,v158,v159
buffer_store_dwordx4 v[152:155],v36,s[12:15],s54 offen offset:1024 sc1
s_nop 0
CV v160,v160,v161
CV v161,v162,v163
CV v162,v164,v165
CV v163,v166,v167
buffer_store_dwordx4 v[160:163],v36,s[12:15],s54 offen offset:2048 sc1
s_nop 0
CV v168,v168,v169
CV v169,v170,v171
CV v170,v172,v173
CV v171,v174,v175
buffer_store_dwordx4 v[168:171],v36,s[12:15],s54 offen offset:3072 sc1
s_add_u32 s54,s54,s55
CV v176,v176,v177
CV v177,v178,v179
CV v178,v180,v181
CV v179,v182,v183
buffer_store_dwordx4 v[176:179],v36,s[12:15],s54 offen sc1
s_nop 0
CV v184,v184,v185
CV v185,v186,v187
CV v186,v188,v189
CV v187,v190,v191
buffer_store_dwordx4 v[184:187],v36,s[12:15],s54 offen offset:1024 sc1
s_nop 0
CV v192,v192,v193
CV v193,v194,v195
CV v194,v196,v197
CV v195,v198,v199
buffer_store_dwordx4 v[192:195],v36,s[12:15],s54 offen offset:2048 sc1
s_nop 0
CV v200,v200,v201
CV v201,v202,v203
CV v202,v204,v205
CV v203,v206,v207
buffer_store_dwordx4 v[200:203],v36,s[12:15],s54 offen offset:3072 sc1
s_add_u32 s54,s54,s55
CV v208,v208,v209
CV v209,v210,v211
CV v210,v212,v213
CV v211,v214,v215
buffer_store_dwordx4 v[208:211],v36,s[12:15],s54 offen sc1
s_nop 0
CV v216,v216,v217
CV v217,v218,v219
CV v218,v220,v221
CV v219,v222,v223
buffer_store_dwordx4 v[216:219],v36,s[12:15],s54 offen offset:1024 sc1
s_nop 0
CV v224,v224,v225
CV v225,v226,v227
CV v226,v228,v229
CV v227,v230,v231
buffer_store_dwordx4 v[224:227],v36,s[12:15],s54 offen offset:2048 sc1
s_nop 0
CV v232,v232,v233
CV v233,v234,v235
CV v234,v236,v237
CV v235,v238,v239
buffer_store_dwordx4 v[232:235],v36,s[12:15],s54 offen offset:3072 sc1
s_add_u32 s54,s54,s55
CV v240,v240,v241
CV v241,v242,v243
CV v242,v244,v245
CV v243,v246,v247
buffer_store_dwordx4 v[240:243],v36,s[12:15],s54 offen sc1
s_nop 0
CV v248,v248,v249
CV v249,v250,v251
CV v250,v252,v253
CV v251,v254,v255
buffer_store_dwordx4 v[248:251],v36,s[12:15],s54 offen offset:1024 sc1
s_nop 0
AR v42,a0
AR v43,a1
AR v44,a2
AR v45,a3
CV v30,v42,v43
CV v31,v44,v45
AR v42,a4
AR v43,a5
AR v44,a6
AR v45,a7
CV v32,v42,v43
CV v33,v44,v45
buffer_store_dwordx4 v[30:33],v36,s[12:15],s54 offen offset:2048 sc1
s_nop 0
s_nop 0
AR v42,a8
AR v43,a9
AR v44,a10
AR v45,a11
CV v30,v42,v43
CV v31,v44,v45
AR v42,a12
AR v43,a13
AR v44,a14
AR v45,a15
CV v32,v42,v43
CV v33,v44,v45
buffer_store_dwordx4 v[30:33],v36,s[12:15],s54 offen offset:3072 sc1
s_add_u32 s54,s54,s55
s_nop 0
AR v42,a16
AR v43,a17
AR v44,a18
AR v45,a19
CV v30,v42,v43
CV v31,v44,v45
AR v42,a20
AR v43,a21
AR v44,a22
AR v45,a23
CV v32,v42,v43
CV v33,v44,v45
buffer_store_dwordx4 v[30:33],v36,s[12:15],s54 offen sc1
s_nop 0
s_nop 0
AR v42,a24
AR v43,a25
AR v44,a26
AR v45,a27
CV v30,v42,v43
CV v31,v44,v45
AR v42,a28
AR v43,a29
AR v44,a30
AR v45,a31
CV v32,v42,v43
CV v33,v44,v45
buffer_store_dwordx4 v[30:33],v36,s[12:15],s54 offen offset:1024 sc1
s_nop 0
s_nop 0
AR v42,a32
AR v43,a33
AR v44,a34
AR v45,a35
CV v30,v42,v43
CV v31,v44,v45
AR v42,a36
AR v43,a37
AR v44,a38
AR v45,a39
CV v32,v42,v43
CV v33,v44,v45
buffer_store_dwordx4 v[30:33],v36,s[12:15],s54 offen offset:2048 sc1
s_nop 0
s_nop 0
AR v42,a40
AR v43,a41
AR v44,a42
AR v45,a43
CV v30,v42,v43
CV v31,v44,v45
AR v42,a44
AR v43,a45
AR v44,a46
AR v45,a47
CV v32,v42,v43
CV v33,v44,v45
buffer_store_dwordx4 v[30:33],v36,s[12:15],s54 offen offset:3072 sc1
s_add_u32 s54,s54,s55
v_lshlrev_b32 v34,7,v0
s_mov_b32 s6,3670016
s_mul_i32 s30,s35,229376
s_add_u32 s30,s30,98304
s_waitcnt vmcnt(0) lgkmcnt(0)
s_barrier
s_cmp_eq_u32 s20,0
s_cbranch_scc0 K1_IDL
v_mov_b32 v30,1
v_mov_b32 v31,0
s_mov_b64 exec,1
buffer_store_dword v30,v31,s[12:15],s77 offen sc1
s_mov_b64 exec,-1
K1_IDL:
buffer_load_dword v1,v34,s[4:7],s30 offen
s_add_u32 s30,s30,32768
buffer_load_dword v1,v34,s[4:7],s30 offen
s_add_u32 s30,s30,32768
buffer_load_dword v1,v34,s[4:7],s30 offen
s_add_u32 s30,s30,32768
buffer_load_dword v1,v34,s[4:7],s30 offen
s_add_u32 s30,s30,32768
s_cmp_eq_u32 s20,0
s_cbranch_scc0 K2_SLOW2
s_mov_b32 s33,0xf80f0f
s_call_b64 s[100:101],SUB_POLL
K2_SLOW2:
s_waitcnt vmcnt(0) lgkmcnt(0)
s_barrier
s_lshl_b32 s21,s20,13
v_mov_b32_e64 v28,v36
v_add_u32 v4,s21,v36
v_add_u32 v5,4096,v4
s_lshl_b32 s30,s35,20
s_add_u32 s31,s30,16777216
s_add_u32 s32,s30,33554432
s_add_u32 s4,s40,s31
s_addc_u32 s5,s41,0
s_add_u32 s8,s40,s32
s_addc_u32 s9,s41,0
s_add_u32 s30,s76,8
s_lshl_b32 s43,s30,15
s_lshl_b32 s31,s74,16
s_add_u32 s31,s31,65536
s_lshr_b32 s32,s31,15
s_sub_u32 s32,s32,s76
s_cmp_eq_u32 s73,0
s_cselect_b32 s6,s31,s43
s_cselect_b32 s10,s31,s43
s_cselect_b32 s42,262144,-1
s_cselect_b32 s24,s32,s76
s_cselect_b32 s25,3,0
s_cselect_b32 s36,2,1
s_cselect_b32 s26,2,1
s_lshl_b32 s22,s75,15
s_mov_b32 s23,s22
s_lshr_b32 s30,s31,15
s_cmp_eq_u32 s73,2
s_cselect_b32 s6,s31,s6
s_cselect_b32 s10,s31,s10
s_cselect_b32 s24,s30,s24
s_cselect_b32 s25,3,s25
s_cselect_b32 s36,0,s36
s_cselect_b32 s26,2,s26
s_lshl_b32 s30,s35,7
s_lshl_b32 s31,s74,3
s_add_u32 s30,s30,s31
s_add_u32 s30,s30,s20
s_lshl_b32 s62,s30,13
s_add_u32 m0,s21,131072
s_nop 0
buffer_load_dwordx4 v4,s[4:7],s22 offen sc1 lds
s_load_dwordx2 s[16:17],s[0:1],64
v_mov_b32 v45,v37
v_mov_b32 v2,v28
v_add_u32 v3,0x10000,v28
v_and_b32_e64 v30,15,v35
buffer_load_dwordx4 v4,s[4:7],s22 offen offset:1024 sc1 lds
v_lshrrev_b32 v31,4,v35
v_lshlrev_b32 v31,2,v31
v_sub_u32 v7,v30,v31
s_lshl_b32 s30,s20,4
v_add_u32_e64 v7,s30,v7
buffer_load_dwordx4 v4,s[4:7],s22 offen offset:2048 sc1 lds
s_lshl_b32 s30,s35,3
s_add_u32 s30,s30,s72
s_lshl_b32 s30,s30,2
s_add_u32 s30,s30,s20
s_mul_i32 s37,s30,17408
buffer_load_dwordx4 v4,s[4:7],s22 offen offset:3072 sc1 lds
s_add_u32 s37,s37,83886080
s_mov_b32 s80,s12
s_mov_b32 s81,s13
s_mov_b32 s83,0x20000
s_cmp_eq_u32 s73,0
s_cselect_b32 s82,138412032,0
s_add_u32 m0,s21,135168
s_nop 0
buffer_load_dwordx4 v5,s[4:7],s22 offen sc1 lds
s_add_u32 s30,s72,24
s_lshl_b32 s28,1,s30
s_cmp_eq_u32 s73,0
s_cselect_b32 s28,s28,0
buffer_load_dwordx4 v5,s[4:7],s22 offen offset:1024 sc1 lds
s_sub_u32 s30,7,s72
s_lshr_b32 s30,s30,1
s_add_u32 s30,s30,16
s_lshl_b32 s29,1,s30
s_cmp_eq_u32 s73,1
s_cselect_b32 s29,s29,0
buffer_load_dwordx4 v5,s[4:7],s22 offen offset:2048 sc1 lds
s_sub_u32 s30,s6,1
s_lshr_b32 s30,s30,17
s_add_u32 s30,s30,1
s_bfm_b32 s30,s30,0
buffer_load_dwordx4 v5,s[4:7],s22 offen offset:3072 sc1 lds
s_mul_i32 s30,s30,0x101
s_or_b32 s29,s29,s30
s_mul_i32 s61,s20,57344
s_add_u32 s56,s61,28672
v_lshrrev_b32_e64 v30,3,v35
s_add_u32 s53,s62,0
buffer_load_dwordx4 a[192:195],v28,s[12:15],s53 offen sc1
v_mul_u32_u24 v30,896,v30
v_lshrrev_b32 v31,4,v35
v_lshlrev_b32 v31,1,v31
v_and_b32 v32,7,v35
v_xor_b32 v31,v31,v32
buffer_load_dwordx4 a[196:199],v28,s[12:15],s53 offen offset:1024 sc1
v_lshl_add_u32 v112,v31,4,v30
v_add_u32 v113,6144,v112
v_add_u32 v114,12288,v112
v_add_u32 v115,18432,v112
v_lshrrev_b32_e64 v30,2,v35
buffer_load_dwordx4 a[200:203],v28,s[12:15],s53 offen offset:2048 sc1
v_lshrrev_b32 v31,1,v30
v_and_b32 v31,3,v31
v_and_b32 v32,3,v35
v_lshlrev_b32 v32,3,v32
v_lshl_add_u32 v30,v30,7,v32
buffer_load_dwordx4 a[204:207],v28,s[12:15],s53 offen offset:3072 sc1
v_xor_b32_e64 v32,0,v31
v_lshl_add_u32 v116,v32,5,v30
v_add_u32 v120,0x10000,v116
v_add_u32 v124,0x20000,v116
v_xor_b32_e64 v32,1,v31
s_add_u32 s53,s62,4096
buffer_load_dwordx4 a[208:211],v28,s[12:15],s53 offen sc1
v_lshl_add_u32 v117,v32,5,v30
v_add_u32 v121,0x10000,v117
v_add_u32 v125,0x20000,v117
v_xor_b32_e64 v32,2,v31
v_lshl_add_u32 v118,v32,5,v30
buffer_load_dwordx4 a[212:215],v28,s[12:15],s53 offen offset:1024 sc1
v_add_u32 v122,0x10000,v118
v_add_u32 v126,0x20000,v118
v_xor_b32_e64 v32,3,v31
v_lshl_add_u32 v119,v32,5,v30
v_add_u32 v123,0x10000,v119
buffer_load_dwordx4 a[216:219],v28,s[12:15],s53 offen offset:2048 sc1
v_add_u32 v44,0x20000,v119
s_mov_b32 s30,0x40000000
s_cmp_eq_u32 s27,15
s_cselect_b32 s30,0xfffe0000,s30
v_lshlrev_b32_e64 v42,7,v0
buffer_load_dwordx4 a[220:223],v28,s[12:15],s53 offen offset:3072 sc1
v_add_u32 v42,s30,v42
s_mul_i32 s30,s35,229376
s_waitcnt lgkmcnt(0)
s_add_u32 s16,s16,s30
s_addc_u32 s17,s17,0
s_add_u32 s53,s62,32768
buffer_load_dwordx4 a[224:227],v28,s[12:15],s53 offen sc1
s_mov_b32 s18,229376
s_mov_b32 s19,0x20000
v_add_u32 v29,0x20000,v28
AW a0,0
AW a1,0
buffer_load_dwordx4 a[228:231],v28,s[12:15],s53 offen offset:1024 sc1
AW a2,0
AW a3,0
AW a4,0
AW a5,0
AW a6,0
buffer_load_dwordx4 a[232:235],v28,s[12:15],s53 offen offset:2048 sc1
AW a7,0
AW a8,0
AW a9,0
AW a10,0
AW a11,0
buffer_load_dwordx4 a[236:239],v28,s[12:15],s53 offen offset:3072 sc1
AW a12,0
AW a13,0
AW a14,0
AW a15,0
AW a16,0
s_add_u32 s53,s62,36864
buffer_load_dwordx4 a[240:243],v28,s[12:15],s53 offen sc1
AW a17,0
AW a18,0
AW a19,0
AW a20,0
AW a21,0
buffer_load_dwordx4 a[244:247],v28,s[12:15],s53 offen offset:1024 sc1
AW a22,0
AW a23,0
AW a24,0
AW a25,0
AW a26,0
buffer_load_dwordx4 a[248:251],v28,s[12:15],s53 offen offset:2048 sc1
AW a27,0
AW a28,0
AW a29,0
AW a30,0
AW a31,0
buffer_load_dwordx4 a[252:255],v28,s[12:15],s53 offen offset:3072 sc1
AW a32,0
AW a33,0
AW a34,0
AW a35,0
AW a36,0
s_add_u32 s22,s22,32768
s_cmp_eq_u32 s22,s42
s_cselect_b32 s22,s43,s22
s_add_u32 m0,s21,98304
s_nop 0
s_nop 0
buffer_load_dwordx4 v4,s[4:7],s22 offen sc1 lds
AW a37,0
AW a38,0
AW a39,0
AW a40,0
AW a41,0
buffer_load_dwordx4 v4,s[4:7],s22 offen offset:1024 sc1 lds
AW a42,0
AW a43,0
AW a44,0
AW a45,0
AW a46,0
buffer_load_dwordx4 v4,s[4:7],s22 offen offset:2048 sc1 lds
AW a47,0
AW a48,0
AW a49,0
AW a50,0
AW a51,0
buffer_load_dwordx4 v4,s[4:7],s22 offen offset:3072 sc1 lds
AW a52,0
AW a53,0
AW a54,0
AW a55,0
AW a56,0
s_add_u32 m0,s21,102400
s_nop 0
s_nop 0
buffer_load_dwordx4 v5,s[4:7],s22 offen sc1 lds
AW a57,0
AW a58,0
AW a59,0
AW a60,0
AW a61,0
buffer_load_dwordx4 v5,s[4:7],s22 offen offset:1024 sc1 lds
AW a62,0
AW a63,0
AW a64,0
AW a65,0
AW a66,0
buffer_load_dwordx4 v5,s[4:7],s22 offen offset:2048 sc1 lds
AW a67,0
AW a68,0
AW a69,0
AW a70,0
AW a71,0
buffer_load_dwordx4 v5,s[4:7],s22 offen offset:3072 sc1 lds
AW a72,0
AW a73,0
AW a74,0
AW a75,0
AW a76,0
s_add_u32 s22,s22,32768
s_cmp_eq_u32 s22,s42
s_cselect_b32 s22,s43,s22
s_add_u32 m0,s21,0
s_nop 0
buffer_load_dwordx4 v4,s[8:11],s23 offen sc1 lds
AW a77,0
AW a78,0
AW a79,0
AW a80,0
AW a81,0
buffer_load_dwordx4 v4,s[8:11],s23 offen offset:1024 sc1 lds
AW a82,0
AW a83,0
AW a84,0
AW a85,0
AW a86,0
buffer_load_dwordx4 v4,s[8:11],s23 offen offset:2048 sc1 lds
AW a87,0
AW a88,0
AW a89,0
AW a90,0
AW a91,0
buffer_load_dwordx4 v4,s[8:11],s23 offen offset:3072 sc1 lds
AW a92,0
AW a93,0
AW a94,0
AW a95,0
AW a96,0
s_add_u32 m0,s21,4096
s_nop 0
s_nop 0
buffer_load_dwordx4 v5,s[8:11],s23 offen sc1 lds
AW a97,0
AW a98,0
AW a99,0
AW a100,0
AW a101,0
buffer_load_dwordx4 v5,s[8:11],s23 offen offset:1024 sc1 lds
AW a102,0
AW a103,0
AW a104,0
AW a105,0
AW a106,0
buffer_load_dwordx4 v5,s[8:11],s23 offen offset:2048 sc1 lds
AW a107,0
AW a108,0
AW a109,0
AW a110,0
AW a111,0
buffer_load_dwordx4 v5,s[8:11],s23 offen offset:3072 sc1 lds
AW a112,0
AW a113,0
AW a114,0
AW a115,0
AW a116,0
s_add_u32 s23,s23,32768
s_cmp_eq_u32 s23,s42
s_cselect_b32 s23,s43,s23
s_add_u32 m0,s21,32768
s_nop 0
s_nop 0
buffer_load_dwordx4 v4,s[4:7],s22 offen sc1 lds
AW a117,0
AW a118,0
AW a119,0
AW a120,0
AW a121,0
buffer_load_dwordx4 v4,s[4:7],s22 offen offset:1024 sc1 lds
AW a122,0
AW a123,0
AW a124,0
AW a125,0
AW a126,0
AW a127,0
s_mov_b32 s38,0
s_mov_b32 s60,1
s_sub_u32 s39,s24,4
s_cmp_ge_u32 s24,6
s_cselect_b32 s39,s39,0
s_waitcnt vmcnt(18)
s_branch K2_SEG0
K1_APOLL:
s_mov_b32 s32,0x80000
s_mov_b32 s31,136318976
K1_APOLL2:
buffer_load_dword v39,v40,s[12:15],s31 offen sc1
s_waitcnt vmcnt(0)
v_cmp_ne_u32 vcc,0,v39
s_sub_u32 s32,s32,1
s_cbranch_scc1 K1_APOLLD
s_andn2_b64 vcc,s[56:57],vcc
s_cbranch_scc0 K1_APOLLD
s_sleep 2
s_branch K1_APOLL2
K1_XAT:
v_readfirstlane_b32 s30,v38
s_add_u32 s30,s30,s20
s_cmp_lg_u32 s30,0
s_cbranch_scc1 K1_XAT2
s_call_b64 s[100:101],SUB_W
K1_XAT2:
s_waitcnt lgkmcnt(0)
M v[48:51],a[48:51],a[128:131],v[48:51]
ds_read_b128 a[56:59],v4 offset:2048
M v[48:51],a[52:55],a[132:135],v[48:51]
ds_read_b128 a[60:63],v5 offset:2048
M v[52:55],a[52:55],a[140:143],v[52:55]
ds_read_b64_tr_b16 a[64:65],v14 offset:0
M v[52:55],a[48:51],a[136:139],v[52:55]
buffer_load_dwordx4 v24,s[4:7],s23 offen offset:2048 sc1 lds
M v[56:59],a[48:51],a[144:147],v[56:59]
ds_read_b64_tr_b16 a[66:67],v14 offset:2048
M v[56:59],a[52:55],a[148:151],v[56:59]
M v[60:63],a[52:55],a[156:159],v[60:63]
ds_read_b64_tr_b16 a[72:73],v15 offset:0
M v[60:63],a[48:51],a[152:155],v[60:63]
M v[64:67],a[48:51],a[160:163],v[64:67]
ds_read_b64_tr_b16 a[74:75],v15 offset:2048
M v[64:67],a[52:55],a[164:167],v[64:67]
M v[68:71],a[52:55],a[172:175],v[68:71]
ds_read_b64_tr_b16 a[80:81],v16 offset:0
M v[68:71],a[48:51],a[168:171],v[68:71]
buffer_load_dwordx4 v25,s[4:7],s23 offen offset:3072 sc1 lds
M v[72:75],a[48:51],a[176:179],v[72:75]
ds_read_b64_tr_b16 a[82:83],v16 offset:2048
M v[72:75],a[52:55],a[180:183],v[72:75]
s_add_u32 s23,s23,128
M v[76:79],a[52:55],a[188:191],v[76:79]
M v[76:79],a[48:51],a[184:187],v[76:79]
s_waitcnt lgkmcnt(6)
M v[80:83],a[56:59],a[128:131],v[80:83]
ds_read_b128 a[48:51],v4 offset:4096
M v[80:83],a[60:63],a[132:135],v[80:83]
ds_read_b128 a[52:55],v5 offset:4096
s_add_u32 m0,s21,49152
M v[84:87],a[60:63],a[140:143],v[84:87]
ds_read_b64_tr_b16 a[88:89],v17 offset:0
M v[84:87],a[56:59],a[136:139],v[84:87]
buffer_load_dwordx4 v26,s[8:11],s24 offen sc1 lds
M v[88:91],a[56:59],a[144:147],v[88:91]
ds_read_b64_tr_b16 a[90:91],v17 offset:2048
M v[88:91],a[60:63],a[148:151],v[88:91]
M v[92:95],a[60:63],a[156:159],v[92:95]
ds_read_b64_tr_b16 a[96:97],v18 offset:0
M v[92:95],a[56:59],a[152:155],v[92:95]
M v[96:99],a[56:59],a[160:163],v[96:99]
ds_read_b64_tr_b16 a[98:99],v18 offset:2048
M v[96:99],a[60:63],a[164:167],v[96:99]
M v[100:103],a[60:63],a[172:175],v[100:103]
ds_read_b64_tr_b16 a[104:105],v19 offset:0
M v[100:103],a[56:59],a[168:171],v[100:103]
buffer_load_dwordx4 v27,s[8:11],s24 offen offset:1024 sc1 lds
M v[104:107],a[56:59],a[176:179],v[104:107]
ds_read_b64_tr_b16 a[106:107],v19 offset:2048
M v[104:107],a[60:63],a[180:183],v[104:107]
M v[108:111],a[60:63],a[188:191],v[108:111]
M v[108:111],a[56:59],a[184:187],v[108:111]
s_waitcnt lgkmcnt(6)
M v[112:115],a[48:51],a[128:131],v[112:115]
ds_read_b128 a[56:59],v4 offset:6144
M v[112:115],a[52:55],a[132:135],v[112:115]
ds_read_b128 a[60:63],v5 offset:6144
M v[116:119],a[52:55],a[140:143],v[116:119]
ds_read_b64_tr_b16 a[112:113],v20 offset:0
M v[116:119],a[48:51],a[136:139],v[116:119]
buffer_load_dwordx4 v28,s[8:11],s24 offen offset:2048 sc1 lds
M v[120:123],a[48:51],a[144:147],v[120:123]
ds_read_b64_tr_b16 a[114:115],v20 offset:2048
M v[120:123],a[52:55],a[148:151],v[120:123]
M v[124:127],a[52:55],a[156:159],v[124:127]
ds_read_b64_tr_b16 a[120:121],v21 offset:0
M v[124:127],a[48:51],a[152:155],v[124:127]
M v[128:131],a[48:51],a[160:163],v[128:131]
ds_read_b64_tr_b16 a[122:123],v21 offset:2048
M v[128:131],a[52:55],a[164:167],v[128:131]
M v[132:135],a[52:55],a[172:175],v[132:135]
M v[132:135],a[48:51],a[168:171],v[132:135]
buffer_load_dwordx4 v29,s[8:11],s24 offen offset:3072 sc1 lds
M v[136:139],a[48:51],a[176:179],v[136:139]
s_add_u32 s24,s24,s25
M v[136:139],a[52:55],a[180:183],v[136:139]
M v[140:143],a[52:55],a[188:191],v[140:143]
M v[140:143],a[48:51],a[184:187],v[140:143]
s_waitcnt vmcnt(17) lgkmcnt(0)
s_barrier
M v[144:147],a[56:59],a[128:131],v[144:147]
ds_read_b128 a[48:51],v4 offset:32768
M v[144:147],a[60:63],a[132:135],v[144:147]
ds_read_b128 a[52:55],v5 offset:32768
s_add_u32 m0,s21,65536
M v[148:151],a[60:63],a[140:143],v[148:151]
ds_read_b64_tr_b16 a[68:69],v14 offset:32768
M v[148:151],a[56:59],a[136:139],v[148:151]
buffer_load_dwordx4 v22,s[4:7],s22 offen sc1 lds
M v[152:155],a[56:59],a[144:147],v[152:155]
ds_read_b64_tr_b16 a[70:71],v14 offset:34816
M v[152:155],a[60:63],a[148:151],v[152:155]
M v[156:159],a[60:63],a[156:159],v[156:159]
ds_read_b64_tr_b16 a[76:77],v15 offset:32768
M v[156:159],a[56:59],a[152:155],v[156:159]
M v[160:163],a[56:59],a[160:163],v[160:163]
ds_read_b64_tr_b16 a[78:79],v15 offset:34816
M v[160:163],a[60:63],a[164:167],v[160:163]
M v[164:167],a[60:63],a[172:175],v[164:167]
ds_read_b64_tr_b16 a[84:85],v16 offset:32768
M v[164:167],a[56:59],a[168:171],v[164:167]
buffer_load_dwordx4 v23,s[4:7],s22 offen offset:1024 sc1 lds
M v[168:171],a[56:59],a[176:179],v[168:171]
M v[168:171],a[60:63],a[180:183],v[168:171]
M v[172:175],a[60:63],a[188:191],v[172:175]
M v[172:175],a[56:59],a[184:187],v[172:175]
s_waitcnt lgkmcnt(5)
M v[176:179],a[48:51],a[128:131],v[176:179]
ds_read_b128 a[56:59],v4 offset:34816
M v[176:179],a[52:55],a[132:135],v[176:179]
ds_read_b128 a[60:63],v5 offset:34816
M v[180:183],a[52:55],a[140:143],v[180:183]
ds_read_b64_tr_b16 a[86:87],v16 offset:34816
M v[180:183],a[48:51],a[136:139],v[180:183]
buffer_load_dwordx4 v24,s[4:7],s22 offen offset:2048 sc1 lds
M v[184:187],a[48:51],a[144:147],v[184:187]
ds_read_b64_tr_b16 a[92:93],v17 offset:32768
M v[184:187],a[52:55],a[148:151],v[184:187]
M v[188:191],a[52:55],a[156:159],v[188:191]
ds_read_b64_tr_b16 a[94:95],v17 offset:34816
M v[188:191],a[48:51],a[152:155],v[188:191]
M v[192:195],a[48:51],a[160:163],v[192:195]
ds_read_b64_tr_b16 a[100:101],v18 offset:32768
M v[192:195],a[52:55],a[164:167],v[192:195]
M v[196:199],a[52:55],a[172:175],v[196:199]
ds_read_b64_tr_b16 a[102:103],v18 offset:34816
M v[196:199],a[48:51],a[168:171],v[196:199]
buffer_load_dwordx4 v25,s[4:7],s22 offen offset:3072 sc1 lds
M v[200:203],a[48:51],a[176:179],v[200:203]
s_add_u32 s22,s22,128
M v[200:203],a[52:55],a[180:183],v[200:203]
M v[204:207],a[52:55],a[188:191],v[204:207]
M v[204:207],a[48:51],a[184:187],v[204:207]
s_waitcnt lgkmcnt(5)
M v[208:211],a[56:59],a[128:131],v[208:211]
ds_read_b128 a[48:51],v4 offset:36864
M v[208:211],a[60:63],a[132:135],v[208:211]
ds_read_b128 a[52:55],v5 offset:36864
M v[212:215],a[60:63],a[140:143],v[212:215]
ds_read_b64_tr_b16 a[108:109],v19 offset:32768
M v[212:215],a[56:59],a[136:139],v[212:215]
M v[216:219],a[56:59],a[144:147],v[216:219]
ds_read_b64_tr_b16 a[110:111],v19 offset:34816
M v[216:219],a[60:63],a[148:151],v[216:219]
s_lshl_b32 s80,s58,3
s_add_u32 s80,s80,s59
M v[220:223],a[60:63],a[156:159],v[220:223]
ds_read_b64_tr_b16 a[116:117],v20 offset:32768
s_sub_u32 s80,s80,8
s_lshl_b32 s94,s80,15
M v[220:223],a[56:59],a[152:155],v[220:223]
s_lshl_b32 s31,s20,12
s_add_u32 s94,s94,s31
M v[224:227],a[56:59],a[160:163],v[224:227]
ds_read_b64_tr_b16 a[118:119],v20 offset:34816
s_add_u32 s94,s94,67108864
s_lshl_b32 s95,s80,15
M v[224:227],a[60:63],a[164:167],v[224:227]
s_lshl_b32 s31,s20,13
s_add_u32 s95,s95,s31
M v[228:231],a[60:63],a[172:175],v[228:231]
s_add_u32 s95,s95,71303168
s_cmp_eq_u32 s80,0
M v[228:231],a[56:59],a[168:171],v[228:231]
s_cselect_b32 s82,0,16384
s_cselect_b32 s83,0,32768
M v[232:235],a[56:59],a[176:179],v[232:235]
M v[232:235],a[60:63],a[180:183],v[232:235]
M v[236:239],a[60:63],a[188:191],v[236:239]
buffer_load_dword v1,v37,s[64:67],0 offen
M v[236:239],a[56:59],a[184:187],v[236:239]
s_waitcnt lgkmcnt(4)
M v[240:243],a[48:51],a[128:131],v[240:243]
ds_read_b128 a[56:59],v4 offset:38912
M v[240:243],a[52:55],a[132:135],v[240:243]
ds_read_b128 a[60:63],v5 offset:38912
M v[244:247],a[52:55],a[140:143],v[244:247]
ds_read_b64_tr_b16 a[124:125],v21 offset:32768
M v[244:247],a[48:51],a[136:139],v[244:247]
M v[248:251],a[48:51],a[144:147],v[248:251]
ds_read_b64_tr_b16 a[126:127],v21 offset:34816
M v[248:251],a[52:55],a[148:151],v[248:251]
s_load_dwordx2 s[8:9],s[0:1],16
M v[252:255],a[52:55],a[156:159],v[252:255]
M v[252:255],a[48:51],a[152:155],v[252:255]
s_mov_b32 s10,401408
s_mul_i32 s81,s20,7168
M a[0:3],a[48:51],a[160:163],a[0:3]
s_mov_b32 s45,s81
v_bfe_u32 v30,v36,8,2
M a[0:3],a[52:55],a[164:167],a[0:3]
v_lshlrev_b32 v30,5,v30
v_xor_b32 v26,v30,v36
M a[4:7],a[52:55],a[172:175],a[4:7]
v_add_u32 v27,4096,v26
M a[4:7],a[48:51],a[168:171],a[4:7]
M a[8:11],a[48:51],a[176:179],a[8:11]
s_add_u32 s24,s24,s25
M a[8:11],a[52:55],a[180:183],a[8:11]
M a[12:15],a[52:55],a[188:191],a[12:15]
M a[12:15],a[48:51],a[184:187],a[12:15]
s_waitcnt vmcnt(13) lgkmcnt(0)
s_barrier
M a[16:19],a[56:59],a[128:131],a[16:19]
ds_read_b128 a[48:51],v2 offset:0
M a[16:19],a[60:63],a[132:135],a[16:19]
ds_read_b128 a[52:55],v3 offset:0
M a[20:23],a[60:63],a[140:143],a[20:23]
s_add_u32 m0,s21,98304
M a[20:23],a[56:59],a[136:139],a[20:23]
buffer_load_dwordx4 v22,s[4:7],s23 offen sc1 lds
M a[24:27],a[56:59],a[144:147],a[24:27]
M a[24:27],a[60:63],a[148:151],a[24:27]
M a[28:31],a[60:63],a[156:159],a[28:31]
M a[28:31],a[56:59],a[152:155],a[28:31]
M a[32:35],a[56:59],a[160:163],a[32:35]
M a[32:35],a[60:63],a[164:167],a[32:35]
M a[36:39],a[60:63],a[172:175],a[36:39]
M a[36:39],a[56:59],a[168:171],a[36:39]
buffer_load_dwordx4 v23,s[4:7],s23 offen offset:1024 sc1 lds
M a[40:43],a[56:59],a[176:179],a[40:43]
M a[40:43],a[60:63],a[180:183],a[40:43]
s_sub_u32 s26,s26,1
M a[44:47],a[60:63],a[188:191],a[44:47]
s_cmp_eq_u32 s26,s43
M a[44:47],a[56:59],a[184:187],a[44:47]
s_waitcnt lgkmcnt(0)
M v[48:51],a[48:51],a[64:67],v[48:51]
ds_read_b128 a[56:59],v2 offset:2048
M v[48:51],a[52:55],a[68:71],v[48:51]
ds_read_b128 a[60:63],v3 offset:2048
M v[52:55],a[52:55],a[76:79],v[52:55]
ds_read_b64_tr_b16 a[128:129],v6 offset:0
M v[52:55],a[48:51],a[72:75],v[52:55]
buffer_load_dwordx4 v24,s[4:7],s23 offen offset:2048 sc1 lds
M v[56:59],a[48:51],a[80:83],v[56:59]
ds_read_b64_tr_b16 a[130:131],v6 offset:2048
M v[56:59],a[52:55],a[84:87],v[56:59]
s_mov_b32 s31,136318976
M v[60:63],a[52:55],a[92:95],v[60:63]
ds_read_b64_tr_b16 a[136:137],v7 offset:0
M v[60:63],a[48:51],a[88:91],v[60:63]
buffer_load_dword v39,v40,s[12:15],s31 offen sc1
M v[64:67],a[48:51],a[96:99],v[64:67]
ds_read_b64_tr_b16 a[138:139],v7 offset:2048
M v[64:67],a[52:55],a[100:103],v[64:67]
M v[68:71],a[52:55],a[108:111],v[68:71]
ds_read_b64_tr_b16 a[144:145],v8 offset:0
M v[68:71],a[48:51],a[104:107],v[68:71]
buffer_load_dwordx4 v25,s[4:7],s23 offen offset:3072 sc1 lds
M v[72:75],a[48:51],a[112:115],v[72:75]
ds_read_b64_tr_b16 a[146:147],v8 offset:2048
M v[72:75],a[52:55],a[116:119],v[72:75]
s_add_u32 s23,s23,128
M v[76:79],a[52:55],a[124:127],v[76:79]
M v[76:79],a[48:51],a[120:123],v[76:79]
s_waitcnt lgkmcnt(6)
M v[80:83],a[56:59],a[64:67],v[80:83]
ds_read_b128 a[48:51],v2 offset:4096
M v[80:83],a[60:63],a[68:71],v[80:83]
ds_read_b128 a[52:55],v3 offset:4096
M v[84:87],a[60:63],a[76:79],v[84:87]
ds_read_b64_tr_b16 a[152:153],v9 offset:0
M v[84:87],a[56:59],a[72:75],v[84:87]
M v[88:91],a[56:59],a[80:83],v[88:91]
ds_read_b64_tr_b16 a[154:155],v9 offset:2048
M v[88:91],a[60:63],a[84:87],v[88:91]
M v[92:95],a[60:63],a[92:95],v[92:95]
ds_read_b64_tr_b16 a[160:161],v10 offset:0
M v[92:95],a[56:59],a[88:91],v[92:95]
M v[96:99],a[56:59],a[96:99],v[96:99]
ds_read_b64_tr_b16 a[162:163],v10 offset:2048
M v[96:99],a[60:63],a[100:103],v[96:99]
M v[100:103],a[60:63],a[108:111],v[100:103]
ds_read_b64_tr_b16 a[168:169],v11 offset:0
M v[100:103],a[56:59],a[104:107],v[100:103]
M v[104:107],a[56:59],a[112:115],v[104:107]
ds_read_b64_tr_b16 a[170:171],v11 offset:2048
M v[104:107],a[60:63],a[116:119],v[104:107]
s_mul_i32 s30,s58,6
s_lshl_b64 s[56:57],63,s30
M v[108:111],a[60:63],a[124:127],v[108:111]
s_lshr_b64 s[46:47],s[56:57],6
s_cmp_eq_u32 s59,8
M v[108:111],a[56:59],a[120:123],v[108:111]
s_cselect_b64 s[46:47],s[46:47],0
s_or_b64 s[56:57],s[56:57],s[46:47]
s_waitcnt lgkmcnt(6)
M v[112:115],a[48:51],a[64:67],v[112:115]
ds_read_b128 a[56:59],v2 offset:6144
M v[112:115],a[52:55],a[68:71],v[112:115]
ds_read_b128 a[60:63],v3 offset:6144
M v[116:119],a[52:55],a[76:79],v[116:119]
ds_read_b64_tr_b16 a[176:177],v12 offset:0
M v[116:119],a[48:51],a[72:75],v[116:119]
M v[120:123],a[48:51],a[80:83],v[120:123]
ds_read_b64_tr_b16 a[178:179],v12 offset:2048
M v[120:123],a[52:55],a[84:87],v[120:123]
M v[124:127],a[52:55],a[92:95],v[124:127]
ds_read_b64_tr_b16 a[184:185],v13 offset:0
M v[124:127],a[48:51],a[88:91],v[124:127]
M v[128:131],a[48:51],a[96:99],v[128:131]
ds_read_b64_tr_b16 a[186:187],v13 offset:2048
M v[128:131],a[52:55],a[100:103],v[128:131]
M v[132:135],a[52:55],a[108:111],v[132:135]
M v[132:135],a[48:51],a[104:107],v[132:135]
M v[136:139],a[48:51],a[112:115],v[136:139]
s_add_u32 s24,s24,s25
M v[136:139],a[52:55],a[116:119],v[136:139]
M v[140:143],a[52:55],a[124:127],v[140:143]
M v[140:143],a[48:51],a[120:123],v[140:143]
s_waitcnt vmcnt(10) lgkmcnt(0)
s_barrier
M v[144:147],a[56:59],a[64:67],v[144:147]
ds_read_b128 a[48:51],v2 offset:32768
M v[144:147],a[60:63],a[68:71],v[144:147]
ds_read_b128 a[52:55],v3 offset:32768
M v[148:151],a[60:63],a[76:79],v[148:151]
ds_read_b64_tr_b16 a[132:133],v6 offset:32768
s_add_u32 m0,s45,0
M v[148:151],a[56:59],a[72:75],v[148:151]
buffer_load_dwordx4 v26,s[8:11],s81 offen lds
M v[152:155],a[56:59],a[80:83],v[152:155]
ds_read_b64_tr_b16 a[134:135],v6 offset:34816
M v[152:155],a[60:63],a[84:87],v[152:155]
M v[156:159],a[60:63],a[92:95],v[156:159]
ds_read_b64_tr_b16 a[140:141],v7 offset:32768
M v[156:159],a[56:59],a[88:91],v[156:159]
M v[160:163],a[56:59],a[96:99],v[160:163]
ds_read_b64_tr_b16 a[142:143],v7 offset:34816
M v[160:163],a[60:63],a[100:103],v[160:163]
M v[164:167],a[60:63],a[108:111],v[164:167]
ds_read_b64_tr_b16 a[148:149],v8 offset:32768
M v[164:167],a[56:59],a[104:107],v[164:167]
buffer_load_dwordx4 v26,s[8:11],s81 offen offset:1024 lds
M v[168:171],a[56:59],a[112:115],v[168:171]
M v[168:171],a[60:63],a[116:119],v[168:171]
M v[172:175],a[60:63],a[124:127],v[172:175]
M v[172:175],a[56:59],a[120:123],v[172:175]
s_waitcnt lgkmcnt(5)
M v[176:179],a[48:51],a[64:67],v[176:179]
ds_read_b128 a[56:59],v2 offset:34816
M v[176:179],a[52:55],a[68:71],v[176:179]
ds_read_b128 a[60:63],v3 offset:34816
M v[180:183],a[52:55],a[76:79],v[180:183]
ds_read_b64_tr_b16 a[150:151],v8 offset:34816
M v[180:183],a[48:51],a[72:75],v[180:183]
buffer_load_dwordx4 v26,s[8:11],s81 offen offset:2048 lds
M v[184:187],a[48:51],a[80:83],v[184:187]
ds_read_b64_tr_b16 a[156:157],v9 offset:32768
M v[184:187],a[52:55],a[84:87],v[184:187]
M v[188:191],a[52:55],a[92:95],v[188:191]
ds_read_b64_tr_b16 a[158:159],v9 offset:34816
M v[188:191],a[48:51],a[88:91],v[188:191]
M v[192:195],a[48:51],a[96:99],v[192:195]
ds_read_b64_tr_b16 a[164:165],v10 offset:32768
M v[192:195],a[52:55],a[100:103],v[192:195]
M v[196:199],a[52:55],a[108:111],v[196:199]
ds_read_b64_tr_b16 a[166:167],v10 offset:34816
M v[196:199],a[48:51],a[104:107],v[196:199]
buffer_load_dwordx4 v26,s[8:11],s81 offen offset:3072 lds
M v[200:203],a[48:51],a[112:115],v[200:203]
s_add_u32 s22,s22,128
M v[200:203],a[52:55],a[116:119],v[200:203]
M v[204:207],a[52:55],a[124:127],v[204:207]
M v[204:207],a[48:51],a[120:123],v[204:207]
s_waitcnt lgkmcnt(5)
M v[208:211],a[56:59],a[64:67],v[208:211]
ds_read_b128 a[48:51],v2 offset:36864
M v[208:211],a[60:63],a[68:71],v[208:211]
ds_read_b128 a[52:55],v3 offset:36864
M v[212:215],a[60:63],a[76:79],v[212:215]
ds_read_b64_tr_b16 a[172:173],v11 offset:32768
s_add_u32 m0,s45,4096
M v[212:215],a[56:59],a[72:75],v[212:215]
buffer_load_dwordx4 v27,s[8:11],s81 offen lds
M v[216:219],a[56:59],a[80:83],v[216:219]
ds_read_b64_tr_b16 a[174:175],v11 offset:34816
M v[216:219],a[60:63],a[84:87],v[216:219]
M v[220:223],a[60:63],a[92:95],v[220:223]
ds_read_b64_tr_b16 a[180:181],v12 offset:32768
M v[220:223],a[56:59],a[88:91],v[220:223]
M v[224:227],a[56:59],a[96:99],v[224:227]
ds_read_b64_tr_b16 a[182:183],v12 offset:34816
M v[224:227],a[60:63],a[100:103],v[224:227]
M v[228:231],a[60:63],a[108:111],v[228:231]
M v[228:231],a[56:59],a[104:107],v[228:231]
buffer_load_dwordx4 v27,s[8:11],s81 offen offset:1024 lds
M v[232:235],a[56:59],a[112:115],v[232:235]
M v[232:235],a[60:63],a[116:119],v[232:235]
M v[236:239],a[60:63],a[124:127],v[236:239]
buffer_load_dword v1,v37,s[64:67],0 offen
M v[236:239],a[56:59],a[120:123],v[236:239]
s_waitcnt lgkmcnt(4)
M v[240:243],a[48:51],a[64:67],v[240:243]
ds_read_b128 a[56:59],v2 offset:38912
M v[240:243],a[52:55],a[68:71],v[240:243]
ds_read_b128 a[60:63],v3 offset:38912
M v[244:247],a[52:55],a[76:79],v[244:247]
ds_read_b64_tr_b16 a[188:189],v13 offset:32768
M v[244:247],a[48:51],a[72:75],v[244:247]
buffer_load_dwordx4 v27,s[8:11],s81 offen offset:2048 lds
M v[248:251],a[48:51],a[80:83],v[248:251]
ds_read_b64_tr_b16 a[190:191],v13 offset:34816
s_add_u32 s81,s81,28672
M v[248:251],a[52:55],a[84:87],v[248:251]
M v[252:255],a[52:55],a[92:95],v[252:255]
M v[252:255],a[48:51],a[88:91],v[252:255]
M a[0:3],a[48:51],a[96:99],a[0:3]
M a[0:3],a[52:55],a[100:103],a[0:3]
M a[4:7],a[52:55],a[108:111],a[4:7]
M a[4:7],a[48:51],a[104:107],a[4:7]
M a[8:11],a[48:51],a[112:115],a[8:11]
s_add_u32 s24,s24,s25
M a[8:11],a[52:55],a[116:119],a[8:11]
M a[12:15],a[52:55],a[124:127],a[12:15]
M a[12:15],a[48:51],a[120:123],a[12:15]
s_waitcnt vmcnt(9) lgkmcnt(0)
s_barrier
M a[16:19],a[56:59],a[64:67],a[16:19]
ds_read_b128 a[48:51],v4 offset:0
M a[16:19],a[60:63],a[68:71],a[16:19]
ds_read_b128 a[52:55],v5 offset:0
M a[20:23],a[60:63],a[76:79],a[20:23]
s_add_u32 m0,s45,28672
M a[20:23],a[56:59],a[72:75],a[20:23]
buffer_load_dwordx4 v26,s[8:11],s81 offen lds
M a[24:27],a[56:59],a[80:83],a[24:27]
M a[24:27],a[60:63],a[84:87],a[24:27]
v_cmp_ne_u32 vcc,0,v39
M a[28:31],a[60:63],a[92:95],a[28:31]
M a[28:31],a[56:59],a[88:91],a[28:31]
M a[32:35],a[56:59],a[96:99],a[32:35]
s_andn2_b64 vcc,s[56:57],vcc
s_cbranch_scc1 K1_APOLL
K1_APOLLD:
M a[32:35],a[60:63],a[100:103],a[32:35]
M a[36:39],a[60:63],a[108:111],a[36:39]
M a[36:39],a[56:59],a[104:107],a[36:39]
buffer_load_dwordx4 v26,s[8:11],s81 offen offset:1024 lds
M a[40:43],a[56:59],a[112:115],a[40:43]
M a[40:43],a[60:63],a[116:119],a[40:43]
s_sub_u32 s26,s26,1
M a[44:47],a[60:63],a[124:127],a[44:47]
s_cmp_eq_u32 s26,s43
M a[44:47],a[56:59],a[120:123],a[44:47]
s_waitcnt lgkmcnt(0)
M v[48:51],a[48:51],a[128:131],v[48:51]
ds_read_b128 a[56:59],v4 offset:2048
M v[48:51],a[52:55],a[132:135],v[48:51]
ds_read_b128 a[60:63],v5 offset:2048
M v[52:55],a[52:55],a[140:143],v[52:55]
M v[52:55],a[48:51],a[136:139],v[52:55]
buffer_load_dwordx4 v26,s[8:11],s81 offen offset:2048 lds
M v[56:59],a[48:51],a[144:147],v[56:59]
M v[56:59],a[52:55],a[148:151],v[56:59]
M v[60:63],a[52:55],a[156:159],v[60:63]
s_add_u32 s33,s94,0
M v[60:63],a[48:51],a[152:155],v[60:63]
buffer_load_dwordx4 a[192:195],v36,s[12:15],s33 offen offset:2048 sc1
M v[64:67],a[48:51],a[160:163],v[64:67]
M v[64:67],a[52:55],a[164:167],v[64:67]
M v[68:71],a[52:55],a[172:175],v[68:71]
s_add_u32 s33,s94,16384
M v[68:71],a[48:51],a[168:171],v[68:71]
buffer_load_dwordx4 a[196:199],v36,s[12:15],s33 offen offset:2048 sc1
M v[72:75],a[48:51],a[176:179],v[72:75]
M v[72:75],a[52:55],a[180:183],v[72:75]
s_add_u32 s23,s23,128
s_add_u32 s33,s94,2097152
s_sub_u32 s33,s33,s82
M v[76:79],a[52:55],a[188:191],v[76:79]
buffer_load_dwordx4 a[200:203],v36,s[12:15],s33 offen offset:2048 sc1
M v[76:79],a[48:51],a[184:187],v[76:79]
s_waitcnt lgkmcnt(0)
M v[80:83],a[56:59],a[128:131],v[80:83]
ds_read_b128 a[48:51],v4 offset:4096
M v[80:83],a[60:63],a[132:135],v[80:83]
ds_read_b128 a[52:55],v5 offset:4096
M v[84:87],a[60:63],a[140:143],v[84:87]
M v[84:87],a[56:59],a[136:139],v[84:87]
buffer_load_dwordx4 v26,s[8:11],s81 offen offset:3072 lds
M v[88:91],a[56:59],a[144:147],v[88:91]
M v[88:91],a[60:63],a[148:151],v[88:91]
M v[92:95],a[60:63],a[156:159],v[92:95]
s_add_u32 s33,s94,2097152
M v[92:95],a[56:59],a[152:155],v[92:95]
buffer_load_dwordx4 a[204:207],v36,s[12:15],s33 offen offset:2048 sc1
M v[96:99],a[56:59],a[160:163],v[96:99]
M v[96:99],a[60:63],a[164:167],v[96:99]
M v[100:103],a[60:63],a[172:175],v[100:103]
s_add_u32 s33,s94,2113536
M v[100:103],a[56:59],a[168:171],v[100:103]
buffer_load_dwordx4 a[208:211],v36,s[12:15],s33 offen offset:2048 sc1
M v[104:107],a[56:59],a[176:179],v[104:107]
M v[104:107],a[60:63],a[180:183],v[104:107]
s_add_u32 s31,s95,4096
s_sub_u32 s33,s31,s83
M v[108:111],a[60:63],a[188:191],v[108:111]
buffer_load_dwordx2 a[212:213],v36,s[12:15],s33 offen offset:8 sc1
M v[108:111],a[56:59],a[184:187],v[108:111]
s_waitcnt lgkmcnt(0)
M v[112:115],a[48:51],a[128:131],v[112:115]
ds_read_b128 a[56:59],v4 offset:6144
s_mov_b32 s84,s54
CV v48,v48,v49
M v[112:115],a[52:55],a[132:135],v[112:115]
ds_read_b128 a[60:63],v5 offset:6144
CV v49,v50,v51
CV v50,v80,v81
M v[116:119],a[52:55],a[140:143],v[116:119]
s_add_u32 m0,s45,32768
CV v51,v82,v83
M v[116:119],a[48:51],a[136:139],v[116:119]
buffer_load_dwordx4 v27,s[8:11],s81 offen lds
M v[120:123],a[48:51],a[144:147],v[120:123]
CV v52,v52,v53
CV v53,v54,v55
M v[120:123],a[52:55],a[148:151],v[120:123]
CV v54,v84,v85
CV v55,v86,v87
M v[124:127],a[52:55],a[156:159],v[124:127]
M v[124:127],a[48:51],a[152:155],v[124:127]
buffer_load_dwordx2 a[218:219],v36,s[12:15],s33 offen offset:1032 sc1
M v[128:131],a[48:51],a[160:163],v[128:131]
CV v56,v56,v57
CV v57,v58,v59
M v[128:131],a[52:55],a[164:167],v[128:131]
CV v58,v88,v89
CV v59,v90,v91
M v[132:135],a[52:55],a[172:175],v[132:135]
M v[132:135],a[48:51],a[168:171],v[132:135]
buffer_load_dwordx4 a[214:217],v36,s[12:15],s31 offen sc1
M v[136:139],a[48:51],a[176:179],v[136:139]
s_add_u32 s24,s24,s25
CV v60,v60,v61
CV v61,v62,v63
M v[136:139],a[52:55],a[180:183],v[136:139]
CV v62,v92,v93
CV v63,v94,v95
M v[140:143],a[52:55],a[188:191],v[140:143]
buffer_store_dwordx4 v[60:63],v36,s[12:15],s54 offen offset:3072 sc1
M v[140:143],a[48:51],a[184:187],v[140:143]
s_add_u32 s54,s54,4096
s_waitcnt vmcnt(22) lgkmcnt(0)
s_barrier
M v[144:147],a[56:59],a[128:131],v[144:147]
ds_read_b128 a[48:51],v4 offset:32768
s_mov_b32 s85,s54
CV v60,v64,v65
M v[144:147],a[60:63],a[132:135],v[144:147]
ds_read_b128 a[52:55],v5 offset:32768
CV v61,v66,v67
M v[148:151],a[60:63],a[140:143],v[148:151]
CV v62,v96,v97
CV v63,v98,v99
M v[148:151],a[56:59],a[136:139],v[148:151]
buffer_load_dwordx4 v27,s[8:11],s81 offen offset:1024 lds
M v[152:155],a[56:59],a[144:147],v[152:155]
CV v64,v68,v69
CV v65,v70,v71
M v[152:155],a[60:63],a[148:151],v[152:155]
CV v66,v100,v101
CV v67,v102,v103
M v[156:159],a[60:63],a[156:159],v[156:159]
M v[156:159],a[56:59],a[152:155],v[156:159]
buffer_load_dwordx4 a[220:223],v36,s[12:15],s31 offen offset:1024 sc1
M v[160:163],a[56:59],a[160:163],v[160:163]
CV v68,v72,v73
CV v69,v74,v75
M v[160:163],a[60:63],a[164:167],v[160:163]
CV v70,v104,v105
CV v71,v106,v107
M v[164:167],a[60:63],a[172:175],v[164:167]
s_add_u32 s33,s94,0
M v[164:167],a[56:59],a[168:171],v[164:167]
buffer_load_dwordx4 a[224:227],v36,s[12:15],s33 offen offset:3072 sc1
M v[168:171],a[56:59],a[176:179],v[168:171]
CV v76,v76,v77
CV v77,v78,v79
M v[168:171],a[60:63],a[180:183],v[168:171]
CV v78,v108,v109
CV v79,v110,v111
M v[172:175],a[60:63],a[188:191],v[172:175]
buffer_store_dwordx4 v[76:79],v36,s[12:15],s54 offen offset:3072 sc1
M v[172:175],a[56:59],a[184:187],v[172:175]
s_add_u32 s54,s54,s55
s_waitcnt lgkmcnt(0)
M v[176:179],a[48:51],a[128:131],v[176:179]
ds_read_b128 a[56:59],v4 offset:34816
s_mov_b32 s86,s54
CV v72,v112,v113
M v[176:179],a[52:55],a[132:135],v[176:179]
ds_read_b128 a[60:63],v5 offset:34816
CV v73,v114,v115
M v[180:183],a[52:55],a[140:143],v[180:183]
CV v74,v144,v145
CV v75,v146,v147
M v[180:183],a[48:51],a[136:139],v[180:183]
buffer_load_dwordx4 v27,s[8:11],s81 offen offset:2048 lds
M v[184:187],a[48:51],a[144:147],v[184:187]
s_add_u32 s81,s81,28672
CV v76,v116,v117
M v[184:187],a[52:55],a[148:151],v[184:187]
CV v77,v118,v119
CV v78,v148,v149
CV v79,v150,v151
M v[188:191],a[52:55],a[156:159],v[188:191]
s_add_u32 s33,s94,16384
M v[188:191],a[48:51],a[152:155],v[188:191]
buffer_load_dwordx4 a[228:231],v36,s[12:15],s33 offen offset:3072 sc1
M v[192:195],a[48:51],a[160:163],v[192:195]
CV v80,v120,v121
CV v81,v122,v123
M v[192:195],a[52:55],a[164:167],v[192:195]
CV v82,v152,v153
CV v83,v154,v155
M v[196:199],a[52:55],a[172:175],v[196:199]
s_add_u32 s33,s94,2097152
s_sub_u32 s33,s33,s82
M v[196:199],a[48:51],a[168:171],v[196:199]
buffer_load_dwordx4 a[232:235],v36,s[12:15],s33 offen offset:3072 sc1
M v[200:203],a[48:51],a[176:179],v[200:203]
s_add_u32 s22,s22,128
CV v124,v124,v125
CV v125,v126,v127
M v[200:203],a[52:55],a[180:183],v[200:203]
CV v126,v156,v157
CV v127,v158,v159
M v[204:207],a[52:55],a[188:191],v[204:207]
buffer_store_dwordx4 v[124:127],v36,s[12:15],s54 offen offset:3072 sc1
M v[204:207],a[48:51],a[184:187],v[204:207]
s_add_u32 s54,s54,4096
s_waitcnt lgkmcnt(0)
M v[208:211],a[56:59],a[128:131],v[208:211]
ds_read_b128 a[48:51],v4 offset:36864
s_mov_b32 s87,s54
M v[208:211],a[60:63],a[132:135],v[208:211]
ds_read_b128 a[52:55],v5 offset:36864
CV v84,v128,v129
M v[212:215],a[60:63],a[140:143],v[212:215]
CV v85,v130,v131
M v[212:215],a[56:59],a[136:139],v[212:215]
CV v86,v160,v161
CV v87,v162,v163
M v[216:219],a[56:59],a[144:147],v[216:219]
CV v88,v132,v133
CV v89,v134,v135
M v[216:219],a[60:63],a[148:151],v[216:219]
CV v90,v164,v165
CV v91,v166,v167
M v[220:223],a[60:63],a[156:159],v[220:223]
s_add_u32 s33,s94,2097152
M v[220:223],a[56:59],a[152:155],v[220:223]
buffer_load_dwordx4 a[236:239],v36,s[12:15],s33 offen offset:3072 sc1
M v[224:227],a[56:59],a[160:163],v[224:227]
CV v92,v136,v137
CV v93,v138,v139
M v[224:227],a[60:63],a[164:167],v[224:227]
CV v94,v168,v169
CV v95,v170,v171
M v[228:231],a[60:63],a[172:175],v[228:231]
s_add_u32 s33,s94,2113536
M v[228:231],a[56:59],a[168:171],v[228:231]
buffer_load_dwordx4 a[240:243],v36,s[12:15],s33 offen offset:3072 sc1
M v[232:235],a[56:59],a[176:179],v[232:235]
CV v140,v140,v141
CV v141,v142,v143
CV v142,v172,v173
M v[232:235],a[60:63],a[180:183],v[232:235]
CV v143,v174,v175
buffer_store_dwordx4 v[140:143],v36,s[12:15],s54 offen offset:3072 sc1
M v[236:239],a[60:63],a[188:191],v[236:239]
buffer_load_dword v1,v37,s[64:67],0 offen
M v[236:239],a[56:59],a[184:187],v[236:239]
s_add_u32 s54,s54,s55
s_waitcnt lgkmcnt(0)
M v[240:243],a[48:51],a[128:131],v[240:243]
ds_read_b128 a[56:59],v4 offset:38912
s_mov_b32 s88,s54
M v[240:243],a[52:55],a[132:135],v[240:243]
ds_read_b128 a[60:63],v5 offset:38912
CV v96,v176,v177
M v[244:247],a[52:55],a[140:143],v[244:247]
CV v97,v178,v179
M v[244:247],a[48:51],a[136:139],v[244:247]
CV v98,v208,v209
CV v99,v210,v211
M v[248:251],a[48:51],a[144:147],v[248:251]
CV v100,v180,v181
CV v101,v182,v183
M v[248:251],a[52:55],a[148:151],v[248:251]
CV v102,v212,v213
CV v103,v214,v215
M v[252:255],a[52:55],a[156:159],v[252:255]
s_add_u32 s31,s95,6144
s_sub_u32 s33,s31,s83
M v[252:255],a[48:51],a[152:155],v[252:255]
buffer_load_dwordx2 a[244:245],v36,s[12:15],s33 offen offset:8 sc1
M a[0:3],a[48:51],a[160:163],a[0:3]
CV v104,v184,v185
CV v105,v186,v187
M a[0:3],a[52:55],a[164:167],a[0:3]
CV v106,v216,v217
CV v107,v218,v219
M a[4:7],a[52:55],a[172:175],a[4:7]
M a[4:7],a[48:51],a[168:171],a[4:7]
buffer_load_dwordx2 a[250:251],v36,s[12:15],s33 offen offset:1032 sc1
M a[8:11],a[48:51],a[176:179],a[8:11]
s_add_u32 s24,s24,s25
CV v188,v188,v189
CV v189,v190,v191
M a[8:11],a[52:55],a[180:183],a[8:11]
CV v190,v220,v221
CV v191,v222,v223
M a[12:15],a[52:55],a[188:191],a[12:15]
buffer_store_dwordx4 v[188:191],v36,s[12:15],s54 offen offset:3072 sc1
M a[12:15],a[48:51],a[184:187],a[12:15]
s_add_u32 s54,s54,4096
s_waitcnt lgkmcnt(0)
s_barrier
M a[16:19],a[56:59],a[128:131],a[16:19]
s_mov_b32 s89,s54
CV v192,v192,v193
M a[16:19],a[60:63],a[132:135],a[16:19]
CV v193,v194,v195
CV v194,v224,v225
CV v195,v226,v227
M a[20:23],a[60:63],a[140:143],a[20:23]
AW a64,v192
AW a65,v193
M a[20:23],a[56:59],a[136:139],a[20:23]
AW a66,v194
AW a67,v195
M a[24:27],a[56:59],a[144:147],a[24:27]
CV v196,v196,v197
CV v197,v198,v199
CV v198,v228,v229
M a[24:27],a[60:63],a[148:151],a[24:27]
CV v199,v230,v231
AW a68,v196
AW a69,v197
M a[28:31],a[60:63],a[156:159],a[28:31]
AW a70,v198
AW a71,v199
M a[28:31],a[56:59],a[152:155],a[28:31]
buffer_load_dwordx4 a[246:249],v36,s[12:15],s31 offen sc1
M a[32:35],a[56:59],a[160:163],a[32:35]
CV v200,v200,v201
CV v201,v202,v203
CV v202,v232,v233
M a[32:35],a[60:63],a[164:167],a[32:35]
CV v203,v234,v235
AW a72,v200
AW a73,v201
M a[36:39],a[60:63],a[172:175],a[36:39]
AW a74,v202
AW a75,v203
M a[36:39],a[56:59],a[168:171],a[36:39]
buffer_load_dwordx4 a[252:255],v36,s[12:15],s31 offen offset:1024 sc1
M a[40:43],a[56:59],a[176:179],a[40:43]
CV v204,v204,v205
CV v205,v206,v207
CV v206,v236,v237
M a[40:43],a[60:63],a[180:183],a[40:43]
s_sub_u32 s26,s26,1
CV v207,v238,v239
M a[44:47],a[60:63],a[188:191],a[44:47]
s_cmp_eq_u32 s26,s43
buffer_store_dwordx4 v[204:207],v36,s[12:15],s54 offen offset:3072 sc1
M a[44:47],a[56:59],a[184:187],a[44:47]
s_add_u32 s54,s54,s55
s_nop 7
s_mov_b32 s90,s54
CV v240,v240,v241
CV v241,v242,v243
AR v42,a16
AR v43,a17
AR v44,a18
AR v45,a19
CV v242,v42,v43
CV v243,v44,v45
AW a76,v240
AW a77,v241
AW a78,v242
AW a79,v243
CV v244,v244,v245
CV v245,v246,v247
AR v42,a20
AR v43,a21
AR v44,a22
AR v45,a23
CV v246,v42,v43
CV v247,v44,v45
AW a80,v244
AW a81,v245
AW a82,v246
AW a83,v247
CV v248,v248,v249
CV v249,v250,v251
AR v42,a24
AR v43,a25
AR v44,a26
AR v45,a27
CV v250,v42,v43
CV v251,v44,v45
AW a84,v248
AW a85,v249
AW a86,v250
AW a87,v251
CV v252,v252,v253
CV v253,v254,v255
AR v42,a28
AR v43,a29
AR v44,a30
AR v45,a31
CV v254,v42,v43
CV v255,v44,v45
buffer_store_dwordx4 v[252:255],v36,s[12:15],s54 offen offset:3072 sc1
s_add_u32 s54,s54,4096
s_mov_b32 s91,s54
s_nop 0
AR v42,a0
AR v43,a1
AR v44,a2
AR v45,a3
CV v30,v42,v43
CV v31,v44,v45
AR v42,a32
AR v43,a33
AR v44,a34
AR v45,a35
CV v32,v42,v43
CV v33,v44,v45
AW a88,v30
AW a89,v31
AW a90,v32
AW a91,v33
AR v42,a4
AR v43,a5
AR v44,a6
AR v45,a7
CV v30,v42,v43
CV v31,v44,v45
AR v42,a36
AR v43,a37
AR v44,a38
AR v45,a39
CV v32,v42,v43
CV v33,v44,v45
AW a92,v30
AW a93,v31
AW a94,v32
AW a95,v33
AR v42,a8
AR v43,a9
AR v44,a10
AR v45,a11
CV v30,v42,v43
CV v31,v44,v45
AR v42,a40
AR v43,a41
AR v44,a42
AR v45,a43
CV v32,v42,v43
CV v33,v44,v45
AW a96,v30
AW a97,v31
AW a98,v32
AW a99,v33
AR v42,a12
AR v43,a13
AR v44,a14
AR v45,a15
CV v30,v42,v43
CV v31,v44,v45
AR v42,a44
AR v43,a45
AR v44,a46
AR v45,a47
CV v32,v42,v43
CV v33,v44,v45
buffer_store_dwordx4 v[30:33],v36,s[12:15],s54 offen offset:3072 sc1
s_load_dwordx2 s[4:5],s[0:1],72
s_mov_b32 s21,s45
v_lshrrev_b32 v30,2,v35
v_mul_u32_u24 v30,896,v30
v_and_b32_e64 v32,3,v35
v_lshl_add_u32 v30,v32,3,v30
s_mul_i32 s30,s20,224
v_add_u32 v30,s30,v30
v_add_u32 v31,0,v30
v_bfe_u32 v32,v31,8,2
v_lshlrev_b32 v32,5,v32
v_xor_b32 v108,v31,v32
v_add_u32 v115,57344,v108
v_add_u32_e64 v31,32,v30
v_bfe_u32 v32,v31,8,2
v_lshlrev_b32 v32,5,v32
v_xor_b32 v109,v31,v32
v_add_u32 v116,57344,v109
v_add_u32_e64 v31,64,v30
v_bfe_u32 v32,v31,8,2
v_lshlrev_b32 v32,5,v32
v_xor_b32 v110,v31,v32
v_add_u32 v117,57344,v110
v_add_u32 v31,96,v30
v_bfe_u32 v32,v31,8,2
v_lshlrev_b32 v32,5,v32
v_xor_b32 v111,v31,v32
v_add_u32 v118,57344,v111
v_add_u32 v31,128,v30
v_bfe_u32 v32,v31,8,2
v_lshlrev_b32 v32,5,v32
v_xor_b32 v112,v31,v32
v_add_u32 v119,57344,v112
v_add_u32 v31,160,v30
v_bfe_u32 v32,v31,8,2
v_lshlrev_b32 v32,5,v32
v_xor_b32 v113,v31,v32
v_add_u32 v120,57344,v113
v_add_u32 v31,192,v30
v_bfe_u32 v32,v31,8,2
v_lshlrev_b32 v32,5,v32
v_xor_b32 v114,v31,v32
v_add_u32 v121,57344,v114
s_mov_b32 s6,3670016
v_and_b32 v30,15,v35
v_lshrrev_b32 v31,4,v35
v_lshlrev_b32 v31,2,v31
v_sub_u32 v30,v30,v31
v_add_u32 v31,16,v30
v_and_b32 v31,0xfffffff1,v31
v_cmp_eq_u32 s[22:23],0,v31
v_add_u32 v31,15,v30
v_and_b32 v31,0xfffffff1,v31
v_cmp_eq_u32 s[24:25],0,v31
v_add_u32 v31,14,v30
v_and_b32 v31,0xfffffff1,v31
v_cmp_eq_u32 s[36:37],0,v31
v_add_u32 v31,13,v30
v_and_b32 v31,0xfffffff1,v31
v_cmp_eq_u32 s[38:39],0,v31
v_add_u32 v31,0,v30
v_and_b32 v31,0xfffffff1,v31
v_cmp_eq_u32 s[42:43],0,v31
v_add_u32 v31,-1,v30
v_and_b32 v31,0xfffffff1,v31
v_cmp_eq_u32 s[52:53],0,v31
v_add_u32 v31,-2,v30
v_and_b32 v31,0xfffffff1,v31
v_cmp_eq_u32 s[46:47],0,v31
v_add_u32 v31,-3,v30
v_and_b32 v31,0xfffffff1,v31
v_cmp_eq_u32 s[48:49],0,v31
s_mov_b32 s16,0x3e41848f
s_mov_b32 s17,0x3fb8aa3b
v_mov_b32 v11,0xff800000
v_cmp_gt_u32 s[28:29],48,v35
s_mul_i32 s30,s20,28
v_lshrrev_b32 v15,4,v35
v_add_u32 v15,s30,v15
s_cmp_eq_u32 s80,0
s_cselect_b64 vcc,0,-1
s_and_b64 s[50:51],s[22:23],vcc
s_and_b64 s[56:57],s[24:25],vcc
s_and_b64 s[54:55],s[36:37],vcc
s_and_b64 s[18:19],s[38:39],vcc
v_and_b32 v13,0xf0,v36
v_add_u32 v13,131072,v13
v_add_u32 v18,14336,v13
v_add_u32 v14,131072,v36
s_waitcnt lgkmcnt(0)
s_waitcnt vmcnt(3)
s_mov_b32 exec_lo,0
s_mov_b32 exec_hi,0xffff0000
AW a194,0
AW a195,0
AW a198,0
AW a199,0
AW a226,0
AW a227,0
AW a230,0
AW a231,0
s_mov_b64 exec,-1
s_nop 1
M v[192:195],a[200:203],a[192:195],0
M v[196:199],a[204:207],a[192:195],0
M v[200:203],a[204:207],a[196:199],0
M v[204:207],a[208:211],a[196:199],0
s_nop 7
s_nop 0
buffer_store_dwordx4 v[48:51],v36,s[12:15],s84 offen sc1
CV v208,v192,v193
CV v209,v194,v195
CV v210,v196,v197
CV v211,v198,v199
CV v212,v200,v201
CV v213,v202,v203
CV v214,v204,v205
CV v215,v206,v207
v_lshlrev_b32 v192,16,v208
v_and_b32 v193,0xffff0000,v208
s_add_u32 s33,s94,0
buffer_load_dwordx4 a[128:131],v36,s[12:15],s33 offen sc1
v_lshlrev_b32_e64 v194,16,v209
v_and_b32 v195,0xffff0000,v209
v_lshlrev_b32_e64 v196,16,v210
v_and_b32 v197,0xffff0000,v210
v_lshlrev_b32_e64 v198,16,v211
v_and_b32 v199,0xffff0000,v211
v_lshlrev_b32_e64 v200,16,v212
v_and_b32 v201,0xffff0000,v212
v_lshlrev_b32_e64 v202,16,v213
v_and_b32 v203,0xffff0000,v213
buffer_store_dwordx4 v[52:55],v36,s[12:15],s84 offen offset:1024 sc1
v_lshlrev_b32_e64 v204,16,v214
v_and_b32 v205,0xffff0000,v214
v_lshlrev_b32_e64 v206,16,v215
v_and_b32 v207,0xffff0000,v215
v_pk_mul_f32 v[192:193],v[192:193],s[16:17] op_sel_hi:[1,0]
v_pk_mul_f32 v[194:195],v[194:195],s[16:17] op_sel_hi:[1,0]
v_pk_mul_f32 v[196:197],v[196:197],s[16:17] op_sel_hi:[1,0]
v_pk_mul_f32 v[198:199],v[198:199],s[16:17] op_sel_hi:[1,0]
v_pk_mul_f32 v[200:201],v[200:201],s[16:17] op_sel_hi:[1,0]
v_pk_mul_f32 v[202:203],v[202:203],s[16:17] op_sel_hi:[1,0]
s_add_u32 s33,s94,16384
buffer_load_dwordx4 a[132:135],v36,s[12:15],s33 offen sc1
v_pk_mul_f32 v[204:205],v[204:205],s[16:17] op_sel_hi:[1,0]
v_pk_mul_f32 v[206:207],v[206:207],s[16:17] op_sel_hi:[1,0]
CV v208,v192,v193
CV v209,v194,v195
CV v210,v196,v197
CV v211,v198,v199
CV v212,v200,v201
CV v213,v202,v203
CV v214,v204,v205
CV v215,v206,v207
buffer_store_dwordx4 v[56:59],v36,s[12:15],s84 offen offset:2048 sc1
v_lshlrev_b32_e64 v192,16,v208
v_and_b32 v193,0xffff0000,v208
v_lshlrev_b32_e64 v194,16,v209
v_and_b32 v195,0xffff0000,v209
v_lshlrev_b32_e64 v196,16,v210
v_and_b32 v197,0xffff0000,v210
v_lshlrev_b32_e64 v198,16,v211
v_and_b32 v199,0xffff0000,v211
v_lshlrev_b32_e64 v200,16,v212
v_and_b32 v201,0xffff0000,v212
s_add_u32 s33,s94,2097152
s_sub_u32 s33,s33,s82
buffer_load_dwordx4 a[136:139],v36,s[12:15],s33 offen sc1
v_lshlrev_b32 v202,16,v213
v_and_b32 v203,0xffff0000,v213
v_lshlrev_b32_e64 v204,16,v214
v_and_b32 v205,0xffff0000,v214
v_lshlrev_b32_e64 v206,16,v215
v_and_b32 v207,0xffff0000,v215
v_cndmask_b32 v192,v11,v192,s[50:51]
v_cndmask_b32 v193,v11,v193,s[56:57]
v_cndmask_b32 v194,v11,v194,s[54:55]
v_cndmask_b32 v195,v11,v195,s[18:19]
buffer_store_dwordx4 v[60:63],v36,s[12:15],s85 offen sc1
v_cndmask_b32 v196,v11,v196,s[42:43]
v_cndmask_b32 v197,v11,v197,s[52:53]
v_cndmask_b32 v198,v11,v198,s[46:47]
v_cndmask_b32 v199,v11,v199,s[48:49]
v_cndmask_b32 v200,v11,v200,s[22:23]
v_cndmask_b32 v201,v11,v201,s[24:25]
v_cndmask_b32 v202,v11,v202,s[36:37]
v_cndmask_b32 v203,v11,v203,s[38:39]
v_cndmask_b32 v204,v11,v204,s[42:43]
v_cndmask_b32 v205,v11,v205,s[52:53]
s_add_u32 s33,s94,2097152
buffer_load_dwordx4 a[140:143],v36,s[12:15],s33 offen sc1
v_cndmask_b32 v206,v11,v206,s[46:47]
v_cndmask_b32 v207,v11,v207,s[48:49]
v_max3_f32 v216,v192,v193,v194
v_max3_f32 v216,v195,v196,v216
v_max3_f32 v216,v197,v198,v216
v_max_f32_e64 v216,v199,v216
v_max3_f32 v217,v200,v201,v202
v_max3_f32 v217,v203,v204,v217
v_max3_f32 v217,v205,v206,v217
v_max_f32_e64 v217,v207,v217
buffer_store_dwordx4 v[64:67],v36,s[12:15],s85 offen offset:1024 sc1
v_mov_b32 v208,v216
v_mov_b32 v209,v217
s_nop 0
v_permlane32_swap_b32 v208,v216
v_permlane32_swap_b32 v209,v217
s_nop 0
v_max_f32 v216,v208,v216
v_max_f32 v217,v209,v217
v_mov_b32 v208,v216
v_mov_b32 v209,v217
s_add_u32 s33,s94,2113536
buffer_load_dwordx4 a[144:147],v36,s[12:15],s33 offen sc1
s_nop 0
v_permlane16_swap_b32 v208,v216
v_permlane16_swap_b32 v209,v217
s_nop 0
v_max_f32 v216,v208,v216
v_max_f32 v217,v209,v217
v_pk_add_f32 v[192:193],v[192:193],v[216:217] op_sel:[0,0] op_sel_hi:[1,0] neg_lo:[0,1] neg_hi:[0,1]
v_pk_add_f32 v[194:195],v[194:195],v[216:217] op_sel:[0,0] op_sel_hi:[1,0] neg_lo:[0,1] neg_hi:[0,1]
v_pk_add_f32 v[196:197],v[196:197],v[216:217] op_sel:[0,0] op_sel_hi:[1,0] neg_lo:[0,1] neg_hi:[0,1]
buffer_store_dwordx4 v[68:71],v36,s[12:15],s85 offen offset:2048 sc1
v_pk_add_f32 v[198:199],v[198:199],v[216:217] op_sel:[0,0] op_sel_hi:[1,0] neg_lo:[0,1] neg_hi:[0,1]
v_pk_add_f32 v[200:201],v[200:201],v[216:217] op_sel:[0,1] op_sel_hi:[1,1] neg_lo:[0,1] neg_hi:[0,1]
v_pk_add_f32 v[202:203],v[202:203],v[216:217] op_sel:[0,1] op_sel_hi:[1,1] neg_lo:[0,1] neg_hi:[0,1]
v_pk_add_f32 v[204:205],v[204:205],v[216:217] op_sel:[0,1] op_sel_hi:[1,1] neg_lo:[0,1] neg_hi:[0,1]
v_pk_add_f32 v[206:207],v[206:207],v[216:217] op_sel:[0,1] op_sel_hi:[1,1] neg_lo:[0,1] neg_hi:[0,1]
v_pk_mul_f32 v[192:193],v[192:193],s[16:17] op_sel:[0,1] op_sel_hi:[1,1]
v_pk_mul_f32 v[194:195],v[194:195],s[16:17] op_sel:[0,1] op_sel_hi:[1,1]
v_pk_mul_f32 v[196:197],v[196:197],s[16:17] op_sel:[0,1] op_sel_hi:[1,1]
v_pk_mul_f32 v[198:199],v[198:199],s[16:17] op_sel:[0,1] op_sel_hi:[1,1]
v_pk_mul_f32 v[200:201],v[200:201],s[16:17] op_sel:[0,1] op_sel_hi:[1,1]
s_add_u32 s31,s95,0
s_sub_u32 s33,s31,s83
buffer_load_dwordx2 a[148:149],v36,s[12:15],s33 offen offset:8 sc1
v_pk_mul_f32 v[202:203],v[202:203],s[16:17] op_sel:[0,1] op_sel_hi:[1,1]
v_pk_mul_f32 v[204:205],v[204:205],s[16:17] op_sel:[0,1] op_sel_hi:[1,1]
v_pk_mul_f32 v[206:207],v[206:207],s[16:17] op_sel:[0,1] op_sel_hi:[1,1]
v_exp_f32 v192,v192
v_exp_f32 v193,v193
v_exp_f32 v194,v194
v_exp_f32 v195,v195
v_exp_f32 v196,v196
v_exp_f32 v197,v197
v_exp_f32_e64 v198,v198
buffer_store_dwordx4 v[72:75],v36,s[12:15],s86 offen sc1
v_exp_f32 v199,v199
v_exp_f32 v200,v200
v_exp_f32 v201,v201
v_exp_f32 v202,v202
v_exp_f32 v203,v203
v_exp_f32 v204,v204
v_exp_f32 v205,v205
v_exp_f32 v206,v206
v_exp_f32_e64 v207,v207
v_pk_add_f32 v[210:211],v[192:193],v[194:195]
buffer_load_dwordx2 a[154:155],v36,s[12:15],s33 offen offset:1032 sc1
v_pk_add_f32 v[210:211],v[210:211],v[196:197]
v_pk_add_f32 v[210:211],v[210:211],v[198:199]
v_add_f32_e64 v216,v210,v211
v_pk_add_f32 v[212:213],v[200:201],v[202:203]
v_pk_add_f32 v[212:213],v[212:213],v[204:205]
v_pk_add_f32 v[212:213],v[212:213],v[206:207]
v_add_f32 v217,v212,v213
v_mov_b32 v208,v216
v_mov_b32 v209,v217
s_nop 0
buffer_store_dwordx4 v[76:79],v36,s[12:15],s86 offen offset:1024 sc1
v_permlane32_swap_b32 v208,v216
v_permlane32_swap_b32 v209,v217
s_nop 0
v_add_f32 v216,v208,v216
v_add_f32 v217,v209,v217
v_mov_b32 v208,v216
v_mov_b32 v209,v217
s_nop 0
v_permlane16_swap_b32 v208,v216
v_permlane16_swap_b32 v209,v217
buffer_load_dwordx4 a[150:153],v36,s[12:15],s31 offen sc1
s_nop 0
v_add_f32 v216,v208,v216
v_add_f32 v217,v209,v217
v_rcp_f32 v216,v216
v_rcp_f32 v217,v217
s_nop 0
v_pk_mul_f32 v[192:193],v[192:193],v[216:217] op_sel:[0,0] op_sel_hi:[1,0]
v_pk_mul_f32 v[194:195],v[194:195],v[216:217] op_sel:[0,0] op_sel_hi:[1,0]
v_pk_mul_f32 v[196:197],v[196:197],v[216:217] op_sel:[0,0] op_sel_hi:[1,0]
v_pk_mul_f32 v[198:199],v[198:199],v[216:217] op_sel:[0,0] op_sel_hi:[1,0]
buffer_store_dwordx4 v[80:83],v36,s[12:15],s86 offen offset:2048 sc1
v_pk_mul_f32 v[200:201],v[200:201],v[216:217] op_sel:[0,1] op_sel_hi:[1,1]
v_pk_mul_f32 v[202:203],v[202:203],v[216:217] op_sel:[0,1] op_sel_hi:[1,1]
v_pk_mul_f32 v[204:205],v[204:205],v[216:217] op_sel:[0,1] op_sel_hi:[1,1]
v_pk_mul_f32 v[206:207],v[206:207],v[216:217] op_sel:[0,1] op_sel_hi:[1,1]
CV v220,v192,v193
CV v221,v194,v195
CV v222,v196,v197
CV v223,v198,v199
CV v224,v200,v201
CV v225,v202,v203
buffer_load_dwordx4 a[156:159],v36,s[12:15],s31 offen offset:1024 sc1
CV v226,v204,v205
CV v227,v206,v207
s_nop 1
M v[228:231],a[212:215],v[220:223],0
M v[232:235],a[218:221],v[220:223],0
M v[236:239],a[214:217],v[224:227],0
M v[240:243],a[220:223],v[224:227],0
v_add_u32 v208,14,v15
v_lshrrev_b32_e64 v209,3,v208
v_lshl_add_u32 v16,v209,10,v13
buffer_store_dwordx4 v[84:87],v36,s[12:15],s87 offen sc1
v_and_b32_e64 v209,3,v208
v_lshl_add_u32 v16,v209,8,v16
v_and_b32_e64 v209,4,v208
v_lshl_add_u32 v16,v209,1,v16
v_add_u32 v208,18,v15
v_lshrrev_b32 v209,3,v208
v_lshl_add_u32 v17,v209,10,v13
v_and_b32_e64 v209,3,v208
v_lshl_add_u32 v17,v209,8,v17
v_and_b32_e64 v209,4,v208
buffer_store_dwordx4 v[88:91],v36,s[12:15],s87 offen offset:1024 sc1
v_lshl_add_u32 v17,v209,1,v17
v_cndmask_b32 v17,v18,v17,s[28:29]
CV v244,v228,v229
CV v245,v230,v231
CV v246,v232,v233
CV v247,v234,v235
ds_write_b64 v16,v[244:245] offset:0
ds_write_b64 v17,v[246:247] offset:0
CV v248,v236,v237
CV v249,v238,v239
buffer_store_dwordx4 v[92:95],v36,s[12:15],s87 offen offset:2048 sc1
CV v250,v240,v241
CV v251,v242,v243
ds_write_b64 v16,v[248:249] offset:16384
ds_write_b64 v17,v[250:251] offset:16384
M v[192:195],a[232:235],a[224:227],0
M v[196:199],a[236:239],a[224:227],0
M v[200:203],a[236:239],a[228:231],0
M v[204:207],a[240:243],a[228:231],0
s_nop 7
s_nop 0
buffer_store_dwordx4 v[96:99],v36,s[12:15],s88 offen sc1
CV v208,v192,v193
CV v209,v194,v195
CV v210,v196,v197
CV v211,v198,v199
CV v212,v200,v201
CV v213,v202,v203
CV v214,v204,v205
CV v215,v206,v207
v_lshlrev_b32 v192,16,v208
v_and_b32 v193,0xffff0000,v208
s_add_u32 s33,s94,0
buffer_load_dwordx4 a[160:163],v36,s[12:15],s33 offen offset:1024 sc1
v_lshlrev_b32_e64 v194,16,v209
v_and_b32 v195,0xffff0000,v209
v_lshlrev_b32_e64 v196,16,v210
v_and_b32 v197,0xffff0000,v210
v_lshlrev_b32_e64 v198,16,v211
v_and_b32 v199,0xffff0000,v211
v_lshlrev_b32_e64 v200,16,v212
v_and_b32 v201,0xffff0000,v212
v_lshlrev_b32_e64 v202,16,v213
v_and_b32 v203,0xffff0000,v213
buffer_store_dwordx4 v[100:103],v36,s[12:15],s88 offen offset:1024 sc1
v_lshlrev_b32_e64 v204,16,v214
v_and_b32 v205,0xffff0000,v214
v_lshlrev_b32_e64 v206,16,v215
v_and_b32 v207,0xffff0000,v215
v_pk_mul_f32 v[192:193],v[192:193],s[16:17] op_sel_hi:[1,0]
v_pk_mul_f32 v[194:195],v[194:195],s[16:17] op_sel_hi:[1,0]
v_pk_mul_f32 v[196:197],v[196:197],s[16:17] op_sel_hi:[1,0]
v_pk_mul_f32 v[198:199],v[198:199],s[16:17] op_sel_hi:[1,0]
v_pk_mul_f32 v[200:201],v[200:201],s[16:17] op_sel_hi:[1,0]
v_pk_mul_f32 v[202:203],v[202:203],s[16:17] op_sel_hi:[1,0]
s_add_u32 s33,s94,16384
buffer_load_dwordx4 a[164:167],v36,s[12:15],s33 offen offset:1024 sc1
v_pk_mul_f32 v[204:205],v[204:205],s[16:17] op_sel_hi:[1,0]
v_pk_mul_f32 v[206:207],v[206:207],s[16:17] op_sel_hi:[1,0]
CV v208,v192,v193
CV v209,v194,v195
CV v210,v196,v197
CV v211,v198,v199
CV v212,v200,v201
CV v213,v202,v203
CV v214,v204,v205
CV v215,v206,v207
buffer_store_dwordx4 v[104:107],v36,s[12:15],s88 offen offset:2048 sc1
v_lshlrev_b32_e64 v192,16,v208
v_and_b32 v193,0xffff0000,v208
v_lshlrev_b32_e64 v194,16,v209
v_and_b32 v195,0xffff0000,v209
v_lshlrev_b32_e64 v196,16,v210
v_and_b32 v197,0xffff0000,v210
v_lshlrev_b32_e64 v198,16,v211
v_and_b32 v199,0xffff0000,v211
v_lshlrev_b32_e64 v200,16,v212
v_and_b32 v201,0xffff0000,v212
s_add_u32 s33,s94,2097152
s_sub_u32 s33,s33,s82
buffer_load_dwordx4 a[168:171],v36,s[12:15],s33 offen offset:1024 sc1
v_lshlrev_b32 v202,16,v213
v_and_b32 v203,0xffff0000,v213
v_lshlrev_b32_e64 v204,16,v214
v_and_b32 v205,0xffff0000,v214
v_lshlrev_b32_e64 v206,16,v215
v_and_b32 v207,0xffff0000,v215
v_cndmask_b32 v192,v11,v192,s[50:51]
v_cndmask_b32 v193,v11,v193,s[56:57]
v_cndmask_b32 v194,v11,v194,s[54:55]
v_cndmask_b32 v195,v11,v195,s[18:19]
buffer_store_dwordx4 a[64:67],v36,s[12:15],s89 offen sc1
v_cndmask_b32 v196,v11,v196,s[42:43]
v_cndmask_b32 v197,v11,v197,s[52:53]
v_cndmask_b32 v198,v11,v198,s[46:47]
v_cndmask_b32 v199,v11,v199,s[48:49]
v_cndmask_b32 v200,v11,v200,s[22:23]
v_cndmask_b32 v201,v11,v201,s[24:25]
v_cndmask_b32 v202,v11,v202,s[36:37]
v_cndmask_b32 v203,v11,v203,s[38:39]
v_cndmask_b32 v204,v11,v204,s[42:43]
v_cndmask_b32 v205,v11,v205,s[52:53]
s_add_u32 s33,s94,2097152
buffer_load_dwordx4 a[172:175],v36,s[12:15],s33 offen offset:1024 sc1
v_cndmask_b32 v206,v11,v206,s[46:47]
v_cndmask_b32 v207,v11,v207,s[48:49]
v_max3_f32 v216,v192,v193,v194
v_max3_f32 v216,v195,v196,v216
v_max3_f32 v216,v197,v198,v216
v_max_f32_e64 v216,v199,v216
v_max3_f32 v217,v200,v201,v202
v_max3_f32 v217,v203,v204,v217
v_max3_f32 v217,v205,v206,v217
v_max_f32_e64 v217,v207,v217
buffer_store_dwordx4 a[68:71],v36,s[12:15],s89 offen offset:1024 sc1
v_mov_b32 v208,v216
v_mov_b32 v209,v217
s_nop 0
v_permlane32_swap_b32 v208,v216
v_permlane32_swap_b32 v209,v217
s_nop 0
v_max_f32 v216,v208,v216
v_max_f32 v217,v209,v217
v_mov_b32 v208,v216
v_mov_b32 v209,v217
s_add_u32 s33,s94,2113536
buffer_load_dwordx4 a[176:179],v36,s[12:15],s33 offen offset:1024 sc1
s_nop 0
v_permlane16_swap_b32 v208,v216
v_permlane16_swap_b32 v209,v217
s_nop 0
v_max_f32 v216,v208,v216
v_max_f32 v217,v209,v217
v_pk_add_f32 v[192:193],v[192:193],v[216:217] op_sel:[0,0] op_sel_hi:[1,0] neg_lo:[0,1] neg_hi:[0,1]
v_pk_add_f32 v[194:195],v[194:195],v[216:217] op_sel:[0,0] op_sel_hi:[1,0] neg_lo:[0,1] neg_hi:[0,1]
v_pk_add_f32 v[196:197],v[196:197],v[216:217] op_sel:[0,0] op_sel_hi:[1,0] neg_lo:[0,1] neg_hi:[0,1]
buffer_store_dwordx4 a[72:75],v36,s[12:15],s89 offen offset:2048 sc1
v_pk_add_f32 v[198:199],v[198:199],v[216:217] op_sel:[0,0] op_sel_hi:[1,0] neg_lo:[0,1] neg_hi:[0,1]
v_pk_add_f32 v[200:201],v[200:201],v[216:217] op_sel:[0,1] op_sel_hi:[1,1] neg_lo:[0,1] neg_hi:[0,1]
v_pk_add_f32 v[202:203],v[202:203],v[216:217] op_sel:[0,1] op_sel_hi:[1,1] neg_lo:[0,1] neg_hi:[0,1]
v_pk_add_f32 v[204:205],v[204:205],v[216:217] op_sel:[0,1] op_sel_hi:[1,1] neg_lo:[0,1] neg_hi:[0,1]
v_pk_add_f32 v[206:207],v[206:207],v[216:217] op_sel:[0,1] op_sel_hi:[1,1] neg_lo:[0,1] neg_hi:[0,1]
v_pk_mul_f32 v[192:193],v[192:193],s[16:17] op_sel:[0,1] op_sel_hi:[1,1]
v_pk_mul_f32 v[194:195],v[194:195],s[16:17] op_sel:[0,1] op_sel_hi:[1,1]
v_pk_mul_f32 v[196:197],v[196:197],s[16:17] op_sel:[0,1] op_sel_hi:[1,1]
v_pk_mul_f32 v[198:199],v[198:199],s[16:17] op_sel:[0,1] op_sel_hi:[1,1]
v_pk_mul_f32 v[200:201],v[200:201],s[16:17] op_sel:[0,1] op_sel_hi:[1,1]
s_add_u32 s31,s95,2048
s_sub_u32 s33,s31,s83
buffer_load_dwordx2 a[180:181],v36,s[12:15],s33 offen offset:8 sc1
v_pk_mul_f32 v[202:203],v[202:203],s[16:17] op_sel:[0,1] op_sel_hi:[1,1]
v_pk_mul_f32 v[204:205],v[204:205],s[16:17] op_sel:[0,1] op_sel_hi:[1,1]
v_pk_mul_f32 v[206:207],v[206:207],s[16:17] op_sel:[0,1] op_sel_hi:[1,1]
v_exp_f32 v192,v192
v_exp_f32 v193,v193
v_exp_f32 v194,v194
v_exp_f32 v195,v195
v_exp_f32 v196,v196
v_exp_f32 v197,v197
v_exp_f32 v198,v198
buffer_store_dwordx4 a[76:79],v36,s[12:15],s90 offen sc1
v_exp_f32 v199,v199
v_exp_f32 v200,v200
v_exp_f32 v201,v201
v_exp_f32 v202,v202
v_exp_f32 v203,v203
v_exp_f32 v204,v204
v_exp_f32 v205,v205
v_exp_f32 v206,v206
v_exp_f32_e64 v207,v207
v_pk_add_f32 v[210:211],v[192:193],v[194:195]
buffer_load_dwordx2 a[186:187],v36,s[12:15],s33 offen offset:1032 sc1
v_pk_add_f32 v[210:211],v[210:211],v[196:197]
v_pk_add_f32 v[210:211],v[210:211],v[198:199]
v_add_f32_e64 v216,v210,v211
v_pk_add_f32 v[212:213],v[200:201],v[202:203]
v_pk_add_f32 v[212:213],v[212:213],v[204:205]
v_pk_add_f32 v[212:213],v[212:213],v[206:207]
v_add_f32 v217,v212,v213
v_mov_b32 v208,v216
v_mov_b32 v209,v217
s_nop 0
buffer_store_dwordx4 a[80:83],v36,s[12:15],s90 offen offset:1024 sc1
v_permlane32_swap_b32 v208,v216
v_permlane32_swap_b32 v209,v217
s_nop 0
v_add_f32 v216,v208,v216
v_add_f32 v217,v209,v217
v_mov_b32 v208,v216
v_mov_b32 v209,v217
s_nop 0
v_permlane16_swap_b32 v208,v216
v_permlane16_swap_b32 v209,v217
buffer_load_dwordx4 a[182:185],v36,s[12:15],s31 offen sc1
s_nop 0
v_add_f32 v216,v208,v216
v_add_f32 v217,v209,v217
v_rcp_f32 v216,v216
v_rcp_f32 v217,v217
s_nop 0
v_pk_mul_f32 v[192:193],v[192:193],v[216:217] op_sel:[0,0] op_sel_hi:[1,0]
v_pk_mul_f32 v[194:195],v[194:195],v[216:217] op_sel:[0,0] op_sel_hi:[1,0]
v_pk_mul_f32 v[196:197],v[196:197],v[216:217] op_sel:[0,0] op_sel_hi:[1,0]
v_pk_mul_f32 v[198:199],v[198:199],v[216:217] op_sel:[0,0] op_sel_hi:[1,0]
buffer_store_dwordx4 a[84:87],v36,s[12:15],s90 offen offset:2048 sc1
v_pk_mul_f32 v[200:201],v[200:201],v[216:217] op_sel:[0,1] op_sel_hi:[1,1]
v_pk_mul_f32 v[202:203],v[202:203],v[216:217] op_sel:[0,1] op_sel_hi:[1,1]
v_pk_mul_f32 v[204:205],v[204:205],v[216:217] op_sel:[0,1] op_sel_hi:[1,1]
v_pk_mul_f32 v[206:207],v[206:207],v[216:217] op_sel:[0,1] op_sel_hi:[1,1]
CV v220,v192,v193
CV v221,v194,v195
CV v222,v196,v197
CV v223,v198,v199
CV v224,v200,v201
CV v225,v202,v203
buffer_load_dwordx4 a[188:191],v36,s[12:15],s31 offen offset:1024 sc1
CV v226,v204,v205
CV v227,v206,v207
s_nop 1
M v[228:231],a[244:247],v[220:223],0
M v[232:235],a[250:253],v[220:223],0
M v[236:239],a[246:249],v[224:227],0
M v[240:243],a[252:255],v[224:227],0
v_add_u32 v208,21,v15
v_lshrrev_b32_e64 v209,3,v208
v_lshl_add_u32 v16,v209,10,v13
buffer_store_dwordx4 a[88:91],v36,s[12:15],s91 offen sc1
v_and_b32_e64 v209,3,v208
v_lshl_add_u32 v16,v209,8,v16
v_and_b32_e64 v209,4,v208
v_lshl_add_u32 v16,v209,1,v16
v_add_u32 v208,25,v15
v_lshrrev_b32 v209,3,v208
v_lshl_add_u32 v17,v209,10,v13
v_and_b32_e64 v209,3,v208
v_lshl_add_u32 v17,v209,8,v17
v_and_b32_e64 v209,4,v208
buffer_store_dwordx4 a[92:95],v36,s[12:15],s91 offen offset:1024 sc1
v_lshl_add_u32 v17,v209,1,v17
v_cndmask_b32 v17,v18,v17,s[28:29]
CV v244,v228,v229
CV v245,v230,v231
CV v246,v232,v233
CV v247,v234,v235
ds_write_b64 v16,v[244:245] offset:0
ds_write_b64 v17,v[246:247] offset:0
CV v248,v236,v237
CV v249,v238,v239
buffer_store_dwordx4 a[96:99],v36,s[12:15],s91 offen offset:2048 sc1
CV v250,v240,v241
CV v251,v242,v243
ds_write_b64 v16,v[248:249] offset:16384
ds_write_b64 v17,v[250:251] offset:16384
s_waitcnt vmcnt(3)
s_mov_b32 exec_lo,0
s_mov_b32 exec_hi,0xffff0000
AW a130,0
AW a131,0
AW a134,0
AW a135,0
AW a162,0
AW a163,0
AW a166,0
AW a167,0
s_mov_b64 exec,-1
s_nop 1
M v[192:195],a[136:139],a[128:131],0
M v[196:199],a[140:143],a[128:131],0
M v[200:203],a[140:143],a[132:135],0
M v[204:207],a[144:147],a[132:135],0
s_nop 7
s_nop 0
CV v208,v192,v193
CV v209,v194,v195
CV v210,v196,v197
CV v211,v198,v199
CV v212,v200,v201
CV v213,v202,v203
CV v214,v204,v205
CV v215,v206,v207
s_add_u32 m0,s45,57344
s_nop 0
buffer_load_dwordx4 v26,s[8:11],s81 offen lds
v_lshlrev_b32 v192,16,v208
v_and_b32 v193,0xffff0000,v208
v_lshlrev_b32_e64 v194,16,v209
v_and_b32 v195,0xffff0000,v209
v_lshlrev_b32_e64 v196,16,v210
v_and_b32 v197,0xffff0000,v210
v_lshlrev_b32_e64 v198,16,v211
v_and_b32 v199,0xffff0000,v211
v_lshlrev_b32_e64 v200,16,v212
v_and_b32 v201,0xffff0000,v212
v_lshlrev_b32_e64 v202,16,v213
v_and_b32 v203,0xffff0000,v213
v_lshlrev_b32_e64 v204,16,v214
v_and_b32 v205,0xffff0000,v214
v_lshlrev_b32_e64 v206,16,v215
v_and_b32 v207,0xffff0000,v215
v_pk_mul_f32 v[192:193],v[192:193],s[16:17] op_sel_hi:[1,0]
v_pk_mul_f32 v[194:195],v[194:195],s[16:17] op_sel_hi:[1,0]
v_pk_mul_f32 v[196:197],v[196:197],s[16:17] op_sel_hi:[1,0]
v_pk_mul_f32 v[198:199],v[198:199],s[16:17] op_sel_hi:[1,0]
v_pk_mul_f32 v[200:201],v[200:201],s[16:17] op_sel_hi:[1,0]
v_pk_mul_f32 v[202:203],v[202:203],s[16:17] op_sel_hi:[1,0]
v_pk_mul_f32 v[204:205],v[204:205],s[16:17] op_sel_hi:[1,0]
v_pk_mul_f32 v[206:207],v[206:207],s[16:17] op_sel_hi:[1,0]
CV v208,v192,v193
CV v209,v194,v195
buffer_load_dwordx4 v26,s[8:11],s81 offen offset:1024 lds
CV v210,v196,v197
CV v211,v198,v199
CV v212,v200,v201
CV v213,v202,v203
CV v214,v204,v205
CV v215,v206,v207
v_lshlrev_b32_e64 v192,16,v208
v_and_b32 v193,0xffff0000,v208
v_lshlrev_b32_e64 v194,16,v209
v_and_b32 v195,0xffff0000,v209
v_lshlrev_b32_e64 v196,16,v210
v_and_b32 v197,0xffff0000,v210
v_lshlrev_b32_e64 v198,16,v211
v_and_b32 v199,0xffff0000,v211
v_lshlrev_b32_e64 v200,16,v212
v_and_b32 v201,0xffff0000,v212
v_lshlrev_b32_e64 v202,16,v213
v_and_b32 v203,0xffff0000,v213
v_lshlrev_b32_e64 v204,16,v214
v_and_b32 v205,0xffff0000,v214
v_lshlrev_b32_e64 v206,16,v215
v_and_b32 v207,0xffff0000,v215
v_cndmask_b32 v192,v11,v192,s[50:51]
v_cndmask_b32 v193,v11,v193,s[56:57]
v_cndmask_b32 v194,v11,v194,s[54:55]
v_cndmask_b32 v195,v11,v195,s[18:19]
buffer_load_dwordx4 v26,s[8:11],s81 offen offset:2048 lds
v_cndmask_b32 v196,v11,v196,s[42:43]
v_cndmask_b32 v197,v11,v197,s[52:53]
v_cndmask_b32 v198,v11,v198,s[46:47]
v_cndmask_b32 v199,v11,v199,s[48:49]
v_cndmask_b32 v200,v11,v200,s[22:23]
v_cndmask_b32 v201,v11,v201,s[24:25]
v_cndmask_b32 v202,v11,v202,s[36:37]
v_cndmask_b32 v203,v11,v203,s[38:39]
v_cndmask_b32 v204,v11,v204,s[42:43]
v_cndmask_b32 v205,v11,v205,s[52:53]
v_cndmask_b32 v206,v11,v206,s[46:47]
v_cndmask_b32 v207,v11,v207,s[48:49]
v_max3_f32 v216,v192,v193,v194
v_max3_f32 v216,v195,v196,v216
v_max3_f32 v216,v197,v198,v216
v_max_f32_e64 v216,v199,v216
v_max3_f32 v217,v200,v201,v202
v_max3_f32 v217,v203,v204,v217
v_max3_f32 v217,v205,v206,v217
v_max_f32 v217,v207,v217
v_mov_b32 v208,v216
v_mov_b32 v209,v217
s_nop 0
v_permlane32_swap_b32 v208,v216
v_permlane32_swap_b32 v209,v217
s_nop 0
s_waitcnt vmcnt(3)
s_barrier
s_cmp_eq_u32 s20,3
s_cbranch_scc0 K1_AT_NS
v_mov_b32 v30,1
v_mov_b32 v31,0
s_mov_b64 exec,1
buffer_store_dword v30,v31,s[12:15],s77 offen sc1
s_mov_b64 exec,-1
K1_AT_NS:
v_max_f32 v216,v208,v216
v_max_f32 v217,v209,v217
v_mov_b32 v208,v216
v_mov_b32 v209,v217
s_nop 0
v_permlane16_swap_b32 v208,v216
v_permlane16_swap_b32 v209,v217
s_nop 0
v_max_f32 v216,v208,v216
v_max_f32_e64 v217,v209,v217
v_pk_add_f32 v[192:193],v[192:193],v[216:217] op_sel:[0,0] op_sel_hi:[1,0] neg_lo:[0,1] neg_hi:[0,1]
v_pk_add_f32 v[194:195],v[194:195],v[216:217] op_sel:[0,0] op_sel_hi:[1,0] neg_lo:[0,1] neg_hi:[0,1]
v_pk_add_f32 v[196:197],v[196:197],v[216:217] op_sel:[0,0] op_sel_hi:[1,0] neg_lo:[0,1] neg_hi:[0,1]
v_pk_add_f32 v[198:199],v[198:199],v[216:217] op_sel:[0,0] op_sel_hi:[1,0] neg_lo:[0,1] neg_hi:[0,1]
v_pk_add_f32 v[200:201],v[200:201],v[216:217] op_sel:[0,1] op_sel_hi:[1,1] neg_lo:[0,1] neg_hi:[0,1]
v_pk_add_f32 v[202:203],v[202:203],v[216:217] op_sel:[0,1] op_sel_hi:[1,1] neg_lo:[0,1] neg_hi:[0,1]
v_pk_add_f32 v[204:205],v[204:205],v[216:217] op_sel:[0,1] op_sel_hi:[1,1] neg_lo:[0,1] neg_hi:[0,1]
v_pk_add_f32 v[206:207],v[206:207],v[216:217] op_sel:[0,1] op_sel_hi:[1,1] neg_lo:[0,1] neg_hi:[0,1]
v_pk_mul_f32 v[192:193],v[192:193],s[16:17] op_sel:[0,1] op_sel_hi:[1,1]
v_pk_mul_f32 v[194:195],v[194:195],s[16:17] op_sel:[0,1] op_sel_hi:[1,1]
v_pk_mul_f32 v[196:197],v[196:197],s[16:17] op_sel:[0,1] op_sel_hi:[1,1]
v_pk_mul_f32 v[198:199],v[198:199],s[16:17] op_sel:[0,1] op_sel_hi:[1,1]
v_pk_mul_f32 v[200:201],v[200:201],s[16:17] op_sel:[0,1] op_sel_hi:[1,1]
v_pk_mul_f32 v[202:203],v[202:203],s[16:17] op_sel:[0,1] op_sel_hi:[1,1]
v_pk_mul_f32 v[204:205],v[204:205],s[16:17] op_sel:[0,1] op_sel_hi:[1,1]
v_pk_mul_f32 v[206:207],v[206:207],s[16:17] op_sel:[0,1] op_sel_hi:[1,1]
buffer_load_dwordx4 v26,s[8:11],s81 offen offset:3072 lds
v_exp_f32 v192,v192
v_exp_f32 v193,v193
v_exp_f32 v194,v194
v_exp_f32 v195,v195
v_exp_f32 v196,v196
v_exp_f32 v197,v197
v_exp_f32 v198,v198
v_exp_f32 v199,v199
v_exp_f32 v200,v200
v_exp_f32 v201,v201
v_exp_f32 v202,v202
v_exp_f32 v203,v203
v_exp_f32 v204,v204
v_exp_f32 v205,v205
v_exp_f32 v206,v206
v_exp_f32 v207,v207
v_pk_add_f32 v[210:211],v[192:193],v[194:195]
v_pk_add_f32 v[210:211],v[210:211],v[196:197]
v_pk_add_f32 v[210:211],v[210:211],v[198:199]
v_add_f32_e64 v216,v210,v211
v_pk_add_f32 v[212:213],v[200:201],v[202:203]
v_pk_add_f32 v[212:213],v[212:213],v[204:205]
v_pk_add_f32 v[212:213],v[212:213],v[206:207]
v_add_f32 v217,v212,v213
v_mov_b32 v208,v216
v_mov_b32 v209,v217
s_add_u32 m0,s45,61440
s_nop 0
buffer_load_dwordx4 v27,s[8:11],s81 offen lds
s_nop 0
v_permlane32_swap_b32 v208,v216
v_permlane32_swap_b32 v209,v217
s_nop 0
v_add_f32 v216,v208,v216
v_add_f32 v217,v209,v217
v_mov_b32 v208,v216
v_mov_b32 v209,v217
s_nop 0
v_permlane16_swap_b32 v208,v216
v_permlane16_swap_b32 v209,v217
s_nop 0
v_add_f32 v216,v208,v216
v_add_f32 v217,v209,v217
v_rcp_f32_e64 v216,v216
v_rcp_f32 v217,v217
s_nop 0
v_pk_mul_f32 v[192:193],v[192:193],v[216:217] op_sel:[0,0] op_sel_hi:[1,0]
v_pk_mul_f32 v[194:195],v[194:195],v[216:217] op_sel:[0,0] op_sel_hi:[1,0]
v_pk_mul_f32 v[196:197],v[196:197],v[216:217] op_sel:[0,0] op_sel_hi:[1,0]
v_pk_mul_f32 v[198:199],v[198:199],v[216:217] op_sel:[0,0] op_sel_hi:[1,0]
v_pk_mul_f32 v[200:201],v[200:201],v[216:217] op_sel:[0,1] op_sel_hi:[1,1]
v_pk_mul_f32 v[202:203],v[202:203],v[216:217] op_sel:[0,1] op_sel_hi:[1,1]
v_pk_mul_f32 v[204:205],v[204:205],v[216:217] op_sel:[0,1] op_sel_hi:[1,1]
v_pk_mul_f32 v[206:207],v[206:207],v[216:217] op_sel:[0,1] op_sel_hi:[1,1]
CV v220,v192,v193
buffer_load_dwordx4 v27,s[8:11],s81 offen offset:1024 lds
CV v221,v194,v195
CV v222,v196,v197
CV v223,v198,v199
CV v224,v200,v201
CV v225,v202,v203
CV v226,v204,v205
CV v227,v206,v207
s_nop 1
M v[228:231],a[148:151],v[220:223],0
M v[232:235],a[154:157],v[220:223],0
M v[236:239],a[150:153],v[224:227],0
M v[240:243],a[156:159],v[224:227],0
v_add_u32 v208,0,v15
v_lshrrev_b32 v209,3,v208
v_lshl_add_u32 v16,v209,10,v13
v_and_b32 v209,3,v208
v_lshl_add_u32 v16,v209,8,v16
v_and_b32_e64 v209,4,v208
v_lshl_add_u32 v16,v209,1,v16
v_add_u32 v208,4,v15
v_lshrrev_b32 v209,3,v208
v_lshl_add_u32 v17,v209,10,v13
v_and_b32_e64 v209,3,v208
v_lshl_add_u32 v17,v209,8,v17
v_and_b32_e64 v209,4,v208
v_lshl_add_u32 v17,v209,1,v17
buffer_load_dwordx4 v27,s[8:11],s81 offen offset:2048 lds
s_add_u32 s81,s81,28672
v_cndmask_b32 v17,v18,v17,s[28:29]
CV v244,v228,v229
CV v245,v230,v231
CV v246,v232,v233
CV v247,v234,v235
ds_write_b64 v16,v[244:245] offset:0
ds_write_b64 v17,v[246:247] offset:0
CV v248,v236,v237
CV v249,v238,v239
CV v250,v240,v241
CV v251,v242,v243
ds_write_b64 v16,v[248:249] offset:16384
ds_write_b64 v17,v[250:251] offset:16384
M v[192:195],a[168:171],a[160:163],0
M v[196:199],a[172:175],a[160:163],0
M v[200:203],a[172:175],a[164:167],0
M v[204:207],a[176:179],a[164:167],0
s_nop 7
s_nop 0
CV v208,v192,v193
CV v209,v194,v195
CV v210,v196,v197
CV v211,v198,v199
CV v212,v200,v201
CV v213,v202,v203
CV v214,v204,v205
CV v215,v206,v207
v_lshlrev_b32_e64 v192,16,v208
v_and_b32 v193,0xffff0000,v208
s_add_u32 m0,s45,86016
s_nop 0
buffer_load_dwordx4 v26,s[8:11],s81 offen lds
v_lshlrev_b32 v194,16,v209
v_and_b32 v195,0xffff0000,v209
v_lshlrev_b32_e64 v196,16,v210
v_and_b32 v197,0xffff0000,v210
v_lshlrev_b32_e64 v198,16,v211
v_and_b32 v199,0xffff0000,v211
v_lshlrev_b32_e64 v200,16,v212
v_and_b32 v201,0xffff0000,v212
v_lshlrev_b32_e64 v202,16,v213
v_and_b32 v203,0xffff0000,v213
v_lshlrev_b32_e64 v204,16,v214
v_and_b32 v205,0xffff0000,v214
v_lshlrev_b32_e64 v206,16,v215
v_and_b32 v207,0xffff0000,v215
v_pk_mul_f32 v[192:193],v[192:193],s[16:17] op_sel_hi:[1,0]
v_pk_mul_f32 v[194:195],v[194:195],s[16:17] op_sel_hi:[1,0]
v_pk_mul_f32 v[196:197],v[196:197],s[16:17] op_sel_hi:[1,0]
v_pk_mul_f32 v[198:199],v[198:199],s[16:17] op_sel_hi:[1,0]
v_pk_mul_f32 v[200:201],v[200:201],s[16:17] op_sel_hi:[1,0]
v_pk_mul_f32 v[202:203],v[202:203],s[16:17] op_sel_hi:[1,0]
v_pk_mul_f32 v[204:205],v[204:205],s[16:17] op_sel_hi:[1,0]
v_pk_mul_f32 v[206:207],v[206:207],s[16:17] op_sel_hi:[1,0]
CV v208,v192,v193
CV v209,v194,v195
CV v210,v196,v197
CV v211,v198,v199
CV v212,v200,v201
CV v213,v202,v203
CV v214,v204,v205
CV v215,v206,v207
buffer_load_dwordx4 v26,s[8:11],s81 offen offset:1024 lds
v_lshlrev_b32_e64 v192,16,v208
v_and_b32 v193,0xffff0000,v208
v_lshlrev_b32_e64 v194,16,v209
v_and_b32 v195,0xffff0000,v209
v_lshlrev_b32_e64 v196,16,v210
v_and_b32 v197,0xffff0000,v210
v_lshlrev_b32_e64 v198,16,v211
v_and_b32 v199,0xffff0000,v211
v_lshlrev_b32_e64 v200,16,v212
v_and_b32 v201,0xffff0000,v212
v_lshlrev_b32_e64 v202,16,v213
v_and_b32 v203,0xffff0000,v213
v_lshlrev_b32_e64 v204,16,v214
v_and_b32 v205,0xffff0000,v214
v_lshlrev_b32_e64 v206,16,v215
v_and_b32 v207,0xffff0000,v215
v_cndmask_b32 v192,v11,v192,s[50:51]
v_cndmask_b32 v193,v11,v193,s[56:57]
v_cndmask_b32 v194,v11,v194,s[54:55]
v_cndmask_b32 v195,v11,v195,s[18:19]
v_cndmask_b32 v196,v11,v196,s[42:43]
v_cndmask_b32 v197,v11,v197,s[52:53]
v_cndmask_b32 v198,v11,v198,s[46:47]
v_cndmask_b32 v199,v11,v199,s[48:49]
v_cndmask_b32 v200,v11,v200,s[22:23]
v_cndmask_b32 v201,v11,v201,s[24:25]
v_cndmask_b32 v202,v11,v202,s[36:37]
v_cndmask_b32 v203,v11,v203,s[38:39]
v_cndmask_b32 v204,v11,v204,s[42:43]
v_cndmask_b32 v205,v11,v205,s[52:53]
buffer_load_dwordx4 v26,s[8:11],s81 offen offset:2048 lds
v_cndmask_b32 v206,v11,v206,s[46:47]
v_cndmask_b32 v207,v11,v207,s[48:49]
v_max3_f32 v216,v192,v193,v194
v_max3_f32 v216,v195,v196,v216
v_max3_f32 v216,v197,v198,v216
v_max_f32_e64 v216,v199,v216
v_max3_f32 v217,v200,v201,v202
v_max3_f32 v217,v203,v204,v217
v_max3_f32 v217,v205,v206,v217
v_max_f32 v217,v207,v217
v_mov_b32 v208,v216
v_mov_b32 v209,v217
s_nop 0
v_permlane32_swap_b32 v208,v216
v_permlane32_swap_b32 v209,v217
s_nop 0
v_max_f32 v216,v208,v216
v_max_f32 v217,v209,v217
v_mov_b32 v208,v216
v_mov_b32 v209,v217
s_nop 0
v_permlane16_swap_b32 v208,v216
v_permlane16_swap_b32 v209,v217
s_nop 0
v_max_f32 v216,v208,v216
v_max_f32_e64 v217,v209,v217
v_pk_add_f32 v[192:193],v[192:193],v[216:217] op_sel:[0,0] op_sel_hi:[1,0] neg_lo:[0,1] neg_hi:[0,1]
v_pk_add_f32 v[194:195],v[194:195],v[216:217] op_sel:[0,0] op_sel_hi:[1,0] neg_lo:[0,1] neg_hi:[0,1]
v_pk_add_f32 v[196:197],v[196:197],v[216:217] op_sel:[0,0] op_sel_hi:[1,0] neg_lo:[0,1] neg_hi:[0,1]
buffer_load_dwordx4 v26,s[8:11],s81 offen offset:3072 lds
v_pk_add_f32 v[198:199],v[198:199],v[216:217] op_sel:[0,0] op_sel_hi:[1,0] neg_lo:[0,1] neg_hi:[0,1]
v_pk_add_f32 v[200:201],v[200:201],v[216:217] op_sel:[0,1] op_sel_hi:[1,1] neg_lo:[0,1] neg_hi:[0,1]
v_pk_add_f32 v[202:203],v[202:203],v[216:217] op_sel:[0,1] op_sel_hi:[1,1] neg_lo:[0,1] neg_hi:[0,1]
v_pk_add_f32 v[204:205],v[204:205],v[216:217] op_sel:[0,1] op_sel_hi:[1,1] neg_lo:[0,1] neg_hi:[0,1]
v_pk_add_f32 v[206:207],v[206:207],v[216:217] op_sel:[0,1] op_sel_hi:[1,1] neg_lo:[0,1] neg_hi:[0,1]
v_pk_mul_f32 v[192:193],v[192:193],s[16:17] op_sel:[0,1] op_sel_hi:[1,1]
v_pk_mul_f32 v[194:195],v[194:195],s[16:17] op_sel:[0,1] op_sel_hi:[1,1]
v_pk_mul_f32 v[196:197],v[196:197],s[16:17] op_sel:[0,1] op_sel_hi:[1,1]
v_pk_mul_f32 v[198:199],v[198:199],s[16:17] op_sel:[0,1] op_sel_hi:[1,1]
v_pk_mul_f32 v[200:201],v[200:201],s[16:17] op_sel:[0,1] op_sel_hi:[1,1]
v_pk_mul_f32 v[202:203],v[202:203],s[16:17] op_sel:[0,1] op_sel_hi:[1,1]
v_pk_mul_f32 v[204:205],v[204:205],s[16:17] op_sel:[0,1] op_sel_hi:[1,1]
v_pk_mul_f32 v[206:207],v[206:207],s[16:17] op_sel:[0,1] op_sel_hi:[1,1]
v_exp_f32 v192,v192
v_exp_f32 v193,v193
v_exp_f32 v194,v194
v_exp_f32 v195,v195
v_exp_f32 v196,v196
v_exp_f32 v197,v197
v_exp_f32 v198,v198
v_exp_f32 v199,v199
v_exp_f32 v200,v200
v_exp_f32 v201,v201
v_exp_f32 v202,v202
v_exp_f32 v203,v203
v_exp_f32 v204,v204
v_exp_f32 v205,v205
v_exp_f32_e64 v206,v206
v_exp_f32 v207,v207
v_pk_add_f32 v[210:211],v[192:193],v[194:195]
s_add_u32 m0,s45,90112
s_nop 0
buffer_load_dwordx4 v27,s[8:11],s81 offen lds
v_pk_add_f32 v[210:211],v[210:211],v[196:197]
v_pk_add_f32 v[210:211],v[210:211],v[198:199]
v_add_f32_e64 v216,v210,v211
v_pk_add_f32 v[212:213],v[200:201],v[202:203]
v_pk_add_f32 v[212:213],v[212:213],v[204:205]
v_pk_add_f32 v[212:213],v[212:213],v[206:207]
v_add_f32 v217,v212,v213
v_mov_b32 v208,v216
v_mov_b32 v209,v217
s_nop 0
v_permlane32_swap_b32 v208,v216
v_permlane32_swap_b32 v209,v217
s_nop 0
v_add_f32 v216,v208,v216
v_add_f32 v217,v209,v217
v_mov_b32 v208,v216
v_mov_b32 v209,v217
s_nop 0
v_permlane16_swap_b32 v208,v216
v_permlane16_swap_b32 v209,v217
s_nop 0
v_add_f32 v216,v208,v216
v_add_f32 v217,v209,v217
v_rcp_f32 v216,v216
v_rcp_f32 v217,v217
s_nop 0
v_pk_mul_f32 v[192:193],v[192:193],v[216:217] op_sel:[0,0] op_sel_hi:[1,0]
v_pk_mul_f32 v[194:195],v[194:195],v[216:217] op_sel:[0,0] op_sel_hi:[1,0]
v_pk_mul_f32 v[196:197],v[196:197],v[216:217] op_sel:[0,0] op_sel_hi:[1,0]
v_pk_mul_f32 v[198:199],v[198:199],v[216:217] op_sel:[0,0] op_sel_hi:[1,0]
buffer_load_dwordx4 v27,s[8:11],s81 offen offset:1024 lds
v_pk_mul_f32 v[200:201],v[200:201],v[216:217] op_sel:[0,1] op_sel_hi:[1,1]
v_pk_mul_f32 v[202:203],v[202:203],v[216:217] op_sel:[0,1] op_sel_hi:[1,1]
v_pk_mul_f32 v[204:205],v[204:205],v[216:217] op_sel:[0,1] op_sel_hi:[1,1]
v_pk_mul_f32 v[206:207],v[206:207],v[216:217] op_sel:[0,1] op_sel_hi:[1,1]
CV v220,v192,v193
CV v221,v194,v195
CV v222,v196,v197
CV v223,v198,v199
CV v224,v200,v201
CV v225,v202,v203
CV v226,v204,v205
CV v227,v206,v207
s_nop 1
M v[228:231],a[180:183],v[220:223],0
M v[232:235],a[186:189],v[220:223],0
M v[236:239],a[182:185],v[224:227],0
M v[240:243],a[188:191],v[224:227],0
v_add_u32 v208,7,v15
v_lshrrev_b32 v209,3,v208
v_lshl_add_u32 v16,v209,10,v13
v_and_b32 v209,3,v208
v_lshl_add_u32 v16,v209,8,v16
v_and_b32_e64 v209,4,v208
v_lshl_add_u32 v16,v209,1,v16
v_add_u32 v208,11,v15
v_lshrrev_b32 v209,3,v208
v_lshl_add_u32 v17,v209,10,v13
v_and_b32_e64 v209,3,v208
v_lshl_add_u32 v17,v209,8,v17
v_and_b32_e64 v209,4,v208
buffer_load_dwordx4 v27,s[8:11],s81 offen offset:2048 lds
s_add_u32 s81,s81,28672
v_lshl_add_u32 v17,v209,1,v17
v_cndmask_b32 v17,v18,v17,s[28:29]
CV v244,v228,v229
CV v245,v230,v231
CV v246,v232,v233
CV v247,v234,v235
ds_write_b64 v16,v[244:245] offset:0
ds_write_b64 v17,v[246:247] offset:0
CV v248,v236,v237
CV v249,v238,v239
CV v250,v240,v241
CV v251,v242,v243
ds_write_b64 v16,v[248:249] offset:16384
ds_write_b64 v17,v[250:251] offset:16384
s_waitcnt vmcnt(63) lgkmcnt(0)
s_barrier
ds_read_b128 v[184:187],v14 offset:0
ds_read_b128 v[188:191],v14 offset:16384
ds_read_b64_tr_b16 v[128:129],v108 offset:0
ds_read_b64_tr_b16 v[130:131],v108 offset:14336
ds_read_b64_tr_b16 v[132:133],v109 offset:0
ds_read_b64_tr_b16 v[134:135],v109 offset:14336
ds_read_b64_tr_b16 v[136:137],v110 offset:0
ds_read_b64_tr_b16 v[138:139],v110 offset:14336
ds_read_b64_tr_b16 v[140:141],v111 offset:0
ds_read_b64_tr_b16 v[142:143],v111 offset:14336
ds_read_b64_tr_b16 v[144:145],v112 offset:0
ds_read_b64_tr_b16 v[146:147],v112 offset:14336
ds_read_b64_tr_b16 v[148:149],v113 offset:0
ds_read_b64_tr_b16 v[150:151],v113 offset:14336
ds_read_b64_tr_b16 v[152:153],v114 offset:0
ds_read_b64_tr_b16 v[154:155],v114 offset:14336
s_waitcnt vmcnt(63) lgkmcnt(0)
s_barrier
M a[0:3],v[128:131],v[184:187],0
ds_read_b128 v[192:195],v14 offset:1024
ds_read_b128 v[196:199],v14 offset:17408
M a[4:7],v[128:131],v[188:191],0
ds_read_b64_tr_b16 v[156:157],v108 offset:28672
ds_read_b64_tr_b16 v[158:159],v108 offset:43008
s_add_u32 m0,s45,0
s_nop 0
buffer_load_dwordx4 v26,s[8:11],s81 offen lds
M a[8:11],v[132:135],v[184:187],0
ds_read_b64_tr_b16 v[160:161],v109 offset:28672
ds_read_b64_tr_b16 v[162:163],v109 offset:43008
M a[12:15],v[132:135],v[188:191],0
ds_read_b64_tr_b16 v[164:165],v110 offset:28672
ds_read_b64_tr_b16 v[166:167],v110 offset:43008
buffer_load_dwordx4 v26,s[8:11],s81 offen offset:1024 lds
M a[16:19],v[136:139],v[184:187],0
ds_read_b64_tr_b16 v[168:169],v111 offset:28672
ds_read_b64_tr_b16 v[170:171],v111 offset:43008
M a[20:23],v[136:139],v[188:191],0
ds_read_b64_tr_b16 v[172:173],v112 offset:28672
ds_read_b64_tr_b16 v[174:175],v112 offset:43008
buffer_load_dwordx4 v26,s[8:11],s81 offen offset:2048 lds
M a[24:27],v[140:143],v[184:187],0
ds_read_b64_tr_b16 v[176:177],v113 offset:28672
ds_read_b64_tr_b16 v[178:179],v113 offset:43008
M a[28:31],v[140:143],v[188:191],0
ds_read_b64_tr_b16 v[180:181],v114 offset:28672
ds_read_b64_tr_b16 v[182:183],v114 offset:43008
buffer_load_dwordx4 v26,s[8:11],s81 offen offset:3072 lds
M a[32:35],v[144:147],v[184:187],0
M a[36:39],v[144:147],v[188:191],0
s_add_u32 m0,s45,4096
s_nop 0
buffer_load_dwordx4 v27,s[8:11],s81 offen lds
M a[40:43],v[148:151],v[184:187],0
M a[44:47],v[148:151],v[188:191],0
buffer_load_dwordx4 v27,s[8:11],s81 offen offset:1024 lds
M a[48:51],v[152:155],v[184:187],0
M a[52:55],v[152:155],v[188:191],0
buffer_load_dwordx4 v27,s[8:11],s81 offen offset:2048 lds
s_add_u32 s81,s81,28672
s_waitcnt vmcnt(14) lgkmcnt(0)
s_barrier
M a[0:3],v[156:159],v[192:195],a[0:3]
ds_read_b128 v[184:187],v14 offset:2048
ds_read_b128 v[188:191],v14 offset:18432
M a[4:7],v[156:159],v[196:199],a[4:7]
ds_read_b64_tr_b16 v[128:129],v115 offset:0
ds_read_b64_tr_b16 v[130:131],v115 offset:14336
s_add_u32 m0,s45,28672
s_nop 0
buffer_load_dwordx4 v26,s[8:11],s81 offen lds
M a[8:11],v[160:163],v[192:195],a[8:11]
ds_read_b64_tr_b16 v[132:133],v116 offset:0
ds_read_b64_tr_b16 v[134:135],v116 offset:14336
M a[12:15],v[160:163],v[196:199],a[12:15]
ds_read_b64_tr_b16 v[136:137],v117 offset:0
ds_read_b64_tr_b16 v[138:139],v117 offset:14336
buffer_load_dwordx4 v26,s[8:11],s81 offen offset:1024 lds
M a[16:19],v[164:167],v[192:195],a[16:19]
ds_read_b64_tr_b16 v[140:141],v118 offset:0
ds_read_b64_tr_b16 v[142:143],v118 offset:14336
M a[20:23],v[164:167],v[196:199],a[20:23]
ds_read_b64_tr_b16 v[144:145],v119 offset:0
ds_read_b64_tr_b16 v[146:147],v119 offset:14336
buffer_load_dwordx4 v26,s[8:11],s81 offen offset:2048 lds
M a[24:27],v[168:171],v[192:195],a[24:27]
ds_read_b64_tr_b16 v[148:149],v120 offset:0
ds_read_b64_tr_b16 v[150:151],v120 offset:14336
M a[28:31],v[168:171],v[196:199],a[28:31]
ds_read_b64_tr_b16 v[152:153],v121 offset:0
ds_read_b64_tr_b16 v[154:155],v121 offset:14336
buffer_load_dwordx4 v26,s[8:11],s81 offen offset:3072 lds
M a[32:35],v[172:175],v[192:195],a[32:35]
M a[36:39],v[172:175],v[196:199],a[36:39]
s_add_u32 m0,s45,32768
s_nop 0
buffer_load_dwordx4 v27,s[8:11],s81 offen lds
M a[40:43],v[176:179],v[192:195],a[40:43]
M a[44:47],v[176:179],v[196:199],a[44:47]
buffer_load_dwordx4 v27,s[8:11],s81 offen offset:1024 lds
M a[48:51],v[180:183],v[192:195],a[48:51]
M a[52:55],v[180:183],v[196:199],a[52:55]
buffer_load_dwordx4 v27,s[8:11],s81 offen offset:2048 lds
s_add_u32 s81,s81,28672
s_waitcnt vmcnt(14) lgkmcnt(0)
s_barrier
M a[0:3],v[128:131],v[184:187],a[0:3]
ds_read_b128 v[192:195],v14 offset:3072
ds_read_b128 v[196:199],v14 offset:19456
M a[4:7],v[128:131],v[188:191],a[4:7]
ds_read_b64_tr_b16 v[156:157],v115 offset:28672
ds_read_b64_tr_b16 v[158:159],v115 offset:43008
s_add_u32 m0,s45,57344
s_nop 0
buffer_load_dwordx4 v26,s[8:11],s81 offen lds
M a[8:11],v[132:135],v[184:187],a[8:11]
ds_read_b64_tr_b16 v[160:161],v116 offset:28672
ds_read_b64_tr_b16 v[162:163],v116 offset:43008
M a[12:15],v[132:135],v[188:191],a[12:15]
ds_read_b64_tr_b16 v[164:165],v117 offset:28672
ds_read_b64_tr_b16 v[166:167],v117 offset:43008
buffer_load_dwordx4 v26,s[8:11],s81 offen offset:1024 lds
M a[16:19],v[136:139],v[184:187],a[16:19]
ds_read_b64_tr_b16 v[168:169],v118 offset:28672
ds_read_b64_tr_b16 v[170:171],v118 offset:43008
M a[20:23],v[136:139],v[188:191],a[20:23]
ds_read_b64_tr_b16 v[172:173],v119 offset:28672
ds_read_b64_tr_b16 v[174:175],v119 offset:43008
buffer_load_dwordx4 v26,s[8:11],s81 offen offset:2048 lds
M a[24:27],v[140:143],v[184:187],a[24:27]
ds_read_b64_tr_b16 v[176:177],v120 offset:28672
ds_read_b64_tr_b16 v[178:179],v120 offset:43008
M a[28:31],v[140:143],v[188:191],a[28:31]
ds_read_b64_tr_b16 v[180:181],v121 offset:28672
ds_read_b64_tr_b16 v[182:183],v121 offset:43008
buffer_load_dwordx4 v26,s[8:11],s81 offen offset:3072 lds
M a[32:35],v[144:147],v[184:187],a[32:35]
M a[36:39],v[144:147],v[188:191],a[36:39]
s_add_u32 m0,s45,61440
s_nop 0
buffer_load_dwordx4 v27,s[8:11],s81 offen lds
M a[40:43],v[148:151],v[184:187],a[40:43]
M a[44:47],v[148:151],v[188:191],a[44:47]
buffer_load_dwordx4 v27,s[8:11],s81 offen offset:1024 lds
M a[48:51],v[152:155],v[184:187],a[48:51]
M a[52:55],v[152:155],v[188:191],a[52:55]
buffer_load_dwordx4 v27,s[8:11],s81 offen offset:2048 lds
s_add_u32 s81,s81,28672
s_waitcnt vmcnt(14) lgkmcnt(0)
s_barrier
M a[0:3],v[156:159],v[192:195],a[0:3]
ds_read_b128 v[184:187],v14 offset:4096
ds_read_b128 v[188:191],v14 offset:20480
M a[4:7],v[156:159],v[196:199],a[4:7]
ds_read_b64_tr_b16 v[128:129],v108 offset:0
ds_read_b64_tr_b16 v[130:131],v108 offset:14336
s_add_u32 m0,s45,86016
s_nop 0
buffer_load_dwordx4 v26,s[8:11],s81 offen lds
M a[8:11],v[160:163],v[192:195],a[8:11]
ds_read_b64_tr_b16 v[132:133],v109 offset:0
ds_read_b64_tr_b16 v[134:135],v109 offset:14336
M a[12:15],v[160:163],v[196:199],a[12:15]
ds_read_b64_tr_b16 v[136:137],v110 offset:0
ds_read_b64_tr_b16 v[138:139],v110 offset:14336
buffer_load_dwordx4 v26,s[8:11],s81 offen offset:1024 lds
M a[16:19],v[164:167],v[192:195],a[16:19]
ds_read_b64_tr_b16 v[140:141],v111 offset:0
ds_read_b64_tr_b16 v[142:143],v111 offset:14336
M a[20:23],v[164:167],v[196:199],a[20:23]
ds_read_b64_tr_b16 v[144:145],v112 offset:0
ds_read_b64_tr_b16 v[146:147],v112 offset:14336
buffer_load_dwordx4 v26,s[8:11],s81 offen offset:2048 lds
M a[24:27],v[168:171],v[192:195],a[24:27]
ds_read_b64_tr_b16 v[148:149],v113 offset:0
ds_read_b64_tr_b16 v[150:151],v113 offset:14336
M a[28:31],v[168:171],v[196:199],a[28:31]
ds_read_b64_tr_b16 v[152:153],v114 offset:0
ds_read_b64_tr_b16 v[154:155],v114 offset:14336
buffer_load_dwordx4 v26,s[8:11],s81 offen offset:3072 lds
M a[32:35],v[172:175],v[192:195],a[32:35]
M a[36:39],v[172:175],v[196:199],a[36:39]
s_add_u32 m0,s45,90112
s_nop 0
buffer_load_dwordx4 v27,s[8:11],s81 offen lds
M a[40:43],v[176:179],v[192:195],a[40:43]
M a[44:47],v[176:179],v[196:199],a[44:47]
buffer_load_dwordx4 v27,s[8:11],s81 offen offset:1024 lds
M a[48:51],v[180:183],v[192:195],a[48:51]
M a[52:55],v[180:183],v[196:199],a[52:55]
buffer_load_dwordx4 v27,s[8:11],s81 offen offset:2048 lds
s_add_u32 s81,s81,28672
s_waitcnt vmcnt(14) lgkmcnt(0)
s_barrier
M a[0:3],v[128:131],v[184:187],a[0:3]
ds_read_b128 v[192:195],v14 offset:5120
ds_read_b128 v[196:199],v14 offset:21504
M a[4:7],v[128:131],v[188:191],a[4:7]
ds_read_b64_tr_b16 v[156:157],v108 offset:28672
ds_read_b64_tr_b16 v[158:159],v108 offset:43008
s_add_u32 m0,s45,0
s_nop 0
buffer_load_dwordx4 v26,s[8:11],s81 offen lds
M a[8:11],v[132:135],v[184:187],a[8:11]
ds_read_b64_tr_b16 v[160:161],v109 offset:28672
ds_read_b64_tr_b16 v[162:163],v109 offset:43008
M a[12:15],v[132:135],v[188:191],a[12:15]
ds_read_b64_tr_b16 v[164:165],v110 offset:28672
ds_read_b64_tr_b16 v[166:167],v110 offset:43008
buffer_load_dwordx4 v26,s[8:11],s81 offen offset:1024 lds
M a[16:19],v[136:139],v[184:187],a[16:19]
ds_read_b64_tr_b16 v[168:169],v111 offset:28672
ds_read_b64_tr_b16 v[170:171],v111 offset:43008
M a[20:23],v[136:139],v[188:191],a[20:23]
ds_read_b64_tr_b16 v[172:173],v112 offset:28672
ds_read_b64_tr_b16 v[174:175],v112 offset:43008
buffer_load_dwordx4 v26,s[8:11],s81 offen offset:2048 lds
M a[24:27],v[140:143],v[184:187],a[24:27]
ds_read_b64_tr_b16 v[176:177],v113 offset:28672
ds_read_b64_tr_b16 v[178:179],v113 offset:43008
M a[28:31],v[140:143],v[188:191],a[28:31]
ds_read_b64_tr_b16 v[180:181],v114 offset:28672
ds_read_b64_tr_b16 v[182:183],v114 offset:43008
buffer_load_dwordx4 v26,s[8:11],s81 offen offset:3072 lds
M a[32:35],v[144:147],v[184:187],a[32:35]
M a[36:39],v[144:147],v[188:191],a[36:39]
s_add_u32 m0,s45,4096
s_nop 0
buffer_load_dwordx4 v27,s[8:11],s81 offen lds
M a[40:43],v[148:151],v[184:187],a[40:43]
M a[44:47],v[148:151],v[188:191],a[44:47]
buffer_load_dwordx4 v27,s[8:11],s81 offen offset:1024 lds
M a[48:51],v[152:155],v[184:187],a[48:51]
M a[52:55],v[152:155],v[188:191],a[52:55]
buffer_load_dwordx4 v27,s[8:11],s81 offen offset:2048 lds
s_add_u32 s81,s81,28672
s_waitcnt vmcnt(14) lgkmcnt(0)
s_barrier
M a[0:3],v[156:159],v[192:195],a[0:3]
ds_read_b128 v[184:187],v14 offset:6144
ds_read_b128 v[188:191],v14 offset:22528
M a[4:7],v[156:159],v[196:199],a[4:7]
ds_read_b64_tr_b16 v[128:129],v115 offset:0
ds_read_b64_tr_b16 v[130:131],v115 offset:14336
s_add_u32 m0,s45,28672
s_nop 0
buffer_load_dwordx4 v26,s[8:11],s81 offen lds
M a[8:11],v[160:163],v[192:195],a[8:11]
ds_read_b64_tr_b16 v[132:133],v116 offset:0
ds_read_b64_tr_b16 v[134:135],v116 offset:14336
M a[12:15],v[160:163],v[196:199],a[12:15]
ds_read_b64_tr_b16 v[136:137],v117 offset:0
ds_read_b64_tr_b16 v[138:139],v117 offset:14336
buffer_load_dwordx4 v26,s[8:11],s81 offen offset:1024 lds
M a[16:19],v[164:167],v[192:195],a[16:19]
ds_read_b64_tr_b16 v[140:141],v118 offset:0
ds_read_b64_tr_b16 v[142:143],v118 offset:14336
M a[20:23],v[164:167],v[196:199],a[20:23]
ds_read_b64_tr_b16 v[144:145],v119 offset:0
ds_read_b64_tr_b16 v[146:147],v119 offset:14336
buffer_load_dwordx4 v26,s[8:11],s81 offen offset:2048 lds
M a[24:27],v[168:171],v[192:195],a[24:27]
ds_read_b64_tr_b16 v[148:149],v120 offset:0
ds_read_b64_tr_b16 v[150:151],v120 offset:14336
M a[28:31],v[168:171],v[196:199],a[28:31]
ds_read_b64_tr_b16 v[152:153],v121 offset:0
ds_read_b64_tr_b16 v[154:155],v121 offset:14336
buffer_load_dwordx4 v26,s[8:11],s81 offen offset:3072 lds
M a[32:35],v[172:175],v[192:195],a[32:35]
M a[36:39],v[172:175],v[196:199],a[36:39]
s_add_u32 m0,s45,32768
s_nop 0
buffer_load_dwordx4 v27,s[8:11],s81 offen lds
M a[40:43],v[176:179],v[192:195],a[40:43]
M a[44:47],v[176:179],v[196:199],a[44:47]
buffer_load_dwordx4 v27,s[8:11],s81 offen offset:1024 lds
M a[48:51],v[180:183],v[192:195],a[48:51]
M a[52:55],v[180:183],v[196:199],a[52:55]
buffer_load_dwordx4 v27,s[8:11],s81 offen offset:2048 lds
s_add_u32 s81,s81,28672
s_waitcnt vmcnt(14) lgkmcnt(0)
s_barrier
s_lshl_b32 s32,s35,7
s_add_u32 s32,s32,136314880
buffer_load_dword v41,v40,s[12:15],s32 offen sc1
M a[0:3],v[128:131],v[184:187],a[0:3]
ds_read_b128 v[192:195],v14 offset:7168
ds_read_b128 v[196:199],v14 offset:23552
M a[4:7],v[128:131],v[188:191],a[4:7]
ds_read_b64_tr_b16 v[156:157],v115 offset:28672
ds_read_b64_tr_b16 v[158:159],v115 offset:43008
s_add_u32 m0,s45,57344
s_nop 0
buffer_load_dwordx4 v26,s[8:11],s81 offen lds
M a[8:11],v[132:135],v[184:187],a[8:11]
ds_read_b64_tr_b16 v[160:161],v116 offset:28672
ds_read_b64_tr_b16 v[162:163],v116 offset:43008
M a[12:15],v[132:135],v[188:191],a[12:15]
ds_read_b64_tr_b16 v[164:165],v117 offset:28672
ds_read_b64_tr_b16 v[166:167],v117 offset:43008
buffer_load_dwordx4 v26,s[8:11],s81 offen offset:1024 lds
M a[16:19],v[136:139],v[184:187],a[16:19]
ds_read_b64_tr_b16 v[168:169],v118 offset:28672
ds_read_b64_tr_b16 v[170:171],v118 offset:43008
M a[20:23],v[136:139],v[188:191],a[20:23]
ds_read_b64_tr_b16 v[172:173],v119 offset:28672
ds_read_b64_tr_b16 v[174:175],v119 offset:43008
buffer_load_dwordx4 v26,s[8:11],s81 offen offset:2048 lds
M a[24:27],v[140:143],v[184:187],a[24:27]
ds_read_b64_tr_b16 v[176:177],v120 offset:28672
ds_read_b64_tr_b16 v[178:179],v120 offset:43008
M a[28:31],v[140:143],v[188:191],a[28:31]
ds_read_b64_tr_b16 v[180:181],v121 offset:28672
ds_read_b64_tr_b16 v[182:183],v121 offset:43008
buffer_load_dwordx4 v26,s[8:11],s81 offen offset:3072 lds
M a[32:35],v[144:147],v[184:187],a[32:35]
M a[36:39],v[144:147],v[188:191],a[36:39]
s_add_u32 m0,s45,61440
s_nop 0
buffer_load_dwordx4 v27,s[8:11],s81 offen lds
M a[40:43],v[148:151],v[184:187],a[40:43]
M a[44:47],v[148:151],v[188:191],a[44:47]
buffer_load_dwordx4 v27,s[8:11],s81 offen offset:1024 lds
M a[48:51],v[152:155],v[184:187],a[48:51]
M a[52:55],v[152:155],v[188:191],a[52:55]
buffer_load_dwordx4 v27,s[8:11],s81 offen offset:2048 lds
s_add_u32 s81,s81,28672
s_waitcnt vmcnt(15) lgkmcnt(0)
s_barrier
M a[0:3],v[156:159],v[192:195],a[0:3]
ds_read_b128 v[184:187],v14 offset:8192
ds_read_b128 v[188:191],v14 offset:24576
M a[4:7],v[156:159],v[196:199],a[4:7]
ds_read_b64_tr_b16 v[128:129],v108 offset:0
ds_read_b64_tr_b16 v[130:131],v108 offset:14336
s_add_u32 m0,s45,86016
s_nop 0
buffer_load_dwordx4 v26,s[8:11],s81 offen lds
M a[8:11],v[160:163],v[192:195],a[8:11]
ds_read_b64_tr_b16 v[132:133],v109 offset:0
ds_read_b64_tr_b16 v[134:135],v109 offset:14336
M a[12:15],v[160:163],v[196:199],a[12:15]
ds_read_b64_tr_b16 v[136:137],v110 offset:0
ds_read_b64_tr_b16 v[138:139],v110 offset:14336
buffer_load_dwordx4 v26,s[8:11],s81 offen offset:1024 lds
M a[16:19],v[164:167],v[192:195],a[16:19]
ds_read_b64_tr_b16 v[140:141],v111 offset:0
ds_read_b64_tr_b16 v[142:143],v111 offset:14336
M a[20:23],v[164:167],v[196:199],a[20:23]
ds_read_b64_tr_b16 v[144:145],v112 offset:0
ds_read_b64_tr_b16 v[146:147],v112 offset:14336
buffer_load_dwordx4 v26,s[8:11],s81 offen offset:2048 lds
M a[24:27],v[168:171],v[192:195],a[24:27]
ds_read_b64_tr_b16 v[148:149],v113 offset:0
ds_read_b64_tr_b16 v[150:151],v113 offset:14336
M a[28:31],v[168:171],v[196:199],a[28:31]
ds_read_b64_tr_b16 v[152:153],v114 offset:0
ds_read_b64_tr_b16 v[154:155],v114 offset:14336
buffer_load_dwordx4 v26,s[8:11],s81 offen offset:3072 lds
M a[32:35],v[172:175],v[192:195],a[32:35]
M a[36:39],v[172:175],v[196:199],a[36:39]
s_add_u32 m0,s45,90112
s_nop 0
buffer_load_dwordx4 v27,s[8:11],s81 offen lds
M a[40:43],v[176:179],v[192:195],a[40:43]
M a[44:47],v[176:179],v[196:199],a[44:47]
buffer_load_dwordx4 v27,s[8:11],s81 offen offset:1024 lds
M a[48:51],v[180:183],v[192:195],a[48:51]
M a[52:55],v[180:183],v[196:199],a[52:55]
buffer_load_dwordx4 v27,s[8:11],s81 offen offset:2048 lds
s_add_u32 s81,s81,28672
s_waitcnt vmcnt(15) lgkmcnt(0)
s_barrier
M a[0:3],v[128:131],v[184:187],a[0:3]
ds_read_b128 v[192:195],v14 offset:9216
ds_read_b128 v[196:199],v14 offset:25600
M a[4:7],v[128:131],v[188:191],a[4:7]
ds_read_b64_tr_b16 v[156:157],v108 offset:28672
ds_read_b64_tr_b16 v[158:159],v108 offset:43008
s_add_u32 m0,s45,0
s_nop 0
buffer_load_dwordx4 v26,s[8:11],s81 offen lds
M a[8:11],v[132:135],v[184:187],a[8:11]
ds_read_b64_tr_b16 v[160:161],v109 offset:28672
ds_read_b64_tr_b16 v[162:163],v109 offset:43008
M a[12:15],v[132:135],v[188:191],a[12:15]
ds_read_b64_tr_b16 v[164:165],v110 offset:28672
ds_read_b64_tr_b16 v[166:167],v110 offset:43008
buffer_load_dwordx4 v26,s[8:11],s81 offen offset:1024 lds
M a[16:19],v[136:139],v[184:187],a[16:19]
ds_read_b64_tr_b16 v[168:169],v111 offset:28672
ds_read_b64_tr_b16 v[170:171],v111 offset:43008
M a[20:23],v[136:139],v[188:191],a[20:23]
ds_read_b64_tr_b16 v[172:173],v112 offset:28672
ds_read_b64_tr_b16 v[174:175],v112 offset:43008
buffer_load_dwordx4 v26,s[8:11],s81 offen offset:2048 lds
M a[24:27],v[140:143],v[184:187],a[24:27]
ds_read_b64_tr_b16 v[176:177],v113 offset:28672
ds_read_b64_tr_b16 v[178:179],v113 offset:43008
M a[28:31],v[140:143],v[188:191],a[28:31]
ds_read_b64_tr_b16 v[180:181],v114 offset:28672
ds_read_b64_tr_b16 v[182:183],v114 offset:43008
buffer_load_dwordx4 v26,s[8:11],s81 offen offset:3072 lds
M a[32:35],v[144:147],v[184:187],a[32:35]
M a[36:39],v[144:147],v[188:191],a[36:39]
s_add_u32 m0,s45,4096
s_nop 0
buffer_load_dwordx4 v27,s[8:11],s81 offen lds
M a[40:43],v[148:151],v[184:187],a[40:43]
M a[44:47],v[148:151],v[188:191],a[44:47]
buffer_load_dwordx4 v27,s[8:11],s81 offen offset:1024 lds
M a[48:51],v[152:155],v[184:187],a[48:51]
M a[52:55],v[152:155],v[188:191],a[52:55]
buffer_load_dwordx4 v27,s[8:11],s81 offen offset:2048 lds
s_add_u32 s81,s81,28672
s_waitcnt vmcnt(14) lgkmcnt(0)
s_barrier
M a[0:3],v[156:159],v[192:195],a[0:3]
ds_read_b128 v[184:187],v14 offset:10240
ds_read_b128 v[188:191],v14 offset:26624
M a[4:7],v[156:159],v[196:199],a[4:7]
ds_read_b64_tr_b16 v[128:129],v115 offset:0
ds_read_b64_tr_b16 v[130:131],v115 offset:14336
s_add_u32 m0,s45,28672
s_nop 0
buffer_load_dwordx4 v26,s[8:11],s81 offen lds
M a[8:11],v[160:163],v[192:195],a[8:11]
ds_read_b64_tr_b16 v[132:133],v116 offset:0
ds_read_b64_tr_b16 v[134:135],v116 offset:14336
M a[12:15],v[160:163],v[196:199],a[12:15]
ds_read_b64_tr_b16 v[136:137],v117 offset:0
ds_read_b64_tr_b16 v[138:139],v117 offset:14336
buffer_load_dwordx4 v26,s[8:11],s81 offen offset:1024 lds
M a[16:19],v[164:167],v[192:195],a[16:19]
ds_read_b64_tr_b16 v[140:141],v118 offset:0
ds_read_b64_tr_b16 v[142:143],v118 offset:14336
M a[20:23],v[164:167],v[196:199],a[20:23]
ds_read_b64_tr_b16 v[144:145],v119 offset:0
ds_read_b64_tr_b16 v[146:147],v119 offset:14336
buffer_load_dwordx4 v26,s[8:11],s81 offen offset:2048 lds
M a[24:27],v[168:171],v[192:195],a[24:27]
ds_read_b64_tr_b16 v[148:149],v120 offset:0
ds_read_b64_tr_b16 v[150:151],v120 offset:14336
M a[28:31],v[168:171],v[196:199],a[28:31]
ds_read_b64_tr_b16 v[152:153],v121 offset:0
ds_read_b64_tr_b16 v[154:155],v121 offset:14336
buffer_load_dwordx4 v26,s[8:11],s81 offen offset:3072 lds
M a[32:35],v[172:175],v[192:195],a[32:35]
M a[36:39],v[172:175],v[196:199],a[36:39]
s_add_u32 m0,s45,32768
s_nop 0
buffer_load_dwordx4 v27,s[8:11],s81 offen lds
M a[40:43],v[176:179],v[192:195],a[40:43]
M a[44:47],v[176:179],v[196:199],a[44:47]
buffer_load_dwordx4 v27,s[8:11],s81 offen offset:1024 lds
M a[48:51],v[180:183],v[192:195],a[48:51]
M a[52:55],v[180:183],v[196:199],a[52:55]
buffer_load_dwordx4 v27,s[8:11],s81 offen offset:2048 lds
s_add_u32 s81,s81,28672
s_waitcnt vmcnt(14) lgkmcnt(0)
s_barrier
s_mov_b32 s33,0xf80f0f
s_call_b64 s[100:101],SUB_CHK
s_lshl_b32 s32,s35,7
s_lshl_b32 s33,s74,3
s_add_u32 s32,s32,s33
s_add_u32 s32,s32,s20
s_lshl_b32 s62,s32,13
s_add_u32 s31,s62,0
buffer_load_dwordx4 a[192:195],v36,s[12:15],s31 offen sc1
M a[0:3],v[128:131],v[184:187],a[0:3]
ds_read_b128 v[192:195],v14 offset:11264
ds_read_b128 v[196:199],v14 offset:27648
M a[4:7],v[128:131],v[188:191],a[4:7]
ds_read_b64_tr_b16 v[156:157],v115 offset:28672
ds_read_b64_tr_b16 v[158:159],v115 offset:43008
M a[8:11],v[132:135],v[184:187],a[8:11]
ds_read_b64_tr_b16 v[160:161],v116 offset:28672
ds_read_b64_tr_b16 v[162:163],v116 offset:43008
M a[12:15],v[132:135],v[188:191],a[12:15]
ds_read_b64_tr_b16 v[164:165],v117 offset:28672
ds_read_b64_tr_b16 v[166:167],v117 offset:43008
buffer_load_dwordx4 a[196:199],v36,s[12:15],s31 offen offset:1024 sc1
M a[16:19],v[136:139],v[184:187],a[16:19]
ds_read_b64_tr_b16 v[168:169],v118 offset:28672
ds_read_b64_tr_b16 v[170:171],v118 offset:43008
M a[20:23],v[136:139],v[188:191],a[20:23]
ds_read_b64_tr_b16 v[172:173],v119 offset:28672
ds_read_b64_tr_b16 v[174:175],v119 offset:43008
M a[24:27],v[140:143],v[184:187],a[24:27]
ds_read_b64_tr_b16 v[176:177],v120 offset:28672
ds_read_b64_tr_b16 v[178:179],v120 offset:43008
M a[28:31],v[140:143],v[188:191],a[28:31]
ds_read_b64_tr_b16 v[180:181],v121 offset:28672
ds_read_b64_tr_b16 v[182:183],v121 offset:43008
buffer_load_dwordx4 a[200:203],v36,s[12:15],s31 offen offset:2048 sc1
M a[32:35],v[144:147],v[184:187],a[32:35]
M a[36:39],v[144:147],v[188:191],a[36:39]
M a[40:43],v[148:151],v[184:187],a[40:43]
M a[44:47],v[148:151],v[188:191],a[44:47]
buffer_load_dwordx4 a[204:207],v36,s[12:15],s31 offen offset:3072 sc1
M a[48:51],v[152:155],v[184:187],a[48:51]
M a[52:55],v[152:155],v[188:191],a[52:55]
s_waitcnt vmcnt(11) lgkmcnt(0)
s_barrier
s_add_u32 s31,s62,4096
buffer_load_dwordx4 a[208:211],v36,s[12:15],s31 offen sc1
M a[0:3],v[156:159],v[192:195],a[0:3]
ds_read_b128 v[184:187],v14 offset:12288
ds_read_b128 v[188:191],v14 offset:28672
M a[4:7],v[156:159],v[196:199],a[4:7]
ds_read_b64_tr_b16 v[128:129],v108 offset:0
ds_read_b64_tr_b16 v[130:131],v108 offset:14336
M a[8:11],v[160:163],v[192:195],a[8:11]
ds_read_b64_tr_b16 v[132:133],v109 offset:0
ds_read_b64_tr_b16 v[134:135],v109 offset:14336
M a[12:15],v[160:163],v[196:199],a[12:15]
ds_read_b64_tr_b16 v[136:137],v110 offset:0
ds_read_b64_tr_b16 v[138:139],v110 offset:14336
buffer_load_dwordx4 a[212:215],v36,s[12:15],s31 offen offset:1024 sc1
M a[16:19],v[164:167],v[192:195],a[16:19]
ds_read_b64_tr_b16 v[140:141],v111 offset:0
ds_read_b64_tr_b16 v[142:143],v111 offset:14336
M a[20:23],v[164:167],v[196:199],a[20:23]
ds_read_b64_tr_b16 v[144:145],v112 offset:0
ds_read_b64_tr_b16 v[146:147],v112 offset:14336
M a[24:27],v[168:171],v[192:195],a[24:27]
ds_read_b64_tr_b16 v[148:149],v113 offset:0
ds_read_b64_tr_b16 v[150:151],v113 offset:14336
M a[28:31],v[168:171],v[196:199],a[28:31]
ds_read_b64_tr_b16 v[152:153],v114 offset:0
ds_read_b64_tr_b16 v[154:155],v114 offset:14336
buffer_load_dwordx4 a[216:219],v36,s[12:15],s31 offen offset:2048 sc1
M a[32:35],v[172:175],v[192:195],a[32:35]
M a[36:39],v[172:175],v[196:199],a[36:39]
M a[40:43],v[176:179],v[192:195],a[40:43]
M a[44:47],v[176:179],v[196:199],a[44:47]
buffer_load_dwordx4 a[220:223],v36,s[12:15],s31 offen offset:3072 sc1
M a[48:51],v[180:183],v[192:195],a[48:51]
M a[52:55],v[180:183],v[196:199],a[52:55]
s_waitcnt vmcnt(8) lgkmcnt(0)
s_barrier
s_add_u32 s31,s62,32768
buffer_load_dwordx4 a[224:227],v36,s[12:15],s31 offen sc1
M a[0:3],v[128:131],v[184:187],a[0:3]
ds_read_b128 v[192:195],v14 offset:13312
ds_read_b128 v[196:199],v14 offset:29696
M a[4:7],v[128:131],v[188:191],a[4:7]
ds_read_b64_tr_b16 v[156:157],v108 offset:28672
ds_read_b64_tr_b16 v[158:159],v108 offset:43008
M a[8:11],v[132:135],v[184:187],a[8:11]
ds_read_b64_tr_b16 v[160:161],v109 offset:28672
ds_read_b64_tr_b16 v[162:163],v109 offset:43008
M a[12:15],v[132:135],v[188:191],a[12:15]
ds_read_b64_tr_b16 v[164:165],v110 offset:28672
ds_read_b64_tr_b16 v[166:167],v110 offset:43008
buffer_load_dwordx4 a[228:231],v36,s[12:15],s31 offen offset:1024 sc1
M a[16:19],v[136:139],v[184:187],a[16:19]
ds_read_b64_tr_b16 v[168:169],v111 offset:28672
ds_read_b64_tr_b16 v[170:171],v111 offset:43008
M a[20:23],v[136:139],v[188:191],a[20:23]
ds_read_b64_tr_b16 v[172:173],v112 offset:28672
ds_read_b64_tr_b16 v[174:175],v112 offset:43008
M a[24:27],v[140:143],v[184:187],a[24:27]
ds_read_b64_tr_b16 v[176:177],v113 offset:28672
ds_read_b64_tr_b16 v[178:179],v113 offset:43008
M a[28:31],v[140:143],v[188:191],a[28:31]
ds_read_b64_tr_b16 v[180:181],v114 offset:28672
ds_read_b64_tr_b16 v[182:183],v114 offset:43008
buffer_load_dwordx4 a[232:235],v36,s[12:15],s31 offen offset:2048 sc1
M a[32:35],v[144:147],v[184:187],a[32:35]
M a[36:39],v[144:147],v[188:191],a[36:39]
M a[40:43],v[148:151],v[184:187],a[40:43]
M a[44:47],v[148:151],v[188:191],a[44:47]
buffer_load_dwordx4 a[236:239],v36,s[12:15],s31 offen offset:3072 sc1
M a[48:51],v[152:155],v[184:187],a[48:51]
M a[52:55],v[152:155],v[188:191],a[52:55]
s_waitcnt lgkmcnt(0)
s_barrier
s_add_u32 s31,s62,36864
buffer_load_dwordx4 a[240:243],v36,s[12:15],s31 offen sc1
M a[0:3],v[156:159],v[192:195],a[0:3]
M a[4:7],v[156:159],v[196:199],a[4:7]
M a[8:11],v[160:163],v[192:195],a[8:11]
M a[12:15],v[160:163],v[196:199],a[12:15]
buffer_load_dwordx4 a[244:247],v36,s[12:15],s31 offen offset:1024 sc1
M a[16:19],v[164:167],v[192:195],a[16:19]
M a[20:23],v[164:167],v[196:199],a[20:23]
M a[24:27],v[168:171],v[192:195],a[24:27]
M a[28:31],v[168:171],v[196:199],a[28:31]
buffer_load_dwordx4 a[248:251],v36,s[12:15],s31 offen offset:2048 sc1
M a[32:35],v[172:175],v[192:195],a[32:35]
M a[36:39],v[172:175],v[196:199],a[36:39]
M a[40:43],v[176:179],v[192:195],a[40:43]
M a[44:47],v[176:179],v[196:199],a[44:47]
buffer_load_dwordx4 a[252:255],v36,s[12:15],s31 offen offset:3072 sc1
M a[48:51],v[180:183],v[192:195],a[48:51]
M a[52:55],v[180:183],v[196:199],a[52:55]
v_and_b32 v30,15,v35
v_mul_u32_u24 v30,912,v30
s_mul_i32 s30,s20,224
v_lshrrev_b32_e64 v31,4,v35
v_lshl_add_u32 v30,v31,3,v30
v_add_u32 v30,s30,v30
s_nop 2
AR v80,a0
AR v81,a1
AR v82,a2
AR v83,a3
CV v84,v80,v81
CV v85,v82,v83
ds_write_b64 v30,v[84:85] offset:0
AR v86,a8
AR v87,a9
AR v88,a10
AR v89,a11
CV v90,v86,v87
CV v91,v88,v89
ds_write_b64 v30,v[90:91] offset:32
AR v92,a16
AR v93,a17
AR v94,a18
AR v95,a19
CV v96,v92,v93
CV v97,v94,v95
ds_write_b64 v30,v[96:97] offset:64
AR v98,a24
AR v99,a25
AR v100,a26
AR v101,a27
CV v102,v98,v99
CV v103,v100,v101
ds_write_b64 v30,v[102:103] offset:96
AR v80,a32
AR v81,a33
AR v82,a34
AR v83,a35
CV v84,v80,v81
CV v85,v82,v83
ds_write_b64 v30,v[84:85] offset:128
AR v86,a40
AR v87,a41
AR v88,a42
AR v89,a43
CV v90,v86,v87
CV v91,v88,v89
ds_write_b64 v30,v[90:91] offset:160
AR v92,a48
AR v93,a49
AR v94,a50
AR v95,a51
CV v96,v92,v93
CV v97,v94,v95
ds_write_b64 v30,v[96:97] offset:192
AR v98,a4
AR v99,a5
AR v100,a6
AR v101,a7
CV v102,v98,v99
CV v103,v100,v101
ds_write_b64 v30,v[102:103] offset:14592
AR v80,a12
AR v81,a13
AR v82,a14
AR v83,a15
CV v84,v80,v81
CV v85,v82,v83
ds_write_b64 v30,v[84:85] offset:14624
AR v86,a20
AR v87,a21
AR v88,a22
AR v89,a23
CV v90,v86,v87
CV v91,v88,v89
ds_write_b64 v30,v[90:91] offset:14656
AR v92,a28
AR v93,a29
AR v94,a30
AR v95,a31
CV v96,v92,v93
CV v97,v94,v95
ds_write_b64 v30,v[96:97] offset:14688
AR v98,a36
AR v99,a37
AR v100,a38
AR v101,a39
CV v102,v98,v99
CV v103,v100,v101
ds_write_b64 v30,v[102:103] offset:14720
AR v80,a44
AR v81,a45
AR v82,a46
AR v83,a47
CV v84,v80,v81
CV v85,v82,v83
ds_write_b64 v30,v[84:85] offset:14752
AR v86,a52
AR v87,a53
AR v88,a54
AR v89,a55
CV v90,v86,v87
CV v91,v88,v89
ds_write_b64 v30,v[90:91] offset:14784
s_mov_b32 s84,s4
s_mov_b32 s85,s5
s_mov_b32 s86,s6
s_mov_b32 s87,0x20000
s_mul_i32 s94,s80,57344
s_mul_i32 s30,s20,448
v_add_u32 v15,s30,v35
v_add_u32_e64 v30,0,v15
v_mul_u32_u24 v31,9363,v30
v_lshrrev_b32_e64 v31,19,v31
v_add_lshl_u32 v16,v30,v31,4
v_mul_u32_u24 v31,880,v31
v_add_u32 v8,v16,v31
v_add_u32 v30,64,v15
v_mul_u32_u24 v31,9363,v30
v_lshrrev_b32_e64 v31,19,v31
v_add_lshl_u32 v17,v30,v31,4
v_mul_u32_u24 v31,880,v31
v_add_u32_e64 v9,v17,v31
v_add_u32 v30,128,v15
v_mul_u32_u24 v31,9363,v30
v_lshrrev_b32_e64 v31,19,v31
v_add_lshl_u32 v18,v30,v31,4
v_mul_u32_u24 v31,880,v31
v_add_u32_e64 v10,v18,v31
v_add_u32 v30,192,v15
v_mul_u32_u24 v31,9363,v30
v_lshrrev_b32_e64 v31,19,v31
v_add_lshl_u32 v19,v30,v31,4
v_mul_u32_u24 v31,880,v31
v_add_u32_e64 v11,v19,v31
v_add_u32 v30,256,v15
v_mul_u32_u24 v31,9363,v30
v_lshrrev_b32_e64 v31,19,v31
v_add_lshl_u32 v20,v30,v31,4
v_mul_u32_u24 v31,880,v31
v_add_u32_e64 v12,v20,v31
v_add_u32 v30,320,v15
v_mul_u32_u24 v31,9363,v30
v_lshrrev_b32_e64 v31,19,v31
v_add_lshl_u32 v21,v30,v31,4
v_mul_u32_u24 v31,880,v31
v_add_u32_e64 v13,v21,v31
v_add_u32 v30,384,v15
v_mul_u32_u24 v31,9363,v30
v_lshrrev_b32_e64 v31,19,v31
v_add_lshl_u32 v22,v30,v31,4
v_mul_u32_u24 v31,880,v31
v_add_u32_e64 v14,v22,v31
s_waitcnt lgkmcnt(0)
s_barrier
ds_read_b128 v[48:51],v16
ds_read_b128 v[52:55],v17
ds_read_b128 v[56:59],v18
ds_read_b128 v[60:63],v19
ds_read_b128 v[64:67],v20
ds_read_b128 v[68:71],v21
ds_read_b128 v[72:75],v22
s_lshl_b32 s21,s20,13
v_mov_b32 v28,v36
v_add_u32 v4,s21,v36
v_add_u32 v5,4096,v4
s_lshl_b32 s30,s35,20
s_add_u32 s31,s30,16777216
s_add_u32 s32,s30,33554432
s_add_u32 s4,s40,s31
s_addc_u32 s5,s41,0
s_add_u32 s8,s40,s32
s_addc_u32 s9,s41,0
s_add_u32 s30,s76,8
s_lshl_b32 s43,s30,15
s_lshl_b32 s31,s74,16
s_add_u32 s31,s31,65536
s_lshr_b32 s32,s31,15
s_sub_u32 s32,s32,s76
s_cmp_eq_u32 s73,0
s_cselect_b32 s6,s31,s43
s_cselect_b32 s10,s31,s43
s_cselect_b32 s42,262144,-1
s_cselect_b32 s24,s32,s76
s_cselect_b32 s25,3,0
s_cselect_b32 s36,2,1
s_cselect_b32 s26,2,1
s_lshl_b32 s22,s75,15
s_mov_b32 s23,s22
s_lshr_b32 s30,s31,15
s_cmp_eq_u32 s73,2
s_cselect_b32 s6,s31,s6
s_cselect_b32 s10,s31,s10
s_cselect_b32 s24,s30,s24
s_cselect_b32 s25,3,s25
s_cselect_b32 s36,0,s36
s_cselect_b32 s26,2,s26
s_waitcnt lgkmcnt(0)
s_barrier
s_add_u32 m0,s21,131072
s_nop 0
buffer_load_dwordx4 v4,s[4:7],s22 offen sc1 lds
s_load_dwordx2 s[16:17],s[0:1],64
v_mov_b32 v45,v37
v_mov_b32_e64 v2,v28
v_add_u32 v3,0x10000,v28
v_and_b32 v30,15,v35
v_lshrrev_b32 v31,4,v35
v_lshlrev_b32 v31,2,v31
v_sub_u32 v7,v30,v31
buffer_load_dwordx4 v4,s[4:7],s22 offen offset:1024 sc1 lds
s_lshl_b32 s30,s20,4
v_add_u32 v7,s30,v7
s_lshl_b32 s30,s35,3
s_add_u32 s30,s30,s72
s_lshl_b32 s30,s30,2
s_add_u32 s30,s30,s20
s_mul_i32 s37,s30,17408
s_add_u32 s37,s37,83886080
buffer_load_dwordx4 v4,s[4:7],s22 offen offset:2048 sc1 lds
s_mov_b32 s80,s12
s_mov_b32 s81,s13
s_mov_b32 s83,0x20000
s_cmp_eq_u32 s73,0
s_cselect_b32 s82,138412032,0
s_add_u32 s30,s72,24
s_lshl_b32 s28,1,s30
s_cmp_eq_u32 s73,0
s_cselect_b32 s28,s28,0
buffer_load_dwordx4 v4,s[4:7],s22 offen offset:3072 sc1 lds
s_sub_u32 s30,7,s72
s_lshr_b32 s30,s30,1
s_add_u32 s30,s30,16
s_lshl_b32 s29,1,s30
s_cmp_eq_u32 s73,1
s_cselect_b32 s29,s29,0
s_sub_u32 s30,s6,1
s_add_u32 m0,s21,135168
s_nop 0
buffer_load_dwordx4 v5,s[4:7],s22 offen sc1 lds
s_lshr_b32 s30,s30,17
s_add_u32 s30,s30,1
s_bfm_b32 s30,s30,0
s_mul_i32 s30,s30,0x101
s_or_b32 s29,s29,s30
s_mul_i32 s61,s20,57344
s_add_u32 s56,s61,28672
v_lshrrev_b32 v30,3,v35
buffer_load_dwordx4 v5,s[4:7],s22 offen offset:1024 sc1 lds
v_mul_u32_u24 v30,896,v30
v_lshrrev_b32 v31,4,v35
v_lshlrev_b32 v31,1,v31
v_and_b32 v32,7,v35
v_xor_b32 v31,v31,v32
v_lshl_add_u32 v112,v31,4,v30
v_add_u32 v113,6144,v112
v_add_u32 v114,12288,v112
buffer_load_dwordx4 v5,s[4:7],s22 offen offset:2048 sc1 lds
v_add_u32 v115,18432,v112
v_lshrrev_b32 v30,2,v35
v_lshrrev_b32 v31,1,v30
v_and_b32 v31,3,v31
v_and_b32 v32,3,v35
v_lshlrev_b32_e64 v32,3,v32
v_lshl_add_u32 v30,v30,7,v32
v_xor_b32_e64 v32,0,v31
buffer_load_dwordx4 v5,s[4:7],s22 offen offset:3072 sc1 lds
v_lshl_add_u32 v116,v32,5,v30
v_add_u32 v120,0x10000,v116
v_add_u32 v124,0x20000,v116
v_xor_b32_e64 v32,1,v31
v_lshl_add_u32 v117,v32,5,v30
v_add_u32 v121,0x10000,v117
v_add_u32 v125,0x20000,v117
v_xor_b32 v32,2,v31
s_add_u32 s22,s22,32768
s_cmp_eq_u32 s22,s42
s_cselect_b32 s22,s43,s22
s_add_u32 m0,s21,98304
s_nop 0
buffer_load_dwordx4 v4,s[4:7],s22 offen sc1 lds
v_lshl_add_u32 v118,v32,5,v30
v_add_u32 v122,0x10000,v118
v_add_u32 v126,0x20000,v118
v_xor_b32_e64 v32,3,v31
v_lshl_add_u32 v119,v32,5,v30
v_add_u32 v123,0x10000,v119
v_add_u32 v44,0x20000,v119
s_mov_b32 s30,0x40000000
s_cmp_eq_u32 s27,15
s_cselect_b32 s30,0xfffe0000,s30
buffer_load_dwordx4 v4,s[4:7],s22 offen offset:1024 sc1 lds
v_lshlrev_b32_e64 v42,7,v0
v_add_u32 v42,s30,v42
s_mul_i32 s30,s35,229376
s_waitcnt lgkmcnt(0)
s_add_u32 s16,s16,s30
s_addc_u32 s17,s17,0
s_mov_b32 s18,229376
buffer_load_dwordx4 v4,s[4:7],s22 offen offset:2048 sc1 lds
s_mov_b32 s19,0x20000
v_add_u32 v29,0x20000,v28
AW a0,0
AW a1,0
AW a2,0
AW a3,0
AW a4,0
AW a5,0
buffer_load_dwordx4 v4,s[4:7],s22 offen offset:3072 sc1 lds
AW a6,0
AW a7,0
AW a8,0
AW a9,0
AW a10,0
AW a11,0
AW a12,0
AW a13,0
s_add_u32 m0,s21,102400
s_nop 0
s_nop 0
buffer_load_dwordx4 v5,s[4:7],s22 offen sc1 lds
AW a14,0
AW a15,0
AW a16,0
AW a17,0
AW a18,0
AW a19,0
AW a20,0
AW a21,0
buffer_load_dwordx4 v5,s[4:7],s22 offen offset:1024 sc1 lds
AW a22,0
AW a23,0
AW a24,0
AW a25,0
AW a26,0
AW a27,0
AW a28,0
AW a29,0
buffer_load_dwordx4 v5,s[4:7],s22 offen offset:2048 sc1 lds
AW a30,0
AW a31,0
AW a32,0
AW a33,0
AW a34,0
AW a35,0
AW a36,0
AW a37,0
buffer_load_dwordx4 v5,s[4:7],s22 offen offset:3072 sc1 lds
AW a38,0
AW a39,0
AW a40,0
AW a41,0
AW a42,0
AW a43,0
AW a44,0
AW a45,0
s_add_u32 s22,s22,32768
s_cmp_eq_u32 s22,s42
s_cselect_b32 s22,s43,s22
s_add_u32 m0,s21,0
s_nop 0
buffer_load_dwordx4 v4,s[8:11],s23 offen sc1 lds
AW a46,0
AW a47,0
AW a48,0
AW a49,0
AW a50,0
AW a51,0
AW a52,0
AW a53,0
buffer_load_dwordx4 v4,s[8:11],s23 offen offset:1024 sc1 lds
AW a54,0
AW a55,0
AW a56,0
AW a57,0
AW a58,0
AW a59,0
AW a60,0
AW a61,0
AW a62,0
buffer_load_dwordx4 v4,s[8:11],s23 offen offset:2048 sc1 lds
AW a63,0
AW a64,0
AW a65,0
AW a66,0
AW a67,0
AW a68,0
AW a69,0
AW a70,0
buffer_load_dwordx4 v4,s[8:11],s23 offen offset:3072 sc1 lds
AW a71,0
AW a72,0
AW a73,0
AW a74,0
AW a75,0
AW a76,0
AW a77,0
AW a78,0
s_add_u32 m0,s21,4096
s_nop 0
s_nop 0
buffer_load_dwordx4 v5,s[8:11],s23 offen sc1 lds
AW a79,0
AW a80,0
AW a81,0
AW a82,0
AW a83,0
AW a84,0
AW a85,0
AW a86,0
buffer_load_dwordx4 v5,s[8:11],s23 offen offset:1024 sc1 lds
AW a87,0
AW a88,0
AW a89,0
AW a90,0
AW a91,0
AW a92,0
AW a93,0
AW a94,0
buffer_load_dwordx4 v5,s[8:11],s23 offen offset:2048 sc1 lds
AW a95,0
AW a96,0
AW a97,0
AW a98,0
AW a99,0
AW a100,0
AW a101,0
AW a102,0
buffer_load_dwordx4 v5,s[8:11],s23 offen offset:3072 sc1 lds
AW a103,0
AW a104,0
AW a105,0
AW a106,0
AW a107,0
AW a108,0
AW a109,0
AW a110,0
s_add_u32 s23,s23,32768
s_cmp_eq_u32 s23,s42
s_cselect_b32 s23,s43,s23
s_add_u32 m0,s21,32768
s_nop 0
s_nop 0
buffer_load_dwordx4 v4,s[4:7],s22 offen sc1 lds
AW a111,0
AW a112,0
AW a113,0
AW a114,0
AW a115,0
AW a116,0
AW a117,0
AW a118,0
buffer_load_dwordx4 v4,s[4:7],s22 offen offset:1024 sc1 lds
AW a119,0
AW a120,0
AW a121,0
AW a122,0
AW a123,0
AW a124,0
AW a125,0
AW a126,0
AW a127,0
buffer_store_dwordx4 v[48:51],v8,s[84:87],s94 offen sc1
buffer_store_dwordx4 v[52:55],v9,s[84:87],s94 offen sc1
buffer_store_dwordx4 v[56:59],v10,s[84:87],s94 offen sc1
buffer_store_dwordx4 v[60:63],v11,s[84:87],s94 offen sc1
buffer_store_dwordx4 v[64:67],v12,s[84:87],s94 offen sc1
buffer_store_dwordx4 v[68:71],v13,s[84:87],s94 offen sc1
buffer_store_dwordx4 v[72:75],v14,s[84:87],s94 offen sc1
s_mov_b32 s38,0
s_mov_b32 s60,1
s_sub_u32 s39,s24,4
s_cmp_ge_u32 s24,6
s_cselect_b32 s39,s39,0
s_waitcnt vmcnt(25)
s_branch K2_SEG0
K1_XV0:
s_cmp_eq_u32 s53,3
s_cbranch_scc1 K1_XAT
s_mov_b32 s94,s54
s_mov_b32 s95,s55
s_mov_b32 s92,s54
s_mov_b32 s19,s53
s_mov_b32 s53,4
s_mov_b32 s54,s56
s_mov_b32 s55,s57
s_mov_b32 s26,s17
s_mov_b32 s43,3
s_cmp_eq_u32 s20,0
s_nop 0
s_cselect_b32 s78,15,99
CV v48,v48,v49
CV v49,v50,v51
CV v50,v80,v81
CV v51,v82,v83
buffer_store_dwordx4 v[48:51],v36,s[12:15],s94 offen sc1
v_mov_b32 v80,0
v_mov_b32 v81,0
v_mov_b32 v82,0
v_mov_b32 v83,0
CV v52,v52,v53
CV v53,v54,v55
CV v54,v84,v85
CV v55,v86,v87
buffer_store_dwordx4 v[52:55],v36,s[12:15],s94 offen offset:1024 sc1
v_mov_b32 v84,0
v_mov_b32 v85,0
v_mov_b32 v86,0
v_mov_b32 v87,0
v_mov_b32 v48,0
v_mov_b32 v49,0
v_mov_b32 v50,0
v_mov_b32 v51,0
CV v56,v56,v57
CV v57,v58,v59
CV v58,v88,v89
CV v59,v90,v91
buffer_store_dwordx4 v[56:59],v36,s[12:15],s94 offen offset:2048 sc1
v_mov_b32 v88,0
v_mov_b32 v89,0
v_mov_b32 v90,0
v_mov_b32 v91,0
v_mov_b32 v52,0
v_mov_b32 v53,0
v_mov_b32 v54,0
v_mov_b32 v55,0
CV v60,v60,v61
CV v61,v62,v63
CV v62,v92,v93
CV v63,v94,v95
buffer_store_dwordx4 v[60:63],v36,s[12:15],s94 offen offset:3072 sc1
s_add_u32 s94,s94,4096
v_mov_b32 v92,0
v_mov_b32 v93,0
v_mov_b32 v94,0
v_mov_b32 v95,0
v_mov_b32 v56,0
v_mov_b32 v57,0
v_mov_b32 v58,0
v_mov_b32 v59,0
CV v64,v64,v65
CV v65,v66,v67
CV v66,v96,v97
CV v67,v98,v99
buffer_store_dwordx4 v[64:67],v36,s[12:15],s94 offen sc1
v_mov_b32 v96,0
v_mov_b32 v97,0
v_mov_b32 v98,0
v_mov_b32 v99,0
v_mov_b32 v60,0
v_mov_b32 v61,0
v_mov_b32 v62,0
v_mov_b32 v63,0
CV v68,v68,v69
CV v69,v70,v71
CV v70,v100,v101
CV v71,v102,v103
buffer_store_dwordx4 v[68:71],v36,s[12:15],s94 offen offset:1024 sc1
v_mov_b32 v100,0
v_mov_b32 v101,0
v_mov_b32 v102,0
v_mov_b32 v103,0
v_mov_b32 v64,0
v_mov_b32 v65,0
v_mov_b32 v66,0
v_mov_b32 v67,0
CV v72,v72,v73
CV v73,v74,v75
CV v74,v104,v105
CV v75,v106,v107
buffer_store_dwordx4 v[72:75],v36,s[12:15],s94 offen offset:2048 sc1
v_mov_b32 v104,0
v_mov_b32 v105,0
v_mov_b32 v106,0
v_mov_b32 v107,0
v_mov_b32 v68,0
v_mov_b32 v69,0
v_mov_b32 v70,0
v_mov_b32 v71,0
CV v76,v76,v77
CV v77,v78,v79
CV v78,v108,v109
CV v79,v110,v111
buffer_store_dwordx4 v[76:79],v36,s[12:15],s94 offen offset:3072 sc1
s_add_u32 s94,s94,s95
v_mov_b32 v108,0
v_mov_b32 v109,0
v_mov_b32 v110,0
v_mov_b32 v111,0
v_mov_b32 v72,0
v_mov_b32 v73,0
v_mov_b32 v74,0
v_mov_b32_e64 v75,0
CV v112,v112,v113
CV v113,v114,v115
CV v114,v144,v145
CV v115,v146,v147
buffer_store_dwordx4 v[112:115],v36,s[12:15],s94 offen sc1
v_mov_b32 v144,0
v_mov_b32 v145,0
v_mov_b32 v146,0
v_mov_b32 v147,0
v_mov_b32 v76,0
v_mov_b32 v77,0
v_mov_b32 v78,0
v_mov_b32 v79,0
CV v116,v116,v117
CV v117,v118,v119
CV v118,v148,v149
CV v119,v150,v151
buffer_store_dwordx4 v[116:119],v36,s[12:15],s94 offen offset:1024 sc1
v_mov_b32 v148,0
v_mov_b32 v149,0
v_mov_b32 v150,0
v_mov_b32 v151,0
v_mov_b32 v112,0
v_mov_b32 v113,0
v_mov_b32 v114,0
v_mov_b32 v115,0
CV v120,v120,v121
CV v121,v122,v123
CV v122,v152,v153
CV v123,v154,v155
buffer_store_dwordx4 v[120:123],v36,s[12:15],s94 offen offset:2048 sc1
v_mov_b32 v152,0
v_mov_b32 v153,0
v_mov_b32 v154,0
v_mov_b32 v155,0
v_mov_b32 v116,0
v_mov_b32 v117,0
v_mov_b32 v118,0
v_mov_b32 v119,0
CV v124,v124,v125
CV v125,v126,v127
CV v126,v156,v157
CV v127,v158,v159
buffer_store_dwordx4 v[124:127],v36,s[12:15],s94 offen offset:3072 sc1
s_add_u32 s94,s94,4096
v_mov_b32 v156,0
v_mov_b32 v157,0
v_mov_b32 v158,0
v_mov_b32 v159,0
v_mov_b32 v120,0
v_mov_b32 v121,0
v_mov_b32 v122,0
v_mov_b32 v123,0
CV v128,v128,v129
CV v129,v130,v131
CV v130,v160,v161
CV v131,v162,v163
buffer_store_dwordx4 v[128:131],v36,s[12:15],s94 offen sc1
v_mov_b32 v160,0
v_mov_b32 v161,0
v_mov_b32 v162,0
v_mov_b32 v163,0
v_mov_b32 v124,0
v_mov_b32 v125,0
v_mov_b32 v126,0
v_mov_b32 v127,0
CV v132,v132,v133
CV v133,v134,v135
CV v134,v164,v165
CV v135,v166,v167
buffer_store_dwordx4 v[132:135],v36,s[12:15],s94 offen offset:1024 sc1
v_mov_b32 v164,0
v_mov_b32 v165,0
v_mov_b32 v166,0
v_mov_b32 v167,0
v_mov_b32 v128,0
v_mov_b32 v129,0
v_mov_b32 v130,0
v_mov_b32 v131,0
CV v136,v136,v137
CV v137,v138,v139
CV v138,v168,v169
CV v139,v170,v171
buffer_store_dwordx4 v[136:139],v36,s[12:15],s94 offen offset:2048 sc1
v_mov_b32 v168,0
v_mov_b32 v169,0
v_mov_b32 v170,0
v_mov_b32 v171,0
v_mov_b32 v132,0
v_mov_b32 v133,0
v_mov_b32 v134,0
v_mov_b32 v135,0
CV v140,v140,v141
CV v141,v142,v143
CV v142,v172,v173
CV v143,v174,v175
buffer_store_dwordx4 v[140:143],v36,s[12:15],s94 offen offset:3072 sc1
s_add_u32 s94,s94,s95
v_mov_b32 v172,0
v_mov_b32 v173,0
v_mov_b32 v174,0
v_mov_b32 v175,0
v_mov_b32 v136,0
v_mov_b32 v137,0
v_mov_b32 v138,0
v_mov_b32_e64 v139,0
CV v176,v176,v177
CV v177,v178,v179
CV v178,v208,v209
CV v179,v210,v211
buffer_store_dwordx4 v[176:179],v36,s[12:15],s94 offen sc1
v_mov_b32 v208,0
v_mov_b32 v209,0
v_mov_b32 v210,0
v_mov_b32 v211,0
v_mov_b32 v140,0
v_mov_b32 v141,0
v_mov_b32 v142,0
v_mov_b32 v143,0
CV v180,v180,v181
CV v181,v182,v183
CV v182,v212,v213
CV v183,v214,v215
buffer_store_dwordx4 v[180:183],v36,s[12:15],s94 offen offset:1024 sc1
v_mov_b32 v212,0
v_mov_b32 v213,0
v_mov_b32 v214,0
v_mov_b32 v215,0
v_mov_b32 v176,0
v_mov_b32 v177,0
v_mov_b32 v178,0
v_mov_b32 v179,0
CV v184,v184,v185
CV v185,v186,v187
CV v186,v216,v217
CV v187,v218,v219
buffer_store_dwordx4 v[184:187],v36,s[12:15],s94 offen offset:2048 sc1
v_mov_b32 v216,0
v_mov_b32 v217,0
v_mov_b32 v218,0
v_mov_b32 v219,0
v_mov_b32 v180,0
v_mov_b32 v181,0
v_mov_b32 v182,0
v_mov_b32 v183,0
CV v188,v188,v189
CV v189,v190,v191
CV v190,v220,v221
CV v191,v222,v223
buffer_store_dwordx4 v[188:191],v36,s[12:15],s94 offen offset:3072 sc1
s_add_u32 s94,s94,4096
v_mov_b32 v220,0
v_mov_b32 v221,0
v_mov_b32 v222,0
v_mov_b32 v223,0
v_mov_b32 v184,0
v_mov_b32 v185,0
v_mov_b32 v186,0
v_mov_b32 v187,0
CV v192,v192,v193
CV v193,v194,v195
CV v194,v224,v225
CV v195,v226,v227
buffer_store_dwordx4 v[192:195],v36,s[12:15],s94 offen sc1
v_mov_b32 v224,0
v_mov_b32 v225,0
v_mov_b32 v226,0
v_mov_b32 v227,0
v_mov_b32 v188,0
v_mov_b32 v189,0
v_mov_b32 v190,0
v_mov_b32 v191,0
CV v196,v196,v197
CV v197,v198,v199
CV v198,v228,v229
CV v199,v230,v231
buffer_store_dwordx4 v[196:199],v36,s[12:15],s94 offen offset:1024 sc1
v_mov_b32 v228,0
v_mov_b32 v229,0
v_mov_b32 v230,0
v_mov_b32 v231,0
v_mov_b32 v192,0
v_mov_b32 v193,0
v_mov_b32 v194,0
v_mov_b32 v195,0
CV v200,v200,v201
CV v201,v202,v203
CV v202,v232,v233
CV v203,v234,v235
buffer_store_dwordx4 v[200:203],v36,s[12:15],s94 offen offset:2048 sc1
v_mov_b32 v232,0
v_mov_b32 v233,0
v_mov_b32 v234,0
v_mov_b32 v235,0
v_mov_b32 v196,0
v_mov_b32 v197,0
v_mov_b32 v198,0
v_mov_b32 v199,0
CV v204,v204,v205
CV v205,v206,v207
CV v206,v236,v237
CV v207,v238,v239
buffer_store_dwordx4 v[204:207],v36,s[12:15],s94 offen offset:3072 sc1
s_add_u32 s94,s94,s95
v_mov_b32 v236,0
v_mov_b32 v237,0
v_mov_b32 v238,0
v_mov_b32 v239,0
v_mov_b32 v200,0
v_mov_b32 v201,0
v_mov_b32 v202,0
v_mov_b32_e64 v203,0
CV v240,v240,v241
CV v241,v242,v243
AR v42,a16
AR v43,a17
AR v44,a18
AR v45,a19
CV v242,v42,v43
CV v243,v44,v45
buffer_store_dwordx4 v[240:243],v36,s[12:15],s94 offen sc1
AW a16,0
AW a17,0
AW a18,0
AW a19,0
v_mov_b32 v204,0
v_mov_b32 v205,0
v_mov_b32 v206,0
v_mov_b32 v207,0
CV v244,v244,v245
CV v245,v246,v247
AR v42,a20
AR v43,a21
AR v44,a22
AR v45,a23
CV v246,v42,v43
CV v247,v44,v45
buffer_store_dwordx4 v[244:247],v36,s[12:15],s94 offen offset:1024 sc1
AW a20,0
AW a21,0
AW a22,0
AW a23,0
v_mov_b32 v240,0
v_mov_b32 v241,0
v_mov_b32 v242,0
v_mov_b32 v243,0
CV v248,v248,v249
CV v249,v250,v251
AR v42,a24
AR v43,a25
AR v44,a26
AR v45,a27
CV v250,v42,v43
CV v251,v44,v45
buffer_store_dwordx4 v[248:251],v36,s[12:15],s94 offen offset:2048 sc1
AW a24,0
AW a25,0
AW a26,0
AW a27,0
v_mov_b32 v244,0
v_mov_b32 v245,0
v_mov_b32 v246,0
v_mov_b32 v247,0
CV v252,v252,v253
CV v253,v254,v255
AR v42,a28
AR v43,a29
AR v44,a30
AR v45,a31
CV v254,v42,v43
CV v255,v44,v45
buffer_store_dwordx4 v[252:255],v36,s[12:15],s94 offen offset:3072 sc1
s_add_u32 s94,s94,4096
AW a28,0
AW a29,0
AW a30,0
AW a31,0
v_mov_b32 v248,0
v_mov_b32 v249,0
v_mov_b32 v250,0
v_mov_b32 v251,0
AR v42,a0
AR v43,a1
AR v44,a2
AR v45,a3
CV v30,v42,v43
CV v31,v44,v45
AR v42,a32
AR v43,a33
AR v44,a34
AR v45,a35
CV v32,v42,v43
CV v33,v44,v45
buffer_store_dwordx4 v[30:33],v36,s[12:15],s94 offen sc1
AW a32,0
AW a33,0
AW a34,0
AW a35,0
v_mov_b32 v252,0
v_mov_b32 v253,0
v_mov_b32 v254,0
v_mov_b32 v255,0
AR v42,a4
AR v43,a5
AR v44,a6
AR v45,a7
CV v30,v42,v43
CV v31,v44,v45
AR v42,a36
AR v43,a37
AR v44,a38
AR v45,a39
CV v32,v42,v43
CV v33,v44,v45
buffer_store_dwordx4 v[30:33],v36,s[12:15],s94 offen offset:1024 sc1
AW a36,0
AW a37,0
AW a38,0
AW a39,0
AW a0,0
AW a1,0
AW a2,0
AW a3,0
AR v42,a8
AR v43,a9
AR v44,a10
AR v45,a11
CV v30,v42,v43
CV v31,v44,v45
AR v42,a40
AR v43,a41
AR v44,a42
AR v45,a43
CV v32,v42,v43
CV v33,v44,v45
buffer_store_dwordx4 v[30:33],v36,s[12:15],s94 offen offset:2048 sc1
AW a40,0
AW a41,0
AW a42,0
AW a43,0
AW a4,0
AW a5,0
AW a6,0
AW a7,0
AR v42,a12
AR v43,a13
AR v44,a14
AR v45,a15
CV v30,v42,v43
CV v31,v44,v45
AR v42,a44
AR v43,a45
AR v44,a46
AR v45,a47
CV v32,v42,v43
CV v33,v44,v45
buffer_store_dwordx4 v[30:33],v36,s[12:15],s94 offen offset:3072 sc1
s_add_u32 s94,s94,s95
s_nop 0
AW a44,0
AW a45,0
AW a46,0
AW a47,0
AW a8,0
AW a9,0
AW a10,0
AW a11,0
AW a12,0
AW a13,0
AW a14,0
AW a15,0
s_branch K1_LOOP1_V
K1_FS0V:
s_waitcnt lgkmcnt(0)
M v[48:51],a[48:51],a[64:67],0
ds_read_b128 a[56:59],v2 offset:2048
M v[48:51],a[52:55],a[68:71],v[48:51]
ds_read_b128 a[60:63],v3 offset:2048
M v[52:55],a[52:55],a[76:79],0
ds_read_b64_tr_b16 a[128:129],v6 offset:0
M v[52:55],a[48:51],a[72:75],v[52:55]
buffer_load_dwordx4 v24,s[4:7],s23 offen offset:2048 sc1 lds
M v[56:59],a[48:51],a[80:83],0
ds_read_b64_tr_b16 a[130:131],v6 offset:2048
M v[56:59],a[52:55],a[84:87],v[56:59]
M v[60:63],a[52:55],a[92:95],0
ds_read_b64_tr_b16 a[136:137],v7 offset:0
M v[60:63],a[48:51],a[88:91],v[60:63]
M v[64:67],a[48:51],a[96:99],0
ds_read_b64_tr_b16 a[138:139],v7 offset:2048
M v[64:67],a[52:55],a[100:103],v[64:67]
M v[68:71],a[52:55],a[108:111],0
ds_read_b64_tr_b16 a[144:145],v8 offset:0
M v[68:71],a[48:51],a[104:107],v[68:71]
buffer_load_dwordx4 v25,s[4:7],s23 offen offset:3072 sc1 lds
M v[72:75],a[48:51],a[112:115],0
ds_read_b64_tr_b16 a[146:147],v8 offset:2048
M v[72:75],a[52:55],a[116:119],v[72:75]
s_add_u32 s23,s23,128
M v[76:79],a[52:55],a[124:127],0
M v[76:79],a[48:51],a[120:123],v[76:79]
s_waitcnt lgkmcnt(6)
M v[80:83],a[56:59],a[64:67],0
ds_read_b128 a[48:51],v2 offset:4096
M v[80:83],a[60:63],a[68:71],v[80:83]
ds_read_b128 a[52:55],v3 offset:4096
s_add_u32 m0,s21,114688
M v[84:87],a[60:63],a[76:79],0
ds_read_b64_tr_b16 a[152:153],v9 offset:0
M v[84:87],a[56:59],a[72:75],v[84:87]
buffer_load_dwordx4 v26,s[8:11],s24 offen sc1 lds
M v[88:91],a[56:59],a[80:83],0
ds_read_b64_tr_b16 a[154:155],v9 offset:2048
M v[88:91],a[60:63],a[84:87],v[88:91]
M v[92:95],a[60:63],a[92:95],0
ds_read_b64_tr_b16 a[160:161],v10 offset:0
M v[92:95],a[56:59],a[88:91],v[92:95]
M v[96:99],a[56:59],a[96:99],0
ds_read_b64_tr_b16 a[162:163],v10 offset:2048
M v[96:99],a[60:63],a[100:103],v[96:99]
M v[100:103],a[60:63],a[108:111],0
ds_read_b64_tr_b16 a[168:169],v11 offset:0
M v[100:103],a[56:59],a[104:107],v[100:103]
buffer_load_dwordx4 v27,s[8:11],s24 offen offset:1024 sc1 lds
M v[104:107],a[56:59],a[112:115],0
ds_read_b64_tr_b16 a[170:171],v11 offset:2048
M v[104:107],a[60:63],a[116:119],v[104:107]
M v[108:111],a[60:63],a[124:127],0
M v[108:111],a[56:59],a[120:123],v[108:111]
s_waitcnt lgkmcnt(6)
M v[112:115],a[48:51],a[64:67],0
ds_read_b128 a[56:59],v2 offset:6144
M v[112:115],a[52:55],a[68:71],v[112:115]
ds_read_b128 a[60:63],v3 offset:6144
M v[116:119],a[52:55],a[76:79],0
ds_read_b64_tr_b16 a[176:177],v12 offset:0
M v[116:119],a[48:51],a[72:75],v[116:119]
buffer_load_dwordx4 v28,s[8:11],s24 offen offset:2048 sc1 lds
M v[120:123],a[48:51],a[80:83],0
ds_read_b64_tr_b16 a[178:179],v12 offset:2048
M v[120:123],a[52:55],a[84:87],v[120:123]
M v[124:127],a[52:55],a[92:95],0
ds_read_b64_tr_b16 a[184:185],v13 offset:0
M v[124:127],a[48:51],a[88:91],v[124:127]
M v[128:131],a[48:51],a[96:99],0
ds_read_b64_tr_b16 a[186:187],v13 offset:2048
M v[128:131],a[52:55],a[100:103],v[128:131]
M v[132:135],a[52:55],a[108:111],0
M v[132:135],a[48:51],a[104:107],v[132:135]
buffer_load_dwordx4 v29,s[8:11],s24 offen offset:3072 sc1 lds
M v[136:139],a[48:51],a[112:115],0
s_add_u32 s24,s24,s25
M v[136:139],a[52:55],a[116:119],v[136:139]
M v[140:143],a[52:55],a[124:127],0
M v[140:143],a[48:51],a[120:123],v[140:143]
s_waitcnt vmcnt(17) lgkmcnt(0)
s_barrier
M v[144:147],a[56:59],a[64:67],0
ds_read_b128 a[48:51],v2 offset:32768
M v[144:147],a[60:63],a[68:71],v[144:147]
ds_read_b128 a[52:55],v3 offset:32768
s_add_u32 m0,s21,0
M v[148:151],a[60:63],a[76:79],0
ds_read_b64_tr_b16 a[132:133],v6 offset:32768
M v[148:151],a[56:59],a[72:75],v[148:151]
buffer_load_dwordx4 v22,s[4:7],s22 offen sc1 lds
M v[152:155],a[56:59],a[80:83],0
ds_read_b64_tr_b16 a[134:135],v6 offset:34816
M v[152:155],a[60:63],a[84:87],v[152:155]
M v[156:159],a[60:63],a[92:95],0
ds_read_b64_tr_b16 a[140:141],v7 offset:32768
M v[156:159],a[56:59],a[88:91],v[156:159]
M v[160:163],a[56:59],a[96:99],0
ds_read_b64_tr_b16 a[142:143],v7 offset:34816
M v[160:163],a[60:63],a[100:103],v[160:163]
M v[164:167],a[60:63],a[108:111],0
ds_read_b64_tr_b16 a[148:149],v8 offset:32768
M v[164:167],a[56:59],a[104:107],v[164:167]
buffer_load_dwordx4 v23,s[4:7],s22 offen offset:1024 sc1 lds
M v[168:171],a[56:59],a[112:115],0
M v[168:171],a[60:63],a[116:119],v[168:171]
M v[172:175],a[60:63],a[124:127],0
M v[172:175],a[56:59],a[120:123],v[172:175]
s_waitcnt lgkmcnt(5)
M v[176:179],a[48:51],a[64:67],0
ds_read_b128 a[56:59],v2 offset:34816
M v[176:179],a[52:55],a[68:71],v[176:179]
ds_read_b128 a[60:63],v3 offset:34816
M v[180:183],a[52:55],a[76:79],0
ds_read_b64_tr_b16 a[150:151],v8 offset:34816
M v[180:183],a[48:51],a[72:75],v[180:183]
buffer_load_dwordx4 v24,s[4:7],s22 offen offset:2048 sc1 lds
M v[184:187],a[48:51],a[80:83],0
ds_read_b64_tr_b16 a[156:157],v9 offset:32768
M v[184:187],a[52:55],a[84:87],v[184:187]
M v[188:191],a[52:55],a[92:95],0
ds_read_b64_tr_b16 a[158:159],v9 offset:34816
M v[188:191],a[48:51],a[88:91],v[188:191]
M v[192:195],a[48:51],a[96:99],0
ds_read_b64_tr_b16 a[164:165],v10 offset:32768
M v[192:195],a[52:55],a[100:103],v[192:195]
M v[196:199],a[52:55],a[108:111],0
ds_read_b64_tr_b16 a[166:167],v10 offset:34816
M v[196:199],a[48:51],a[104:107],v[196:199]
buffer_load_dwordx4 v25,s[4:7],s22 offen offset:3072 sc1 lds
M v[200:203],a[48:51],a[112:115],0
s_add_u32 s22,s22,128
M v[200:203],a[52:55],a[116:119],v[200:203]
M v[204:207],a[52:55],a[124:127],0
M v[204:207],a[48:51],a[120:123],v[204:207]
s_waitcnt lgkmcnt(5)
M v[208:211],a[56:59],a[64:67],0
ds_read_b128 a[48:51],v2 offset:36864
M v[208:211],a[60:63],a[68:71],v[208:211]
ds_read_b128 a[52:55],v3 offset:36864
s_add_u32 m0,s21,16384
M v[212:215],a[60:63],a[76:79],0
ds_read_b64_tr_b16 a[172:173],v11 offset:32768
M v[212:215],a[56:59],a[72:75],v[212:215]
buffer_load_dwordx4 v26,s[8:11],s24 offen sc1 lds
M v[216:219],a[56:59],a[80:83],0
ds_read_b64_tr_b16 a[174:175],v11 offset:34816
M v[216:219],a[60:63],a[84:87],v[216:219]
M v[220:223],a[60:63],a[92:95],0
ds_read_b64_tr_b16 a[180:181],v12 offset:32768
M v[220:223],a[56:59],a[88:91],v[220:223]
M v[224:227],a[56:59],a[96:99],0
ds_read_b64_tr_b16 a[182:183],v12 offset:34816
M v[224:227],a[60:63],a[100:103],v[224:227]
M v[228:231],a[60:63],a[108:111],0
M v[228:231],a[56:59],a[104:107],v[228:231]
buffer_load_dwordx4 v27,s[8:11],s24 offen offset:1024 sc1 lds
M v[232:235],a[56:59],a[112:115],0
M v[232:235],a[60:63],a[116:119],v[232:235]
s_cmp_lg_u32 s29,0
M v[236:239],a[60:63],a[124:127],0
buffer_load_dword v1,v37,s[64:67],0 offen
s_cbranch_scc1 HSUB_PF_F0V0
HSUB_PF_F0V0_R:
M v[236:239],a[56:59],a[120:123],v[236:239]
s_waitcnt lgkmcnt(4)
M v[240:243],a[48:51],a[64:67],0
ds_read_b128 a[56:59],v2 offset:38912
M v[240:243],a[52:55],a[68:71],v[240:243]
ds_read_b128 a[60:63],v3 offset:38912
M v[244:247],a[52:55],a[76:79],0
ds_read_b64_tr_b16 a[188:189],v13 offset:32768
M v[244:247],a[48:51],a[72:75],v[244:247]
buffer_load_dwordx4 v28,s[8:11],s24 offen offset:2048 sc1 lds
M v[248:251],a[48:51],a[80:83],0
ds_read_b64_tr_b16 a[190:191],v13 offset:34816
M v[248:251],a[52:55],a[84:87],v[248:251]
M v[252:255],a[52:55],a[92:95],0
M v[252:255],a[48:51],a[88:91],v[252:255]
M a[0:3],a[48:51],a[96:99],0
M a[0:3],a[52:55],a[100:103],a[0:3]
M a[4:7],a[52:55],a[108:111],0
M a[4:7],a[48:51],a[104:107],a[4:7]
buffer_load_dwordx4 v29,s[8:11],s24 offen offset:3072 sc1 lds
M a[8:11],a[48:51],a[112:115],0
s_add_u32 s24,s24,s25
M a[8:11],a[52:55],a[116:119],a[8:11]
M a[12:15],a[52:55],a[124:127],0
M a[12:15],a[48:51],a[120:123],a[12:15]
s_waitcnt vmcnt(17) lgkmcnt(0)
s_barrier
M a[16:19],a[56:59],a[64:67],0
ds_read_b128 a[48:51],v4 offset:0
M a[16:19],a[60:63],a[68:71],a[16:19]
ds_read_b128 a[52:55],v5 offset:0
M a[20:23],a[60:63],a[76:79],0
s_add_u32 m0,s21,32768
M a[20:23],a[56:59],a[72:75],a[20:23]
buffer_load_dwordx4 v22,s[4:7],s23 offen sc1 lds
M a[24:27],a[56:59],a[80:83],0
M a[24:27],a[60:63],a[84:87],a[24:27]
M a[28:31],a[60:63],a[92:95],0
M a[28:31],a[56:59],a[88:91],a[28:31]
M a[32:35],a[56:59],a[96:99],0
M a[32:35],a[60:63],a[100:103],a[32:35]
M a[36:39],a[60:63],a[108:111],0
M a[36:39],a[56:59],a[104:107],a[36:39]
buffer_load_dwordx4 v23,s[4:7],s23 offen offset:1024 sc1 lds
M a[40:43],a[56:59],a[112:115],0
M a[40:43],a[60:63],a[116:119],a[40:43]
s_sub_u32 s26,s26,1
M a[44:47],a[60:63],a[124:127],0
s_cmp_eq_u32 s26,s43
M a[44:47],a[56:59],a[120:123],a[44:47]
s_branch K1_LOOP1_V
K1_FS_QV:
s_mov_b32 s94,s54
s_mov_b32 s95,s55
s_mov_b32 s92,s54
s_mov_b32 s19,s53
s_mov_b32 s53,4
s_mov_b32 s54,s56
s_mov_b32 s55,s57
s_mov_b32 s26,s17
s_mov_b32 s43,3
s_cmp_eq_u32 s20,0
s_cselect_b32 s78,12,99
v_mul_f32 v48,s93,v48
v_mul_f32 v49,s93,v49
v_mul_f32 v50,s93,v50
v_mul_f32_e64 v51,s93,v51
CV v48,v48,v49
CV v49,v50,v51
v_mul_f32 v52,s93,v52
v_mul_f32 v53,s93,v53
v_mul_f32 v54,s93,v54
v_mul_f32 v55,s93,v55
CV v50,v52,v53
CV v51,v54,v55
buffer_store_dwordx4 v[48:51],v36,s[12:15],s94 offen sc1
s_nop 0
s_waitcnt lgkmcnt(0)
M v[48:51],a[48:51],a[128:131],0
ds_read_b128 a[56:59],v4 offset:2048
v_mul_f32 v56,s93,v56
v_mul_f32 v57,s93,v57
v_mul_f32 v58,s93,v58
v_mul_f32 v59,s93,v59
CV v56,v56,v57
M v[48:51],a[52:55],a[132:135],v[48:51]
ds_read_b128 a[60:63],v5 offset:2048
CV v57,v58,v59
v_mul_f32 v60,s93,v60
v_mul_f32 v61,s93,v61
v_mul_f32 v62,s93,v62
M v[52:55],a[52:55],a[140:143],0
ds_read_b64_tr_b16 a[64:65],v14 offset:0
v_mul_f32 v63,s93,v63
CV v58,v60,v61
CV v59,v62,v63
AW a192,v56
AW a193,v57
M v[52:55],a[48:51],a[136:139],v[52:55]
buffer_load_dwordx4 v24,s[4:7],s23 offen offset:2048 sc1 lds
AW a194,v58
AW a195,v59
M v[56:59],a[48:51],a[144:147],0
ds_read_b64_tr_b16 a[66:67],v14 offset:2048
v_mul_f32 v64,s93,v64
v_mul_f32 v65,s93,v65
v_mul_f32 v66,s93,v66
v_mul_f32 v67,s93,v67
M v[56:59],a[52:55],a[148:151],v[56:59]
CV v64,v64,v65
CV v65,v66,v67
v_mul_f32 v68,s93,v68
v_mul_f32 v69,s93,v69
M v[60:63],a[52:55],a[156:159],0
ds_read_b64_tr_b16 a[72:73],v15 offset:0
v_mul_f32 v70,s93,v70
v_mul_f32 v71,s93,v71
CV v66,v68,v69
CV v67,v70,v71
M v[60:63],a[48:51],a[152:155],v[60:63]
buffer_store_dwordx4 v[64:67],v36,s[12:15],s94 offen offset:2048 sc1
s_nop 0
M v[64:67],a[48:51],a[160:163],0
ds_read_b64_tr_b16 a[74:75],v15 offset:2048
v_mul_f32 v72,s93,v72
v_mul_f32 v73,s93,v73
v_mul_f32 v74,s93,v74
v_mul_f32 v75,s93,v75
CV v72,v72,v73
M v[64:67],a[52:55],a[164:167],v[64:67]
CV v73,v74,v75
v_mul_f32 v76,s93,v76
v_mul_f32 v77,s93,v77
v_mul_f32 v78,s93,v78
v_mul_f32 v79,s93,v79
M v[68:71],a[52:55],a[172:175],0
ds_read_b64_tr_b16 a[80:81],v16 offset:0
CV v74,v76,v77
CV v75,v78,v79
AW a196,v72
AW a197,v73
AW a198,v74
M v[68:71],a[48:51],a[168:171],v[68:71]
buffer_load_dwordx4 v25,s[4:7],s23 offen offset:3072 sc1 lds
AW a199,v75
s_add_u32 s94,s94,s95
M v[72:75],a[48:51],a[176:179],0
ds_read_b64_tr_b16 a[82:83],v16 offset:2048
v_mul_f32 v80,s93,v80
v_mul_f32 v81,s93,v81
v_mul_f32 v82,s93,v82
v_mul_f32 v83,s93,v83
M v[72:75],a[52:55],a[180:183],v[72:75]
s_add_u32 s23,s23,128
CV v80,v80,v81
CV v81,v82,v83
v_mul_f32 v84,s93,v84
v_mul_f32 v85,s93,v85
M v[76:79],a[52:55],a[188:191],0
v_mul_f32 v86,s93,v86
v_mul_f32 v87,s93,v87
CV v82,v84,v85
CV v83,v86,v87
M v[76:79],a[48:51],a[184:187],v[76:79]
buffer_store_dwordx4 v[80:83],v36,s[12:15],s94 offen sc1
s_nop 0
s_waitcnt lgkmcnt(6)
M v[80:83],a[56:59],a[128:131],0
ds_read_b128 a[48:51],v4 offset:4096
v_mul_f32 v88,s93,v88
v_mul_f32 v89,s93,v89
v_mul_f32 v90,s93,v90
v_mul_f32 v91,s93,v91
CV v88,v88,v89
M v[80:83],a[60:63],a[132:135],v[80:83]
ds_read_b128 a[52:55],v5 offset:4096
s_add_u32 m0,s21,49152
CV v89,v90,v91
v_mul_f32 v92,s93,v92
v_mul_f32 v93,s93,v93
v_mul_f32 v94,s93,v94
M v[84:87],a[60:63],a[140:143],0
ds_read_b64_tr_b16 a[88:89],v17 offset:0
v_mul_f32 v95,s93,v95
CV v90,v92,v93
CV v91,v94,v95
AW a200,v88
M v[84:87],a[56:59],a[136:139],v[84:87]
buffer_load_dwordx4 v26,s[8:11],s24 offen sc1 lds
AW a201,v89
AW a202,v90
AW a203,v91
M v[88:91],a[56:59],a[144:147],0
ds_read_b64_tr_b16 a[90:91],v17 offset:2048
v_mul_f32 v96,s93,v96
v_mul_f32 v97,s93,v97
v_mul_f32 v98,s93,v98
v_mul_f32 v99,s93,v99
M v[88:91],a[60:63],a[148:151],v[88:91]
CV v96,v96,v97
CV v97,v98,v99
v_mul_f32 v100,s93,v100
v_mul_f32 v101,s93,v101
M v[92:95],a[60:63],a[156:159],0
ds_read_b64_tr_b16 a[96:97],v18 offset:0
v_mul_f32 v102,s93,v102
v_mul_f32 v103,s93,v103
CV v98,v100,v101
CV v99,v102,v103
M v[92:95],a[56:59],a[152:155],v[92:95]
buffer_store_dwordx4 v[96:99],v36,s[12:15],s94 offen offset:2048 sc1
s_nop 0
M v[96:99],a[56:59],a[160:163],0
ds_read_b64_tr_b16 a[98:99],v18 offset:2048
v_mul_f32 v104,s93,v104
v_mul_f32 v105,s93,v105
v_mul_f32 v106,s93,v106
v_mul_f32 v107,s93,v107
CV v104,v104,v105
M v[96:99],a[60:63],a[164:167],v[96:99]
CV v105,v106,v107
v_mul_f32 v108,s93,v108
v_mul_f32 v109,s93,v109
v_mul_f32 v110,s93,v110
v_mul_f32 v111,s93,v111
M v[100:103],a[60:63],a[172:175],0
ds_read_b64_tr_b16 a[104:105],v19 offset:0
CV v106,v108,v109
CV v107,v110,v111
AW a204,v104
AW a205,v105
AW a206,v106
M v[100:103],a[56:59],a[168:171],v[100:103]
buffer_load_dwordx4 v27,s[8:11],s24 offen offset:1024 sc1 lds
AW a207,v107
s_add_u32 s94,s94,s95
M v[104:107],a[56:59],a[176:179],0
ds_read_b64_tr_b16 a[106:107],v19 offset:2048
v_mul_f32 v112,s93,v112
v_mul_f32 v113,s93,v113
v_mul_f32 v114,s93,v114
v_mul_f32 v115,s93,v115
M v[104:107],a[60:63],a[180:183],v[104:107]
CV v112,v112,v113
CV v113,v114,v115
v_mul_f32 v116,s93,v116
v_mul_f32 v117,s93,v117
M v[108:111],a[60:63],a[188:191],0
v_mul_f32 v118,s93,v118
v_mul_f32 v119,s93,v119
CV v114,v116,v117
CV v115,v118,v119
M v[108:111],a[56:59],a[184:187],v[108:111]
buffer_store_dwordx4 v[112:115],v36,s[12:15],s94 offen sc1
s_nop 0
s_waitcnt lgkmcnt(6)
M v[112:115],a[48:51],a[128:131],0
ds_read_b128 a[56:59],v4 offset:6144
v_mul_f32 v120,s93,v120
v_mul_f32 v121,s93,v121
v_mul_f32 v122,s93,v122
v_mul_f32 v123,s93,v123
CV v120,v120,v121
M v[112:115],a[52:55],a[132:135],v[112:115]
ds_read_b128 a[60:63],v5 offset:6144
CV v121,v122,v123
v_mul_f32 v124,s93,v124
v_mul_f32 v125,s93,v125
v_mul_f32 v126,s93,v126
M v[116:119],a[52:55],a[140:143],0
ds_read_b64_tr_b16 a[112:113],v20 offset:0
v_mul_f32 v127,s93,v127
CV v122,v124,v125
CV v123,v126,v127
AW a208,v120
AW a209,v121
M v[116:119],a[48:51],a[136:139],v[116:119]
buffer_load_dwordx4 v28,s[8:11],s24 offen offset:2048 sc1 lds
AW a210,v122
AW a211,v123
M v[120:123],a[48:51],a[144:147],0
ds_read_b64_tr_b16 a[114:115],v20 offset:2048
v_mul_f32 v128,s93,v128
v_mul_f32 v129,s93,v129
v_mul_f32 v130,s93,v130
v_mul_f32 v131,s93,v131
M v[120:123],a[52:55],a[148:151],v[120:123]
CV v128,v128,v129
CV v129,v130,v131
v_mul_f32 v132,s93,v132
v_mul_f32 v133,s93,v133
M v[124:127],a[52:55],a[156:159],0
ds_read_b64_tr_b16 a[120:121],v21 offset:0
v_mul_f32 v134,s93,v134
v_mul_f32 v135,s93,v135
CV v130,v132,v133
CV v131,v134,v135
M v[124:127],a[48:51],a[152:155],v[124:127]
buffer_store_dwordx4 v[128:131],v36,s[12:15],s94 offen offset:2048 sc1
s_nop 0
M v[128:131],a[48:51],a[160:163],0
ds_read_b64_tr_b16 a[122:123],v21 offset:2048
v_mul_f32 v136,s93,v136
v_mul_f32 v137,s93,v137
v_mul_f32 v138,s93,v138
v_mul_f32 v139,s93,v139
M v[128:131],a[52:55],a[164:167],v[128:131]
CV v136,v136,v137
CV v137,v138,v139
v_mul_f32 v140,s93,v140
v_mul_f32 v141,s93,v141
v_mul_f32 v142,s93,v142
v_mul_f32 v143,s93,v143
M v[132:135],a[52:55],a[172:175],0
CV v138,v140,v141
CV v139,v142,v143
AW a212,v136
AW a213,v137
AW a214,v138
M v[132:135],a[48:51],a[168:171],v[132:135]
buffer_load_dwordx4 v29,s[8:11],s24 offen offset:3072 sc1 lds
AW a215,v139
s_add_u32 s94,s94,s95
M v[136:139],a[48:51],a[176:179],0
s_add_u32 s24,s24,s25
v_mul_f32 v144,s93,v144
v_mul_f32 v145,s93,v145
v_mul_f32 v146,s93,v146
v_mul_f32 v147,s93,v147
M v[136:139],a[52:55],a[180:183],v[136:139]
CV v144,v144,v145
CV v145,v146,v147
v_mul_f32 v148,s93,v148
v_mul_f32 v149,s93,v149
M v[140:143],a[52:55],a[188:191],0
v_mul_f32 v150,s93,v150
v_mul_f32 v151,s93,v151
CV v146,v148,v149
CV v147,v150,v151
M v[140:143],a[48:51],a[184:187],v[140:143]
buffer_store_dwordx4 v[144:147],v36,s[12:15],s94 offen sc1
s_nop 0
s_waitcnt vmcnt(24) lgkmcnt(0)
s_barrier
M v[144:147],a[56:59],a[128:131],0
ds_read_b128 a[48:51],v4 offset:32768
v_mul_f32 v152,s93,v152
v_mul_f32 v153,s93,v153
v_mul_f32 v154,s93,v154
v_mul_f32 v155,s93,v155
CV v152,v152,v153
M v[144:147],a[60:63],a[132:135],v[144:147]
ds_read_b128 a[52:55],v5 offset:32768
s_add_u32 m0,s21,65536
CV v153,v154,v155
v_mul_f32 v156,s93,v156
v_mul_f32 v157,s93,v157
v_mul_f32 v158,s93,v158
M v[148:151],a[60:63],a[140:143],0
ds_read_b64_tr_b16 a[68:69],v14 offset:32768
v_mul_f32 v159,s93,v159
CV v154,v156,v157
CV v155,v158,v159
AW a216,v152
M v[148:151],a[56:59],a[136:139],v[148:151]
buffer_load_dwordx4 v22,s[4:7],s22 offen sc1 lds
AW a217,v153
AW a218,v154
AW a219,v155
M v[152:155],a[56:59],a[144:147],0
ds_read_b64_tr_b16 a[70:71],v14 offset:34816
v_mul_f32 v160,s93,v160
v_mul_f32 v161,s93,v161
v_mul_f32 v162,s93,v162
v_mul_f32 v163,s93,v163
M v[152:155],a[60:63],a[148:151],v[152:155]
CV v160,v160,v161
CV v161,v162,v163
v_mul_f32 v164,s93,v164
v_mul_f32 v165,s93,v165
M v[156:159],a[60:63],a[156:159],0
ds_read_b64_tr_b16 a[76:77],v15 offset:32768
v_mul_f32 v166,s93,v166
v_mul_f32 v167,s93,v167
CV v162,v164,v165
CV v163,v166,v167
M v[156:159],a[56:59],a[152:155],v[156:159]
buffer_store_dwordx4 v[160:163],v36,s[12:15],s94 offen offset:2048 sc1
s_nop 0
M v[160:163],a[56:59],a[160:163],0
ds_read_b64_tr_b16 a[78:79],v15 offset:34816
v_mul_f32 v168,s93,v168
v_mul_f32 v169,s93,v169
v_mul_f32 v170,s93,v170
v_mul_f32 v171,s93,v171
CV v168,v168,v169
M v[160:163],a[60:63],a[164:167],v[160:163]
CV v169,v170,v171
v_mul_f32 v172,s93,v172
v_mul_f32 v173,s93,v173
v_mul_f32 v174,s93,v174
v_mul_f32 v175,s93,v175
M v[164:167],a[60:63],a[172:175],0
ds_read_b64_tr_b16 a[84:85],v16 offset:32768
CV v170,v172,v173
CV v171,v174,v175
AW a220,v168
AW a221,v169
AW a222,v170
M v[164:167],a[56:59],a[168:171],v[164:167]
buffer_load_dwordx4 v23,s[4:7],s22 offen offset:1024 sc1 lds
AW a223,v171
s_add_u32 s94,s94,s95
M v[168:171],a[56:59],a[176:179],0
v_mul_f32 v176,s93,v176
v_mul_f32 v177,s93,v177
v_mul_f32 v178,s93,v178
v_mul_f32 v179,s93,v179
M v[168:171],a[60:63],a[180:183],v[168:171]
CV v176,v176,v177
CV v177,v178,v179
v_mul_f32 v180,s93,v180
v_mul_f32 v181,s93,v181
v_mul_f32 v182,s93,v182
M v[172:175],a[60:63],a[188:191],0
v_mul_f32 v183,s93,v183
CV v178,v180,v181
CV v179,v182,v183
M v[172:175],a[56:59],a[184:187],v[172:175]
buffer_store_dwordx4 v[176:179],v36,s[12:15],s94 offen sc1
s_nop 0
s_waitcnt lgkmcnt(5)
M v[176:179],a[48:51],a[128:131],0
ds_read_b128 a[56:59],v4 offset:34816
v_mul_f32 v184,s93,v184
v_mul_f32 v185,s93,v185
v_mul_f32 v186,s93,v186
v_mul_f32 v187,s93,v187
CV v184,v184,v185
M v[176:179],a[52:55],a[132:135],v[176:179]
ds_read_b128 a[60:63],v5 offset:34816
CV v185,v186,v187
v_mul_f32 v188,s93,v188
v_mul_f32 v189,s93,v189
v_mul_f32 v190,s93,v190
M v[180:183],a[52:55],a[140:143],0
ds_read_b64_tr_b16 a[86:87],v16 offset:34816
v_mul_f32 v191,s93,v191
CV v186,v188,v189
CV v187,v190,v191
AW a224,v184
AW a225,v185
M v[180:183],a[48:51],a[136:139],v[180:183]
buffer_load_dwordx4 v24,s[4:7],s22 offen offset:2048 sc1 lds
AW a226,v186
AW a227,v187
M v[184:187],a[48:51],a[144:147],0
ds_read_b64_tr_b16 a[92:93],v17 offset:32768
v_mul_f32 v192,s93,v192
v_mul_f32 v193,s93,v193
v_mul_f32 v194,s93,v194
v_mul_f32 v195,s93,v195
M v[184:187],a[52:55],a[148:151],v[184:187]
CV v192,v192,v193
CV v193,v194,v195
v_mul_f32 v196,s93,v196
v_mul_f32 v197,s93,v197
M v[188:191],a[52:55],a[156:159],0
ds_read_b64_tr_b16 a[94:95],v17 offset:34816
v_mul_f32 v198,s93,v198
v_mul_f32 v199,s93,v199
CV v194,v196,v197
CV v195,v198,v199
M v[188:191],a[48:51],a[152:155],v[188:191]
buffer_store_dwordx4 v[192:195],v36,s[12:15],s94 offen offset:2048 sc1
s_nop 0
M v[192:195],a[48:51],a[160:163],0
ds_read_b64_tr_b16 a[100:101],v18 offset:32768
v_mul_f32 v200,s93,v200
v_mul_f32 v201,s93,v201
v_mul_f32 v202,s93,v202
v_mul_f32 v203,s93,v203
CV v200,v200,v201
M v[192:195],a[52:55],a[164:167],v[192:195]
CV v201,v202,v203
v_mul_f32 v204,s93,v204
v_mul_f32 v205,s93,v205
v_mul_f32 v206,s93,v206
v_mul_f32 v207,s93,v207
M v[196:199],a[52:55],a[172:175],0
ds_read_b64_tr_b16 a[102:103],v18 offset:34816
CV v202,v204,v205
CV v203,v206,v207
AW a228,v200
AW a229,v201
AW a230,v202
M v[196:199],a[48:51],a[168:171],v[196:199]
buffer_load_dwordx4 v25,s[4:7],s22 offen offset:3072 sc1 lds
AW a231,v203
s_add_u32 s94,s94,s95
M v[200:203],a[48:51],a[176:179],0
s_add_u32 s22,s22,128
v_mul_f32 v208,s93,v208
v_mul_f32 v209,s93,v209
v_mul_f32 v210,s93,v210
v_mul_f32 v211,s93,v211
M v[200:203],a[52:55],a[180:183],v[200:203]
CV v208,v208,v209
CV v209,v210,v211
v_mul_f32 v212,s93,v212
v_mul_f32 v213,s93,v213
M v[204:207],a[52:55],a[188:191],0
v_mul_f32 v214,s93,v214
v_mul_f32 v215,s93,v215
CV v210,v212,v213
CV v211,v214,v215
M v[204:207],a[48:51],a[184:187],v[204:207]
buffer_store_dwordx4 v[208:211],v36,s[12:15],s94 offen sc1
s_nop 0
s_waitcnt lgkmcnt(5)
M v[208:211],a[56:59],a[128:131],0
ds_read_b128 a[48:51],v4 offset:36864
v_mul_f32 v216,s93,v216
v_mul_f32 v217,s93,v217
v_mul_f32 v218,s93,v218
v_mul_f32 v219,s93,v219
CV v216,v216,v217
M v[208:211],a[60:63],a[132:135],v[208:211]
ds_read_b128 a[52:55],v5 offset:36864
s_add_u32 m0,s21,81920
CV v217,v218,v219
v_mul_f32 v220,s93,v220
v_mul_f32 v221,s93,v221
v_mul_f32 v222,s93,v222
M v[212:215],a[60:63],a[140:143],0
ds_read_b64_tr_b16 a[108:109],v19 offset:32768
v_mul_f32 v223,s93,v223
CV v218,v220,v221
CV v219,v222,v223
AW a232,v216
M v[212:215],a[56:59],a[136:139],v[212:215]
buffer_load_dwordx4 v26,s[8:11],s24 offen sc1 lds
AW a233,v217
AW a234,v218
AW a235,v219
M v[216:219],a[56:59],a[144:147],0
ds_read_b64_tr_b16 a[110:111],v19 offset:34816
v_mul_f32 v224,s93,v224
v_mul_f32 v225,s93,v225
v_mul_f32 v226,s93,v226
v_mul_f32 v227,s93,v227
M v[216:219],a[60:63],a[148:151],v[216:219]
CV v224,v224,v225
CV v225,v226,v227
v_mul_f32 v228,s93,v228
v_mul_f32 v229,s93,v229
M v[220:223],a[60:63],a[156:159],0
ds_read_b64_tr_b16 a[116:117],v20 offset:32768
v_mul_f32 v230,s93,v230
v_mul_f32 v231,s93,v231
CV v226,v228,v229
CV v227,v230,v231
M v[220:223],a[56:59],a[152:155],v[220:223]
buffer_store_dwordx4 v[224:227],v36,s[12:15],s94 offen offset:2048 sc1
s_nop 0
M v[224:227],a[56:59],a[160:163],0
ds_read_b64_tr_b16 a[118:119],v20 offset:34816
v_mul_f32 v232,s93,v232
v_mul_f32 v233,s93,v233
v_mul_f32 v234,s93,v234
v_mul_f32 v235,s93,v235
M v[224:227],a[60:63],a[164:167],v[224:227]
CV v232,v232,v233
CV v233,v234,v235
v_mul_f32 v236,s93,v236
v_mul_f32 v237,s93,v237
v_mul_f32 v238,s93,v238
v_mul_f32 v239,s93,v239
M v[228:231],a[60:63],a[172:175],0
CV v234,v236,v237
CV v235,v238,v239
AW a236,v232
AW a237,v233
AW a238,v234
M v[228:231],a[56:59],a[168:171],v[228:231]
buffer_load_dwordx4 v27,s[8:11],s24 offen offset:1024 sc1 lds
AW a239,v235
s_add_u32 s94,s94,s95
M v[232:235],a[56:59],a[176:179],0
v_mul_f32 v240,s93,v240
v_mul_f32 v241,s93,v241
v_mul_f32 v242,s93,v242
v_mul_f32 v243,s93,v243
CV v240,v240,v241
M v[232:235],a[60:63],a[180:183],v[232:235]
CV v241,v242,v243
v_mul_f32 v244,s93,v244
v_mul_f32 v245,s93,v245
v_mul_f32 v246,s93,v246
v_mul_f32 v247,s93,v247
M v[236:239],a[60:63],a[188:191],0
buffer_load_dword v1,v37,s[64:67],0 offen
CV v242,v244,v245
CV v243,v246,v247
M v[236:239],a[56:59],a[184:187],v[236:239]
buffer_store_dwordx4 v[240:243],v36,s[12:15],s94 offen sc1
s_nop 0
s_waitcnt lgkmcnt(4)
M v[240:243],a[48:51],a[128:131],0
ds_read_b128 a[56:59],v4 offset:38912
v_mul_f32 v248,s93,v248
v_mul_f32 v249,s93,v249
v_mul_f32 v250,s93,v250
v_mul_f32 v251,s93,v251
CV v248,v248,v249
M v[240:243],a[52:55],a[132:135],v[240:243]
ds_read_b128 a[60:63],v5 offset:38912
CV v249,v250,v251
v_mul_f32 v252,s93,v252
v_mul_f32 v253,s93,v253
v_mul_f32 v254,s93,v254
M v[244:247],a[52:55],a[140:143],0
ds_read_b64_tr_b16 a[124:125],v21 offset:32768
v_mul_f32 v255,s93,v255
CV v250,v252,v253
CV v251,v254,v255
AW a240,v248
AW a241,v249
M v[244:247],a[48:51],a[136:139],v[244:247]
buffer_load_dwordx4 v28,s[8:11],s24 offen offset:2048 sc1 lds
AW a242,v250
AW a243,v251
M v[248:251],a[48:51],a[144:147],0
ds_read_b64_tr_b16 a[126:127],v21 offset:34816
AR v42,a0
AR v43,a1
AR v44,a2
AR v45,a3
v_mul_f32 v42,s93,v42
M v[248:251],a[52:55],a[148:151],v[248:251]
v_mul_f32 v43,s93,v43
v_mul_f32 v44,s93,v44
v_mul_f32 v45,s93,v45
CV v30,v42,v43
CV v31,v44,v45
AR v42,a4
AR v43,a5
M v[252:255],a[52:55],a[156:159],0
AR v44,a6
AR v45,a7
v_mul_f32 v42,s93,v42
v_mul_f32 v43,s93,v43
v_mul_f32_e64 v44,s93,v44
v_mul_f32 v45,s93,v45
M v[252:255],a[48:51],a[152:155],v[252:255]
CV v32,v42,v43
CV v33,v44,v45
buffer_store_dwordx4 v[30:33],v36,s[12:15],s94 offen offset:2048 sc1
s_nop 0
M a[0:3],a[48:51],a[160:163],0
AR v42,a8
AR v43,a9
AR v44,a10
AR v45,a11
v_mul_f32 v42,s93,v42
v_mul_f32 v43,s93,v43
v_mul_f32 v44,s93,v44
M a[0:3],a[52:55],a[164:167],a[0:3]
v_mul_f32 v45,s93,v45
CV v30,v42,v43
CV v31,v44,v45
AR v42,a12
AR v43,a13
AR v44,a14
AR v45,a15
M a[4:7],a[52:55],a[172:175],0
v_mul_f32 v42,s93,v42
v_mul_f32 v43,s93,v43
v_mul_f32 v44,s93,v44
v_mul_f32 v45,s93,v45
CV v32,v42,v43
CV v33,v44,v45
AW a244,v30
M a[4:7],a[48:51],a[168:171],a[4:7]
buffer_load_dwordx4 v29,s[8:11],s24 offen offset:3072 sc1 lds
AW a245,v31
AW a246,v32
AW a247,v33
s_add_u32 s94,s94,s95
M a[8:11],a[48:51],a[176:179],0
s_add_u32 s24,s24,s25
AR v42,a16
AR v43,a17
AR v44,a18
AR v45,a19
v_mul_f32 v42,s93,v42
v_mul_f32 v43,s93,v43
M a[8:11],a[52:55],a[180:183],a[8:11]
v_mul_f32 v44,s93,v44
v_mul_f32 v45,s93,v45
CV v30,v42,v43
CV v31,v44,v45
AR v42,a20
AR v43,a21
M a[12:15],a[52:55],a[188:191],0
AR v44,a22
AR v45,a23
v_mul_f32 v42,s93,v42
v_mul_f32 v43,s93,v43
v_mul_f32_e64 v44,s93,v44
v_mul_f32 v45,s93,v45
CV v32,v42,v43
M a[12:15],a[48:51],a[184:187],a[12:15]
CV v33,v44,v45
buffer_store_dwordx4 v[30:33],v36,s[12:15],s94 offen sc1
s_nop 0
s_waitcnt vmcnt(32) lgkmcnt(0)
s_barrier
M a[16:19],a[56:59],a[128:131],0
ds_read_b128 a[48:51],v2 offset:0
AR v42,a24
AR v43,a25
AR v44,a26
AR v45,a27
v_mul_f32 v42,s93,v42
v_mul_f32 v43,s93,v43
v_mul_f32 v44,s93,v44
M a[16:19],a[60:63],a[132:135],a[16:19]
ds_read_b128 a[52:55],v3 offset:0
v_mul_f32 v45,s93,v45
CV v30,v42,v43
CV v31,v44,v45
AR v42,a28
AR v43,a29
AR v44,a30
M a[20:23],a[60:63],a[140:143],0
s_add_u32 m0,s21,98304
AR v45,a31
v_mul_f32 v42,s93,v42
v_mul_f32 v43,s93,v43
v_mul_f32 v44,s93,v44
v_mul_f32 v45,s93,v45
CV v32,v42,v43
CV v33,v44,v45
M a[20:23],a[56:59],a[136:139],a[20:23]
buffer_load_dwordx4 v22,s[4:7],s23 offen sc1 lds
AW a248,v30
AW a249,v31
AW a250,v32
AW a251,v33
M a[24:27],a[56:59],a[144:147],0
AR v42,a32
AR v43,a33
AR v44,a34
AR v45,a35
v_mul_f32 v42,s93,v42
v_mul_f32 v43,s93,v43
M a[24:27],a[60:63],a[148:151],a[24:27]
v_mul_f32 v44,s93,v44
v_mul_f32 v45,s93,v45
CV v30,v42,v43
CV v31,v44,v45
AR v42,a36
AR v43,a37
M a[28:31],a[60:63],a[156:159],0
AR v44,a38
AR v45,a39
v_mul_f32 v42,s93,v42
v_mul_f32 v43,s93,v43
v_mul_f32_e64 v44,s93,v44
v_mul_f32 v45,s93,v45
M a[28:31],a[56:59],a[152:155],a[28:31]
CV v32,v42,v43
CV v33,v44,v45
buffer_store_dwordx4 v[30:33],v36,s[12:15],s94 offen offset:2048 sc1
s_nop 0
M a[32:35],a[56:59],a[160:163],0
AR v42,a40
AR v43,a41
AR v44,a42
AR v45,a43
v_mul_f32 v42,s93,v42
v_mul_f32 v43,s93,v43
v_mul_f32 v44,s93,v44
M a[32:35],a[60:63],a[164:167],a[32:35]
v_mul_f32 v45,s93,v45
CV v30,v42,v43
CV v31,v44,v45
AR v42,a44
AR v43,a45
AR v44,a46
AR v45,a47
M a[36:39],a[60:63],a[172:175],0
v_mul_f32 v42,s93,v42
v_mul_f32 v43,s93,v43
v_mul_f32 v44,s93,v44
v_mul_f32 v45,s93,v45
CV v32,v42,v43
CV v33,v44,v45
AW a252,v30
M a[36:39],a[56:59],a[168:171],a[36:39]
buffer_load_dwordx4 v23,s[4:7],s23 offen offset:1024 sc1 lds
AW a253,v31
AW a254,v32
AW a255,v33
s_add_u32 s94,s94,s95
M a[40:43],a[56:59],a[176:179],0
M a[40:43],a[60:63],a[180:183],a[40:43]
s_sub_u32 s26,s26,1
M a[44:47],a[60:63],a[188:191],0
s_cmp_eq_u32 s26,s43
M a[44:47],a[56:59],a[184:187],a[44:47]
s_branch K1_FS_V2
K1_FS_AV:
s_mov_b32 s94,s54
s_mov_b32 s95,s55
s_mov_b32 s92,s54
s_mov_b32 s19,s53
s_mov_b32 s53,4
s_mov_b32 s54,s56
s_mov_b32 s55,s57
s_mov_b32 s26,s17
s_mov_b32 s43,3
s_cmp_eq_u32 s20,0
s_cselect_b32 s78,12,99
CV v48,v48,v49
CV v49,v50,v51
CV v50,v52,v53
CV v51,v54,v55
buffer_store_dwordx4 v[48:51],v36,s[12:15],s94 offen sc1
s_nop 0
s_waitcnt lgkmcnt(0)
M v[48:51],a[48:51],a[128:131],0
ds_read_b128 a[56:59],v4 offset:2048
CV v56,v56,v57
CV v57,v58,v59
CV v58,v60,v61
M v[48:51],a[52:55],a[132:135],v[48:51]
ds_read_b128 a[60:63],v5 offset:2048
CV v59,v62,v63
AW a192,v56
M v[52:55],a[52:55],a[140:143],0
ds_read_b64_tr_b16 a[64:65],v14 offset:0
AW a193,v57
AW a194,v58
AW a195,v59
M v[52:55],a[48:51],a[136:139],v[52:55]
buffer_load_dwordx4 v24,s[4:7],s23 offen offset:2048 sc1 lds
M v[56:59],a[48:51],a[144:147],0
ds_read_b64_tr_b16 a[66:67],v14 offset:2048
CV v64,v64,v65
CV v65,v66,v67
M v[56:59],a[52:55],a[148:151],v[56:59]
CV v66,v68,v69
CV v67,v70,v71
M v[60:63],a[52:55],a[156:159],0
ds_read_b64_tr_b16 a[72:73],v15 offset:0
buffer_store_dwordx4 v[64:67],v36,s[12:15],s94 offen offset:2048 sc1
M v[60:63],a[48:51],a[152:155],v[60:63]
s_nop 0
M v[64:67],a[48:51],a[160:163],0
ds_read_b64_tr_b16 a[74:75],v15 offset:2048
CV v72,v72,v73
CV v73,v74,v75
CV v74,v76,v77
M v[64:67],a[52:55],a[164:167],v[64:67]
CV v75,v78,v79
AW a196,v72
AW a197,v73
M v[68:71],a[52:55],a[172:175],0
ds_read_b64_tr_b16 a[80:81],v16 offset:0
AW a198,v74
AW a199,v75
s_add_u32 s94,s94,s95
M v[68:71],a[48:51],a[168:171],v[68:71]
buffer_load_dwordx4 v25,s[4:7],s23 offen offset:3072 sc1 lds
M v[72:75],a[48:51],a[176:179],0
ds_read_b64_tr_b16 a[82:83],v16 offset:2048
CV v80,v80,v81
CV v81,v82,v83
M v[72:75],a[52:55],a[180:183],v[72:75]
s_add_u32 s23,s23,128
CV v82,v84,v85
CV v83,v86,v87
M v[76:79],a[52:55],a[188:191],0
buffer_store_dwordx4 v[80:83],v36,s[12:15],s94 offen sc1
M v[76:79],a[48:51],a[184:187],v[76:79]
s_nop 0
s_waitcnt lgkmcnt(6)
M v[80:83],a[56:59],a[128:131],0
ds_read_b128 a[48:51],v4 offset:4096
CV v88,v88,v89
CV v89,v90,v91
CV v90,v92,v93
M v[80:83],a[60:63],a[132:135],v[80:83]
ds_read_b128 a[52:55],v5 offset:4096
s_add_u32 m0,s21,49152
CV v91,v94,v95
AW a200,v88
M v[84:87],a[60:63],a[140:143],0
ds_read_b64_tr_b16 a[88:89],v17 offset:0
AW a201,v89
AW a202,v90
M v[84:87],a[56:59],a[136:139],v[84:87]
buffer_load_dwordx4 v26,s[8:11],s24 offen sc1 lds
AW a203,v91
M v[88:91],a[56:59],a[144:147],0
ds_read_b64_tr_b16 a[90:91],v17 offset:2048
CV v96,v96,v97
CV v97,v98,v99
M v[88:91],a[60:63],a[148:151],v[88:91]
CV v98,v100,v101
CV v99,v102,v103
M v[92:95],a[60:63],a[156:159],0
ds_read_b64_tr_b16 a[96:97],v18 offset:0
buffer_store_dwordx4 v[96:99],v36,s[12:15],s94 offen offset:2048 sc1
M v[92:95],a[56:59],a[152:155],v[92:95]
s_nop 0
M v[96:99],a[56:59],a[160:163],0
ds_read_b64_tr_b16 a[98:99],v18 offset:2048
CV v104,v104,v105
CV v105,v106,v107
CV v106,v108,v109
M v[96:99],a[60:63],a[164:167],v[96:99]
CV v107,v110,v111
AW a204,v104
AW a205,v105
M v[100:103],a[60:63],a[172:175],0
ds_read_b64_tr_b16 a[104:105],v19 offset:0
AW a206,v106
AW a207,v107
s_add_u32 s94,s94,s95
M v[100:103],a[56:59],a[168:171],v[100:103]
buffer_load_dwordx4 v27,s[8:11],s24 offen offset:1024 sc1 lds
M v[104:107],a[56:59],a[176:179],0
ds_read_b64_tr_b16 a[106:107],v19 offset:2048
CV v112,v112,v113
CV v113,v114,v115
M v[104:107],a[60:63],a[180:183],v[104:107]
CV v114,v116,v117
CV v115,v118,v119
M v[108:111],a[60:63],a[188:191],0
buffer_store_dwordx4 v[112:115],v36,s[12:15],s94 offen sc1
M v[108:111],a[56:59],a[184:187],v[108:111]
s_nop 0
s_waitcnt lgkmcnt(6)
M v[112:115],a[48:51],a[128:131],0
ds_read_b128 a[56:59],v4 offset:6144
CV v120,v120,v121
CV v121,v122,v123
CV v122,v124,v125
M v[112:115],a[52:55],a[132:135],v[112:115]
ds_read_b128 a[60:63],v5 offset:6144
CV v123,v126,v127
AW a208,v120
M v[116:119],a[52:55],a[140:143],0
ds_read_b64_tr_b16 a[112:113],v20 offset:0
AW a209,v121
AW a210,v122
AW a211,v123
M v[116:119],a[48:51],a[136:139],v[116:119]
buffer_load_dwordx4 v28,s[8:11],s24 offen offset:2048 sc1 lds
M v[120:123],a[48:51],a[144:147],0
ds_read_b64_tr_b16 a[114:115],v20 offset:2048
CV v128,v128,v129
CV v129,v130,v131
M v[120:123],a[52:55],a[148:151],v[120:123]
CV v130,v132,v133
CV v131,v134,v135
M v[124:127],a[52:55],a[156:159],0
ds_read_b64_tr_b16 a[120:121],v21 offset:0
buffer_store_dwordx4 v[128:131],v36,s[12:15],s94 offen offset:2048 sc1
M v[124:127],a[48:51],a[152:155],v[124:127]
s_nop 0
M v[128:131],a[48:51],a[160:163],0
ds_read_b64_tr_b16 a[122:123],v21 offset:2048
CV v136,v136,v137
CV v137,v138,v139
M v[128:131],a[52:55],a[164:167],v[128:131]
CV v138,v140,v141
CV v139,v142,v143
AW a212,v136
AW a213,v137
M v[132:135],a[52:55],a[172:175],0
AW a214,v138
AW a215,v139
s_add_u32 s94,s94,s95
M v[132:135],a[48:51],a[168:171],v[132:135]
buffer_load_dwordx4 v29,s[8:11],s24 offen offset:3072 sc1 lds
M v[136:139],a[48:51],a[176:179],0
s_add_u32 s24,s24,s25
CV v144,v144,v145
CV v145,v146,v147
M v[136:139],a[52:55],a[180:183],v[136:139]
CV v146,v148,v149
CV v147,v150,v151
M v[140:143],a[52:55],a[188:191],0
buffer_store_dwordx4 v[144:147],v36,s[12:15],s94 offen sc1
M v[140:143],a[48:51],a[184:187],v[140:143]
s_nop 0
s_waitcnt vmcnt(24) lgkmcnt(0)
s_barrier
M v[144:147],a[56:59],a[128:131],0
ds_read_b128 a[48:51],v4 offset:32768
CV v152,v152,v153
CV v153,v154,v155
CV v154,v156,v157
M v[144:147],a[60:63],a[132:135],v[144:147]
ds_read_b128 a[52:55],v5 offset:32768
s_add_u32 m0,s21,65536
CV v155,v158,v159
AW a216,v152
M v[148:151],a[60:63],a[140:143],0
ds_read_b64_tr_b16 a[68:69],v14 offset:32768
AW a217,v153
AW a218,v154
M v[148:151],a[56:59],a[136:139],v[148:151]
buffer_load_dwordx4 v22,s[4:7],s22 offen sc1 lds
AW a219,v155
M v[152:155],a[56:59],a[144:147],0
ds_read_b64_tr_b16 a[70:71],v14 offset:34816
CV v160,v160,v161
CV v161,v162,v163
M v[152:155],a[60:63],a[148:151],v[152:155]
CV v162,v164,v165
CV v163,v166,v167
M v[156:159],a[60:63],a[156:159],0
ds_read_b64_tr_b16 a[76:77],v15 offset:32768
buffer_store_dwordx4 v[160:163],v36,s[12:15],s94 offen offset:2048 sc1
M v[156:159],a[56:59],a[152:155],v[156:159]
s_nop 0
M v[160:163],a[56:59],a[160:163],0
ds_read_b64_tr_b16 a[78:79],v15 offset:34816
CV v168,v168,v169
CV v169,v170,v171
CV v170,v172,v173
M v[160:163],a[60:63],a[164:167],v[160:163]
CV v171,v174,v175
AW a220,v168
AW a221,v169
M v[164:167],a[60:63],a[172:175],0
ds_read_b64_tr_b16 a[84:85],v16 offset:32768
AW a222,v170
AW a223,v171
s_add_u32 s94,s94,s95
M v[164:167],a[56:59],a[168:171],v[164:167]
buffer_load_dwordx4 v23,s[4:7],s22 offen offset:1024 sc1 lds
M v[168:171],a[56:59],a[176:179],0
CV v176,v176,v177
CV v177,v178,v179
M v[168:171],a[60:63],a[180:183],v[168:171]
CV v178,v180,v181
CV v179,v182,v183
M v[172:175],a[60:63],a[188:191],0
buffer_store_dwordx4 v[176:179],v36,s[12:15],s94 offen sc1
M v[172:175],a[56:59],a[184:187],v[172:175]
s_nop 0
s_waitcnt lgkmcnt(5)
M v[176:179],a[48:51],a[128:131],0
ds_read_b128 a[56:59],v4 offset:34816
CV v184,v184,v185
CV v185,v186,v187
CV v186,v188,v189
M v[176:179],a[52:55],a[132:135],v[176:179]
ds_read_b128 a[60:63],v5 offset:34816
CV v187,v190,v191
AW a224,v184
M v[180:183],a[52:55],a[140:143],0
ds_read_b64_tr_b16 a[86:87],v16 offset:34816
AW a225,v185
AW a226,v186
AW a227,v187
M v[180:183],a[48:51],a[136:139],v[180:183]
buffer_load_dwordx4 v24,s[4:7],s22 offen offset:2048 sc1 lds
M v[184:187],a[48:51],a[144:147],0
ds_read_b64_tr_b16 a[92:93],v17 offset:32768
CV v192,v192,v193
CV v193,v194,v195
M v[184:187],a[52:55],a[148:151],v[184:187]
CV v194,v196,v197
CV v195,v198,v199
M v[188:191],a[52:55],a[156:159],0
ds_read_b64_tr_b16 a[94:95],v17 offset:34816
buffer_store_dwordx4 v[192:195],v36,s[12:15],s94 offen offset:2048 sc1
M v[188:191],a[48:51],a[152:155],v[188:191]
s_nop 0
M v[192:195],a[48:51],a[160:163],0
ds_read_b64_tr_b16 a[100:101],v18 offset:32768
CV v200,v200,v201
CV v201,v202,v203
CV v202,v204,v205
M v[192:195],a[52:55],a[164:167],v[192:195]
CV v203,v206,v207
AW a228,v200
AW a229,v201
M v[196:199],a[52:55],a[172:175],0
ds_read_b64_tr_b16 a[102:103],v18 offset:34816
AW a230,v202
AW a231,v203
s_add_u32 s94,s94,s95
M v[196:199],a[48:51],a[168:171],v[196:199]
buffer_load_dwordx4 v25,s[4:7],s22 offen offset:3072 sc1 lds
M v[200:203],a[48:51],a[176:179],0
s_add_u32 s22,s22,128
CV v208,v208,v209
CV v209,v210,v211
M v[200:203],a[52:55],a[180:183],v[200:203]
CV v210,v212,v213
CV v211,v214,v215
M v[204:207],a[52:55],a[188:191],0
buffer_store_dwordx4 v[208:211],v36,s[12:15],s94 offen sc1
M v[204:207],a[48:51],a[184:187],v[204:207]
s_nop 0
s_waitcnt lgkmcnt(5)
M v[208:211],a[56:59],a[128:131],0
ds_read_b128 a[48:51],v4 offset:36864
CV v216,v216,v217
CV v217,v218,v219
CV v218,v220,v221
M v[208:211],a[60:63],a[132:135],v[208:211]
ds_read_b128 a[52:55],v5 offset:36864
s_add_u32 m0,s21,81920
CV v219,v222,v223
AW a232,v216
M v[212:215],a[60:63],a[140:143],0
ds_read_b64_tr_b16 a[108:109],v19 offset:32768
AW a233,v217
AW a234,v218
M v[212:215],a[56:59],a[136:139],v[212:215]
buffer_load_dwordx4 v26,s[8:11],s24 offen sc1 lds
AW a235,v219
M v[216:219],a[56:59],a[144:147],0
ds_read_b64_tr_b16 a[110:111],v19 offset:34816
CV v224,v224,v225
CV v225,v226,v227
M v[216:219],a[60:63],a[148:151],v[216:219]
CV v226,v228,v229
CV v227,v230,v231
M v[220:223],a[60:63],a[156:159],0
ds_read_b64_tr_b16 a[116:117],v20 offset:32768
buffer_store_dwordx4 v[224:227],v36,s[12:15],s94 offen offset:2048 sc1
M v[220:223],a[56:59],a[152:155],v[220:223]
s_nop 0
M v[224:227],a[56:59],a[160:163],0
ds_read_b64_tr_b16 a[118:119],v20 offset:34816
CV v232,v232,v233
CV v233,v234,v235
M v[224:227],a[60:63],a[164:167],v[224:227]
CV v234,v236,v237
CV v235,v238,v239
AW a236,v232
AW a237,v233
M v[228:231],a[60:63],a[172:175],0
AW a238,v234
AW a239,v235
s_add_u32 s94,s94,s95
M v[228:231],a[56:59],a[168:171],v[228:231]
buffer_load_dwordx4 v27,s[8:11],s24 offen offset:1024 sc1 lds
M v[232:235],a[56:59],a[176:179],0
CV v240,v240,v241
CV v241,v242,v243
CV v242,v244,v245
M v[232:235],a[60:63],a[180:183],v[232:235]
CV v243,v246,v247
buffer_store_dwordx4 v[240:243],v36,s[12:15],s94 offen sc1
M v[236:239],a[60:63],a[188:191],0
buffer_load_dword v1,v37,s[64:67],0 offen
M v[236:239],a[56:59],a[184:187],v[236:239]
s_nop 0
s_waitcnt lgkmcnt(4)
M v[240:243],a[48:51],a[128:131],0
ds_read_b128 a[56:59],v4 offset:38912
CV v248,v248,v249
CV v249,v250,v251
CV v250,v252,v253
M v[240:243],a[52:55],a[132:135],v[240:243]
ds_read_b128 a[60:63],v5 offset:38912
CV v251,v254,v255
AW a240,v248
M v[244:247],a[52:55],a[140:143],0
ds_read_b64_tr_b16 a[124:125],v21 offset:32768
AW a241,v249
AW a242,v250
AW a243,v251
M v[244:247],a[48:51],a[136:139],v[244:247]
buffer_load_dwordx4 v28,s[8:11],s24 offen offset:2048 sc1 lds
M v[248:251],a[48:51],a[144:147],0
ds_read_b64_tr_b16 a[126:127],v21 offset:34816
AR v42,a0
AR v43,a1
AR v44,a2
M v[248:251],a[52:55],a[148:151],v[248:251]
AR v45,a3
CV v30,v42,v43
CV v31,v44,v45
AR v42,a4
AR v43,a5
M v[252:255],a[52:55],a[156:159],0
AR v44,a6
AR v45,a7
CV v32,v42,v43
CV v33,v44,v45
M v[252:255],a[48:51],a[152:155],v[252:255]
buffer_store_dwordx4 v[30:33],v36,s[12:15],s94 offen offset:2048 sc1
s_nop 0
M a[0:3],a[48:51],a[160:163],0
AR v42,a8
AR v43,a9
AR v44,a10
AR v45,a11
CV v30,v42,v43
M a[0:3],a[52:55],a[164:167],a[0:3]
CV v31,v44,v45
AR v42,a12
AR v43,a13
AR v44,a14
AR v45,a15
M a[4:7],a[52:55],a[172:175],0
CV v32,v42,v43
CV v33,v44,v45
AW a244,v30
AW a245,v31
AW a246,v32
M a[4:7],a[48:51],a[168:171],a[4:7]
buffer_load_dwordx4 v29,s[8:11],s24 offen offset:3072 sc1 lds
AW a247,v33
s_add_u32 s94,s94,s95
M a[8:11],a[48:51],a[176:179],0
s_add_u32 s24,s24,s25
AR v42,a16
AR v43,a17
AR v44,a18
AR v45,a19
M a[8:11],a[52:55],a[180:183],a[8:11]
CV v30,v42,v43
CV v31,v44,v45
AR v42,a20
AR v43,a21
M a[12:15],a[52:55],a[188:191],0
AR v44,a22
AR v45,a23
CV v32,v42,v43
CV v33,v44,v45
M a[12:15],a[48:51],a[184:187],a[12:15]
buffer_store_dwordx4 v[30:33],v36,s[12:15],s94 offen sc1
s_nop 0
s_waitcnt vmcnt(32) lgkmcnt(0)
s_barrier
M a[16:19],a[56:59],a[128:131],0
ds_read_b128 a[48:51],v2 offset:0
AR v42,a24
AR v43,a25
AR v44,a26
AR v45,a27
CV v30,v42,v43
M a[16:19],a[60:63],a[132:135],a[16:19]
ds_read_b128 a[52:55],v3 offset:0
CV v31,v44,v45
AR v42,a28
AR v43,a29
AR v44,a30
M a[20:23],a[60:63],a[140:143],0
s_add_u32 m0,s21,98304
AR v45,a31
CV v32,v42,v43
CV v33,v44,v45
AW a248,v30
AW a249,v31
M a[20:23],a[56:59],a[136:139],a[20:23]
buffer_load_dwordx4 v22,s[4:7],s23 offen sc1 lds
AW a250,v32
AW a251,v33
M a[24:27],a[56:59],a[144:147],0
AR v42,a32
AR v43,a33
AR v44,a34
AR v45,a35
M a[24:27],a[60:63],a[148:151],a[24:27]
CV v30,v42,v43
CV v31,v44,v45
AR v42,a36
AR v43,a37
M a[28:31],a[60:63],a[156:159],0
AR v44,a38
AR v45,a39
CV v32,v42,v43
CV v33,v44,v45
M a[28:31],a[56:59],a[152:155],a[28:31]
buffer_store_dwordx4 v[30:33],v36,s[12:15],s94 offen offset:2048 sc1
s_nop 0
M a[32:35],a[56:59],a[160:163],0
AR v42,a40
AR v43,a41
AR v44,a42
AR v45,a43
CV v30,v42,v43
M a[32:35],a[60:63],a[164:167],a[32:35]
CV v31,v44,v45
AR v42,a44
AR v43,a45
AR v44,a46
AR v45,a47
M a[36:39],a[60:63],a[172:175],0
CV v32,v42,v43
CV v33,v44,v45
AW a252,v30
AW a253,v31
AW a254,v32
M a[36:39],a[56:59],a[168:171],a[36:39]
buffer_load_dwordx4 v23,s[4:7],s23 offen offset:1024 sc1 lds
AW a255,v33
s_add_u32 s94,s94,s95
M a[40:43],a[56:59],a[176:179],0
M a[40:43],a[60:63],a[180:183],a[40:43]
s_sub_u32 s26,s26,1
M a[44:47],a[60:63],a[188:191],0
s_cmp_eq_u32 s26,s43
M a[44:47],a[56:59],a[184:187],a[44:47]
K1_FS_V2:
s_waitcnt lgkmcnt(0)
M v[48:51],a[48:51],a[64:67],v[48:51]
ds_read_b128 a[56:59],v2 offset:2048
M v[48:51],a[52:55],a[68:71],v[48:51]
ds_read_b128 a[60:63],v3 offset:2048
M v[52:55],a[52:55],a[76:79],v[52:55]
ds_read_b64_tr_b16 a[128:129],v6 offset:0
M v[52:55],a[48:51],a[72:75],v[52:55]
buffer_load_dwordx4 v24,s[4:7],s23 offen offset:2048 sc1 lds
M v[56:59],a[48:51],a[80:83],v[56:59]
ds_read_b64_tr_b16 a[130:131],v6 offset:2048
M v[56:59],a[52:55],a[84:87],v[56:59]
M v[60:63],a[52:55],a[92:95],v[60:63]
ds_read_b64_tr_b16 a[136:137],v7 offset:0
M v[60:63],a[48:51],a[88:91],v[60:63]
buffer_store_dwordx4 a[192:195],v36,s[12:15],s92 offen offset:1024 sc1
M v[64:67],a[48:51],a[96:99],v[64:67]
ds_read_b64_tr_b16 a[138:139],v7 offset:2048
M v[64:67],a[52:55],a[100:103],v[64:67]
M v[68:71],a[52:55],a[108:111],v[68:71]
ds_read_b64_tr_b16 a[144:145],v8 offset:0
M v[68:71],a[48:51],a[104:107],v[68:71]
buffer_load_dwordx4 v25,s[4:7],s23 offen offset:3072 sc1 lds
M v[72:75],a[48:51],a[112:115],v[72:75]
ds_read_b64_tr_b16 a[146:147],v8 offset:2048
M v[72:75],a[52:55],a[116:119],v[72:75]
s_add_u32 s23,s23,128
M v[76:79],a[52:55],a[124:127],v[76:79]
M v[76:79],a[48:51],a[120:123],v[76:79]
s_waitcnt lgkmcnt(6)
M v[80:83],a[56:59],a[64:67],v[80:83]
ds_read_b128 a[48:51],v2 offset:4096
M v[80:83],a[60:63],a[68:71],v[80:83]
ds_read_b128 a[52:55],v3 offset:4096
s_add_u32 m0,s21,114688
M v[84:87],a[60:63],a[76:79],v[84:87]
ds_read_b64_tr_b16 a[152:153],v9 offset:0
M v[84:87],a[56:59],a[72:75],v[84:87]
buffer_load_dwordx4 v26,s[8:11],s24 offen sc1 lds
M v[88:91],a[56:59],a[80:83],v[88:91]
ds_read_b64_tr_b16 a[154:155],v9 offset:2048
M v[88:91],a[60:63],a[84:87],v[88:91]
M v[92:95],a[60:63],a[92:95],v[92:95]
ds_read_b64_tr_b16 a[160:161],v10 offset:0
M v[92:95],a[56:59],a[88:91],v[92:95]
buffer_store_dwordx4 a[196:199],v36,s[12:15],s92 offen offset:3072 sc1
M v[96:99],a[56:59],a[96:99],v[96:99]
ds_read_b64_tr_b16 a[162:163],v10 offset:2048
M v[96:99],a[60:63],a[100:103],v[96:99]
s_add_u32 s92,s92,s95
M v[100:103],a[60:63],a[108:111],v[100:103]
ds_read_b64_tr_b16 a[168:169],v11 offset:0
M v[100:103],a[56:59],a[104:107],v[100:103]
buffer_load_dwordx4 v27,s[8:11],s24 offen offset:1024 sc1 lds
M v[104:107],a[56:59],a[112:115],v[104:107]
ds_read_b64_tr_b16 a[170:171],v11 offset:2048
M v[104:107],a[60:63],a[116:119],v[104:107]
M v[108:111],a[60:63],a[124:127],v[108:111]
M v[108:111],a[56:59],a[120:123],v[108:111]
s_waitcnt lgkmcnt(6)
M v[112:115],a[48:51],a[64:67],v[112:115]
ds_read_b128 a[56:59],v2 offset:6144
M v[112:115],a[52:55],a[68:71],v[112:115]
ds_read_b128 a[60:63],v3 offset:6144
M v[116:119],a[52:55],a[76:79],v[116:119]
ds_read_b64_tr_b16 a[176:177],v12 offset:0
M v[116:119],a[48:51],a[72:75],v[116:119]
buffer_load_dwordx4 v28,s[8:11],s24 offen offset:2048 sc1 lds
M v[120:123],a[48:51],a[80:83],v[120:123]
ds_read_b64_tr_b16 a[178:179],v12 offset:2048
M v[120:123],a[52:55],a[84:87],v[120:123]
M v[124:127],a[52:55],a[92:95],v[124:127]
ds_read_b64_tr_b16 a[184:185],v13 offset:0
M v[124:127],a[48:51],a[88:91],v[124:127]
buffer_store_dwordx4 a[200:203],v36,s[12:15],s92 offen offset:1024 sc1
M v[128:131],a[48:51],a[96:99],v[128:131]
ds_read_b64_tr_b16 a[186:187],v13 offset:2048
M v[128:131],a[52:55],a[100:103],v[128:131]
M v[132:135],a[52:55],a[108:111],v[132:135]
M v[132:135],a[48:51],a[104:107],v[132:135]
buffer_load_dwordx4 v29,s[8:11],s24 offen offset:3072 sc1 lds
M v[136:139],a[48:51],a[112:115],v[136:139]
s_add_u32 s24,s24,s25
M v[136:139],a[52:55],a[116:119],v[136:139]
M v[140:143],a[52:55],a[124:127],v[140:143]
M v[140:143],a[48:51],a[120:123],v[140:143]
s_waitcnt vmcnt(30) lgkmcnt(0)
s_barrier
M v[144:147],a[56:59],a[64:67],v[144:147]
ds_read_b128 a[48:51],v2 offset:32768
M v[144:147],a[60:63],a[68:71],v[144:147]
ds_read_b128 a[52:55],v3 offset:32768
s_add_u32 m0,s21,0
M v[148:151],a[60:63],a[76:79],v[148:151]
ds_read_b64_tr_b16 a[132:133],v6 offset:32768
M v[148:151],a[56:59],a[72:75],v[148:151]
buffer_load_dwordx4 v22,s[4:7],s22 offen sc1 lds
M v[152:155],a[56:59],a[80:83],v[152:155]
ds_read_b64_tr_b16 a[134:135],v6 offset:34816
M v[152:155],a[60:63],a[84:87],v[152:155]
M v[156:159],a[60:63],a[92:95],v[156:159]
ds_read_b64_tr_b16 a[140:141],v7 offset:32768
M v[156:159],a[56:59],a[88:91],v[156:159]
buffer_store_dwordx4 a[204:207],v36,s[12:15],s92 offen offset:3072 sc1
M v[160:163],a[56:59],a[96:99],v[160:163]
ds_read_b64_tr_b16 a[142:143],v7 offset:34816
M v[160:163],a[60:63],a[100:103],v[160:163]
s_add_u32 s92,s92,s95
M v[164:167],a[60:63],a[108:111],v[164:167]
ds_read_b64_tr_b16 a[148:149],v8 offset:32768
M v[164:167],a[56:59],a[104:107],v[164:167]
buffer_load_dwordx4 v23,s[4:7],s22 offen offset:1024 sc1 lds
M v[168:171],a[56:59],a[112:115],v[168:171]
M v[168:171],a[60:63],a[116:119],v[168:171]
M v[172:175],a[60:63],a[124:127],v[172:175]
M v[172:175],a[56:59],a[120:123],v[172:175]
s_waitcnt lgkmcnt(5)
M v[176:179],a[48:51],a[64:67],v[176:179]
ds_read_b128 a[56:59],v2 offset:34816
M v[176:179],a[52:55],a[68:71],v[176:179]
ds_read_b128 a[60:63],v3 offset:34816
M v[180:183],a[52:55],a[76:79],v[180:183]
ds_read_b64_tr_b16 a[150:151],v8 offset:34816
M v[180:183],a[48:51],a[72:75],v[180:183]
buffer_load_dwordx4 v24,s[4:7],s22 offen offset:2048 sc1 lds
M v[184:187],a[48:51],a[80:83],v[184:187]
ds_read_b64_tr_b16 a[156:157],v9 offset:32768
M v[184:187],a[52:55],a[84:87],v[184:187]
M v[188:191],a[52:55],a[92:95],v[188:191]
ds_read_b64_tr_b16 a[158:159],v9 offset:34816
M v[188:191],a[48:51],a[88:91],v[188:191]
buffer_store_dwordx4 a[208:211],v36,s[12:15],s92 offen offset:1024 sc1
M v[192:195],a[48:51],a[96:99],v[192:195]
ds_read_b64_tr_b16 a[164:165],v10 offset:32768
M v[192:195],a[52:55],a[100:103],v[192:195]
M v[196:199],a[52:55],a[108:111],v[196:199]
ds_read_b64_tr_b16 a[166:167],v10 offset:34816
M v[196:199],a[48:51],a[104:107],v[196:199]
buffer_load_dwordx4 v25,s[4:7],s22 offen offset:3072 sc1 lds
M v[200:203],a[48:51],a[112:115],v[200:203]
s_add_u32 s22,s22,128
M v[200:203],a[52:55],a[116:119],v[200:203]
M v[204:207],a[52:55],a[124:127],v[204:207]
M v[204:207],a[48:51],a[120:123],v[204:207]
s_waitcnt lgkmcnt(5)
M v[208:211],a[56:59],a[64:67],v[208:211]
ds_read_b128 a[48:51],v2 offset:36864
M v[208:211],a[60:63],a[68:71],v[208:211]
ds_read_b128 a[52:55],v3 offset:36864
s_add_u32 m0,s21,16384
M v[212:215],a[60:63],a[76:79],v[212:215]
ds_read_b64_tr_b16 a[172:173],v11 offset:32768
M v[212:215],a[56:59],a[72:75],v[212:215]
buffer_load_dwordx4 v26,s[8:11],s24 offen sc1 lds
M v[216:219],a[56:59],a[80:83],v[216:219]
ds_read_b64_tr_b16 a[174:175],v11 offset:34816
M v[216:219],a[60:63],a[84:87],v[216:219]
M v[220:223],a[60:63],a[92:95],v[220:223]
ds_read_b64_tr_b16 a[180:181],v12 offset:32768
M v[220:223],a[56:59],a[88:91],v[220:223]
buffer_store_dwordx4 a[212:215],v36,s[12:15],s92 offen offset:3072 sc1
M v[224:227],a[56:59],a[96:99],v[224:227]
ds_read_b64_tr_b16 a[182:183],v12 offset:34816
M v[224:227],a[60:63],a[100:103],v[224:227]
s_add_u32 s92,s92,s95
M v[228:231],a[60:63],a[108:111],v[228:231]
M v[228:231],a[56:59],a[104:107],v[228:231]
buffer_load_dwordx4 v27,s[8:11],s24 offen offset:1024 sc1 lds
M v[232:235],a[56:59],a[112:115],v[232:235]
M v[232:235],a[60:63],a[116:119],v[232:235]
M v[236:239],a[60:63],a[124:127],v[236:239]
buffer_load_dword v1,v37,s[64:67],0 offen
M v[236:239],a[56:59],a[120:123],v[236:239]
s_waitcnt lgkmcnt(4)
M v[240:243],a[48:51],a[64:67],v[240:243]
ds_read_b128 a[56:59],v2 offset:38912
M v[240:243],a[52:55],a[68:71],v[240:243]
ds_read_b128 a[60:63],v3 offset:38912
M v[244:247],a[52:55],a[76:79],v[244:247]
ds_read_b64_tr_b16 a[188:189],v13 offset:32768
M v[244:247],a[48:51],a[72:75],v[244:247]
buffer_load_dwordx4 v28,s[8:11],s24 offen offset:2048 sc1 lds
M v[248:251],a[48:51],a[80:83],v[248:251]
ds_read_b64_tr_b16 a[190:191],v13 offset:34816
M v[248:251],a[52:55],a[84:87],v[248:251]
M v[252:255],a[52:55],a[92:95],v[252:255]
M v[252:255],a[48:51],a[88:91],v[252:255]
buffer_store_dwordx4 a[216:219],v36,s[12:15],s92 offen offset:1024 sc1
M a[0:3],a[48:51],a[96:99],a[0:3]
M a[0:3],a[52:55],a[100:103],a[0:3]
M a[4:7],a[52:55],a[108:111],a[4:7]
M a[4:7],a[48:51],a[104:107],a[4:7]
buffer_load_dwordx4 v29,s[8:11],s24 offen offset:3072 sc1 lds
M a[8:11],a[48:51],a[112:115],a[8:11]
s_add_u32 s24,s24,s25
M a[8:11],a[52:55],a[116:119],a[8:11]
M a[12:15],a[52:55],a[124:127],a[12:15]
M a[12:15],a[48:51],a[120:123],a[12:15]
s_waitcnt vmcnt(26) lgkmcnt(0)
s_barrier
M a[16:19],a[56:59],a[64:67],a[16:19]
ds_read_b128 a[48:51],v4 offset:0
M a[16:19],a[60:63],a[68:71],a[16:19]
ds_read_b128 a[52:55],v5 offset:0
M a[20:23],a[60:63],a[76:79],a[20:23]
s_add_u32 m0,s21,32768
M a[20:23],a[56:59],a[72:75],a[20:23]
buffer_load_dwordx4 v22,s[4:7],s23 offen sc1 lds
M a[24:27],a[56:59],a[80:83],a[24:27]
M a[24:27],a[60:63],a[84:87],a[24:27]
M a[28:31],a[60:63],a[92:95],a[28:31]
M a[28:31],a[56:59],a[88:91],a[28:31]
buffer_store_dwordx4 a[220:223],v36,s[12:15],s92 offen offset:3072 sc1
M a[32:35],a[56:59],a[96:99],a[32:35]
M a[32:35],a[60:63],a[100:103],a[32:35]
s_add_u32 s92,s92,s95
M a[36:39],a[60:63],a[108:111],a[36:39]
M a[36:39],a[56:59],a[104:107],a[36:39]
buffer_load_dwordx4 v23,s[4:7],s23 offen offset:1024 sc1 lds
M a[40:43],a[56:59],a[112:115],a[40:43]
M a[40:43],a[60:63],a[116:119],a[40:43]
s_sub_u32 s26,s26,1
M a[44:47],a[60:63],a[124:127],a[44:47]
s_cmp_eq_u32 s26,s43
M a[44:47],a[56:59],a[120:123],a[44:47]
s_waitcnt lgkmcnt(0)
M v[48:51],a[48:51],a[128:131],v[48:51]
ds_read_b128 a[56:59],v4 offset:2048
M v[48:51],a[52:55],a[132:135],v[48:51]
ds_read_b128 a[60:63],v5 offset:2048
M v[52:55],a[52:55],a[140:143],v[52:55]
ds_read_b64_tr_b16 a[64:65],v14 offset:0
M v[52:55],a[48:51],a[136:139],v[52:55]
buffer_load_dwordx4 v24,s[4:7],s23 offen offset:2048 sc1 lds
M v[56:59],a[48:51],a[144:147],v[56:59]
ds_read_b64_tr_b16 a[66:67],v14 offset:2048
M v[56:59],a[52:55],a[148:151],v[56:59]
M v[60:63],a[52:55],a[156:159],v[60:63]
ds_read_b64_tr_b16 a[72:73],v15 offset:0
M v[60:63],a[48:51],a[152:155],v[60:63]
buffer_store_dwordx4 a[224:227],v36,s[12:15],s92 offen offset:1024 sc1
M v[64:67],a[48:51],a[160:163],v[64:67]
ds_read_b64_tr_b16 a[74:75],v15 offset:2048
M v[64:67],a[52:55],a[164:167],v[64:67]
M v[68:71],a[52:55],a[172:175],v[68:71]
ds_read_b64_tr_b16 a[80:81],v16 offset:0
M v[68:71],a[48:51],a[168:171],v[68:71]
buffer_load_dwordx4 v25,s[4:7],s23 offen offset:3072 sc1 lds
M v[72:75],a[48:51],a[176:179],v[72:75]
ds_read_b64_tr_b16 a[82:83],v16 offset:2048
M v[72:75],a[52:55],a[180:183],v[72:75]
s_add_u32 s23,s23,128
M v[76:79],a[52:55],a[188:191],v[76:79]
M v[76:79],a[48:51],a[184:187],v[76:79]
s_waitcnt lgkmcnt(6)
M v[80:83],a[56:59],a[128:131],v[80:83]
ds_read_b128 a[48:51],v4 offset:4096
M v[80:83],a[60:63],a[132:135],v[80:83]
ds_read_b128 a[52:55],v5 offset:4096
s_add_u32 m0,s21,49152
M v[84:87],a[60:63],a[140:143],v[84:87]
ds_read_b64_tr_b16 a[88:89],v17 offset:0
M v[84:87],a[56:59],a[136:139],v[84:87]
buffer_load_dwordx4 v26,s[8:11],s24 offen sc1 lds
M v[88:91],a[56:59],a[144:147],v[88:91]
ds_read_b64_tr_b16 a[90:91],v17 offset:2048
M v[88:91],a[60:63],a[148:151],v[88:91]
M v[92:95],a[60:63],a[156:159],v[92:95]
ds_read_b64_tr_b16 a[96:97],v18 offset:0
M v[92:95],a[56:59],a[152:155],v[92:95]
buffer_store_dwordx4 a[228:231],v36,s[12:15],s92 offen offset:3072 sc1
M v[96:99],a[56:59],a[160:163],v[96:99]
ds_read_b64_tr_b16 a[98:99],v18 offset:2048
M v[96:99],a[60:63],a[164:167],v[96:99]
s_add_u32 s92,s92,s95
M v[100:103],a[60:63],a[172:175],v[100:103]
ds_read_b64_tr_b16 a[104:105],v19 offset:0
M v[100:103],a[56:59],a[168:171],v[100:103]
buffer_load_dwordx4 v27,s[8:11],s24 offen offset:1024 sc1 lds
M v[104:107],a[56:59],a[176:179],v[104:107]
ds_read_b64_tr_b16 a[106:107],v19 offset:2048
M v[104:107],a[60:63],a[180:183],v[104:107]
M v[108:111],a[60:63],a[188:191],v[108:111]
M v[108:111],a[56:59],a[184:187],v[108:111]
s_waitcnt lgkmcnt(6)
M v[112:115],a[48:51],a[128:131],v[112:115]
ds_read_b128 a[56:59],v4 offset:6144
M v[112:115],a[52:55],a[132:135],v[112:115]
ds_read_b128 a[60:63],v5 offset:6144
M v[116:119],a[52:55],a[140:143],v[116:119]
ds_read_b64_tr_b16 a[112:113],v20 offset:0
M v[116:119],a[48:51],a[136:139],v[116:119]
buffer_load_dwordx4 v28,s[8:11],s24 offen offset:2048 sc1 lds
M v[120:123],a[48:51],a[144:147],v[120:123]
ds_read_b64_tr_b16 a[114:115],v20 offset:2048
M v[120:123],a[52:55],a[148:151],v[120:123]
M v[124:127],a[52:55],a[156:159],v[124:127]
ds_read_b64_tr_b16 a[120:121],v21 offset:0
M v[124:127],a[48:51],a[152:155],v[124:127]
buffer_store_dwordx4 a[232:235],v36,s[12:15],s92 offen offset:1024 sc1
M v[128:131],a[48:51],a[160:163],v[128:131]
ds_read_b64_tr_b16 a[122:123],v21 offset:2048
M v[128:131],a[52:55],a[164:167],v[128:131]
M v[132:135],a[52:55],a[172:175],v[132:135]
M v[132:135],a[48:51],a[168:171],v[132:135]
buffer_load_dwordx4 v29,s[8:11],s24 offen offset:3072 sc1 lds
M v[136:139],a[48:51],a[176:179],v[136:139]
s_add_u32 s24,s24,s25
M v[136:139],a[52:55],a[180:183],v[136:139]
M v[140:143],a[52:55],a[188:191],v[140:143]
M v[140:143],a[48:51],a[184:187],v[140:143]
s_waitcnt vmcnt(25) lgkmcnt(0)
s_barrier
M v[144:147],a[56:59],a[128:131],v[144:147]
ds_read_b128 a[48:51],v4 offset:32768
M v[144:147],a[60:63],a[132:135],v[144:147]
ds_read_b128 a[52:55],v5 offset:32768
s_add_u32 m0,s21,65536
M v[148:151],a[60:63],a[140:143],v[148:151]
ds_read_b64_tr_b16 a[68:69],v14 offset:32768
M v[148:151],a[56:59],a[136:139],v[148:151]
buffer_load_dwordx4 v22,s[4:7],s22 offen sc1 lds
M v[152:155],a[56:59],a[144:147],v[152:155]
ds_read_b64_tr_b16 a[70:71],v14 offset:34816
M v[152:155],a[60:63],a[148:151],v[152:155]
M v[156:159],a[60:63],a[156:159],v[156:159]
ds_read_b64_tr_b16 a[76:77],v15 offset:32768
M v[156:159],a[56:59],a[152:155],v[156:159]
buffer_store_dwordx4 a[236:239],v36,s[12:15],s92 offen offset:3072 sc1
M v[160:163],a[56:59],a[160:163],v[160:163]
ds_read_b64_tr_b16 a[78:79],v15 offset:34816
M v[160:163],a[60:63],a[164:167],v[160:163]
s_add_u32 s92,s92,s95
M v[164:167],a[60:63],a[172:175],v[164:167]
ds_read_b64_tr_b16 a[84:85],v16 offset:32768
M v[164:167],a[56:59],a[168:171],v[164:167]
buffer_load_dwordx4 v23,s[4:7],s22 offen offset:1024 sc1 lds
M v[168:171],a[56:59],a[176:179],v[168:171]
M v[168:171],a[60:63],a[180:183],v[168:171]
M v[172:175],a[60:63],a[188:191],v[172:175]
M v[172:175],a[56:59],a[184:187],v[172:175]
s_waitcnt lgkmcnt(5)
M v[176:179],a[48:51],a[128:131],v[176:179]
ds_read_b128 a[56:59],v4 offset:34816
M v[176:179],a[52:55],a[132:135],v[176:179]
ds_read_b128 a[60:63],v5 offset:34816
M v[180:183],a[52:55],a[140:143],v[180:183]
ds_read_b64_tr_b16 a[86:87],v16 offset:34816
M v[180:183],a[48:51],a[136:139],v[180:183]
buffer_load_dwordx4 v24,s[4:7],s22 offen offset:2048 sc1 lds
M v[184:187],a[48:51],a[144:147],v[184:187]
ds_read_b64_tr_b16 a[92:93],v17 offset:32768
M v[184:187],a[52:55],a[148:151],v[184:187]
M v[188:191],a[52:55],a[156:159],v[188:191]
ds_read_b64_tr_b16 a[94:95],v17 offset:34816
M v[188:191],a[48:51],a[152:155],v[188:191]
buffer_store_dwordx4 a[240:243],v36,s[12:15],s92 offen offset:1024 sc1
M v[192:195],a[48:51],a[160:163],v[192:195]
ds_read_b64_tr_b16 a[100:101],v18 offset:32768
M v[192:195],a[52:55],a[164:167],v[192:195]
M v[196:199],a[52:55],a[172:175],v[196:199]
ds_read_b64_tr_b16 a[102:103],v18 offset:34816
M v[196:199],a[48:51],a[168:171],v[196:199]
buffer_load_dwordx4 v25,s[4:7],s22 offen offset:3072 sc1 lds
M v[200:203],a[48:51],a[176:179],v[200:203]
s_add_u32 s22,s22,128
M v[200:203],a[52:55],a[180:183],v[200:203]
M v[204:207],a[52:55],a[188:191],v[204:207]
M v[204:207],a[48:51],a[184:187],v[204:207]
s_waitcnt lgkmcnt(5)
M v[208:211],a[56:59],a[128:131],v[208:211]
ds_read_b128 a[48:51],v4 offset:36864
M v[208:211],a[60:63],a[132:135],v[208:211]
ds_read_b128 a[52:55],v5 offset:36864
s_add_u32 m0,s21,81920
M v[212:215],a[60:63],a[140:143],v[212:215]
ds_read_b64_tr_b16 a[108:109],v19 offset:32768
M v[212:215],a[56:59],a[136:139],v[212:215]
buffer_load_dwordx4 v26,s[8:11],s24 offen sc1 lds
M v[216:219],a[56:59],a[144:147],v[216:219]
ds_read_b64_tr_b16 a[110:111],v19 offset:34816
M v[216:219],a[60:63],a[148:151],v[216:219]
M v[220:223],a[60:63],a[156:159],v[220:223]
ds_read_b64_tr_b16 a[116:117],v20 offset:32768
M v[220:223],a[56:59],a[152:155],v[220:223]
buffer_store_dwordx4 a[244:247],v36,s[12:15],s92 offen offset:3072 sc1
M v[224:227],a[56:59],a[160:163],v[224:227]
ds_read_b64_tr_b16 a[118:119],v20 offset:34816
M v[224:227],a[60:63],a[164:167],v[224:227]
s_add_u32 s92,s92,s95
M v[228:231],a[60:63],a[172:175],v[228:231]
M v[228:231],a[56:59],a[168:171],v[228:231]
buffer_load_dwordx4 v27,s[8:11],s24 offen offset:1024 sc1 lds
M v[232:235],a[56:59],a[176:179],v[232:235]
M v[232:235],a[60:63],a[180:183],v[232:235]
M v[236:239],a[60:63],a[188:191],v[236:239]
buffer_load_dword v1,v37,s[64:67],0 offen
M v[236:239],a[56:59],a[184:187],v[236:239]
s_waitcnt lgkmcnt(4)
M v[240:243],a[48:51],a[128:131],v[240:243]
ds_read_b128 a[56:59],v4 offset:38912
M v[240:243],a[52:55],a[132:135],v[240:243]
ds_read_b128 a[60:63],v5 offset:38912
M v[244:247],a[52:55],a[140:143],v[244:247]
ds_read_b64_tr_b16 a[124:125],v21 offset:32768
M v[244:247],a[48:51],a[136:139],v[244:247]
buffer_load_dwordx4 v28,s[8:11],s24 offen offset:2048 sc1 lds
M v[248:251],a[48:51],a[144:147],v[248:251]
ds_read_b64_tr_b16 a[126:127],v21 offset:34816
M v[248:251],a[52:55],a[148:151],v[248:251]
M v[252:255],a[52:55],a[156:159],v[252:255]
M v[252:255],a[48:51],a[152:155],v[252:255]
buffer_store_dwordx4 a[248:251],v36,s[12:15],s92 offen offset:1024 sc1
M a[0:3],a[48:51],a[160:163],a[0:3]
M a[0:3],a[52:55],a[164:167],a[0:3]
M a[4:7],a[52:55],a[172:175],a[4:7]
M a[4:7],a[48:51],a[168:171],a[4:7]
buffer_load_dwordx4 v29,s[8:11],s24 offen offset:3072 sc1 lds
M a[8:11],a[48:51],a[176:179],a[8:11]
s_add_u32 s24,s24,s25
M a[8:11],a[52:55],a[180:183],a[8:11]
M a[12:15],a[52:55],a[188:191],a[12:15]
M a[12:15],a[48:51],a[184:187],a[12:15]
s_waitcnt vmcnt(25) lgkmcnt(0)
s_barrier
M a[16:19],a[56:59],a[128:131],a[16:19]
ds_read_b128 a[48:51],v2 offset:0
M a[16:19],a[60:63],a[132:135],a[16:19]
ds_read_b128 a[52:55],v3 offset:0
M a[20:23],a[60:63],a[140:143],a[20:23]
s_add_u32 m0,s21,98304
M a[20:23],a[56:59],a[136:139],a[20:23]
buffer_load_dwordx4 v22,s[4:7],s23 offen sc1 lds
M a[24:27],a[56:59],a[144:147],a[24:27]
M a[24:27],a[60:63],a[148:151],a[24:27]
M a[28:31],a[60:63],a[156:159],a[28:31]
M a[28:31],a[56:59],a[152:155],a[28:31]
buffer_store_dwordx4 a[252:255],v36,s[12:15],s92 offen offset:3072 sc1
M a[32:35],a[56:59],a[160:163],a[32:35]
M a[32:35],a[60:63],a[164:167],a[32:35]
s_add_u32 s92,s92,s95
M a[36:39],a[60:63],a[172:175],a[36:39]
M a[36:39],a[56:59],a[168:171],a[36:39]
buffer_load_dwordx4 v23,s[4:7],s23 offen offset:1024 sc1 lds
M a[40:43],a[56:59],a[176:179],a[40:43]
M a[40:43],a[60:63],a[180:183],a[40:43]
s_sub_u32 s26,s26,1
M a[44:47],a[60:63],a[188:191],a[44:47]
s_cmp_eq_u32 s26,s43
M a[44:47],a[56:59],a[184:187],a[44:47]
.p2align 6
K1_LOOP_V:
s_waitcnt lgkmcnt(0)
M v[48:51],a[48:51],a[64:67],v[48:51]
ds_read_b128 a[56:59],v2 offset:2048
M v[48:51],a[52:55],a[68:71],v[48:51]
ds_read_b128 a[60:63],v3 offset:2048
M v[52:55],a[52:55],a[76:79],v[52:55]
ds_read_b64_tr_b16 a[128:129],v6 offset:0
M v[52:55],a[48:51],a[72:75],v[52:55]
buffer_load_dwordx4 v24,s[4:7],s23 offen offset:2048 sc1 lds
M v[56:59],a[48:51],a[80:83],v[56:59]
ds_read_b64_tr_b16 a[130:131],v6 offset:2048
M v[56:59],a[52:55],a[84:87],v[56:59]
M v[60:63],a[52:55],a[92:95],v[60:63]
ds_read_b64_tr_b16 a[136:137],v7 offset:0
M v[60:63],a[48:51],a[88:91],v[60:63]
M v[64:67],a[48:51],a[96:99],v[64:67]
ds_read_b64_tr_b16 a[138:139],v7 offset:2048
M v[64:67],a[52:55],a[100:103],v[64:67]
M v[68:71],a[52:55],a[108:111],v[68:71]
ds_read_b64_tr_b16 a[144:145],v8 offset:0
M v[68:71],a[48:51],a[104:107],v[68:71]
buffer_load_dwordx4 v25,s[4:7],s23 offen offset:3072 sc1 lds
M v[72:75],a[48:51],a[112:115],v[72:75]
ds_read_b64_tr_b16 a[146:147],v8 offset:2048
M v[72:75],a[52:55],a[116:119],v[72:75]
s_add_u32 s23,s23,128
M v[76:79],a[52:55],a[124:127],v[76:79]
M v[76:79],a[48:51],a[120:123],v[76:79]
s_waitcnt lgkmcnt(6)
M v[80:83],a[56:59],a[64:67],v[80:83]
ds_read_b128 a[48:51],v2 offset:4096
M v[80:83],a[60:63],a[68:71],v[80:83]
ds_read_b128 a[52:55],v3 offset:4096
s_add_u32 m0,s21,114688
M v[84:87],a[60:63],a[76:79],v[84:87]
ds_read_b64_tr_b16 a[152:153],v9 offset:0
M v[84:87],a[56:59],a[72:75],v[84:87]
buffer_load_dwordx4 v26,s[8:11],s24 offen sc1 lds
M v[88:91],a[56:59],a[80:83],v[88:91]
ds_read_b64_tr_b16 a[154:155],v9 offset:2048
M v[88:91],a[60:63],a[84:87],v[88:91]
M v[92:95],a[60:63],a[92:95],v[92:95]
ds_read_b64_tr_b16 a[160:161],v10 offset:0
M v[92:95],a[56:59],a[88:91],v[92:95]
M v[96:99],a[56:59],a[96:99],v[96:99]
ds_read_b64_tr_b16 a[162:163],v10 offset:2048
M v[96:99],a[60:63],a[100:103],v[96:99]
M v[100:103],a[60:63],a[108:111],v[100:103]
ds_read_b64_tr_b16 a[168:169],v11 offset:0
M v[100:103],a[56:59],a[104:107],v[100:103]
buffer_load_dwordx4 v27,s[8:11],s24 offen offset:1024 sc1 lds
M v[104:107],a[56:59],a[112:115],v[104:107]
ds_read_b64_tr_b16 a[170:171],v11 offset:2048
M v[104:107],a[60:63],a[116:119],v[104:107]
M v[108:111],a[60:63],a[124:127],v[108:111]
M v[108:111],a[56:59],a[120:123],v[108:111]
s_waitcnt lgkmcnt(6)
M v[112:115],a[48:51],a[64:67],v[112:115]
ds_read_b128 a[56:59],v2 offset:6144
M v[112:115],a[52:55],a[68:71],v[112:115]
ds_read_b128 a[60:63],v3 offset:6144
M v[116:119],a[52:55],a[76:79],v[116:119]
ds_read_b64_tr_b16 a[176:177],v12 offset:0
M v[116:119],a[48:51],a[72:75],v[116:119]
buffer_load_dwordx4 v28,s[8:11],s24 offen offset:2048 sc1 lds
M v[120:123],a[48:51],a[80:83],v[120:123]
ds_read_b64_tr_b16 a[178:179],v12 offset:2048
M v[120:123],a[52:55],a[84:87],v[120:123]
M v[124:127],a[52:55],a[92:95],v[124:127]
ds_read_b64_tr_b16 a[184:185],v13 offset:0
M v[124:127],a[48:51],a[88:91],v[124:127]
M v[128:131],a[48:51],a[96:99],v[128:131]
ds_read_b64_tr_b16 a[186:187],v13 offset:2048
M v[128:131],a[52:55],a[100:103],v[128:131]
M v[132:135],a[52:55],a[108:111],v[132:135]
M v[132:135],a[48:51],a[104:107],v[132:135]
buffer_load_dwordx4 v29,s[8:11],s24 offen offset:3072 sc1 lds
M v[136:139],a[48:51],a[112:115],v[136:139]
s_add_u32 s24,s24,s25
M v[136:139],a[52:55],a[116:119],v[136:139]
s_cmp_eq_u32 s26,2
M v[140:143],a[52:55],a[124:127],v[140:143]
s_cbranch_scc1 HSUB_X_V0
HSUB_X_V0_R:
M v[140:143],a[48:51],a[120:123],v[140:143]
s_waitcnt vmcnt(17) lgkmcnt(0)
s_barrier
M v[144:147],a[56:59],a[64:67],v[144:147]
ds_read_b128 a[48:51],v2 offset:32768
M v[144:147],a[60:63],a[68:71],v[144:147]
ds_read_b128 a[52:55],v3 offset:32768
s_add_u32 m0,s21,0
M v[148:151],a[60:63],a[76:79],v[148:151]
ds_read_b64_tr_b16 a[132:133],v6 offset:32768
M v[148:151],a[56:59],a[72:75],v[148:151]
buffer_load_dwordx4 v22,s[4:7],s22 offen sc1 lds
M v[152:155],a[56:59],a[80:83],v[152:155]
ds_read_b64_tr_b16 a[134:135],v6 offset:34816
M v[152:155],a[60:63],a[84:87],v[152:155]
M v[156:159],a[60:63],a[92:95],v[156:159]
ds_read_b64_tr_b16 a[140:141],v7 offset:32768
M v[156:159],a[56:59],a[88:91],v[156:159]
M v[160:163],a[56:59],a[96:99],v[160:163]
ds_read_b64_tr_b16 a[142:143],v7 offset:34816
M v[160:163],a[60:63],a[100:103],v[160:163]
M v[164:167],a[60:63],a[108:111],v[164:167]
ds_read_b64_tr_b16 a[148:149],v8 offset:32768
M v[164:167],a[56:59],a[104:107],v[164:167]
buffer_load_dwordx4 v23,s[4:7],s22 offen offset:1024 sc1 lds
M v[168:171],a[56:59],a[112:115],v[168:171]
M v[168:171],a[60:63],a[116:119],v[168:171]
s_cmp_eq_u32 s26,s78
M v[172:175],a[60:63],a[124:127],v[172:175]
s_cbranch_scc1 HSUB_S_V0
HSUB_S_V0_R:
M v[172:175],a[56:59],a[120:123],v[172:175]
s_waitcnt lgkmcnt(5)
M v[176:179],a[48:51],a[64:67],v[176:179]
ds_read_b128 a[56:59],v2 offset:34816
M v[176:179],a[52:55],a[68:71],v[176:179]
ds_read_b128 a[60:63],v3 offset:34816
M v[180:183],a[52:55],a[76:79],v[180:183]
ds_read_b64_tr_b16 a[150:151],v8 offset:34816
M v[180:183],a[48:51],a[72:75],v[180:183]
buffer_load_dwordx4 v24,s[4:7],s22 offen offset:2048 sc1 lds
M v[184:187],a[48:51],a[80:83],v[184:187]
ds_read_b64_tr_b16 a[156:157],v9 offset:32768
M v[184:187],a[52:55],a[84:87],v[184:187]
M v[188:191],a[52:55],a[92:95],v[188:191]
ds_read_b64_tr_b16 a[158:159],v9 offset:34816
M v[188:191],a[48:51],a[88:91],v[188:191]
M v[192:195],a[48:51],a[96:99],v[192:195]
ds_read_b64_tr_b16 a[164:165],v10 offset:32768
M v[192:195],a[52:55],a[100:103],v[192:195]
M v[196:199],a[52:55],a[108:111],v[196:199]
ds_read_b64_tr_b16 a[166:167],v10 offset:34816
M v[196:199],a[48:51],a[104:107],v[196:199]
buffer_load_dwordx4 v25,s[4:7],s22 offen offset:3072 sc1 lds
M v[200:203],a[48:51],a[112:115],v[200:203]
s_add_u32 s22,s22,128
M v[200:203],a[52:55],a[116:119],v[200:203]
s_cmp_eq_u32 s26,3
M v[204:207],a[52:55],a[124:127],v[204:207]
s_cbranch_scc1 HSUB_W_V0
HSUB_W_V0_R:
M v[204:207],a[48:51],a[120:123],v[204:207]
s_waitcnt lgkmcnt(5)
M v[208:211],a[56:59],a[64:67],v[208:211]
ds_read_b128 a[48:51],v2 offset:36864
M v[208:211],a[60:63],a[68:71],v[208:211]
ds_read_b128 a[52:55],v3 offset:36864
s_add_u32 m0,s21,16384
M v[212:215],a[60:63],a[76:79],v[212:215]
ds_read_b64_tr_b16 a[172:173],v11 offset:32768
M v[212:215],a[56:59],a[72:75],v[212:215]
buffer_load_dwordx4 v26,s[8:11],s24 offen sc1 lds
M v[216:219],a[56:59],a[80:83],v[216:219]
ds_read_b64_tr_b16 a[174:175],v11 offset:34816
M v[216:219],a[60:63],a[84:87],v[216:219]
M v[220:223],a[60:63],a[92:95],v[220:223]
ds_read_b64_tr_b16 a[180:181],v12 offset:32768
M v[220:223],a[56:59],a[88:91],v[220:223]
M v[224:227],a[56:59],a[96:99],v[224:227]
ds_read_b64_tr_b16 a[182:183],v12 offset:34816
M v[224:227],a[60:63],a[100:103],v[224:227]
M v[228:231],a[60:63],a[108:111],v[228:231]
M v[228:231],a[56:59],a[104:107],v[228:231]
buffer_load_dwordx4 v27,s[8:11],s24 offen offset:1024 sc1 lds
M v[232:235],a[56:59],a[112:115],v[232:235]
M v[232:235],a[60:63],a[116:119],v[232:235]
s_cmp_lg_u32 s29,0
M v[236:239],a[60:63],a[124:127],v[236:239]
buffer_load_dword v1,v37,s[64:67],0 offen
s_cbranch_scc1 HSUB_PF_V0
HSUB_PF_V0_R:
M v[236:239],a[56:59],a[120:123],v[236:239]
s_waitcnt lgkmcnt(4)
M v[240:243],a[48:51],a[64:67],v[240:243]
ds_read_b128 a[56:59],v2 offset:38912
M v[240:243],a[52:55],a[68:71],v[240:243]
ds_read_b128 a[60:63],v3 offset:38912
M v[244:247],a[52:55],a[76:79],v[244:247]
ds_read_b64_tr_b16 a[188:189],v13 offset:32768
M v[244:247],a[48:51],a[72:75],v[244:247]
buffer_load_dwordx4 v28,s[8:11],s24 offen offset:2048 sc1 lds
M v[248:251],a[48:51],a[80:83],v[248:251]
ds_read_b64_tr_b16 a[190:191],v13 offset:34816
M v[248:251],a[52:55],a[84:87],v[248:251]
M v[252:255],a[52:55],a[92:95],v[252:255]
M v[252:255],a[48:51],a[88:91],v[252:255]
M a[0:3],a[48:51],a[96:99],a[0:3]
M a[0:3],a[52:55],a[100:103],a[0:3]
M a[4:7],a[52:55],a[108:111],a[4:7]
M a[4:7],a[48:51],a[104:107],a[4:7]
buffer_load_dwordx4 v29,s[8:11],s24 offen offset:3072 sc1 lds
M a[8:11],a[48:51],a[112:115],a[8:11]
s_add_u32 s24,s24,s25
M a[8:11],a[52:55],a[116:119],a[8:11]
M a[12:15],a[52:55],a[124:127],a[12:15]
M a[12:15],a[48:51],a[120:123],a[12:15]
s_waitcnt vmcnt(17) lgkmcnt(0)
s_barrier
M a[16:19],a[56:59],a[64:67],a[16:19]
ds_read_b128 a[48:51],v4 offset:0
M a[16:19],a[60:63],a[68:71],a[16:19]
ds_read_b128 a[52:55],v5 offset:0
M a[20:23],a[60:63],a[76:79],a[20:23]
s_add_u32 m0,s21,32768
M a[20:23],a[56:59],a[72:75],a[20:23]
buffer_load_dwordx4 v22,s[4:7],s23 offen sc1 lds
M a[24:27],a[56:59],a[80:83],a[24:27]
M a[24:27],a[60:63],a[84:87],a[24:27]
M a[28:31],a[60:63],a[92:95],a[28:31]
M a[28:31],a[56:59],a[88:91],a[28:31]
M a[32:35],a[56:59],a[96:99],a[32:35]
M a[32:35],a[60:63],a[100:103],a[32:35]
M a[36:39],a[60:63],a[108:111],a[36:39]
M a[36:39],a[56:59],a[104:107],a[36:39]
buffer_load_dwordx4 v23,s[4:7],s23 offen offset:1024 sc1 lds
M a[40:43],a[56:59],a[112:115],a[40:43]
M a[40:43],a[60:63],a[116:119],a[40:43]
s_sub_u32 s26,s26,1
M a[44:47],a[60:63],a[124:127],a[44:47]
s_cmp_eq_u32 s26,s43
M a[44:47],a[56:59],a[120:123],a[44:47]
s_cbranch_scc1 K1_XV0
K1_LOOP1_V:
s_waitcnt lgkmcnt(0)
M v[48:51],a[48:51],a[128:131],v[48:51]
ds_read_b128 a[56:59],v4 offset:2048
M v[48:51],a[52:55],a[132:135],v[48:51]
ds_read_b128 a[60:63],v5 offset:2048
M v[52:55],a[52:55],a[140:143],v[52:55]
ds_read_b64_tr_b16 a[64:65],v14 offset:0
M v[52:55],a[48:51],a[136:139],v[52:55]
buffer_load_dwordx4 v24,s[4:7],s23 offen offset:2048 sc1 lds
M v[56:59],a[48:51],a[144:147],v[56:59]
ds_read_b64_tr_b16 a[66:67],v14 offset:2048
M v[56:59],a[52:55],a[148:151],v[56:59]
M v[60:63],a[52:55],a[156:159],v[60:63]
ds_read_b64_tr_b16 a[72:73],v15 offset:0
M v[60:63],a[48:51],a[152:155],v[60:63]
M v[64:67],a[48:51],a[160:163],v[64:67]
ds_read_b64_tr_b16 a[74:75],v15 offset:2048
M v[64:67],a[52:55],a[164:167],v[64:67]
M v[68:71],a[52:55],a[172:175],v[68:71]
ds_read_b64_tr_b16 a[80:81],v16 offset:0
M v[68:71],a[48:51],a[168:171],v[68:71]
buffer_load_dwordx4 v25,s[4:7],s23 offen offset:3072 sc1 lds
M v[72:75],a[48:51],a[176:179],v[72:75]
ds_read_b64_tr_b16 a[82:83],v16 offset:2048
M v[72:75],a[52:55],a[180:183],v[72:75]
s_add_u32 s23,s23,128
M v[76:79],a[52:55],a[188:191],v[76:79]
M v[76:79],a[48:51],a[184:187],v[76:79]
s_waitcnt lgkmcnt(6)
M v[80:83],a[56:59],a[128:131],v[80:83]
ds_read_b128 a[48:51],v4 offset:4096
M v[80:83],a[60:63],a[132:135],v[80:83]
ds_read_b128 a[52:55],v5 offset:4096
s_add_u32 m0,s21,49152
M v[84:87],a[60:63],a[140:143],v[84:87]
ds_read_b64_tr_b16 a[88:89],v17 offset:0
M v[84:87],a[56:59],a[136:139],v[84:87]
buffer_load_dwordx4 v26,s[8:11],s24 offen sc1 lds
M v[88:91],a[56:59],a[144:147],v[88:91]
ds_read_b64_tr_b16 a[90:91],v17 offset:2048
M v[88:91],a[60:63],a[148:151],v[88:91]
M v[92:95],a[60:63],a[156:159],v[92:95]
ds_read_b64_tr_b16 a[96:97],v18 offset:0
M v[92:95],a[56:59],a[152:155],v[92:95]
M v[96:99],a[56:59],a[160:163],v[96:99]
ds_read_b64_tr_b16 a[98:99],v18 offset:2048
M v[96:99],a[60:63],a[164:167],v[96:99]
M v[100:103],a[60:63],a[172:175],v[100:103]
ds_read_b64_tr_b16 a[104:105],v19 offset:0
M v[100:103],a[56:59],a[168:171],v[100:103]
buffer_load_dwordx4 v27,s[8:11],s24 offen offset:1024 sc1 lds
M v[104:107],a[56:59],a[176:179],v[104:107]
ds_read_b64_tr_b16 a[106:107],v19 offset:2048
M v[104:107],a[60:63],a[180:183],v[104:107]
M v[108:111],a[60:63],a[188:191],v[108:111]
M v[108:111],a[56:59],a[184:187],v[108:111]
s_waitcnt lgkmcnt(6)
M v[112:115],a[48:51],a[128:131],v[112:115]
ds_read_b128 a[56:59],v4 offset:6144
M v[112:115],a[52:55],a[132:135],v[112:115]
ds_read_b128 a[60:63],v5 offset:6144
M v[116:119],a[52:55],a[140:143],v[116:119]
ds_read_b64_tr_b16 a[112:113],v20 offset:0
M v[116:119],a[48:51],a[136:139],v[116:119]
buffer_load_dwordx4 v28,s[8:11],s24 offen offset:2048 sc1 lds
M v[120:123],a[48:51],a[144:147],v[120:123]
ds_read_b64_tr_b16 a[114:115],v20 offset:2048
M v[120:123],a[52:55],a[148:151],v[120:123]
M v[124:127],a[52:55],a[156:159],v[124:127]
ds_read_b64_tr_b16 a[120:121],v21 offset:0
M v[124:127],a[48:51],a[152:155],v[124:127]
M v[128:131],a[48:51],a[160:163],v[128:131]
ds_read_b64_tr_b16 a[122:123],v21 offset:2048
M v[128:131],a[52:55],a[164:167],v[128:131]
M v[132:135],a[52:55],a[172:175],v[132:135]
M v[132:135],a[48:51],a[168:171],v[132:135]
buffer_load_dwordx4 v29,s[8:11],s24 offen offset:3072 sc1 lds
M v[136:139],a[48:51],a[176:179],v[136:139]
s_add_u32 s24,s24,s25
M v[136:139],a[52:55],a[180:183],v[136:139]
s_cmp_eq_u32 s26,2
M v[140:143],a[52:55],a[188:191],v[140:143]
s_cbranch_scc1 HSUB_X_V1
HSUB_X_V1_R:
M v[140:143],a[48:51],a[184:187],v[140:143]
s_waitcnt vmcnt(17) lgkmcnt(0)
s_barrier
M v[144:147],a[56:59],a[128:131],v[144:147]
ds_read_b128 a[48:51],v4 offset:32768
M v[144:147],a[60:63],a[132:135],v[144:147]
ds_read_b128 a[52:55],v5 offset:32768
s_add_u32 m0,s21,65536
M v[148:151],a[60:63],a[140:143],v[148:151]
ds_read_b64_tr_b16 a[68:69],v14 offset:32768
M v[148:151],a[56:59],a[136:139],v[148:151]
buffer_load_dwordx4 v22,s[4:7],s22 offen sc1 lds
M v[152:155],a[56:59],a[144:147],v[152:155]
ds_read_b64_tr_b16 a[70:71],v14 offset:34816
M v[152:155],a[60:63],a[148:151],v[152:155]
M v[156:159],a[60:63],a[156:159],v[156:159]
ds_read_b64_tr_b16 a[76:77],v15 offset:32768
M v[156:159],a[56:59],a[152:155],v[156:159]
M v[160:163],a[56:59],a[160:163],v[160:163]
ds_read_b64_tr_b16 a[78:79],v15 offset:34816
M v[160:163],a[60:63],a[164:167],v[160:163]
M v[164:167],a[60:63],a[172:175],v[164:167]
ds_read_b64_tr_b16 a[84:85],v16 offset:32768
M v[164:167],a[56:59],a[168:171],v[164:167]
buffer_load_dwordx4 v23,s[4:7],s22 offen offset:1024 sc1 lds
M v[168:171],a[56:59],a[176:179],v[168:171]
M v[168:171],a[60:63],a[180:183],v[168:171]
s_cmp_eq_u32 s26,s78
M v[172:175],a[60:63],a[188:191],v[172:175]
s_cbranch_scc1 HSUB_S_V1
HSUB_S_V1_R:
M v[172:175],a[56:59],a[184:187],v[172:175]
s_waitcnt lgkmcnt(5)
M v[176:179],a[48:51],a[128:131],v[176:179]
ds_read_b128 a[56:59],v4 offset:34816
M v[176:179],a[52:55],a[132:135],v[176:179]
ds_read_b128 a[60:63],v5 offset:34816
M v[180:183],a[52:55],a[140:143],v[180:183]
ds_read_b64_tr_b16 a[86:87],v16 offset:34816
M v[180:183],a[48:51],a[136:139],v[180:183]
buffer_load_dwordx4 v24,s[4:7],s22 offen offset:2048 sc1 lds
M v[184:187],a[48:51],a[144:147],v[184:187]
ds_read_b64_tr_b16 a[92:93],v17 offset:32768
M v[184:187],a[52:55],a[148:151],v[184:187]
M v[188:191],a[52:55],a[156:159],v[188:191]
ds_read_b64_tr_b16 a[94:95],v17 offset:34816
M v[188:191],a[48:51],a[152:155],v[188:191]
M v[192:195],a[48:51],a[160:163],v[192:195]
ds_read_b64_tr_b16 a[100:101],v18 offset:32768
M v[192:195],a[52:55],a[164:167],v[192:195]
M v[196:199],a[52:55],a[172:175],v[196:199]
ds_read_b64_tr_b16 a[102:103],v18 offset:34816
M v[196:199],a[48:51],a[168:171],v[196:199]
buffer_load_dwordx4 v25,s[4:7],s22 offen offset:3072 sc1 lds
M v[200:203],a[48:51],a[176:179],v[200:203]
s_add_u32 s22,s22,128
M v[200:203],a[52:55],a[180:183],v[200:203]
s_cmp_eq_u32 s26,3
M v[204:207],a[52:55],a[188:191],v[204:207]
s_cbranch_scc1 HSUB_W_V1
HSUB_W_V1_R:
M v[204:207],a[48:51],a[184:187],v[204:207]
s_waitcnt lgkmcnt(5)
M v[208:211],a[56:59],a[128:131],v[208:211]
ds_read_b128 a[48:51],v4 offset:36864
M v[208:211],a[60:63],a[132:135],v[208:211]
ds_read_b128 a[52:55],v5 offset:36864
s_add_u32 m0,s21,81920
M v[212:215],a[60:63],a[140:143],v[212:215]
ds_read_b64_tr_b16 a[108:109],v19 offset:32768
M v[212:215],a[56:59],a[136:139],v[212:215]
buffer_load_dwordx4 v26,s[8:11],s24 offen sc1 lds
M v[216:219],a[56:59],a[144:147],v[216:219]
ds_read_b64_tr_b16 a[110:111],v19 offset:34816
M v[216:219],a[60:63],a[148:151],v[216:219]
M v[220:223],a[60:63],a[156:159],v[220:223]
ds_read_b64_tr_b16 a[116:117],v20 offset:32768
M v[220:223],a[56:59],a[152:155],v[220:223]
M v[224:227],a[56:59],a[160:163],v[224:227]
ds_read_b64_tr_b16 a[118:119],v20 offset:34816
M v[224:227],a[60:63],a[164:167],v[224:227]
M v[228:231],a[60:63],a[172:175],v[228:231]
M v[228:231],a[56:59],a[168:171],v[228:231]
buffer_load_dwordx4 v27,s[8:11],s24 offen offset:1024 sc1 lds
M v[232:235],a[56:59],a[176:179],v[232:235]
M v[232:235],a[60:63],a[180:183],v[232:235]
s_cmp_lg_u32 s29,0
M v[236:239],a[60:63],a[188:191],v[236:239]
buffer_load_dword v1,v37,s[64:67],0 offen
s_cbranch_scc1 HSUB_PF_V1
HSUB_PF_V1_R:
M v[236:239],a[56:59],a[184:187],v[236:239]
s_waitcnt lgkmcnt(4)
M v[240:243],a[48:51],a[128:131],v[240:243]
ds_read_b128 a[56:59],v4 offset:38912
M v[240:243],a[52:55],a[132:135],v[240:243]
ds_read_b128 a[60:63],v5 offset:38912
M v[244:247],a[52:55],a[140:143],v[244:247]
ds_read_b64_tr_b16 a[124:125],v21 offset:32768
M v[244:247],a[48:51],a[136:139],v[244:247]
buffer_load_dwordx4 v28,s[8:11],s24 offen offset:2048 sc1 lds
M v[248:251],a[48:51],a[144:147],v[248:251]
ds_read_b64_tr_b16 a[126:127],v21 offset:34816
M v[248:251],a[52:55],a[148:151],v[248:251]
M v[252:255],a[52:55],a[156:159],v[252:255]
M v[252:255],a[48:51],a[152:155],v[252:255]
M a[0:3],a[48:51],a[160:163],a[0:3]
M a[0:3],a[52:55],a[164:167],a[0:3]
M a[4:7],a[52:55],a[172:175],a[4:7]
M a[4:7],a[48:51],a[168:171],a[4:7]
buffer_load_dwordx4 v29,s[8:11],s24 offen offset:3072 sc1 lds
M a[8:11],a[48:51],a[176:179],a[8:11]
s_add_u32 s24,s24,s25
M a[8:11],a[52:55],a[180:183],a[8:11]
M a[12:15],a[52:55],a[188:191],a[12:15]
M a[12:15],a[48:51],a[184:187],a[12:15]
s_waitcnt vmcnt(17) lgkmcnt(0)
s_barrier
M a[16:19],a[56:59],a[128:131],a[16:19]
ds_read_b128 a[48:51],v2 offset:0
M a[16:19],a[60:63],a[132:135],a[16:19]
ds_read_b128 a[52:55],v3 offset:0
M a[20:23],a[60:63],a[140:143],a[20:23]
s_add_u32 m0,s21,98304
M a[20:23],a[56:59],a[136:139],a[20:23]
buffer_load_dwordx4 v22,s[4:7],s23 offen sc1 lds
M a[24:27],a[56:59],a[144:147],a[24:27]
M a[24:27],a[60:63],a[148:151],a[24:27]
M a[28:31],a[60:63],a[156:159],a[28:31]
M a[28:31],a[56:59],a[152:155],a[28:31]
M a[32:35],a[56:59],a[160:163],a[32:35]
M a[32:35],a[60:63],a[164:167],a[32:35]
M a[36:39],a[60:63],a[172:175],a[36:39]
M a[36:39],a[56:59],a[168:171],a[36:39]
buffer_load_dwordx4 v23,s[4:7],s23 offen offset:1024 sc1 lds
M a[40:43],a[56:59],a[176:179],a[40:43]
M a[40:43],a[60:63],a[180:183],a[40:43]
s_sub_u32 s26,s26,1
M a[44:47],a[60:63],a[188:191],a[44:47]
s_cmp_eq_u32 s26,s43
M a[44:47],a[56:59],a[184:187],a[44:47]
s_cbranch_scc0 K1_LOOP_V
s_waitcnt lgkmcnt(0)
M v[48:51],a[48:51],a[64:67],v[48:51]
ds_read_b128 a[56:59],v2 offset:2048
M v[48:51],a[52:55],a[68:71],v[48:51]
ds_read_b128 a[60:63],v3 offset:2048
M v[52:55],a[52:55],a[76:79],v[52:55]
ds_read_b64_tr_b16 a[128:129],v6 offset:0
M v[52:55],a[48:51],a[72:75],v[52:55]
buffer_load_dwordx4 v24,s[4:7],s23 offen offset:2048 sc1 lds
M v[56:59],a[48:51],a[80:83],v[56:59]
ds_read_b64_tr_b16 a[130:131],v6 offset:2048
M v[56:59],a[52:55],a[84:87],v[56:59]
s_lshl_b32 s31,s35,7
s_add_u32 s31,s31,136314880
M v[60:63],a[52:55],a[92:95],v[60:63]
ds_read_b64_tr_b16 a[136:137],v7 offset:0
M v[60:63],a[48:51],a[88:91],v[60:63]
buffer_load_dword v41,v40,s[12:15],s31 offen sc1
M v[64:67],a[48:51],a[96:99],v[64:67]
ds_read_b64_tr_b16 a[138:139],v7 offset:2048
M v[64:67],a[52:55],a[100:103],v[64:67]
M v[68:71],a[52:55],a[108:111],v[68:71]
ds_read_b64_tr_b16 a[144:145],v8 offset:0
M v[68:71],a[48:51],a[104:107],v[68:71]
buffer_load_dwordx4 v25,s[4:7],s23 offen offset:3072 sc1 lds
M v[72:75],a[48:51],a[112:115],v[72:75]
ds_read_b64_tr_b16 a[146:147],v8 offset:2048
M v[72:75],a[52:55],a[116:119],v[72:75]
s_add_u32 s23,s23,128
M v[76:79],a[52:55],a[124:127],v[76:79]
M v[76:79],a[48:51],a[120:123],v[76:79]
s_waitcnt lgkmcnt(6)
M v[80:83],a[56:59],a[64:67],v[80:83]
ds_read_b128 a[48:51],v2 offset:4096
M v[80:83],a[60:63],a[68:71],v[80:83]
ds_read_b128 a[52:55],v3 offset:4096
s_add_u32 m0,s21,114688
M v[84:87],a[60:63],a[76:79],v[84:87]
ds_read_b64_tr_b16 a[152:153],v9 offset:0
M v[84:87],a[56:59],a[72:75],v[84:87]
buffer_load_dwordx4 v26,s[8:11],s24 offen sc1 lds
M v[88:91],a[56:59],a[80:83],v[88:91]
ds_read_b64_tr_b16 a[154:155],v9 offset:2048
M v[88:91],a[60:63],a[84:87],v[88:91]
M v[92:95],a[60:63],a[92:95],v[92:95]
ds_read_b64_tr_b16 a[160:161],v10 offset:0
M v[92:95],a[56:59],a[88:91],v[92:95]
M v[96:99],a[56:59],a[96:99],v[96:99]
ds_read_b64_tr_b16 a[162:163],v10 offset:2048
M v[96:99],a[60:63],a[100:103],v[96:99]
M v[100:103],a[60:63],a[108:111],v[100:103]
ds_read_b64_tr_b16 a[168:169],v11 offset:0
M v[100:103],a[56:59],a[104:107],v[100:103]
buffer_load_dwordx4 v27,s[8:11],s24 offen offset:1024 sc1 lds
M v[104:107],a[56:59],a[112:115],v[104:107]
ds_read_b64_tr_b16 a[170:171],v11 offset:2048
M v[104:107],a[60:63],a[116:119],v[104:107]
M v[108:111],a[60:63],a[124:127],v[108:111]
M v[108:111],a[56:59],a[120:123],v[108:111]
s_waitcnt lgkmcnt(6)
M v[112:115],a[48:51],a[64:67],v[112:115]
ds_read_b128 a[56:59],v2 offset:6144
M v[112:115],a[52:55],a[68:71],v[112:115]
ds_read_b128 a[60:63],v3 offset:6144
M v[116:119],a[52:55],a[76:79],v[116:119]
ds_read_b64_tr_b16 a[176:177],v12 offset:0
M v[116:119],a[48:51],a[72:75],v[116:119]
buffer_load_dwordx4 v28,s[8:11],s24 offen offset:2048 sc1 lds
M v[120:123],a[48:51],a[80:83],v[120:123]
ds_read_b64_tr_b16 a[178:179],v12 offset:2048
M v[120:123],a[52:55],a[84:87],v[120:123]
M v[124:127],a[52:55],a[92:95],v[124:127]
ds_read_b64_tr_b16 a[184:185],v13 offset:0
M v[124:127],a[48:51],a[88:91],v[124:127]
M v[128:131],a[48:51],a[96:99],v[128:131]
ds_read_b64_tr_b16 a[186:187],v13 offset:2048
M v[128:131],a[52:55],a[100:103],v[128:131]
M v[132:135],a[52:55],a[108:111],v[132:135]
M v[132:135],a[48:51],a[104:107],v[132:135]
buffer_load_dwordx4 v29,s[8:11],s24 offen offset:3072 sc1 lds
M v[136:139],a[48:51],a[112:115],v[136:139]
s_add_u32 s24,s24,s25
M v[136:139],a[52:55],a[116:119],v[136:139]
M v[140:143],a[52:55],a[124:127],v[140:143]
M v[140:143],a[48:51],a[120:123],v[140:143]
s_waitcnt vmcnt(18) lgkmcnt(0)
s_barrier
M v[144:147],a[56:59],a[64:67],v[144:147]
ds_read_b128 a[48:51],v2 offset:32768
M v[144:147],a[60:63],a[68:71],v[144:147]
ds_read_b128 a[52:55],v3 offset:32768
s_add_u32 m0,s21,0
M v[148:151],a[60:63],a[76:79],v[148:151]
ds_read_b64_tr_b16 a[132:133],v6 offset:32768
M v[148:151],a[56:59],a[72:75],v[148:151]
buffer_load_dwordx4 v22,s[4:7],s22 offen sc1 lds
M v[152:155],a[56:59],a[80:83],v[152:155]
ds_read_b64_tr_b16 a[134:135],v6 offset:34816
M v[152:155],a[60:63],a[84:87],v[152:155]
M v[156:159],a[60:63],a[92:95],v[156:159]
ds_read_b64_tr_b16 a[140:141],v7 offset:32768
M v[156:159],a[56:59],a[88:91],v[156:159]
M v[160:163],a[56:59],a[96:99],v[160:163]
ds_read_b64_tr_b16 a[142:143],v7 offset:34816
M v[160:163],a[60:63],a[100:103],v[160:163]
M v[164:167],a[60:63],a[108:111],v[164:167]
ds_read_b64_tr_b16 a[148:149],v8 offset:32768
M v[164:167],a[56:59],a[104:107],v[164:167]
buffer_load_dwordx4 v23,s[4:7],s22 offen offset:1024 sc1 lds
M v[168:171],a[56:59],a[112:115],v[168:171]
M v[168:171],a[60:63],a[116:119],v[168:171]
M v[172:175],a[60:63],a[124:127],v[172:175]
M v[172:175],a[56:59],a[120:123],v[172:175]
s_waitcnt lgkmcnt(5)
M v[176:179],a[48:51],a[64:67],v[176:179]
ds_read_b128 a[56:59],v2 offset:34816
M v[176:179],a[52:55],a[68:71],v[176:179]
ds_read_b128 a[60:63],v3 offset:34816
M v[180:183],a[52:55],a[76:79],v[180:183]
ds_read_b64_tr_b16 a[150:151],v8 offset:34816
M v[180:183],a[48:51],a[72:75],v[180:183]
buffer_load_dwordx4 v24,s[4:7],s22 offen offset:2048 sc1 lds
M v[184:187],a[48:51],a[80:83],v[184:187]
ds_read_b64_tr_b16 a[156:157],v9 offset:32768
M v[184:187],a[52:55],a[84:87],v[184:187]
M v[188:191],a[52:55],a[92:95],v[188:191]
ds_read_b64_tr_b16 a[158:159],v9 offset:34816
M v[188:191],a[48:51],a[88:91],v[188:191]
M v[192:195],a[48:51],a[96:99],v[192:195]
ds_read_b64_tr_b16 a[164:165],v10 offset:32768
M v[192:195],a[52:55],a[100:103],v[192:195]
M v[196:199],a[52:55],a[108:111],v[196:199]
ds_read_b64_tr_b16 a[166:167],v10 offset:34816
M v[196:199],a[48:51],a[104:107],v[196:199]
buffer_load_dwordx4 v25,s[4:7],s22 offen offset:3072 sc1 lds
M v[200:203],a[48:51],a[112:115],v[200:203]
s_add_u32 s22,s22,128
M v[200:203],a[52:55],a[116:119],v[200:203]
M v[204:207],a[52:55],a[124:127],v[204:207]
M v[204:207],a[48:51],a[120:123],v[204:207]
s_waitcnt lgkmcnt(5)
M v[208:211],a[56:59],a[64:67],v[208:211]
ds_read_b128 a[48:51],v2 offset:36864
M v[208:211],a[60:63],a[68:71],v[208:211]
ds_read_b128 a[52:55],v3 offset:36864
s_add_u32 m0,s21,16384
M v[212:215],a[60:63],a[76:79],v[212:215]
ds_read_b64_tr_b16 a[172:173],v11 offset:32768
M v[212:215],a[56:59],a[72:75],v[212:215]
M v[216:219],a[56:59],a[80:83],v[216:219]
ds_read_b64_tr_b16 a[174:175],v11 offset:34816
M v[216:219],a[60:63],a[84:87],v[216:219]
M v[220:223],a[60:63],a[92:95],v[220:223]
ds_read_b64_tr_b16 a[180:181],v12 offset:32768
M v[220:223],a[56:59],a[88:91],v[220:223]
M v[224:227],a[56:59],a[96:99],v[224:227]
ds_read_b64_tr_b16 a[182:183],v12 offset:34816
M v[224:227],a[60:63],a[100:103],v[224:227]
s_lshl_b32 s30,s35,20
s_lshl_b32 s31,s75,15
M v[228:231],a[60:63],a[108:111],v[228:231]
s_add_u32 s44,s30,s31
s_lshl_b32 s30,s35,7
M v[228:231],a[56:59],a[104:107],v[228:231]
s_lshl_b32 s31,s74,3
s_add_u32 s30,s30,s31
M v[232:235],a[56:59],a[112:115],v[232:235]
s_add_u32 s30,s30,s20
s_lshl_b32 s62,s30,13
M v[232:235],a[60:63],a[116:119],v[232:235]
M v[236:239],a[60:63],a[124:127],v[236:239]
buffer_load_dword v1,v37,s[64:67],0 offen
M v[236:239],a[56:59],a[120:123],v[236:239]
s_waitcnt lgkmcnt(4)
M v[240:243],a[48:51],a[64:67],v[240:243]
ds_read_b128 a[56:59],v2 offset:38912
M v[240:243],a[52:55],a[68:71],v[240:243]
ds_read_b128 a[60:63],v3 offset:38912
M v[244:247],a[52:55],a[76:79],v[244:247]
ds_read_b64_tr_b16 a[188:189],v13 offset:32768
M v[244:247],a[48:51],a[72:75],v[244:247]
M v[248:251],a[48:51],a[80:83],v[248:251]
ds_read_b64_tr_b16 a[190:191],v13 offset:34816
M v[248:251],a[52:55],a[84:87],v[248:251]
M v[252:255],a[52:55],a[92:95],v[252:255]
M v[252:255],a[48:51],a[88:91],v[252:255]
M a[0:3],a[48:51],a[96:99],a[0:3]
M a[0:3],a[52:55],a[100:103],a[0:3]
M a[4:7],a[52:55],a[108:111],a[4:7]
M a[4:7],a[48:51],a[104:107],a[4:7]
M a[8:11],a[48:51],a[112:115],a[8:11]
s_add_u32 s24,s24,s25
M a[8:11],a[52:55],a[116:119],a[8:11]
M a[12:15],a[52:55],a[124:127],a[12:15]
M a[12:15],a[48:51],a[120:123],a[12:15]
s_waitcnt vmcnt(10) lgkmcnt(0)
s_barrier
M a[16:19],a[56:59],a[64:67],a[16:19]
ds_read_b128 a[48:51],v4 offset:0
M a[16:19],a[60:63],a[68:71],a[16:19]
ds_read_b128 a[52:55],v5 offset:0
M a[20:23],a[60:63],a[76:79],a[20:23]
s_add_u32 m0,s21,32768
M a[20:23],a[56:59],a[72:75],a[20:23]
buffer_load_dwordx4 v22,s[4:7],s23 offen sc1 lds
M a[24:27],a[56:59],a[80:83],a[24:27]
M a[24:27],a[60:63],a[84:87],a[24:27]
v_cmp_ne_u32 vcc,0,v41
s_mov_b32 s33,0xf80f0f
M a[28:31],a[60:63],a[92:95],a[28:31]
M a[28:31],a[56:59],a[88:91],a[28:31]
s_and_b32 s30,vcc_lo,s33
M a[32:35],a[56:59],a[96:99],a[32:35]
s_cmp_eq_u32 s30,s33
s_cbranch_scc0 TLC_V
TLC_VR:
M a[32:35],a[60:63],a[100:103],a[32:35]
M a[36:39],a[60:63],a[108:111],a[36:39]
M a[36:39],a[56:59],a[104:107],a[36:39]
buffer_load_dwordx4 v23,s[4:7],s23 offen offset:1024 sc1 lds
M a[40:43],a[56:59],a[112:115],a[40:43]
M a[40:43],a[60:63],a[116:119],a[40:43]
s_sub_u32 s26,s26,1
s_add_u32 s31,s62,0
M a[44:47],a[60:63],a[124:127],a[44:47]
s_cmp_eq_u32 s26,s43
buffer_load_dwordx4 a[192:195],v36,s[12:15],s31 offen sc1
M a[44:47],a[56:59],a[120:123],a[44:47]
s_waitcnt lgkmcnt(0)
M v[48:51],a[48:51],a[128:131],v[48:51]
ds_read_b128 a[56:59],v4 offset:2048
M v[48:51],a[52:55],a[132:135],v[48:51]
ds_read_b128 a[60:63],v5 offset:2048
M v[52:55],a[52:55],a[140:143],v[52:55]
ds_read_b64_tr_b16 a[64:65],v14 offset:0
M v[52:55],a[48:51],a[136:139],v[52:55]
buffer_load_dwordx4 v24,s[4:7],s23 offen offset:2048 sc1 lds
M v[56:59],a[48:51],a[144:147],v[56:59]
ds_read_b64_tr_b16 a[66:67],v14 offset:2048
M v[56:59],a[52:55],a[148:151],v[56:59]
M v[60:63],a[52:55],a[156:159],v[60:63]
ds_read_b64_tr_b16 a[72:73],v15 offset:0
M v[60:63],a[48:51],a[152:155],v[60:63]
buffer_load_dwordx4 a[196:199],v36,s[12:15],s31 offen offset:1024 sc1
M v[64:67],a[48:51],a[160:163],v[64:67]
ds_read_b64_tr_b16 a[74:75],v15 offset:2048
M v[64:67],a[52:55],a[164:167],v[64:67]
M v[68:71],a[52:55],a[172:175],v[68:71]
ds_read_b64_tr_b16 a[80:81],v16 offset:0
M v[68:71],a[48:51],a[168:171],v[68:71]
buffer_load_dwordx4 v25,s[4:7],s23 offen offset:3072 sc1 lds
M v[72:75],a[48:51],a[176:179],v[72:75]
ds_read_b64_tr_b16 a[82:83],v16 offset:2048
M v[72:75],a[52:55],a[180:183],v[72:75]
s_add_u32 s23,s23,128
M v[76:79],a[52:55],a[188:191],v[76:79]
M v[76:79],a[48:51],a[184:187],v[76:79]
s_waitcnt lgkmcnt(6)
M v[80:83],a[56:59],a[128:131],v[80:83]
ds_read_b128 a[48:51],v4 offset:4096
M v[80:83],a[60:63],a[132:135],v[80:83]
ds_read_b128 a[52:55],v5 offset:4096
s_add_u32 m0,s21,49152
M v[84:87],a[60:63],a[140:143],v[84:87]
ds_read_b64_tr_b16 a[88:89],v17 offset:0
M v[84:87],a[56:59],a[136:139],v[84:87]
buffer_load_dwordx4 a[200:203],v36,s[12:15],s31 offen offset:2048 sc1
M v[88:91],a[56:59],a[144:147],v[88:91]
ds_read_b64_tr_b16 a[90:91],v17 offset:2048
M v[88:91],a[60:63],a[148:151],v[88:91]
M v[92:95],a[60:63],a[156:159],v[92:95]
ds_read_b64_tr_b16 a[96:97],v18 offset:0
M v[92:95],a[56:59],a[152:155],v[92:95]
M v[96:99],a[56:59],a[160:163],v[96:99]
ds_read_b64_tr_b16 a[98:99],v18 offset:2048
buffer_load_dwordx4 a[204:207],v36,s[12:15],s31 offen offset:3072 sc1
M v[96:99],a[60:63],a[164:167],v[96:99]
M v[100:103],a[60:63],a[172:175],v[100:103]
ds_read_b64_tr_b16 a[104:105],v19 offset:0
M v[100:103],a[56:59],a[168:171],v[100:103]
M v[104:107],a[56:59],a[176:179],v[104:107]
ds_read_b64_tr_b16 a[106:107],v19 offset:2048
s_mov_b64 s[8:9],s[12:13]
s_mov_b32 s10,138412032
s_add_u32 s31,s62,4096
M v[104:107],a[60:63],a[180:183],v[104:107]
s_mov_b32 s25,32768
v_add_u32 v26,s21,v36
buffer_load_dwordx4 a[208:211],v36,s[12:15],s31 offen sc1
M v[108:111],a[60:63],a[188:191],v[108:111]
v_add_u32 v27,s21,v36
v_add_u32 v28,s21,v36
M v[108:111],a[56:59],a[184:187],v[108:111]
v_add_u32 v29,s21,v36
s_waitcnt lgkmcnt(6)
M v[112:115],a[48:51],a[128:131],v[112:115]
ds_read_b128 a[56:59],v4 offset:6144
M v[112:115],a[52:55],a[132:135],v[112:115]
ds_read_b128 a[60:63],v5 offset:6144
M v[116:119],a[52:55],a[140:143],v[116:119]
ds_read_b64_tr_b16 a[112:113],v20 offset:0
M v[116:119],a[48:51],a[136:139],v[116:119]
buffer_load_dwordx4 a[212:215],v36,s[12:15],s31 offen offset:1024 sc1
M v[120:123],a[48:51],a[144:147],v[120:123]
ds_read_b64_tr_b16 a[114:115],v20 offset:2048
M v[120:123],a[52:55],a[148:151],v[120:123]
M v[124:127],a[52:55],a[156:159],v[124:127]
ds_read_b64_tr_b16 a[120:121],v21 offset:0
M v[124:127],a[48:51],a[152:155],v[124:127]
M v[128:131],a[48:51],a[160:163],v[128:131]
ds_read_b64_tr_b16 a[122:123],v21 offset:2048
buffer_load_dwordx4 a[216:219],v36,s[12:15],s31 offen offset:2048 sc1
M v[128:131],a[52:55],a[164:167],v[128:131]
s_mov_b64 s[4:5],s[12:13]
s_mov_b32 s6,138412032
M v[132:135],a[52:55],a[172:175],v[132:135]
v_add_u32 v22,s21,v36
v_add_u32 v23,s21,v36
M v[132:135],a[48:51],a[168:171],v[132:135]
v_add_u32 v24,s21,v36
v_add_u32 v25,s21,v36
M v[136:139],a[48:51],a[176:179],v[136:139]
s_add_u32 s24,s24,s25
M v[136:139],a[52:55],a[180:183],v[136:139]
s_add_u32 s22,s44,16777216
s_add_u32 s23,s44,16809984
M v[140:143],a[52:55],a[188:191],v[140:143]
s_add_u32 s24,s44,16793600
buffer_load_dwordx4 a[220:223],v36,s[12:15],s31 offen offset:3072 sc1
M v[140:143],a[48:51],a[184:187],v[140:143]
s_waitcnt vmcnt(17) lgkmcnt(0)
s_barrier
M v[144:147],a[56:59],a[128:131],v[144:147]
ds_read_b128 a[48:51],v4 offset:32768
M v[144:147],a[60:63],a[132:135],v[144:147]
ds_read_b128 a[52:55],v5 offset:32768
s_add_u32 m0,s21,65536
M v[148:151],a[60:63],a[140:143],v[148:151]
ds_read_b64_tr_b16 a[68:69],v14 offset:32768
M v[148:151],a[56:59],a[136:139],v[148:151]
buffer_load_dwordx4 v22,s[4:7],s22 offen sc1 lds
M v[152:155],a[56:59],a[144:147],v[152:155]
ds_read_b64_tr_b16 a[70:71],v14 offset:34816
M v[152:155],a[60:63],a[148:151],v[152:155]
M v[156:159],a[60:63],a[156:159],v[156:159]
ds_read_b64_tr_b16 a[76:77],v15 offset:32768
s_add_u32 s31,s62,32768
M v[156:159],a[56:59],a[152:155],v[156:159]
buffer_load_dwordx4 a[224:227],v36,s[12:15],s31 offen sc1
M v[160:163],a[56:59],a[160:163],v[160:163]
ds_read_b64_tr_b16 a[78:79],v15 offset:34816
M v[160:163],a[60:63],a[164:167],v[160:163]
M v[164:167],a[60:63],a[172:175],v[164:167]
ds_read_b64_tr_b16 a[84:85],v16 offset:32768
M v[164:167],a[56:59],a[168:171],v[164:167]
buffer_load_dwordx4 v23,s[4:7],s22 offen offset:1024 sc1 lds
M v[168:171],a[56:59],a[176:179],v[168:171]
M v[168:171],a[60:63],a[180:183],v[168:171]
M v[172:175],a[60:63],a[188:191],v[172:175]
M v[172:175],a[56:59],a[184:187],v[172:175]
s_waitcnt lgkmcnt(5)
M v[176:179],a[48:51],a[128:131],v[176:179]
ds_read_b128 a[56:59],v4 offset:34816
M v[176:179],a[52:55],a[132:135],v[176:179]
ds_read_b128 a[60:63],v5 offset:34816
M v[180:183],a[52:55],a[140:143],v[180:183]
ds_read_b64_tr_b16 a[86:87],v16 offset:34816
M v[180:183],a[48:51],a[136:139],v[180:183]
buffer_load_dwordx4 v24,s[4:7],s22 offen offset:2048 sc1 lds
M v[184:187],a[48:51],a[144:147],v[184:187]
ds_read_b64_tr_b16 a[92:93],v17 offset:32768
M v[184:187],a[52:55],a[148:151],v[184:187]
M v[188:191],a[52:55],a[156:159],v[188:191]
ds_read_b64_tr_b16 a[94:95],v17 offset:34816
M v[188:191],a[48:51],a[152:155],v[188:191]
buffer_load_dwordx4 a[228:231],v36,s[12:15],s31 offen offset:1024 sc1
M v[192:195],a[48:51],a[160:163],v[192:195]
ds_read_b64_tr_b16 a[100:101],v18 offset:32768
M v[192:195],a[52:55],a[164:167],v[192:195]
M v[196:199],a[52:55],a[172:175],v[196:199]
ds_read_b64_tr_b16 a[102:103],v18 offset:34816
M v[196:199],a[48:51],a[168:171],v[196:199]
buffer_load_dwordx4 v25,s[4:7],s22 offen offset:3072 sc1 lds
M v[200:203],a[48:51],a[176:179],v[200:203]
s_add_u32 s22,s22,128
M v[200:203],a[52:55],a[180:183],v[200:203]
M v[204:207],a[52:55],a[188:191],v[204:207]
M v[204:207],a[48:51],a[184:187],v[204:207]
s_waitcnt lgkmcnt(5)
M v[208:211],a[56:59],a[128:131],v[208:211]
ds_read_b128 a[48:51],v4 offset:36864
M v[208:211],a[60:63],a[132:135],v[208:211]
ds_read_b128 a[52:55],v5 offset:36864
s_add_u32 m0,s21,81920
M v[212:215],a[60:63],a[140:143],v[212:215]
ds_read_b64_tr_b16 a[108:109],v19 offset:32768
M v[212:215],a[56:59],a[136:139],v[212:215]
buffer_load_dwordx4 v26,s[8:11],s24 offen sc1 lds
M v[216:219],a[56:59],a[144:147],v[216:219]
ds_read_b64_tr_b16 a[110:111],v19 offset:34816
M v[216:219],a[60:63],a[148:151],v[216:219]
M v[220:223],a[60:63],a[156:159],v[220:223]
ds_read_b64_tr_b16 a[116:117],v20 offset:32768
M v[220:223],a[56:59],a[152:155],v[220:223]
buffer_load_dwordx4 a[232:235],v36,s[12:15],s31 offen offset:2048 sc1
M v[224:227],a[56:59],a[160:163],v[224:227]
ds_read_b64_tr_b16 a[118:119],v20 offset:34816
M v[224:227],a[60:63],a[164:167],v[224:227]
M v[228:231],a[60:63],a[172:175],v[228:231]
M v[228:231],a[56:59],a[168:171],v[228:231]
buffer_load_dwordx4 v27,s[8:11],s24 offen offset:1024 sc1 lds
M v[232:235],a[56:59],a[176:179],v[232:235]
M v[232:235],a[60:63],a[180:183],v[232:235]
M v[236:239],a[60:63],a[188:191],v[236:239]
buffer_load_dword v1,v37,s[64:67],0 offen
M v[236:239],a[56:59],a[184:187],v[236:239]
s_waitcnt lgkmcnt(4)
M v[240:243],a[48:51],a[128:131],v[240:243]
ds_read_b128 a[56:59],v4 offset:38912
M v[240:243],a[52:55],a[132:135],v[240:243]
ds_read_b128 a[60:63],v5 offset:38912
M v[244:247],a[52:55],a[140:143],v[244:247]
ds_read_b64_tr_b16 a[124:125],v21 offset:32768
M v[244:247],a[48:51],a[136:139],v[244:247]
buffer_load_dwordx4 v28,s[8:11],s24 offen offset:2048 sc1 lds
M v[248:251],a[48:51],a[144:147],v[248:251]
ds_read_b64_tr_b16 a[126:127],v21 offset:34816
M v[248:251],a[52:55],a[148:151],v[248:251]
M v[252:255],a[52:55],a[156:159],v[252:255]
M v[252:255],a[48:51],a[152:155],v[252:255]
buffer_load_dwordx4 a[236:239],v36,s[12:15],s31 offen offset:3072 sc1
M a[0:3],a[48:51],a[160:163],a[0:3]
M a[0:3],a[52:55],a[164:167],a[0:3]
M a[4:7],a[52:55],a[172:175],a[4:7]
M a[4:7],a[48:51],a[168:171],a[4:7]
buffer_load_dwordx4 v29,s[8:11],s24 offen offset:3072 sc1 lds
M a[8:11],a[48:51],a[176:179],a[8:11]
s_add_u32 s24,s24,s25
M a[8:11],a[52:55],a[180:183],a[8:11]
M a[12:15],a[52:55],a[188:191],a[12:15]
M a[12:15],a[48:51],a[184:187],a[12:15]
s_waitcnt vmcnt(26) lgkmcnt(0)
s_barrier
M a[16:19],a[56:59],a[128:131],a[16:19]
ds_read_b128 a[48:51],v2 offset:0
M a[16:19],a[60:63],a[132:135],a[16:19]
ds_read_b128 a[52:55],v3 offset:0
M a[20:23],a[60:63],a[140:143],a[20:23]
s_add_u32 m0,s21,98304
M a[20:23],a[56:59],a[136:139],a[20:23]
buffer_load_dwordx4 v22,s[4:7],s23 offen sc1 lds
M a[24:27],a[56:59],a[144:147],a[24:27]
M a[24:27],a[60:63],a[148:151],a[24:27]
M a[28:31],a[60:63],a[156:159],a[28:31]
s_add_u32 s31,s62,36864
M a[28:31],a[56:59],a[152:155],a[28:31]
buffer_load_dwordx4 a[240:243],v36,s[12:15],s31 offen sc1
M a[32:35],a[56:59],a[160:163],a[32:35]
M a[32:35],a[60:63],a[164:167],a[32:35]
M a[36:39],a[60:63],a[172:175],a[36:39]
M a[36:39],a[56:59],a[168:171],a[36:39]
buffer_load_dwordx4 v23,s[4:7],s23 offen offset:1024 sc1 lds
M a[40:43],a[56:59],a[176:179],a[40:43]
M a[40:43],a[60:63],a[180:183],a[40:43]
s_sub_u32 s26,s26,1
M a[44:47],a[60:63],a[188:191],a[44:47]
s_cmp_eq_u32 s26,s43
M a[44:47],a[56:59],a[184:187],a[44:47]
s_waitcnt lgkmcnt(0)
M v[48:51],a[48:51],a[64:67],v[48:51]
ds_read_b128 a[56:59],v2 offset:2048
M v[48:51],a[52:55],a[68:71],v[48:51]
ds_read_b128 a[60:63],v3 offset:2048
M v[52:55],a[52:55],a[76:79],v[52:55]
M v[52:55],a[48:51],a[72:75],v[52:55]
buffer_load_dwordx4 v24,s[4:7],s23 offen offset:2048 sc1 lds
M v[56:59],a[48:51],a[80:83],v[56:59]
M v[56:59],a[52:55],a[84:87],v[56:59]
M v[60:63],a[52:55],a[92:95],v[60:63]
M v[60:63],a[48:51],a[88:91],v[60:63]
buffer_load_dwordx4 a[244:247],v36,s[12:15],s31 offen offset:1024 sc1
M v[64:67],a[48:51],a[96:99],v[64:67]
M v[64:67],a[52:55],a[100:103],v[64:67]
M v[68:71],a[52:55],a[108:111],v[68:71]
M v[68:71],a[48:51],a[104:107],v[68:71]
buffer_load_dwordx4 v25,s[4:7],s23 offen offset:3072 sc1 lds
M v[72:75],a[48:51],a[112:115],v[72:75]
M v[72:75],a[52:55],a[116:119],v[72:75]
s_add_u32 s23,s23,128
M v[76:79],a[52:55],a[124:127],v[76:79]
M v[76:79],a[48:51],a[120:123],v[76:79]
s_waitcnt lgkmcnt(0)
M v[80:83],a[56:59],a[64:67],v[80:83]
ds_read_b128 a[48:51],v2 offset:4096
M v[80:83],a[60:63],a[68:71],v[80:83]
ds_read_b128 a[52:55],v3 offset:4096
s_add_u32 m0,s21,114688
M v[84:87],a[60:63],a[76:79],v[84:87]
M v[84:87],a[56:59],a[72:75],v[84:87]
buffer_load_dwordx4 v26,s[8:11],s24 offen sc1 lds
M v[88:91],a[56:59],a[80:83],v[88:91]
M v[88:91],a[60:63],a[84:87],v[88:91]
M v[92:95],a[60:63],a[92:95],v[92:95]
M v[92:95],a[56:59],a[88:91],v[92:95]
buffer_load_dwordx4 a[248:251],v36,s[12:15],s31 offen offset:2048 sc1
M v[96:99],a[56:59],a[96:99],v[96:99]
M v[96:99],a[60:63],a[100:103],v[96:99]
M v[100:103],a[60:63],a[108:111],v[100:103]
M v[100:103],a[56:59],a[104:107],v[100:103]
buffer_load_dwordx4 v27,s[8:11],s24 offen offset:1024 sc1 lds
M v[104:107],a[56:59],a[112:115],v[104:107]
M v[104:107],a[60:63],a[116:119],v[104:107]
M v[108:111],a[60:63],a[124:127],v[108:111]
M v[108:111],a[56:59],a[120:123],v[108:111]
s_waitcnt lgkmcnt(0)
M v[112:115],a[48:51],a[64:67],v[112:115]
ds_read_b128 a[56:59],v2 offset:6144
s_mov_b32 s84,s54
CV v48,v48,v49
M v[112:115],a[52:55],a[68:71],v[112:115]
ds_read_b128 a[60:63],v3 offset:6144
CV v49,v50,v51
M v[116:119],a[52:55],a[76:79],v[116:119]
CV v50,v80,v81
CV v51,v82,v83
M v[116:119],a[48:51],a[72:75],v[116:119]
buffer_load_dwordx4 v28,s[8:11],s24 offen offset:2048 sc1 lds
M v[120:123],a[48:51],a[80:83],v[120:123]
CV v52,v52,v53
CV v53,v54,v55
M v[120:123],a[52:55],a[84:87],v[120:123]
CV v54,v84,v85
CV v55,v86,v87
M v[124:127],a[52:55],a[92:95],v[124:127]
M v[124:127],a[48:51],a[88:91],v[124:127]
buffer_load_dwordx4 a[252:255],v36,s[12:15],s31 offen offset:3072 sc1
M v[128:131],a[48:51],a[96:99],v[128:131]
CV v56,v56,v57
CV v57,v58,v59
M v[128:131],a[52:55],a[100:103],v[128:131]
CV v58,v88,v89
CV v59,v90,v91
M v[132:135],a[52:55],a[108:111],v[132:135]
M v[132:135],a[48:51],a[104:107],v[132:135]
buffer_load_dwordx4 v29,s[8:11],s24 offen offset:3072 sc1 lds
M v[136:139],a[48:51],a[112:115],v[136:139]
s_add_u32 s24,s24,s25
CV v60,v60,v61
CV v61,v62,v63
M v[136:139],a[52:55],a[116:119],v[136:139]
s_add_u32 s22,s44,33554432
CV v62,v92,v93
CV v63,v94,v95
M v[140:143],a[52:55],a[124:127],v[140:143]
s_add_u32 s24,s44,33570816
buffer_store_dwordx4 v[60:63],v36,s[12:15],s54 offen offset:3072 sc1
M v[140:143],a[48:51],a[120:123],v[140:143]
s_add_u32 s54,s54,4096
s_waitcnt vmcnt(32) lgkmcnt(0)
s_barrier
M v[144:147],a[56:59],a[64:67],v[144:147]
ds_read_b128 a[48:51],v2 offset:32768
s_mov_b32 s85,s54
CV v60,v64,v65
M v[144:147],a[60:63],a[68:71],v[144:147]
ds_read_b128 a[52:55],v3 offset:32768
s_add_u32 m0,s21,0
CV v61,v66,v67
M v[148:151],a[60:63],a[76:79],v[148:151]
CV v62,v96,v97
CV v63,v98,v99
M v[148:151],a[56:59],a[72:75],v[148:151]
buffer_load_dwordx4 v22,s[4:7],s22 offen sc1 lds
M v[152:155],a[56:59],a[80:83],v[152:155]
CV v64,v68,v69
M v[152:155],a[60:63],a[84:87],v[152:155]
CV v65,v70,v71
M v[156:159],a[60:63],a[92:95],v[156:159]
CV v66,v100,v101
M v[156:159],a[56:59],a[88:91],v[156:159]
CV v67,v102,v103
M v[160:163],a[56:59],a[96:99],v[160:163]
CV v68,v72,v73
CV v69,v74,v75
M v[160:163],a[60:63],a[100:103],v[160:163]
CV v70,v104,v105
CV v71,v106,v107
M v[164:167],a[60:63],a[108:111],v[164:167]
M v[164:167],a[56:59],a[104:107],v[164:167]
buffer_load_dwordx4 v23,s[4:7],s22 offen offset:1024 sc1 lds
M v[168:171],a[56:59],a[112:115],v[168:171]
CV v76,v76,v77
CV v77,v78,v79
M v[168:171],a[60:63],a[116:119],v[168:171]
CV v78,v108,v109
CV v79,v110,v111
M v[172:175],a[60:63],a[124:127],v[172:175]
buffer_store_dwordx4 v[76:79],v36,s[12:15],s54 offen offset:3072 sc1
M v[172:175],a[56:59],a[120:123],v[172:175]
s_add_u32 s54,s54,s55
s_waitcnt lgkmcnt(0)
M v[176:179],a[48:51],a[64:67],v[176:179]
ds_read_b128 a[56:59],v2 offset:34816
s_mov_b32 s86,s54
CV v72,v112,v113
M v[176:179],a[52:55],a[68:71],v[176:179]
ds_read_b128 a[60:63],v3 offset:34816
CV v73,v114,v115
M v[180:183],a[52:55],a[76:79],v[180:183]
CV v74,v144,v145
CV v75,v146,v147
M v[180:183],a[48:51],a[72:75],v[180:183]
buffer_load_dwordx4 v24,s[4:7],s22 offen offset:2048 sc1 lds
M v[184:187],a[48:51],a[80:83],v[184:187]
CV v76,v116,v117
M v[184:187],a[52:55],a[84:87],v[184:187]
CV v77,v118,v119
M v[188:191],a[52:55],a[92:95],v[188:191]
CV v78,v148,v149
M v[188:191],a[48:51],a[88:91],v[188:191]
CV v79,v150,v151
M v[192:195],a[48:51],a[96:99],v[192:195]
CV v80,v120,v121
CV v81,v122,v123
M v[192:195],a[52:55],a[100:103],v[192:195]
CV v82,v152,v153
CV v83,v154,v155
M v[196:199],a[52:55],a[108:111],v[196:199]
M v[196:199],a[48:51],a[104:107],v[196:199]
buffer_load_dwordx4 v25,s[4:7],s22 offen offset:3072 sc1 lds
M v[200:203],a[48:51],a[112:115],v[200:203]
s_add_u32 s22,s22,128
CV v124,v124,v125
CV v125,v126,v127
M v[200:203],a[52:55],a[116:119],v[200:203]
CV v126,v156,v157
CV v127,v158,v159
M v[204:207],a[52:55],a[124:127],v[204:207]
buffer_store_dwordx4 v[124:127],v36,s[12:15],s54 offen offset:3072 sc1
M v[204:207],a[48:51],a[120:123],v[204:207]
s_add_u32 s54,s54,4096
s_waitcnt lgkmcnt(0)
M v[208:211],a[56:59],a[64:67],v[208:211]
ds_read_b128 a[48:51],v2 offset:36864
s_mov_b32 s87,s54
CV v84,v128,v129
M v[208:211],a[60:63],a[68:71],v[208:211]
ds_read_b128 a[52:55],v3 offset:36864
s_add_u32 m0,s21,16384
CV v85,v130,v131
M v[212:215],a[60:63],a[76:79],v[212:215]
CV v86,v160,v161
CV v87,v162,v163
M v[212:215],a[56:59],a[72:75],v[212:215]
buffer_load_dwordx4 v26,s[8:11],s24 offen sc1 lds
M v[216:219],a[56:59],a[80:83],v[216:219]
CV v88,v132,v133
M v[216:219],a[60:63],a[84:87],v[216:219]
CV v89,v134,v135
M v[220:223],a[60:63],a[92:95],v[220:223]
CV v90,v164,v165
M v[220:223],a[56:59],a[88:91],v[220:223]
CV v91,v166,v167
M v[224:227],a[56:59],a[96:99],v[224:227]
CV v92,v136,v137
CV v93,v138,v139
M v[224:227],a[60:63],a[100:103],v[224:227]
CV v94,v168,v169
CV v95,v170,v171
M v[228:231],a[60:63],a[108:111],v[228:231]
M v[228:231],a[56:59],a[104:107],v[228:231]
buffer_load_dwordx4 v27,s[8:11],s24 offen offset:1024 sc1 lds
M v[232:235],a[56:59],a[112:115],v[232:235]
CV v140,v140,v141
CV v141,v142,v143
CV v142,v172,v173
M v[232:235],a[60:63],a[116:119],v[232:235]
CV v143,v174,v175
buffer_store_dwordx4 v[140:143],v36,s[12:15],s54 offen offset:3072 sc1
M v[236:239],a[60:63],a[124:127],v[236:239]
buffer_load_dword v1,v37,s[64:67],0 offen
M v[236:239],a[56:59],a[120:123],v[236:239]
s_add_u32 s54,s54,s55
s_waitcnt lgkmcnt(0)
M v[240:243],a[48:51],a[64:67],v[240:243]
ds_read_b128 a[56:59],v2 offset:38912
s_mov_b32 s88,s54
CV v96,v176,v177
M v[240:243],a[52:55],a[68:71],v[240:243]
ds_read_b128 a[60:63],v3 offset:38912
CV v97,v178,v179
M v[244:247],a[52:55],a[76:79],v[244:247]
CV v98,v208,v209
CV v99,v210,v211
M v[244:247],a[48:51],a[72:75],v[244:247]
buffer_load_dwordx4 v28,s[8:11],s24 offen offset:2048 sc1 lds
M v[248:251],a[48:51],a[80:83],v[248:251]
CV v100,v180,v181
M v[248:251],a[52:55],a[84:87],v[248:251]
CV v101,v182,v183
M v[252:255],a[52:55],a[92:95],v[252:255]
CV v102,v212,v213
M v[252:255],a[48:51],a[88:91],v[252:255]
CV v103,v214,v215
M a[0:3],a[48:51],a[96:99],a[0:3]
CV v104,v184,v185
CV v105,v186,v187
M a[0:3],a[52:55],a[100:103],a[0:3]
CV v106,v216,v217
CV v107,v218,v219
M a[4:7],a[52:55],a[108:111],a[4:7]
M a[4:7],a[48:51],a[104:107],a[4:7]
buffer_load_dwordx4 v29,s[8:11],s24 offen offset:3072 sc1 lds
M a[8:11],a[48:51],a[112:115],a[8:11]
s_add_u32 s24,s24,s25
CV v188,v188,v189
CV v189,v190,v191
M a[8:11],a[52:55],a[116:119],a[8:11]
CV v190,v220,v221
CV v191,v222,v223
M a[12:15],a[52:55],a[124:127],a[12:15]
buffer_store_dwordx4 v[188:191],v36,s[12:15],s54 offen offset:3072 sc1
M a[12:15],a[48:51],a[120:123],a[12:15]
s_add_u32 s54,s54,4096
s_waitcnt lgkmcnt(0)
s_barrier
M a[16:19],a[56:59],a[64:67],a[16:19]
s_mov_b32 s89,s54
CV v192,v192,v193
CV v193,v194,v195
M a[16:19],a[60:63],a[68:71],a[16:19]
CV v194,v224,v225
CV v195,v226,v227
M a[20:23],a[60:63],a[76:79],a[20:23]
s_add_u32 m0,s21,32768
AW a128,v192
AW a129,v193
M a[20:23],a[56:59],a[72:75],a[20:23]
AW a130,v194
AW a131,v195
M a[24:27],a[56:59],a[80:83],a[24:27]
CV v196,v196,v197
CV v197,v198,v199
M a[24:27],a[60:63],a[84:87],a[24:27]
CV v198,v228,v229
CV v199,v230,v231
M a[28:31],a[60:63],a[92:95],a[28:31]
AW a132,v196
AW a133,v197
M a[28:31],a[56:59],a[88:91],a[28:31]
AW a134,v198
AW a135,v199
M a[32:35],a[56:59],a[96:99],a[32:35]
CV v200,v200,v201
CV v201,v202,v203
M a[32:35],a[60:63],a[100:103],a[32:35]
CV v202,v232,v233
CV v203,v234,v235
M a[36:39],a[60:63],a[108:111],a[36:39]
AW a136,v200
AW a137,v201
M a[36:39],a[56:59],a[104:107],a[36:39]
AW a138,v202
AW a139,v203
M a[40:43],a[56:59],a[112:115],a[40:43]
CV v204,v204,v205
CV v205,v206,v207
CV v206,v236,v237
M a[40:43],a[60:63],a[116:119],a[40:43]
s_sub_u32 s26,s26,1
CV v207,v238,v239
M a[44:47],a[60:63],a[124:127],a[44:47]
s_cmp_eq_u32 s26,s43
buffer_store_dwordx4 v[204:207],v36,s[12:15],s54 offen offset:3072 sc1
M a[44:47],a[56:59],a[120:123],a[44:47]
s_add_u32 s54,s54,s55
s_nop 7
s_mov_b32 s90,s54
CV v240,v240,v241
CV v241,v242,v243
AR v42,a16
AR v43,a17
AR v44,a18
AR v45,a19
CV v242,v42,v43
CV v243,v44,v45
AW a140,v240
AW a141,v241
AW a142,v242
AW a143,v243
CV v244,v244,v245
CV v245,v246,v247
AR v42,a20
AR v43,a21
AR v44,a22
AR v45,a23
CV v246,v42,v43
CV v247,v44,v45
AW a144,v244
AW a145,v245
AW a146,v246
AW a147,v247
CV v248,v248,v249
CV v249,v250,v251
AR v42,a24
AR v43,a25
AR v44,a26
AR v45,a27
CV v250,v42,v43
CV v251,v44,v45
AW a148,v248
AW a149,v249
AW a150,v250
AW a151,v251
CV v252,v252,v253
CV v253,v254,v255
AR v42,a28
AR v43,a29
AR v44,a30
AR v45,a31
CV v254,v42,v43
CV v255,v44,v45
buffer_store_dwordx4 v[252:255],v36,s[12:15],s54 offen offset:3072 sc1
s_add_u32 s54,s54,4096
s_mov_b32 s91,s54
s_nop 0
AR v42,a0
AR v43,a1
AR v44,a2
AR v45,a3
CV v30,v42,v43
CV v31,v44,v45
AR v42,a32
AR v43,a33
AR v44,a34
AR v45,a35
CV v32,v42,v43
CV v33,v44,v45
AW a152,v30
AW a153,v31
AW a154,v32
AW a155,v33
AR v42,a4
AR v43,a5
AR v44,a6
AR v45,a7
CV v30,v42,v43
CV v31,v44,v45
AR v42,a36
AR v43,a37
AR v44,a38
AR v45,a39
CV v32,v42,v43
CV v33,v44,v45
AW a156,v30
AW a157,v31
AW a158,v32
AW a159,v33
AR v42,a8
AR v43,a9
AR v44,a10
AR v45,a11
CV v30,v42,v43
CV v31,v44,v45
AR v42,a40
AR v43,a41
AR v44,a42
AR v45,a43
CV v32,v42,v43
CV v33,v44,v45
AW a160,v30
AW a161,v31
AW a162,v32
AW a163,v33
AR v42,a12
AR v43,a13
AR v44,a14
AR v45,a15
CV v30,v42,v43
CV v31,v44,v45
AR v42,a44
AR v43,a45
AR v44,a46
AR v45,a47
CV v32,v42,v43
CV v33,v44,v45
buffer_store_dwordx4 v[30:33],v36,s[12:15],s54 offen offset:3072 sc1
K2_FASTX:
s_lshl_b32 s21,s20,13
v_mov_b32 v28,v36
v_add_u32 v4,s21,v36
v_add_u32 v5,4096,v4
s_lshl_b32 s30,s35,20
s_add_u32 s31,s30,16777216
s_add_u32 s32,s30,33554432
s_add_u32 s4,s40,s31
s_addc_u32 s5,s41,0
s_add_u32 s8,s40,s32
s_addc_u32 s9,s41,0
s_add_u32 s30,s76,8
s_lshl_b32 s43,s30,15
s_lshl_b32 s31,s74,16
s_add_u32 s31,s31,65536
s_lshr_b32 s32,s31,15
s_sub_u32 s32,s32,s76
s_cmp_eq_u32 s73,0
s_cselect_b32 s6,s31,s43
s_cselect_b32 s10,s31,s43
s_cselect_b32 s42,262144,-1
s_cselect_b32 s24,s32,s76
s_cselect_b32 s25,3,0
s_cselect_b32 s36,2,1
s_cselect_b32 s26,2,1
s_lshl_b32 s22,s75,15
s_mov_b32 s23,s22
s_lshr_b32 s30,s31,15
s_cmp_eq_u32 s73,2
s_cselect_b32 s6,s31,s6
s_cselect_b32 s10,s31,s10
s_cselect_b32 s24,s30,s24
s_cselect_b32 s25,3,s25
s_cselect_b32 s36,0,s36
s_cselect_b32 s26,2,s26
s_add_u32 s22,s22,65536
s_add_u32 s23,s23,32768
s_add_u32 m0,s21,32768
s_nop 0
buffer_load_dwordx4 v4,s[4:7],s22 offen sc1 lds
buffer_load_dwordx4 v4,s[4:7],s22 offen offset:1024 sc1 lds
s_load_dwordx2 s[16:17],s[0:1],64
v_mov_b32 v45,v37
v_mov_b32_e64 v2,v28
v_add_u32 v3,0x10000,v28
v_and_b32 v30,15,v35
v_lshrrev_b32 v31,4,v35
v_lshlrev_b32 v31,2,v31
v_sub_u32 v7,v30,v31
s_lshl_b32 s30,s20,4
v_add_u32 v7,s30,v7
s_lshl_b32 s30,s35,3
s_add_u32 s30,s30,s72
s_lshl_b32 s30,s30,2
s_add_u32 s30,s30,s20
s_mul_i32 s37,s30,17408
s_add_u32 s37,s37,83886080
s_mov_b32 s80,s12
s_mov_b32 s81,s13
s_mov_b32 s83,0x20000
s_cmp_eq_u32 s73,0
s_cselect_b32 s82,138412032,0
s_add_u32 s30,s72,24
s_lshl_b32 s28,1,s30
s_cmp_eq_u32 s73,0
s_cselect_b32 s28,s28,0
s_sub_u32 s30,7,s72
s_lshr_b32 s30,s30,1
s_add_u32 s30,s30,16
s_lshl_b32 s29,1,s30
s_cmp_eq_u32 s73,1
s_cselect_b32 s29,s29,0
s_sub_u32 s30,s6,1
s_lshr_b32 s30,s30,17
s_add_u32 s30,s30,1
s_bfm_b32 s30,s30,0
s_mul_i32 s30,s30,0x101
s_or_b32 s29,s29,s30
s_mul_i32 s61,s20,57344
s_add_u32 s56,s61,28672
v_lshrrev_b32_e64 v30,3,v35
v_mul_u32_u24 v30,896,v30
v_lshrrev_b32 v31,4,v35
v_lshlrev_b32 v31,1,v31
v_and_b32 v32,7,v35
v_xor_b32 v31,v31,v32
v_lshl_add_u32 v112,v31,4,v30
v_add_u32 v113,6144,v112
v_add_u32 v114,12288,v112
v_add_u32 v115,18432,v112
v_lshrrev_b32 v30,2,v35
v_lshrrev_b32 v31,1,v30
v_and_b32 v31,3,v31
v_and_b32 v32,3,v35
v_lshlrev_b32_e64 v32,3,v32
v_lshl_add_u32 v30,v30,7,v32
v_xor_b32_e64 v32,0,v31
v_lshl_add_u32 v116,v32,5,v30
v_add_u32 v120,0x10000,v116
v_add_u32 v124,0x20000,v116
v_xor_b32_e64 v32,1,v31
v_lshl_add_u32 v117,v32,5,v30
v_add_u32 v121,0x10000,v117
v_add_u32 v125,0x20000,v117
v_xor_b32_e64 v32,2,v31
v_lshl_add_u32 v118,v32,5,v30
v_add_u32 v122,0x10000,v118
v_add_u32 v126,0x20000,v118
v_xor_b32_e64 v32,3,v31
v_lshl_add_u32 v119,v32,5,v30
v_add_u32 v123,0x10000,v119
v_add_u32 v44,0x20000,v119
s_mov_b32 s30,0x40000000
s_cmp_eq_u32 s27,15
s_cselect_b32 s30,0xfffe0000,s30
v_lshlrev_b32 v42,7,v0
v_add_u32 v42,s30,v42
s_mul_i32 s30,s35,229376
s_waitcnt lgkmcnt(0)
s_add_u32 s16,s16,s30
s_addc_u32 s17,s17,0
s_mov_b32 s18,229376
s_mov_b32 s19,0x20000
v_add_u32 v29,65536,v28
s_mov_b32 s38,4
s_mov_b32 s60,0
s_sub_u32 s39,s24,3
s_waitcnt vmcnt(17)
K2_SEG0:
s_cmp_eq_u32 s20,0
s_cselect_b32 s39,s39,0
s_cselect_b32 s60,s60,9
K2_SEG:
s_mov_b32 s48,s12
s_mov_b32 s49,s13
s_mov_b32 s51,0x20000
s_cmp_eq_u32 s38,4
s_cselect_b32 s50,138412032,0
s_barrier
ds_read_b128 v[192:195],v29 offset:0
ds_read_b128 v[196:199],v29 offset:1024
ds_read_b128 v[200:203],v29 offset:2048
ds_read_b128 v[204:207],v29 offset:3072
ds_read_b128 v[208:211],v29 offset:4096
ds_read_b128 v[212:215],v29 offset:5120
ds_read_b128 v[216:219],v29 offset:6144
ds_read_b128 v[220:223],v29 offset:7168
s_waitcnt lgkmcnt(4)
M v[128:131],v[192:195],a[192:195],0
ds_read_b128 v[224:227],v29 offset:8192
ds_read_b128 v[228:231],v29 offset:9216
M v[128:131],v[196:199],a[196:199],v[128:131]
ds_read_b128 v[232:235],v29 offset:10240
ds_read_b128 v[236:239],v29 offset:11264
M v[128:131],v[200:203],a[200:203],v[128:131]
buffer_store_dwordx4 v[48:51],v28,s[48:51],s84 offen sc1
M v[128:131],v[204:207],a[204:207],v[128:131]
v_mov_b32 v127,0
v_mov_b32 v46,0
M v[132:135],v[204:207],a[236:239],0
buffer_load_dwordx4 v4,s[4:7],s22 offen offset:2048 sc1 lds
M v[132:135],v[200:203],a[232:235],v[132:135]
M v[132:135],v[196:199],a[228:231],v[132:135]
M v[132:135],v[192:195],a[224:227],v[132:135]
s_waitcnt lgkmcnt(4)
M v[132:135],v[208:211],a[240:243],v[132:135]
ds_read_b128 v[240:243],v29 offset:12288
ds_read_b128 v[244:247],v29 offset:13312
M v[132:135],v[212:215],a[244:247],v[132:135]
ds_read_b128 v[248:251],v29 offset:14336
ds_read_b128 v[252:255],v29 offset:15360
M v[132:135],v[216:219],a[248:251],v[132:135]
buffer_store_dwordx4 v[52:55],v28,s[48:51],s84 offen offset:1024 sc1
M v[132:135],v[220:223],a[252:255],v[132:135]
M v[128:131],v[220:223],a[220:223],v[128:131]
buffer_load_dwordx4 v4,s[4:7],s22 offen offset:3072 sc1 lds
M v[128:131],v[216:219],a[216:219],v[128:131]
M v[128:131],v[212:215],a[212:215],v[128:131]
M v[128:131],v[208:211],a[208:211],v[128:131]
s_waitcnt lgkmcnt(4)
M v[136:139],v[224:227],a[192:195],0
ds_read_b128 v[192:195],v29 offset:16384
ds_read_b128 v[196:199],v29 offset:17408
M v[136:139],v[228:231],a[196:199],v[136:139]
ds_read_b128 v[200:203],v29 offset:18432
ds_read_b128 v[204:207],v29 offset:19456
M v[136:139],v[232:235],a[200:203],v[136:139]
buffer_store_dwordx4 v[56:59],v28,s[48:51],s84 offen offset:2048 sc1
M v[136:139],v[236:239],a[204:207],v[136:139]
s_add_u32 m0,s21,36864
M v[140:143],v[236:239],a[236:239],0
buffer_load_dwordx4 v5,s[4:7],s22 offen sc1 lds
M v[140:143],v[232:235],a[232:235],v[140:143]
M v[140:143],v[228:231],a[228:231],v[140:143]
M v[140:143],v[224:227],a[224:227],v[140:143]
s_waitcnt lgkmcnt(4)
M v[140:143],v[240:243],a[240:243],v[140:143]
ds_read_b128 v[208:211],v29 offset:20480
ds_read_b128 v[212:215],v29 offset:21504
M v[140:143],v[244:247],a[244:247],v[140:143]
ds_read_b128 v[216:219],v29 offset:22528
ds_read_b128 v[220:223],v29 offset:23552
M v[140:143],v[248:251],a[248:251],v[140:143]
buffer_store_dwordx4 v[60:63],v28,s[48:51],s85 offen sc1
M v[140:143],v[252:255],a[252:255],v[140:143]
M v[136:139],v[252:255],a[220:223],v[136:139]
buffer_load_dwordx4 v5,s[4:7],s22 offen offset:1024 sc1 lds
M v[136:139],v[248:251],a[216:219],v[136:139]
M v[136:139],v[244:247],a[212:215],v[136:139]
M v[136:139],v[240:243],a[208:211],v[136:139]
s_waitcnt lgkmcnt(4)
M v[144:147],v[192:195],a[192:195],0
ds_read_b128 v[224:227],v29 offset:24576
ds_read_b128 v[228:231],v29 offset:25600
M v[144:147],v[196:199],a[196:199],v[144:147]
ds_read_b128 v[232:235],v29 offset:26624
ds_read_b128 v[236:239],v29 offset:27648
M v[144:147],v[200:203],a[200:203],v[144:147]
buffer_store_dwordx4 v[64:67],v28,s[48:51],s85 offen offset:1024 sc1
M v[144:147],v[204:207],a[204:207],v[144:147]
M v[148:151],v[204:207],a[236:239],0
buffer_load_dwordx4 v5,s[4:7],s22 offen offset:2048 sc1 lds
M v[148:151],v[200:203],a[232:235],v[148:151]
M v[148:151],v[196:199],a[228:231],v[148:151]
M v[148:151],v[192:195],a[224:227],v[148:151]
s_waitcnt lgkmcnt(4)
M v[148:151],v[208:211],a[240:243],v[148:151]
ds_read_b128 v[240:243],v29 offset:28672
ds_read_b128 v[244:247],v29 offset:29696
M v[148:151],v[212:215],a[244:247],v[148:151]
ds_read_b128 v[248:251],v29 offset:30720
ds_read_b128 v[252:255],v29 offset:31744
M v[148:151],v[216:219],a[248:251],v[148:151]
buffer_store_dwordx4 v[68:71],v28,s[48:51],s85 offen offset:2048 sc1
M v[148:151],v[220:223],a[252:255],v[148:151]
M v[144:147],v[220:223],a[220:223],v[144:147]
buffer_load_dwordx4 v5,s[4:7],s22 offen offset:3072 sc1 lds
M v[144:147],v[216:219],a[216:219],v[144:147]
M v[144:147],v[212:215],a[212:215],v[144:147]
M v[144:147],v[208:211],a[208:211],v[144:147]
s_lshr_b32 s30,0x12,s38
s_bitcmp1_b32 s30,0
s_cbranch_scc1 K2_B0S
s_waitcnt vmcnt(22)
s_cmp_eq_u32 s38,0
s_cbranch_scc1 K2_B0S
s_waitcnt vmcnt(12)
K2_B0S:
s_waitcnt lgkmcnt(0)
s_barrier
M v[152:155],v[224:227],a[192:195],0
ds_read_b128 v[192:195],v3 offset:32768
ds_read_b128 v[196:199],v3 offset:33792
M v[152:155],v[228:231],a[196:199],v[152:155]
ds_read_b128 v[200:203],v3 offset:34816
ds_read_b128 v[204:207],v3 offset:35840
M v[152:155],v[232:235],a[200:203],v[152:155]
buffer_store_dwordx4 v[72:75],v28,s[48:51],s86 offen sc1
M v[152:155],v[236:239],a[204:207],v[152:155]
s_add_u32 m0,s21,65536
M v[156:159],v[236:239],a[236:239],0
buffer_load_dwordx4 v4,s[8:11],s23 offen sc1 lds
M v[156:159],v[232:235],a[232:235],v[156:159]
s_add_u32 s22,s22,32768
M v[156:159],v[228:231],a[228:231],v[156:159]
M v[156:159],v[224:227],a[224:227],v[156:159]
M v[156:159],v[240:243],a[240:243],v[156:159]
ds_read_b128 v[208:211],v3 offset:36864
ds_read_b128 v[212:215],v3 offset:37888
M v[156:159],v[244:247],a[244:247],v[156:159]
ds_read_b128 v[216:219],v3 offset:38912
ds_read_b128 v[220:223],v3 offset:39936
M v[156:159],v[248:251],a[248:251],v[156:159]
buffer_store_dwordx4 v[76:79],v28,s[48:51],s86 offen offset:1024 sc1
M v[156:159],v[252:255],a[252:255],v[156:159]
s_cmp_eq_u32 s22,s42
s_cselect_b32 s22,s43,s22
M v[152:155],v[252:255],a[220:223],v[152:155]
buffer_load_dwordx4 v4,s[8:11],s23 offen offset:1024 sc1 lds
M v[152:155],v[248:251],a[216:219],v[152:155]
M v[152:155],v[244:247],a[212:215],v[152:155]
M v[152:155],v[240:243],a[208:211],v[152:155]
s_cmp_eq_u32 s38,3
s_cbranch_scc0 K2_NOSIG0
v_mov_b32 v34,1
v_mov_b32_e64 v35,0
s_mov_b64 exec,1
buffer_store_dword v34,v35,s[12:15],s77 offen sc1
s_mov_b64 exec,-1
K2_NOSIG0:
s_add_u32 s30,s24,1
s_cmp_eq_u32 s30,s25
s_nop 4
s_cbranch_scc0 K2_NOMASK0
v_mov_b32 v30,0xff800000
v_cmp_le_i32 s[44:45],0,v7
v_cmp_le_i32 s[46:47],1,v7
v_cmp_le_i32 s[48:49],2,v7
v_cmp_le_i32 s[50:51],3,v7
v_cndmask_b32 v128,v30,v128,s[44:45]
v_cndmask_b32 v129,v30,v129,s[46:47]
v_cndmask_b32 v130,v30,v130,s[48:49]
v_cndmask_b32 v131,v30,v131,s[50:51]
v_cmp_le_i32 s[44:45],16,v7
v_cmp_le_i32 s[46:47],17,v7
v_cmp_le_i32 s[48:49],18,v7
v_cmp_le_i32 s[50:51],19,v7
v_cndmask_b32 v136,v30,v136,s[44:45]
v_cndmask_b32 v137,v30,v137,s[46:47]
v_cndmask_b32 v138,v30,v138,s[48:49]
v_cndmask_b32 v139,v30,v139,s[50:51]
v_cmp_le_i32 s[44:45],32,v7
v_cmp_le_i32 s[46:47],33,v7
v_cmp_le_i32 s[48:49],34,v7
v_cmp_le_i32 s[50:51],35,v7
v_cndmask_b32 v144,v30,v144,s[44:45]
v_cndmask_b32 v145,v30,v145,s[46:47]
v_cndmask_b32 v146,v30,v146,s[48:49]
v_cndmask_b32 v147,v30,v147,s[50:51]
v_cmp_le_i32 s[44:45],48,v7
v_cmp_le_i32 s[46:47],49,v7
v_cmp_le_i32 s[48:49],50,v7
v_cmp_le_i32 s[50:51],51,v7
v_cndmask_b32 v152,v30,v152,s[44:45]
v_cndmask_b32 v153,v30,v153,s[46:47]
v_cndmask_b32 v154,v30,v154,s[48:49]
v_cndmask_b32 v155,v30,v155,s[50:51]
K2_NOMASK0:
v_max3_f32 v30,v128,v129,v130
v_max3_f32 v31,v132,v133,v134
v_max3_f32 v30,v131,v136,v30
v_max3_f32 v31,v135,v140,v31
v_max3_f32 v30,v137,v138,v30
v_max3_f32 v31,v141,v142,v31
v_max3_f32 v30,v139,v144,v30
v_max3_f32 v31,v143,v148,v31
v_max3_f32 v30,v145,v146,v30
v_max3_f32 v31,v149,v150,v31
v_max3_f32 v30,v147,v152,v30
v_max3_f32 v31,v151,v156,v31
v_max3_f32 v30,v153,v154,v30
v_max3_f32 v31,v157,v158,v31
v_max_f32 v30,v155,v30
v_max_f32 v31,v159,v31
v_mov_b32 v32,v30
v_mov_b32 v33,v31
s_nop 0
v_permlane32_swap_b32 v32,v30
v_permlane32_swap_b32 v33,v31
s_nop 0
v_max_f32 v30,v32,v30
v_max_f32 v31,v33,v31
v_mov_b32 v32,v30
v_mov_b32 v33,v31
s_nop 0
v_permlane16_swap_b32 v32,v30
v_permlane16_swap_b32 v33,v31
s_nop 0
v_max_f32 v30,v32,v30
v_max_f32 v31,v33,v31
v_sub_f32 v8,0xc2000000,v30
v_mov_b32 v9,v8
v_mov_b32 v10,v8
v_mov_b32_e64 v11,v8
v_sub_f32 v12,0xc2000000,v31
v_mov_b32 v13,v12
v_mov_b32 v14,v12
v_mov_b32_e64 v15,v12
v_pk_add_f32 v[128:129],v[128:129],v[8:9]
v_pk_add_f32 v[130:131],v[130:131],v[8:9]
v_pk_add_f32 v[136:137],v[136:137],v[8:9]
v_pk_add_f32 v[138:139],v[138:139],v[8:9]
v_pk_add_f32 v[144:145],v[144:145],v[8:9]
v_pk_add_f32 v[146:147],v[146:147],v[8:9]
v_pk_add_f32 v[152:153],v[152:153],v[8:9]
v_pk_add_f32 v[154:155],v[154:155],v[8:9]
v_pk_add_f32 v[132:133],v[132:133],v[12:13]
v_pk_add_f32 v[134:135],v[134:135],v[12:13]
v_pk_add_f32 v[140:141],v[140:141],v[12:13]
v_pk_add_f32 v[142:143],v[142:143],v[12:13]
v_pk_add_f32 v[148:149],v[148:149],v[12:13]
v_pk_add_f32 v[150:151],v[150:151],v[12:13]
v_pk_add_f32 v[156:157],v[156:157],v[12:13]
v_pk_add_f32 v[158:159],v[158:159],v[12:13]
v_exp_f32 v20,v128
v_exp_f32 v21,v129
v_exp_f32 v22,v130
v_exp_f32 v23,v131
CV v48,v20,v21
v_add_f32 v6,v20,v21
v_exp_f32 v24,v136
v_exp_f32_e64 v25,v137
CV v49,v22,v23
v_add_f32 v6,v6,v22
v_add_f32 v6,v6,v23
v_exp_f32 v26,v138
v_exp_f32 v27,v139
CV v50,v24,v25
v_add_f32 v6,v6,v24
v_add_f32 v6,v6,v25
v_exp_f32 v20,v132
v_exp_f32 v21,v133
CV v51,v26,v27
v_add_f32 v6,v6,v26
v_add_f32 v6,v6,v27
v_exp_f32 v22,v134
v_exp_f32 v23,v135
CV v52,v20,v21
v_add_f32 v43,v20,v21
v_exp_f32 v24,v140
v_exp_f32_e64 v25,v141
CV v53,v22,v23
v_add_f32 v43,v43,v22
v_add_f32 v43,v43,v23
v_exp_f32 v26,v142
v_exp_f32 v27,v143
CV v54,v24,v25
v_add_f32 v43,v43,v24
v_add_f32 v43,v43,v25
v_add_f32_e64 v43,v43,v26
CV v55,v26,v27
v_add_f32 v43,v43,v27
s_waitcnt lgkmcnt(4)
s_cmp_eq_u32 s24,s26
s_cbranch_scc1 K2_LAST2
s_cmp_eq_u32 s38,4
s_cbranch_scc0 K2_LOOPA
M v[160:163],v[192:195],a[192:195],v[8:11]
ds_read_b128 v[224:227],v3 offset:40960
ds_read_b128 v[228:231],v3 offset:41984
M v[160:163],v[196:199],a[196:199],v[160:163]
ds_read_b128 v[232:235],v3 offset:43008
ds_read_b128 v[236:239],v3 offset:44032
M v[160:163],v[200:203],a[200:203],v[160:163]
buffer_store_dwordx4 v[80:83],v28,s[12:15],s86 offen offset:2048 sc1
M v[160:163],v[204:207],a[204:207],v[160:163]
v_exp_f32 v20,v144
M v[164:167],v[204:207],a[236:239],v[12:15]
buffer_load_dwordx4 v4,s[8:11],s23 offen offset:2048 sc1 lds
M v[164:167],v[200:203],a[232:235],v[164:167]
v_exp_f32 v21,v145
M v[164:167],v[196:199],a[228:231],v[164:167]
v_exp_f32 v22,v146
M v[164:167],v[192:195],a[224:227],v[164:167]
s_waitcnt lgkmcnt(4)
v_exp_f32 v23,v147
M v[164:167],v[208:211],a[240:243],v[164:167]
ds_read_b128 v[240:243],v3 offset:45056
ds_read_b128 v[244:247],v3 offset:46080
M v[164:167],v[212:215],a[244:247],v[164:167]
ds_read_b128 v[248:251],v3 offset:47104
ds_read_b128 v[252:255],v3 offset:48128
M v[164:167],v[216:219],a[248:251],v[164:167]
buffer_store_dwordx4 v[84:87],v28,s[12:15],s87 offen sc1
M v[164:167],v[220:223],a[252:255],v[164:167]
CV v56,v20,v21
v_add_f32 v6,v6,v20
M v[160:163],v[220:223],a[220:223],v[160:163]
buffer_load_dwordx4 v4,s[8:11],s23 offen offset:3072 sc1 lds
M v[160:163],v[216:219],a[216:219],v[160:163]
v_add_f32 v6,v6,v21
M v[160:163],v[212:215],a[212:215],v[160:163]
v_exp_f32 v24,v152
M v[160:163],v[208:211],a[208:211],v[160:163]
s_waitcnt lgkmcnt(4)
v_exp_f32 v25,v153
CV v57,v22,v23
M v[168:171],v[224:227],a[192:195],v[8:11]
ds_read_b128 v[192:195],v3 offset:49152
ds_read_b128 v[196:199],v3 offset:50176
M v[168:171],v[228:231],a[196:199],v[168:171]
ds_read_b128 v[200:203],v3 offset:51200
ds_read_b128 v[204:207],v3 offset:52224
M v[168:171],v[232:235],a[200:203],v[168:171]
v_add_f32 v6,v6,v22
v_add_f32 v6,v6,v23
M v[168:171],v[236:239],a[204:207],v[168:171]
s_add_u32 m0,s21,69632
v_exp_f32 v26,v154
M v[172:175],v[236:239],a[236:239],v[12:15]
buffer_load_dwordx4 v5,s[8:11],s23 offen sc1 lds
M v[172:175],v[232:235],a[232:235],v[172:175]
v_exp_f32 v27,v155
M v[172:175],v[228:231],a[228:231],v[172:175]
CV v58,v24,v25
v_add_f32 v6,v6,v24
M v[172:175],v[224:227],a[224:227],v[172:175]
s_waitcnt lgkmcnt(4)
v_add_f32 v6,v6,v25
M v[172:175],v[240:243],a[240:243],v[172:175]
ds_read_b128 v[208:211],v3 offset:53248
ds_read_b128 v[212:215],v3 offset:54272
M v[172:175],v[244:247],a[244:247],v[172:175]
ds_read_b128 v[216:219],v3 offset:55296
ds_read_b128 v[220:223],v3 offset:56320
M v[172:175],v[248:251],a[248:251],v[172:175]
buffer_store_dwordx4 v[88:91],v28,s[12:15],s87 offen offset:1024 sc1
M v[172:175],v[252:255],a[252:255],v[172:175]
v_exp_f32 v20,v148
M v[168:171],v[252:255],a[220:223],v[168:171]
buffer_load_dwordx4 v5,s[8:11],s23 offen offset:1024 sc1 lds
M v[168:171],v[248:251],a[216:219],v[168:171]
v_exp_f32 v21,v149
M v[168:171],v[244:247],a[212:215],v[168:171]
CV v59,v26,v27
v_add_f32 v6,v6,v26
M v[168:171],v[240:243],a[208:211],v[168:171]
s_waitcnt lgkmcnt(4)
v_add_f32 v6,v6,v27
v_exp_f32 v22,v150
M v[176:179],v[192:195],a[192:195],v[8:11]
ds_read_b128 v[224:227],v3 offset:57344
ds_read_b128 v[228:231],v3 offset:58368
M v[176:179],v[196:199],a[196:199],v[176:179]
ds_read_b128 v[232:235],v3 offset:59392
ds_read_b128 v[236:239],v3 offset:60416
M v[176:179],v[200:203],a[200:203],v[176:179]
buffer_store_dwordx4 v[92:95],v28,s[12:15],s87 offen offset:2048 sc1
M v[176:179],v[204:207],a[204:207],v[176:179]
v_exp_f32 v23,v151
M v[180:183],v[204:207],a[236:239],v[12:15]
buffer_load_dwordx4 v5,s[8:11],s23 offen offset:2048 sc1 lds
M v[180:183],v[200:203],a[232:235],v[180:183]
CV v60,v20,v21
v_add_f32 v43,v43,v20
M v[180:183],v[196:199],a[228:231],v[180:183]
v_add_f32 v43,v43,v21
M v[180:183],v[192:195],a[224:227],v[180:183]
s_waitcnt lgkmcnt(4)
v_exp_f32 v24,v156
M v[180:183],v[208:211],a[240:243],v[180:183]
ds_read_b128 v[240:243],v3 offset:61440
ds_read_b128 v[244:247],v3 offset:62464
M v[180:183],v[212:215],a[244:247],v[180:183]
ds_read_b128 v[248:251],v3 offset:63488
ds_read_b128 v[252:255],v3 offset:64512
M v[180:183],v[216:219],a[248:251],v[180:183]
v_exp_f32 v25,v157
M v[180:183],v[220:223],a[252:255],v[180:183]
CV v61,v22,v23
v_add_f32 v43,v43,v22
M v[176:179],v[220:223],a[220:223],v[176:179]
buffer_load_dwordx4 v5,s[8:11],s23 offen offset:3072 sc1 lds
M v[176:179],v[216:219],a[216:219],v[176:179]
v_add_f32 v43,v43,v23
M v[176:179],v[212:215],a[212:215],v[176:179]
v_exp_f32 v26,v158
M v[176:179],v[208:211],a[208:211],v[176:179]
s_waitcnt vmcnt(28) lgkmcnt(0)
s_barrier
M v[184:187],v[224:227],a[192:195],v[8:11]
ds_read_b128 v[192:195],v2 offset:0
ds_read_b128 v[196:199],v2 offset:16384
M v[184:187],v[228:231],a[196:199],v[184:187]
ds_read_b128 v[200:203],v2 offset:1024
ds_read_b128 v[204:207],v2 offset:17408
M v[184:187],v[232:235],a[200:203],v[184:187]
buffer_store_dwordx4 v[96:99],v28,s[12:15],s88 offen sc1
M v[184:187],v[236:239],a[204:207],v[184:187]
s_add_u32 m0,s21,98304
v_exp_f32 v27,v159
M v[188:191],v[236:239],a[236:239],v[12:15]
buffer_load_dwordx4 v4,s[4:7],s22 offen sc1 lds
M v[188:191],v[232:235],a[232:235],v[188:191]
s_add_u32 s23,s23,32768
CV v62,v24,v25
v_add_f32 v43,v43,v24
M v[188:191],v[228:231],a[228:231],v[188:191]
v_add_f32 v43,v43,v25
v_add_f32 v43,v43,v26
M v[188:191],v[224:227],a[224:227],v[188:191]
CV v63,v26,v27
v_add_f32 v43,v43,v27
M v[188:191],v[240:243],a[240:243],v[188:191]
ds_read_b128 v[208:211],v2 offset:2048
ds_read_b128 v[212:215],v2 offset:18432
M v[188:191],v[244:247],a[244:247],v[188:191]
ds_read_b128 v[216:219],v2 offset:3072
ds_read_b128 v[220:223],v2 offset:19456
M v[188:191],v[248:251],a[248:251],v[188:191]
buffer_store_dwordx4 v[100:103],v28,s[12:15],s88 offen offset:1024 sc1
M v[188:191],v[252:255],a[252:255],v[188:191]
s_cmp_eq_u32 s23,s42
s_cselect_b32 s23,s43,s23
M v[184:187],v[252:255],a[220:223],v[184:187]
buffer_load_dwordx4 v4,s[4:7],s22 offen offset:1024 sc1 lds
M v[184:187],v[248:251],a[216:219],v[184:187]
s_waitcnt lgkmcnt(4)
v_add_f32 v30,v6,v43
v_cmp_ngt_f32 vcc,1.0,v30
M v[184:187],v[244:247],a[212:215],v[184:187]
M v[184:187],v[240:243],a[208:211],v[184:187]
s_cbranch_vccnz CK_2
CK_2R:
M a[0:3],v[192:195],v[48:51],0
ds_read_b128 v[224:227],v2 offset:4096
ds_read_b128 v[228:231],v2 offset:20480
M a[0:3],v[196:199],v[56:59],a[0:3]
ds_read_b128 v[232:235],v2 offset:5120
ds_read_b128 v[236:239],v2 offset:21504
M a[4:7],v[196:199],v[60:63],0
buffer_store_dwordx4 v[104:107],v28,s[12:15],s88 offen offset:2048 sc1
M a[4:7],v[192:195],v[52:55],a[4:7]
v_add_f32 v127,v127,v6
v_add_f32 v46,v46,v43
M a[12:15],v[200:203],v[52:55],0
buffer_load_dwordx4 v4,s[4:7],s22 offen offset:2048 sc1 lds
M a[12:15],v[204:207],v[60:63],a[12:15]
v_exp_f32 v20,v160
M a[8:11],v[204:207],v[56:59],0
v_exp_f32 v21,v161
M a[8:11],v[200:203],v[48:51],a[8:11]
s_waitcnt lgkmcnt(4)
v_exp_f32 v22,v162
M a[16:19],v[208:211],v[48:51],0
ds_read_b128 v[240:243],v2 offset:6144
ds_read_b128 v[244:247],v2 offset:22528
M a[16:19],v[212:215],v[56:59],a[16:19]
ds_read_b128 v[248:251],v2 offset:7168
ds_read_b128 v[252:255],v2 offset:23552
M a[20:23],v[212:215],v[60:63],0
buffer_store_dwordx4 a[128:131],v28,s[12:15],s89 offen sc1
M a[20:23],v[208:211],v[52:55],a[20:23]
v_exp_f32 v23,v163
M a[28:31],v[216:219],v[52:55],0
buffer_load_dwordx4 v4,s[4:7],s22 offen offset:3072 sc1 lds
M a[28:31],v[220:223],v[60:63],a[28:31]
CV v64,v20,v21
v_add_f32 v6,v20,v21
M a[24:27],v[220:223],v[56:59],0
v_exp_f32 v24,v168
M a[24:27],v[216:219],v[48:51],a[24:27]
s_waitcnt lgkmcnt(4)
v_exp_f32 v25,v169
M a[32:35],v[224:227],v[48:51],0
ds_read_b128 v[192:195],v2 offset:8192
ds_read_b128 v[196:199],v2 offset:24576
M a[32:35],v[228:231],v[56:59],a[32:35]
ds_read_b128 v[200:203],v2 offset:9216
ds_read_b128 v[204:207],v2 offset:25600
M a[36:39],v[228:231],v[60:63],0
CV v65,v22,v23
v_add_f32 v6,v6,v22
M a[36:39],v[224:227],v[52:55],a[36:39]
s_add_u32 m0,s21,102400
v_add_f32 v6,v6,v23
M a[44:47],v[232:235],v[52:55],0
buffer_load_dwordx4 v5,s[4:7],s22 offen sc1 lds
M a[44:47],v[236:239],v[60:63],a[44:47]
v_exp_f32 v26,v170
M a[40:43],v[236:239],v[56:59],0
v_exp_f32 v27,v171
M a[40:43],v[232:235],v[48:51],a[40:43]
s_waitcnt lgkmcnt(4)
CV v66,v24,v25
v_add_f32 v6,v6,v24
M a[48:51],v[240:243],v[48:51],0
ds_read_b128 v[208:211],v2 offset:10240
ds_read_b128 v[212:215],v2 offset:26624
M a[48:51],v[244:247],v[56:59],a[48:51]
ds_read_b128 v[216:219],v2 offset:11264
ds_read_b128 v[220:223],v2 offset:27648
M a[52:55],v[244:247],v[60:63],0
buffer_store_dwordx4 a[132:135],v28,s[12:15],s89 offen offset:1024 sc1
M a[52:55],v[240:243],v[52:55],a[52:55]
v_add_f32 v6,v6,v25
M a[60:63],v[248:251],v[52:55],0
buffer_load_dwordx4 v5,s[4:7],s22 offen offset:1024 sc1 lds
M a[60:63],v[252:255],v[60:63],a[60:63]
v_exp_f32 v20,v164
M a[56:59],v[252:255],v[56:59],0
v_exp_f32 v21,v165
M a[56:59],v[248:251],v[48:51],a[56:59]
s_waitcnt lgkmcnt(4)
CV v67,v26,v27
v_add_f32 v6,v6,v26
M a[64:67],v[192:195],v[48:51],0
ds_read_b128 v[224:227],v2 offset:12288
ds_read_b128 v[228:231],v2 offset:28672
M a[64:67],v[196:199],v[56:59],a[64:67]
ds_read_b128 v[232:235],v2 offset:13312
ds_read_b128 v[236:239],v2 offset:29696
M a[68:71],v[196:199],v[60:63],0
buffer_store_dwordx4 a[136:139],v28,s[12:15],s89 offen offset:2048 sc1
M a[68:71],v[192:195],v[52:55],a[68:71]
v_add_f32 v6,v6,v27
M a[76:79],v[200:203],v[52:55],0
buffer_load_dwordx4 v5,s[4:7],s22 offen offset:2048 sc1 lds
M a[76:79],v[204:207],v[60:63],a[76:79]
v_exp_f32 v22,v166
M a[72:75],v[204:207],v[56:59],0
v_exp_f32 v23,v167
M a[72:75],v[200:203],v[48:51],a[72:75]
s_waitcnt lgkmcnt(4)
CV v68,v20,v21
v_add_f32 v43,v20,v21
M a[80:83],v[208:211],v[48:51],0
ds_read_b128 v[240:243],v2 offset:14336
ds_read_b128 v[244:247],v2 offset:30720
M a[80:83],v[212:215],v[56:59],a[80:83]
ds_read_b128 v[248:251],v2 offset:15360
ds_read_b128 v[252:255],v2 offset:31744
M a[84:87],v[212:215],v[60:63],0
v_exp_f32 v24,v172
M a[84:87],v[208:211],v[52:55],a[84:87]
v_exp_f32 v25,v173
M a[92:95],v[216:219],v[52:55],0
buffer_load_dwordx4 v5,s[4:7],s22 offen offset:3072 sc1 lds
M a[92:95],v[220:223],v[60:63],a[92:95]
CV v69,v22,v23
v_add_f32 v43,v43,v22
M a[88:91],v[220:223],v[56:59],0
v_add_f32 v43,v43,v23
M a[88:91],v[216:219],v[48:51],a[88:91]
s_waitcnt vmcnt(28) lgkmcnt(0)
s_barrier
M a[96:99],v[224:227],v[48:51],0
ds_read_b128 v[192:195],v2 offset:32768
ds_read_b128 v[196:199],v2 offset:33792
M a[96:99],v[228:231],v[56:59],a[96:99]
ds_read_b128 v[200:203],v2 offset:34816
ds_read_b128 v[204:207],v2 offset:35840
M a[100:103],v[228:231],v[60:63],0
buffer_store_dwordx4 a[140:143],v28,s[12:15],s90 offen sc1
M a[100:103],v[224:227],v[52:55],a[100:103]
s_add_u32 m0,s21,0
v_exp_f32 v26,v174
M a[108:111],v[232:235],v[52:55],0
buffer_load_dwordx4 v4,s[8:11],s23 offen sc1 lds
M a[108:111],v[236:239],v[60:63],a[108:111]
s_add_u32 s22,s22,32768
v_exp_f32 v27,v175
M a[104:107],v[236:239],v[56:59],0
CV v70,v24,v25
v_add_f32 v43,v43,v24
M a[104:107],v[232:235],v[48:51],a[104:107]
v_add_f32 v43,v43,v25
v_add_f32 v43,v43,v26
M a[112:115],v[240:243],v[48:51],0
ds_read_b128 v[208:211],v2 offset:36864
ds_read_b128 v[212:215],v2 offset:37888
M a[112:115],v[244:247],v[56:59],a[112:115]
ds_read_b128 v[216:219],v2 offset:38912
ds_read_b128 v[220:223],v2 offset:39936
M a[116:119],v[244:247],v[60:63],0
buffer_store_dwordx4 a[144:147],v28,s[12:15],s90 offen offset:1024 sc1
s_sub_u32 s24,s24,1
M a[116:119],v[240:243],v[52:55],a[116:119]
s_cmp_eq_u32 s22,s42
s_cselect_b32 s22,s43,s22
M a[124:127],v[248:251],v[52:55],0
buffer_load_dwordx4 v4,s[8:11],s23 offen offset:1024 sc1 lds
M a[124:127],v[252:255],v[60:63],a[124:127]
CV v71,v26,v27
v_add_f32 v43,v43,v27
M a[120:123],v[252:255],v[56:59],0
s_waitcnt lgkmcnt(4)
M a[120:123],v[248:251],v[48:51],a[120:123]
M v[128:131],v[192:195],a[192:195],v[8:11]
ds_read_b128 v[224:227],v2 offset:40960
ds_read_b128 v[228:231],v2 offset:41984
M v[128:131],v[196:199],a[196:199],v[128:131]
ds_read_b128 v[232:235],v2 offset:43008
ds_read_b128 v[236:239],v2 offset:44032
M v[128:131],v[200:203],a[200:203],v[128:131]
buffer_store_dwordx4 a[148:151],v28,s[12:15],s90 offen offset:2048 sc1
M v[128:131],v[204:207],a[204:207],v[128:131]
v_exp_f32 v20,v176
M v[132:135],v[204:207],a[236:239],v[12:15]
buffer_load_dwordx4 v4,s[8:11],s23 offen offset:2048 sc1 lds
M v[132:135],v[200:203],a[232:235],v[132:135]
v_exp_f32 v21,v177
M v[132:135],v[196:199],a[228:231],v[132:135]
v_exp_f32 v22,v178
M v[132:135],v[192:195],a[224:227],v[132:135]
s_waitcnt lgkmcnt(4)
v_exp_f32 v23,v179
M v[132:135],v[208:211],a[240:243],v[132:135]
ds_read_b128 v[240:243],v2 offset:45056
ds_read_b128 v[244:247],v2 offset:46080
M v[132:135],v[212:215],a[244:247],v[132:135]
ds_read_b128 v[248:251],v2 offset:47104
ds_read_b128 v[252:255],v2 offset:48128
M v[132:135],v[216:219],a[248:251],v[132:135]
buffer_store_dwordx4 a[152:155],v28,s[12:15],s91 offen sc1
M v[132:135],v[220:223],a[252:255],v[132:135]
CV v72,v20,v21
v_add_f32 v6,v6,v20
M v[128:131],v[220:223],a[220:223],v[128:131]
buffer_load_dwordx4 v4,s[8:11],s23 offen offset:3072 sc1 lds
M v[128:131],v[216:219],a[216:219],v[128:131]
v_add_f32 v6,v6,v21
M v[128:131],v[212:215],a[212:215],v[128:131]
v_exp_f32 v24,v184
M v[128:131],v[208:211],a[208:211],v[128:131]
s_waitcnt lgkmcnt(4)
v_exp_f32 v25,v185
M v[136:139],v[224:227],a[192:195],v[8:11]
ds_read_b128 v[192:195],v2 offset:49152
ds_read_b128 v[196:199],v2 offset:50176
M v[136:139],v[228:231],a[196:199],v[136:139]
ds_read_b128 v[200:203],v2 offset:51200
ds_read_b128 v[204:207],v2 offset:52224
M v[136:139],v[232:235],a[200:203],v[136:139]
CV v73,v22,v23
v_add_f32 v6,v6,v22
M v[136:139],v[236:239],a[204:207],v[136:139]
s_add_u32 m0,s21,4096
v_add_f32 v6,v6,v23
M v[140:143],v[236:239],a[236:239],v[12:15]
buffer_load_dwordx4 v5,s[8:11],s23 offen sc1 lds
M v[140:143],v[232:235],a[232:235],v[140:143]
v_exp_f32 v26,v186
M v[140:143],v[228:231],a[228:231],v[140:143]
v_exp_f32 v27,v187
M v[140:143],v[224:227],a[224:227],v[140:143]
s_waitcnt lgkmcnt(4)
CV v74,v24,v25
v_add_f32 v6,v6,v24
M v[140:143],v[240:243],a[240:243],v[140:143]
ds_read_b128 v[208:211],v2 offset:53248
ds_read_b128 v[212:215],v2 offset:54272
M v[140:143],v[244:247],a[244:247],v[140:143]
ds_read_b128 v[216:219],v2 offset:55296
ds_read_b128 v[220:223],v2 offset:56320
M v[140:143],v[248:251],a[248:251],v[140:143]
buffer_store_dwordx4 a[156:159],v28,s[12:15],s91 offen offset:1024 sc1
M v[140:143],v[252:255],a[252:255],v[140:143]
v_add_f32 v6,v6,v25
M v[136:139],v[252:255],a[220:223],v[136:139]
buffer_load_dwordx4 v5,s[8:11],s23 offen offset:1024 sc1 lds
M v[136:139],v[248:251],a[216:219],v[136:139]
v_exp_f32 v20,v180
M v[136:139],v[244:247],a[212:215],v[136:139]
v_exp_f32 v21,v181
M v[136:139],v[240:243],a[208:211],v[136:139]
s_waitcnt lgkmcnt(4)
CV v75,v26,v27
v_add_f32 v6,v6,v26
M v[144:147],v[192:195],a[192:195],v[8:11]
ds_read_b128 v[224:227],v2 offset:57344
ds_read_b128 v[228:231],v2 offset:58368
M v[144:147],v[196:199],a[196:199],v[144:147]
ds_read_b128 v[232:235],v2 offset:59392
ds_read_b128 v[236:239],v2 offset:60416
M v[144:147],v[200:203],a[200:203],v[144:147]
buffer_store_dwordx4 a[160:163],v28,s[12:15],s91 offen offset:2048 sc1
M v[144:147],v[204:207],a[204:207],v[144:147]
v_add_f32 v6,v6,v27
M v[148:151],v[204:207],a[236:239],v[12:15]
buffer_load_dwordx4 v5,s[8:11],s23 offen offset:2048 sc1 lds
M v[148:151],v[200:203],a[232:235],v[148:151]
v_exp_f32 v22,v182
M v[148:151],v[196:199],a[228:231],v[148:151]
v_exp_f32 v23,v183
M v[148:151],v[192:195],a[224:227],v[148:151]
s_waitcnt lgkmcnt(4)
CV v76,v20,v21
v_add_f32 v43,v43,v20
M v[148:151],v[208:211],a[240:243],v[148:151]
ds_read_b128 v[240:243],v2 offset:61440
ds_read_b128 v[244:247],v2 offset:62464
M v[148:151],v[212:215],a[244:247],v[148:151]
ds_read_b128 v[248:251],v2 offset:63488
ds_read_b128 v[252:255],v2 offset:64512
M v[148:151],v[216:219],a[248:251],v[148:151]
v_add_f32 v43,v43,v21
M v[148:151],v[220:223],a[252:255],v[148:151]
v_exp_f32 v24,v188
M v[144:147],v[220:223],a[220:223],v[144:147]
buffer_load_dwordx4 v5,s[8:11],s23 offen offset:3072 sc1 lds
M v[144:147],v[216:219],a[216:219],v[144:147]
v_exp_f32 v25,v189
M v[144:147],v[212:215],a[212:215],v[144:147]
CV v77,v22,v23
v_add_f32 v43,v43,v22
M v[144:147],v[208:211],a[208:211],v[144:147]
s_waitcnt vmcnt(28) lgkmcnt(0)
s_barrier
M v[152:155],v[224:227],a[192:195],v[8:11]
ds_read_b128 v[192:195],v3 offset:0
ds_read_b128 v[196:199],v3 offset:16384
M v[152:155],v[228:231],a[196:199],v[152:155]
ds_read_b128 v[200:203],v3 offset:1024
ds_read_b128 v[204:207],v3 offset:17408
M v[152:155],v[232:235],a[200:203],v[152:155]
v_add_f32 v43,v43,v23
M v[152:155],v[236:239],a[204:207],v[152:155]
s_add_u32 m0,s21,32768
v_exp_f32 v26,v190
M v[156:159],v[236:239],a[236:239],v[12:15]
buffer_load_dwordx4 v4,s[4:7],s22 offen sc1 lds
M v[156:159],v[232:235],a[232:235],v[156:159]
s_add_u32 s23,s23,32768
v_exp_f32 v27,v191
M v[156:159],v[228:231],a[228:231],v[156:159]
CV v78,v24,v25
v_add_f32 v43,v43,v24
M v[156:159],v[224:227],a[224:227],v[156:159]
v_add_f32 v43,v43,v25
v_add_f32 v43,v43,v26
M v[156:159],v[240:243],a[240:243],v[156:159]
ds_read_b128 v[208:211],v3 offset:2048
ds_read_b128 v[212:215],v3 offset:18432
M v[156:159],v[244:247],a[244:247],v[156:159]
ds_read_b128 v[216:219],v3 offset:3072
ds_read_b128 v[220:223],v3 offset:19456
M v[156:159],v[248:251],a[248:251],v[156:159]
CV v79,v26,v27
v_add_f32 v43,v43,v27
M v[156:159],v[252:255],a[252:255],v[156:159]
s_cmp_eq_u32 s23,s42
s_cselect_b32 s23,s43,s23
M v[152:155],v[252:255],a[220:223],v[152:155]
buffer_load_dwordx4 v4,s[4:7],s22 offen offset:1024 sc1 lds
M v[152:155],v[248:251],a[216:219],v[152:155]
s_waitcnt lgkmcnt(4)
v_add_f32 v30,v6,v43
v_cmp_ngt_f32 vcc,1.0,v30
M v[152:155],v[244:247],a[212:215],v[152:155]
M v[152:155],v[240:243],a[208:211],v[152:155]
s_cbranch_vccnz CK_3
CK_3R:
.p2align 6
K2_LOOP:
M a[0:3],v[192:195],v[64:67],a[0:3]
ds_read_b128 v[224:227],v3 offset:4096
ds_read_b128 v[228:231],v3 offset:20480
M a[0:3],v[196:199],v[72:75],a[0:3]
ds_read_b128 v[232:235],v3 offset:5120
ds_read_b128 v[236:239],v3 offset:21504
M a[4:7],v[196:199],v[76:79],a[4:7]
v_add_f32 v127,v127,v6
v_add_f32 v46,v46,v43
M a[4:7],v[192:195],v[68:71],a[4:7]
v_exp_f32 v20,v128
M a[12:15],v[200:203],v[68:71],a[12:15]
buffer_load_dwordx4 v4,s[4:7],s22 offen offset:2048 sc1 lds
M a[12:15],v[204:207],v[76:79],a[12:15]
v_exp_f32 v21,v129
M a[8:11],v[204:207],v[72:75],a[8:11]
v_exp_f32 v22,v130
M a[8:11],v[200:203],v[64:67],a[8:11]
s_waitcnt lgkmcnt(4)
v_exp_f32 v23,v131
M a[16:19],v[208:211],v[64:67],a[16:19]
ds_read_b128 v[240:243],v3 offset:6144
ds_read_b128 v[244:247],v3 offset:22528
M a[16:19],v[212:215],v[72:75],a[16:19]
ds_read_b128 v[248:251],v3 offset:7168
ds_read_b128 v[252:255],v3 offset:23552
M a[20:23],v[212:215],v[76:79],a[20:23]
CV v48,v20,v21
v_add_f32 v6,v20,v21
M a[20:23],v[208:211],v[68:71],a[20:23]
v_exp_f32 v24,v136
M a[28:31],v[216:219],v[68:71],a[28:31]
buffer_load_dwordx4 v4,s[4:7],s22 offen offset:3072 sc1 lds
M a[28:31],v[220:223],v[76:79],a[28:31]
v_exp_f32 v25,v137
M a[24:27],v[220:223],v[72:75],a[24:27]
CV v49,v22,v23
v_add_f32 v6,v6,v22
M a[24:27],v[216:219],v[64:67],a[24:27]
s_waitcnt lgkmcnt(4)
v_add_f32 v6,v6,v23
M a[32:35],v[224:227],v[64:67],a[32:35]
ds_read_b128 v[192:195],v3 offset:8192
ds_read_b128 v[196:199],v3 offset:24576
M a[32:35],v[228:231],v[72:75],a[32:35]
ds_read_b128 v[200:203],v3 offset:9216
ds_read_b128 v[204:207],v3 offset:25600
M a[36:39],v[228:231],v[76:79],a[36:39]
v_exp_f32 v26,v138
M a[36:39],v[224:227],v[68:71],a[36:39]
s_add_u32 m0,s21,36864
v_exp_f32 v27,v139
M a[44:47],v[232:235],v[68:71],a[44:47]
buffer_load_dwordx4 v5,s[4:7],s22 offen sc1 lds
M a[44:47],v[236:239],v[76:79],a[44:47]
CV v50,v24,v25
v_add_f32 v6,v6,v24
M a[40:43],v[236:239],v[72:75],a[40:43]
v_add_f32 v6,v6,v25
M a[40:43],v[232:235],v[64:67],a[40:43]
s_waitcnt lgkmcnt(4)
v_exp_f32 v20,v132
M a[48:51],v[240:243],v[64:67],a[48:51]
ds_read_b128 v[208:211],v3 offset:10240
ds_read_b128 v[212:215],v3 offset:26624
M a[48:51],v[244:247],v[72:75],a[48:51]
ds_read_b128 v[216:219],v3 offset:11264
ds_read_b128 v[220:223],v3 offset:27648
v_add_u32 v42,32768,v42
M a[52:55],v[244:247],v[76:79],a[52:55]
buffer_load_dword v1,v42,s[16:19],0 offen
M a[52:55],v[240:243],v[68:71],a[52:55]
v_exp_f32 v21,v133
M a[60:63],v[248:251],v[68:71],a[60:63]
buffer_load_dwordx4 v5,s[4:7],s22 offen offset:1024 sc1 lds
M a[60:63],v[252:255],v[76:79],a[60:63]
CV v51,v26,v27
v_add_f32 v6,v6,v26
M a[56:59],v[252:255],v[72:75],a[56:59]
v_add_f32 v6,v6,v27
M a[56:59],v[248:251],v[64:67],a[56:59]
s_waitcnt lgkmcnt(4)
v_exp_f32 v22,v134
M a[64:67],v[192:195],v[64:67],a[64:67]
ds_read_b128 v[224:227],v3 offset:12288
ds_read_b128 v[228:231],v3 offset:28672
M a[64:67],v[196:199],v[72:75],a[64:67]
ds_read_b128 v[232:235],v3 offset:13312
ds_read_b128 v[236:239],v3 offset:29696
M a[68:71],v[196:199],v[76:79],a[68:71]
v_exp_f32 v23,v135
M a[68:71],v[192:195],v[68:71],a[68:71]
CV v52,v20,v21
v_add_f32 v43,v20,v21
M a[76:79],v[200:203],v[68:71],a[76:79]
buffer_load_dwordx4 v5,s[4:7],s22 offen offset:2048 sc1 lds
M a[76:79],v[204:207],v[76:79],a[76:79]
v_exp_f32 v24,v140
M a[72:75],v[204:207],v[72:75],a[72:75]
v_exp_f32 v25,v141
M a[72:75],v[200:203],v[64:67],a[72:75]
s_waitcnt lgkmcnt(4)
CV v53,v22,v23
v_add_f32 v43,v43,v22
M a[80:83],v[208:211],v[64:67],a[80:83]
ds_read_b128 v[240:243],v3 offset:14336
ds_read_b128 v[244:247],v3 offset:30720
M a[80:83],v[212:215],v[72:75],a[80:83]
ds_read_b128 v[248:251],v3 offset:15360
ds_read_b128 v[252:255],v3 offset:31744
M a[84:87],v[212:215],v[76:79],a[84:87]
v_add_f32 v43,v43,v23
M a[84:87],v[208:211],v[68:71],a[84:87]
v_exp_f32 v26,v142
M a[92:95],v[216:219],v[68:71],a[92:95]
buffer_load_dwordx4 v5,s[4:7],s22 offen offset:3072 sc1 lds
M a[92:95],v[220:223],v[76:79],a[92:95]
v_exp_f32 v27,v143
M a[88:91],v[220:223],v[72:75],a[88:91]
CV v54,v24,v25
v_add_f32 v43,v43,v24
M a[88:91],v[216:219],v[64:67],a[88:91]
s_waitcnt vmcnt(16) lgkmcnt(0)
s_barrier
M a[96:99],v[224:227],v[64:67],a[96:99]
ds_read_b128 v[192:195],v3 offset:32768
ds_read_b128 v[196:199],v3 offset:33792
M a[96:99],v[228:231],v[72:75],a[96:99]
ds_read_b128 v[200:203],v3 offset:34816
ds_read_b128 v[204:207],v3 offset:35840
M a[100:103],v[228:231],v[76:79],a[100:103]
v_add_f32 v43,v43,v25
v_add_f32 v43,v43,v26
M a[100:103],v[224:227],v[68:71],a[100:103]
s_add_u32 m0,s21,65536
CV v55,v26,v27
v_add_f32 v43,v43,v27
M a[108:111],v[232:235],v[68:71],a[108:111]
buffer_load_dwordx4 v4,s[8:11],s23 offen sc1 lds
M a[108:111],v[236:239],v[76:79],a[108:111]
s_add_u32 s22,s22,32768
M a[104:107],v[236:239],v[72:75],a[104:107]
M a[104:107],v[232:235],v[64:67],a[104:107]
M a[112:115],v[240:243],v[64:67],a[112:115]
ds_read_b128 v[208:211],v3 offset:36864
ds_read_b128 v[212:215],v3 offset:37888
M a[112:115],v[244:247],v[72:75],a[112:115]
ds_read_b128 v[216:219],v3 offset:38912
ds_read_b128 v[220:223],v3 offset:39936
M a[116:119],v[244:247],v[76:79],a[116:119]
s_sub_u32 s24,s24,1
M a[116:119],v[240:243],v[68:71],a[116:119]
s_cmp_eq_u32 s22,s42
s_cselect_b32 s22,s43,s22
M a[124:127],v[248:251],v[68:71],a[124:127]
buffer_load_dwordx4 v4,s[8:11],s23 offen offset:1024 sc1 lds
M a[124:127],v[252:255],v[76:79],a[124:127]
s_cmp_eq_u32 s24,s39
s_cbranch_scc1 K2_HK1
K2_HK1R:
M a[120:123],v[252:255],v[72:75],a[120:123]
s_waitcnt lgkmcnt(4)
M a[120:123],v[248:251],v[64:67],a[120:123]
K2_LOOPA:
M v[160:163],v[192:195],a[192:195],v[8:11]
ds_read_b128 v[224:227],v3 offset:40960
ds_read_b128 v[228:231],v3 offset:41984
M v[160:163],v[196:199],a[196:199],v[160:163]
ds_read_b128 v[232:235],v3 offset:43008
ds_read_b128 v[236:239],v3 offset:44032
M v[160:163],v[200:203],a[200:203],v[160:163]
v_exp_f32 v20,v144
M v[160:163],v[204:207],a[204:207],v[160:163]
v_exp_f32 v21,v145
M v[164:167],v[204:207],a[236:239],v[12:15]
buffer_load_dwordx4 v4,s[8:11],s23 offen offset:2048 sc1 lds
M v[164:167],v[200:203],a[232:235],v[164:167]
v_exp_f32 v22,v146
M v[164:167],v[196:199],a[228:231],v[164:167]
v_exp_f32 v23,v147
M v[164:167],v[192:195],a[224:227],v[164:167]
s_waitcnt lgkmcnt(4)
CV v56,v20,v21
v_add_f32 v6,v6,v20
M v[164:167],v[208:211],a[240:243],v[164:167]
ds_read_b128 v[240:243],v3 offset:45056
ds_read_b128 v[244:247],v3 offset:46080
M v[164:167],v[212:215],a[244:247],v[164:167]
ds_read_b128 v[248:251],v3 offset:47104
ds_read_b128 v[252:255],v3 offset:48128
M v[164:167],v[216:219],a[248:251],v[164:167]
v_add_f32 v6,v6,v21
M v[164:167],v[220:223],a[252:255],v[164:167]
v_exp_f32 v24,v152
M v[160:163],v[220:223],a[220:223],v[160:163]
buffer_load_dwordx4 v4,s[8:11],s23 offen offset:3072 sc1 lds
M v[160:163],v[216:219],a[216:219],v[160:163]
v_exp_f32 v25,v153
M v[160:163],v[212:215],a[212:215],v[160:163]
CV v57,v22,v23
v_add_f32 v6,v6,v22
M v[160:163],v[208:211],a[208:211],v[160:163]
s_waitcnt lgkmcnt(4)
v_add_f32 v6,v6,v23
M v[168:171],v[224:227],a[192:195],v[8:11]
ds_read_b128 v[192:195],v3 offset:49152
ds_read_b128 v[196:199],v3 offset:50176
M v[168:171],v[228:231],a[196:199],v[168:171]
ds_read_b128 v[200:203],v3 offset:51200
ds_read_b128 v[204:207],v3 offset:52224
M v[168:171],v[232:235],a[200:203],v[168:171]
v_exp_f32 v26,v154
M v[168:171],v[236:239],a[204:207],v[168:171]
s_add_u32 m0,s21,69632
v_exp_f32 v27,v155
M v[172:175],v[236:239],a[236:239],v[12:15]
buffer_load_dwordx4 v5,s[8:11],s23 offen sc1 lds
M v[172:175],v[232:235],a[232:235],v[172:175]
CV v58,v24,v25
v_add_f32 v6,v6,v24
M v[172:175],v[228:231],a[228:231],v[172:175]
v_add_f32 v6,v6,v25
M v[172:175],v[224:227],a[224:227],v[172:175]
s_waitcnt lgkmcnt(4)
v_exp_f32 v20,v148
M v[172:175],v[240:243],a[240:243],v[172:175]
ds_read_b128 v[208:211],v3 offset:53248
ds_read_b128 v[212:215],v3 offset:54272
M v[172:175],v[244:247],a[244:247],v[172:175]
ds_read_b128 v[216:219],v3 offset:55296
ds_read_b128 v[220:223],v3 offset:56320
M v[172:175],v[248:251],a[248:251],v[172:175]
v_exp_f32 v21,v149
M v[172:175],v[252:255],a[252:255],v[172:175]
CV v59,v26,v27
v_add_f32 v6,v6,v26
M v[168:171],v[252:255],a[220:223],v[168:171]
buffer_load_dwordx4 v5,s[8:11],s23 offen offset:1024 sc1 lds
M v[168:171],v[248:251],a[216:219],v[168:171]
v_add_f32 v6,v6,v27
M v[168:171],v[244:247],a[212:215],v[168:171]
v_exp_f32 v22,v150
M v[168:171],v[240:243],a[208:211],v[168:171]
s_waitcnt lgkmcnt(4)
v_exp_f32 v23,v151
M v[176:179],v[192:195],a[192:195],v[8:11]
ds_read_b128 v[224:227],v3 offset:57344
ds_read_b128 v[228:231],v3 offset:58368
M v[176:179],v[196:199],a[196:199],v[176:179]
ds_read_b128 v[232:235],v3 offset:59392
ds_read_b128 v[236:239],v3 offset:60416
M v[176:179],v[200:203],a[200:203],v[176:179]
CV v60,v20,v21
v_add_f32 v43,v43,v20
M v[176:179],v[204:207],a[204:207],v[176:179]
v_add_f32 v43,v43,v21
M v[180:183],v[204:207],a[236:239],v[12:15]
buffer_load_dwordx4 v5,s[8:11],s23 offen offset:2048 sc1 lds
M v[180:183],v[200:203],a[232:235],v[180:183]
v_exp_f32 v24,v156
M v[180:183],v[196:199],a[228:231],v[180:183]
v_exp_f32 v25,v157
M v[180:183],v[192:195],a[224:227],v[180:183]
s_waitcnt lgkmcnt(4)
CV v61,v22,v23
v_add_f32 v43,v43,v22
M v[180:183],v[208:211],a[240:243],v[180:183]
ds_read_b128 v[240:243],v3 offset:61440
ds_read_b128 v[244:247],v3 offset:62464
M v[180:183],v[212:215],a[244:247],v[180:183]
ds_read_b128 v[248:251],v3 offset:63488
ds_read_b128 v[252:255],v3 offset:64512
M v[180:183],v[216:219],a[248:251],v[180:183]
v_add_f32 v43,v43,v23
M v[180:183],v[220:223],a[252:255],v[180:183]
v_exp_f32 v26,v158
M v[176:179],v[220:223],a[220:223],v[176:179]
buffer_load_dwordx4 v5,s[8:11],s23 offen offset:3072 sc1 lds
M v[176:179],v[216:219],a[216:219],v[176:179]
v_exp_f32 v27,v159
M v[176:179],v[212:215],a[212:215],v[176:179]
CV v62,v24,v25
v_add_f32 v43,v43,v24
M v[176:179],v[208:211],a[208:211],v[176:179]
s_waitcnt vmcnt(16) lgkmcnt(0)
s_barrier
M v[184:187],v[224:227],a[192:195],v[8:11]
ds_read_b128 v[192:195],v2 offset:0
ds_read_b128 v[196:199],v2 offset:16384
M v[184:187],v[228:231],a[196:199],v[184:187]
ds_read_b128 v[200:203],v2 offset:1024
ds_read_b128 v[204:207],v2 offset:17408
M v[184:187],v[232:235],a[200:203],v[184:187]
v_add_f32 v43,v43,v25
v_add_f32 v43,v43,v26
M v[184:187],v[236:239],a[204:207],v[184:187]
s_add_u32 m0,s21,98304
CV v63,v26,v27
v_add_f32 v43,v43,v27
M v[188:191],v[236:239],a[236:239],v[12:15]
buffer_load_dwordx4 v4,s[4:7],s22 offen sc1 lds
M v[188:191],v[232:235],a[232:235],v[188:191]
s_add_u32 s23,s23,32768
v_add_f32 v30,v6,v43
v_cmp_ngt_f32 vcc,1.0,v30
M v[188:191],v[228:231],a[228:231],v[188:191]
M v[188:191],v[224:227],a[224:227],v[188:191]
M v[188:191],v[240:243],a[240:243],v[188:191]
ds_read_b128 v[208:211],v2 offset:2048
ds_read_b128 v[212:215],v2 offset:18432
M v[188:191],v[244:247],a[244:247],v[188:191]
ds_read_b128 v[216:219],v2 offset:3072
ds_read_b128 v[220:223],v2 offset:19456
M v[188:191],v[248:251],a[248:251],v[188:191]
M v[188:191],v[252:255],a[252:255],v[188:191]
s_cmp_eq_u32 s23,s42
s_cselect_b32 s23,s43,s23
M v[184:187],v[252:255],a[220:223],v[184:187]
buffer_load_dwordx4 v4,s[4:7],s22 offen offset:1024 sc1 lds
M v[184:187],v[248:251],a[216:219],v[184:187]
s_waitcnt lgkmcnt(4)
M v[184:187],v[244:247],a[212:215],v[184:187]
s_cmp_eq_u32 s24,2
M v[184:187],v[240:243],a[208:211],v[184:187]
s_cbranch_vccnz CK_4
CK_4R:
s_cbranch_scc1 K2_TAILM
M a[0:3],v[192:195],v[48:51],a[0:3]
ds_read_b128 v[224:227],v2 offset:4096
ds_read_b128 v[228:231],v2 offset:20480
M a[0:3],v[196:199],v[56:59],a[0:3]
ds_read_b128 v[232:235],v2 offset:5120
ds_read_b128 v[236:239],v2 offset:21504
M a[4:7],v[196:199],v[60:63],a[4:7]
v_add_f32 v127,v127,v6
v_add_f32 v46,v46,v43
M a[4:7],v[192:195],v[52:55],a[4:7]
v_exp_f32 v20,v160
M a[12:15],v[200:203],v[52:55],a[12:15]
buffer_load_dwordx4 v4,s[4:7],s22 offen offset:2048 sc1 lds
M a[12:15],v[204:207],v[60:63],a[12:15]
v_exp_f32 v21,v161
M a[8:11],v[204:207],v[56:59],a[8:11]
v_exp_f32 v22,v162
M a[8:11],v[200:203],v[48:51],a[8:11]
s_waitcnt lgkmcnt(4)
v_exp_f32 v23,v163
M a[16:19],v[208:211],v[48:51],a[16:19]
ds_read_b128 v[240:243],v2 offset:6144
ds_read_b128 v[244:247],v2 offset:22528
M a[16:19],v[212:215],v[56:59],a[16:19]
ds_read_b128 v[248:251],v2 offset:7168
ds_read_b128 v[252:255],v2 offset:23552
M a[20:23],v[212:215],v[60:63],a[20:23]
CV v64,v20,v21
v_add_f32 v6,v20,v21
M a[20:23],v[208:211],v[52:55],a[20:23]
v_exp_f32 v24,v168
M a[28:31],v[216:219],v[52:55],a[28:31]
buffer_load_dwordx4 v4,s[4:7],s22 offen offset:3072 sc1 lds
M a[28:31],v[220:223],v[60:63],a[28:31]
v_exp_f32 v25,v169
M a[24:27],v[220:223],v[56:59],a[24:27]
CV v65,v22,v23
v_add_f32 v6,v6,v22
M a[24:27],v[216:219],v[48:51],a[24:27]
s_waitcnt lgkmcnt(4)
v_add_f32 v6,v6,v23
M a[32:35],v[224:227],v[48:51],a[32:35]
ds_read_b128 v[192:195],v2 offset:8192
ds_read_b128 v[196:199],v2 offset:24576
M a[32:35],v[228:231],v[56:59],a[32:35]
ds_read_b128 v[200:203],v2 offset:9216
ds_read_b128 v[204:207],v2 offset:25600
M a[36:39],v[228:231],v[60:63],a[36:39]
v_exp_f32 v26,v170
M a[36:39],v[224:227],v[52:55],a[36:39]
s_add_u32 m0,s21,102400
v_exp_f32 v27,v171
M a[44:47],v[232:235],v[52:55],a[44:47]
buffer_load_dwordx4 v5,s[4:7],s22 offen sc1 lds
M a[44:47],v[236:239],v[60:63],a[44:47]
CV v66,v24,v25
v_add_f32 v6,v6,v24
M a[40:43],v[236:239],v[56:59],a[40:43]
v_add_f32 v6,v6,v25
M a[40:43],v[232:235],v[48:51],a[40:43]
s_waitcnt lgkmcnt(4)
v_exp_f32 v20,v164
M a[48:51],v[240:243],v[48:51],a[48:51]
ds_read_b128 v[208:211],v2 offset:10240
ds_read_b128 v[212:215],v2 offset:26624
M a[48:51],v[244:247],v[56:59],a[48:51]
ds_read_b128 v[216:219],v2 offset:11264
ds_read_b128 v[220:223],v2 offset:27648
M a[52:55],v[244:247],v[60:63],a[52:55]
buffer_load_dword v1,v45,s[64:67],0 offen
M a[52:55],v[240:243],v[52:55],a[52:55]
v_exp_f32 v21,v165
M a[60:63],v[248:251],v[52:55],a[60:63]
buffer_load_dwordx4 v5,s[4:7],s22 offen offset:1024 sc1 lds
M a[60:63],v[252:255],v[60:63],a[60:63]
CV v67,v26,v27
v_add_f32 v6,v6,v26
M a[56:59],v[252:255],v[56:59],a[56:59]
v_add_f32 v6,v6,v27
M a[56:59],v[248:251],v[48:51],a[56:59]
s_waitcnt lgkmcnt(4)
v_exp_f32 v22,v166
M a[64:67],v[192:195],v[48:51],a[64:67]
ds_read_b128 v[224:227],v2 offset:12288
ds_read_b128 v[228:231],v2 offset:28672
M a[64:67],v[196:199],v[56:59],a[64:67]
ds_read_b128 v[232:235],v2 offset:13312
ds_read_b128 v[236:239],v2 offset:29696
M a[68:71],v[196:199],v[60:63],a[68:71]
v_exp_f32 v23,v167
M a[68:71],v[192:195],v[52:55],a[68:71]
CV v68,v20,v21
v_add_f32 v43,v20,v21
M a[76:79],v[200:203],v[52:55],a[76:79]
buffer_load_dwordx4 v5,s[4:7],s22 offen offset:2048 sc1 lds
M a[76:79],v[204:207],v[60:63],a[76:79]
v_exp_f32 v24,v172
M a[72:75],v[204:207],v[56:59],a[72:75]
v_exp_f32 v25,v173
M a[72:75],v[200:203],v[48:51],a[72:75]
s_waitcnt lgkmcnt(4)
CV v69,v22,v23
v_add_f32 v43,v43,v22
M a[80:83],v[208:211],v[48:51],a[80:83]
ds_read_b128 v[240:243],v2 offset:14336
ds_read_b128 v[244:247],v2 offset:30720
M a[80:83],v[212:215],v[56:59],a[80:83]
ds_read_b128 v[248:251],v2 offset:15360
ds_read_b128 v[252:255],v2 offset:31744
M a[84:87],v[212:215],v[60:63],a[84:87]
v_add_f32 v43,v43,v23
M a[84:87],v[208:211],v[52:55],a[84:87]
v_exp_f32 v26,v174
M a[92:95],v[216:219],v[52:55],a[92:95]
buffer_load_dwordx4 v5,s[4:7],s22 offen offset:3072 sc1 lds
M a[92:95],v[220:223],v[60:63],a[92:95]
v_exp_f32 v27,v175
M a[88:91],v[220:223],v[56:59],a[88:91]
CV v70,v24,v25
v_add_f32 v43,v43,v24
M a[88:91],v[216:219],v[48:51],a[88:91]
s_waitcnt vmcnt(16) lgkmcnt(0)
s_barrier
M a[96:99],v[224:227],v[48:51],a[96:99]
ds_read_b128 v[192:195],v2 offset:32768
ds_read_b128 v[196:199],v2 offset:33792
M a[96:99],v[228:231],v[56:59],a[96:99]
ds_read_b128 v[200:203],v2 offset:34816
ds_read_b128 v[204:207],v2 offset:35840
M a[100:103],v[228:231],v[60:63],a[100:103]
v_add_f32 v43,v43,v25
v_add_f32 v43,v43,v26
M a[100:103],v[224:227],v[52:55],a[100:103]
s_add_u32 m0,s21,0
CV v71,v26,v27
v_add_f32 v43,v43,v27
M a[108:111],v[232:235],v[52:55],a[108:111]
buffer_load_dwordx4 v4,s[8:11],s23 offen sc1 lds
M a[108:111],v[236:239],v[60:63],a[108:111]
s_add_u32 s22,s22,32768
M a[104:107],v[236:239],v[56:59],a[104:107]
M a[104:107],v[232:235],v[48:51],a[104:107]
M a[112:115],v[240:243],v[48:51],a[112:115]
ds_read_b128 v[208:211],v2 offset:36864
ds_read_b128 v[212:215],v2 offset:37888
M a[112:115],v[244:247],v[56:59],a[112:115]
ds_read_b128 v[216:219],v2 offset:38912
ds_read_b128 v[220:223],v2 offset:39936
M a[116:119],v[244:247],v[60:63],a[116:119]
s_sub_u32 s24,s24,1
M a[116:119],v[240:243],v[52:55],a[116:119]
s_cmp_eq_u32 s22,s42
s_cselect_b32 s22,s43,s22
M a[124:127],v[248:251],v[52:55],a[124:127]
buffer_load_dwordx4 v4,s[8:11],s23 offen offset:1024 sc1 lds
M a[124:127],v[252:255],v[60:63],a[124:127]
s_cmp_eq_u32 s24,s39
s_cbranch_scc1 K2_HK0
K2_HK0R:
M a[120:123],v[252:255],v[56:59],a[120:123]
s_waitcnt lgkmcnt(4)
M a[120:123],v[248:251],v[48:51],a[120:123]
M v[128:131],v[192:195],a[192:195],v[8:11]
ds_read_b128 v[224:227],v2 offset:40960
ds_read_b128 v[228:231],v2 offset:41984
M v[128:131],v[196:199],a[196:199],v[128:131]
ds_read_b128 v[232:235],v2 offset:43008
ds_read_b128 v[236:239],v2 offset:44032
M v[128:131],v[200:203],a[200:203],v[128:131]
v_exp_f32 v20,v176
M v[128:131],v[204:207],a[204:207],v[128:131]
v_exp_f32 v21,v177
M v[132:135],v[204:207],a[236:239],v[12:15]
buffer_load_dwordx4 v4,s[8:11],s23 offen offset:2048 sc1 lds
M v[132:135],v[200:203],a[232:235],v[132:135]
v_exp_f32 v22,v178
M v[132:135],v[196:199],a[228:231],v[132:135]
v_exp_f32 v23,v179
M v[132:135],v[192:195],a[224:227],v[132:135]
s_waitcnt lgkmcnt(4)
CV v72,v20,v21
v_add_f32 v6,v6,v20
M v[132:135],v[208:211],a[240:243],v[132:135]
ds_read_b128 v[240:243],v2 offset:45056
ds_read_b128 v[244:247],v2 offset:46080
M v[132:135],v[212:215],a[244:247],v[132:135]
ds_read_b128 v[248:251],v2 offset:47104
ds_read_b128 v[252:255],v2 offset:48128
M v[132:135],v[216:219],a[248:251],v[132:135]
v_add_f32 v6,v6,v21
M v[132:135],v[220:223],a[252:255],v[132:135]
v_exp_f32 v24,v184
M v[128:131],v[220:223],a[220:223],v[128:131]
buffer_load_dwordx4 v4,s[8:11],s23 offen offset:3072 sc1 lds
M v[128:131],v[216:219],a[216:219],v[128:131]
v_exp_f32 v25,v185
M v[128:131],v[212:215],a[212:215],v[128:131]
CV v73,v22,v23
v_add_f32 v6,v6,v22
M v[128:131],v[208:211],a[208:211],v[128:131]
s_waitcnt lgkmcnt(4)
v_add_f32 v6,v6,v23
M v[136:139],v[224:227],a[192:195],v[8:11]
ds_read_b128 v[192:195],v2 offset:49152
ds_read_b128 v[196:199],v2 offset:50176
M v[136:139],v[228:231],a[196:199],v[136:139]
ds_read_b128 v[200:203],v2 offset:51200
ds_read_b128 v[204:207],v2 offset:52224
M v[136:139],v[232:235],a[200:203],v[136:139]
v_exp_f32 v26,v186
M v[136:139],v[236:239],a[204:207],v[136:139]
s_add_u32 m0,s21,4096
v_exp_f32 v27,v187
M v[140:143],v[236:239],a[236:239],v[12:15]
buffer_load_dwordx4 v5,s[8:11],s23 offen sc1 lds
M v[140:143],v[232:235],a[232:235],v[140:143]
CV v74,v24,v25
v_add_f32 v6,v6,v24
M v[140:143],v[228:231],a[228:231],v[140:143]
v_add_f32 v6,v6,v25
M v[140:143],v[224:227],a[224:227],v[140:143]
s_waitcnt lgkmcnt(4)
v_exp_f32 v20,v180
M v[140:143],v[240:243],a[240:243],v[140:143]
ds_read_b128 v[208:211],v2 offset:53248
ds_read_b128 v[212:215],v2 offset:54272
M v[140:143],v[244:247],a[244:247],v[140:143]
ds_read_b128 v[216:219],v2 offset:55296
ds_read_b128 v[220:223],v2 offset:56320
M v[140:143],v[248:251],a[248:251],v[140:143]
v_exp_f32 v21,v181
M v[140:143],v[252:255],a[252:255],v[140:143]
CV v75,v26,v27
v_add_f32 v6,v6,v26
M v[136:139],v[252:255],a[220:223],v[136:139]
buffer_load_dwordx4 v5,s[8:11],s23 offen offset:1024 sc1 lds
M v[136:139],v[248:251],a[216:219],v[136:139]
v_add_f32 v6,v6,v27
M v[136:139],v[244:247],a[212:215],v[136:139]
v_exp_f32 v22,v182
M v[136:139],v[240:243],a[208:211],v[136:139]
s_waitcnt lgkmcnt(4)
v_exp_f32 v23,v183
M v[144:147],v[192:195],a[192:195],v[8:11]
ds_read_b128 v[224:227],v2 offset:57344
ds_read_b128 v[228:231],v2 offset:58368
M v[144:147],v[196:199],a[196:199],v[144:147]
ds_read_b128 v[232:235],v2 offset:59392
ds_read_b128 v[236:239],v2 offset:60416
M v[144:147],v[200:203],a[200:203],v[144:147]
CV v76,v20,v21
v_add_f32 v43,v43,v20
M v[144:147],v[204:207],a[204:207],v[144:147]
v_add_f32 v43,v43,v21
M v[148:151],v[204:207],a[236:239],v[12:15]
buffer_load_dwordx4 v5,s[8:11],s23 offen offset:2048 sc1 lds
M v[148:151],v[200:203],a[232:235],v[148:151]
v_exp_f32 v24,v188
M v[148:151],v[196:199],a[228:231],v[148:151]
v_exp_f32 v25,v189
M v[148:151],v[192:195],a[224:227],v[148:151]
s_waitcnt lgkmcnt(4)
CV v77,v22,v23
v_add_f32 v43,v43,v22
M v[148:151],v[208:211],a[240:243],v[148:151]
ds_read_b128 v[240:243],v2 offset:61440
ds_read_b128 v[244:247],v2 offset:62464
M v[148:151],v[212:215],a[244:247],v[148:151]
ds_read_b128 v[248:251],v2 offset:63488
ds_read_b128 v[252:255],v2 offset:64512
M v[148:151],v[216:219],a[248:251],v[148:151]
v_add_f32 v43,v43,v23
M v[148:151],v[220:223],a[252:255],v[148:151]
v_exp_f32 v26,v190
M v[144:147],v[220:223],a[220:223],v[144:147]
buffer_load_dwordx4 v5,s[8:11],s23 offen offset:3072 sc1 lds
M v[144:147],v[216:219],a[216:219],v[144:147]
v_exp_f32 v27,v191
M v[144:147],v[212:215],a[212:215],v[144:147]
CV v78,v24,v25
v_add_f32 v43,v43,v24
M v[144:147],v[208:211],a[208:211],v[144:147]
s_waitcnt vmcnt(16) lgkmcnt(0)
s_barrier
M v[152:155],v[224:227],a[192:195],v[8:11]
ds_read_b128 v[192:195],v3 offset:0
ds_read_b128 v[196:199],v3 offset:16384
M v[152:155],v[228:231],a[196:199],v[152:155]
ds_read_b128 v[200:203],v3 offset:1024
ds_read_b128 v[204:207],v3 offset:17408
M v[152:155],v[232:235],a[200:203],v[152:155]
v_add_f32 v43,v43,v25
v_add_f32 v43,v43,v26
M v[152:155],v[236:239],a[204:207],v[152:155]
s_add_u32 m0,s21,32768
CV v79,v26,v27
v_add_f32 v43,v43,v27
M v[156:159],v[236:239],a[236:239],v[12:15]
buffer_load_dwordx4 v4,s[4:7],s22 offen sc1 lds
M v[156:159],v[232:235],a[232:235],v[156:159]
s_add_u32 s23,s23,32768
v_add_f32 v30,v6,v43
v_cmp_ngt_f32 vcc,1.0,v30
M v[156:159],v[228:231],a[228:231],v[156:159]
M v[156:159],v[224:227],a[224:227],v[156:159]
M v[156:159],v[240:243],a[240:243],v[156:159]
ds_read_b128 v[208:211],v3 offset:2048
ds_read_b128 v[212:215],v3 offset:18432
M v[156:159],v[244:247],a[244:247],v[156:159]
ds_read_b128 v[216:219],v3 offset:3072
ds_read_b128 v[220:223],v3 offset:19456
M v[156:159],v[248:251],a[248:251],v[156:159]
M v[156:159],v[252:255],a[252:255],v[156:159]
s_cmp_eq_u32 s23,s42
s_cselect_b32 s23,s43,s23
M v[152:155],v[252:255],a[220:223],v[152:155]
buffer_load_dwordx4 v4,s[4:7],s22 offen offset:1024 sc1 lds
M v[152:155],v[248:251],a[216:219],v[152:155]
s_waitcnt lgkmcnt(4)
M v[152:155],v[244:247],a[212:215],v[152:155]
s_cmp_eq_u32 s24,s25
M v[152:155],v[240:243],a[208:211],v[152:155]
s_cbranch_vccnz CK_5
CK_5R:
s_cbranch_scc0 K2_LOOP
M a[0:3],v[192:195],v[64:67],a[0:3]
ds_read_b128 v[224:227],v3 offset:4096
ds_read_b128 v[228:231],v3 offset:20480
M a[0:3],v[196:199],v[72:75],a[0:3]
ds_read_b128 v[232:235],v3 offset:5120
ds_read_b128 v[236:239],v3 offset:21504
v_add_f32 v127,v127,v6
s_lshl_b32 s31,s35,7
s_add_u32 s31,s31,136314880
M a[4:7],v[196:199],v[76:79],a[4:7]
buffer_load_dword v41,v40,s[12:15],s31 offen sc1
M a[4:7],v[192:195],v[68:71],a[4:7]
v_add_f32 v46,v46,v43
v_exp_f32 v20,v132
M a[12:15],v[200:203],v[68:71],a[12:15]
v_exp_f32 v21,v133
M a[12:15],v[204:207],v[76:79],a[12:15]
s_add_u32 m0,s21,131072
v_exp_f32 v22,v134
M a[8:11],v[204:207],v[72:75],a[8:11]
buffer_load_dwordx4 v112,s[16:19],s61 offen lds
M a[8:11],v[200:203],v[64:67],a[8:11]
s_waitcnt lgkmcnt(4)
v_exp_f32 v23,v135
CV v52,v20,v21
M a[16:19],v[208:211],v[64:67],a[16:19]
ds_read_b128 v[240:243],v3 offset:6144
ds_read_b128 v[244:247],v3 offset:22528
M a[16:19],v[212:215],v[72:75],a[16:19]
ds_read_b128 v[248:251],v3 offset:7168
ds_read_b128 v[252:255],v3 offset:23552
v_add_f32 v43,v20,v21
M a[20:23],v[212:215],v[76:79],a[20:23]
buffer_load_dwordx4 v113,s[16:19],s61 offen offset:1024 lds
M a[20:23],v[208:211],v[68:71],a[20:23]
v_exp_f32 v24,v140
M a[28:31],v[216:219],v[68:71],a[28:31]
v_exp_f32 v25,v141
M a[28:31],v[220:223],v[76:79],a[28:31]
CV v53,v22,v23
v_add_f32 v43,v43,v22
v_mov_b32 v30,0xff800000
M a[24:27],v[220:223],v[72:75],a[24:27]
buffer_load_dwordx4 v114,s[16:19],s61 offen offset:2048 lds
M a[24:27],v[216:219],v[64:67],a[24:27]
s_waitcnt lgkmcnt(4)
v_cmp_le_i32 s[44:45],0,v7
v_cmp_le_i32 s[46:47],1,v7
v_cmp_le_i32 s[48:49],2,v7
M a[32:35],v[224:227],v[64:67],a[32:35]
ds_read_b128 v[192:195],v3 offset:8192
ds_read_b128 v[196:199],v3 offset:24576
M a[32:35],v[228:231],v[72:75],a[32:35]
ds_read_b128 v[200:203],v3 offset:9216
ds_read_b128 v[204:207],v3 offset:25600
v_cmp_le_i32 s[50:51],3,v7
M a[36:39],v[228:231],v[76:79],a[36:39]
buffer_load_dwordx4 v115,s[16:19],s61 offen offset:3072 lds
M a[36:39],v[224:227],v[68:71],a[36:39]
v_cndmask_b32 v128,v30,v128,s[44:45]
v_cndmask_b32 v129,v30,v129,s[46:47]
v_cndmask_b32 v130,v30,v130,s[48:49]
M a[44:47],v[232:235],v[68:71],a[44:47]
v_cndmask_b32 v131,v30,v131,s[50:51]
v_cmp_le_i32 s[44:45],16,v7
M a[44:47],v[236:239],v[76:79],a[44:47]
s_add_u32 m0,s21,135168
v_cmp_le_i32 s[46:47],17,v7
v_cmp_le_i32 s[48:49],18,v7
v_cmp_le_i32 s[50:51],19,v7
M a[40:43],v[236:239],v[72:75],a[40:43]
buffer_load_dwordx4 v112,s[16:19],s56 offen lds
M a[40:43],v[232:235],v[64:67],a[40:43]
s_waitcnt lgkmcnt(4)
v_cndmask_b32 v136,v30,v136,s[44:45]
v_cndmask_b32 v137,v30,v137,s[46:47]
v_cndmask_b32 v138,v30,v138,s[48:49]
M a[48:51],v[240:243],v[64:67],a[48:51]
ds_read_b128 v[208:211],v3 offset:10240
ds_read_b128 v[212:215],v3 offset:26624
M a[48:51],v[244:247],v[72:75],a[48:51]
ds_read_b128 v[216:219],v3 offset:11264
ds_read_b128 v[220:223],v3 offset:27648
v_cndmask_b32 v139,v30,v139,s[50:51]
M a[52:55],v[244:247],v[76:79],a[52:55]
buffer_load_dwordx4 v113,s[16:19],s56 offen offset:1024 lds
M a[52:55],v[240:243],v[68:71],a[52:55]
v_add_f32 v43,v43,v23
v_exp_f32 v26,v142
M a[60:63],v[248:251],v[68:71],a[60:63]
v_exp_f32 v27,v143
M a[60:63],v[252:255],v[76:79],a[60:63]
CV v54,v24,v25
v_add_f32 v43,v43,v24
v_add_f32 v43,v43,v25
M a[56:59],v[252:255],v[72:75],a[56:59]
v_exp_f32 v20,v128
M a[56:59],v[248:251],v[64:67],a[56:59]
s_waitcnt lgkmcnt(4)
v_exp_f32 v21,v129
CV v55,v26,v27
M a[64:67],v[192:195],v[64:67],a[64:67]
ds_read_b128 v[224:227],v3 offset:12288
ds_read_b128 v[228:231],v3 offset:28672
M a[64:67],v[196:199],v[72:75],a[64:67]
ds_read_b128 v[232:235],v3 offset:13312
ds_read_b128 v[236:239],v3 offset:29696
v_add_f32 v43,v43,v26
M a[68:71],v[196:199],v[76:79],a[68:71]
buffer_load_dwordx4 v114,s[16:19],s56 offen offset:2048 lds
M a[68:71],v[192:195],v[68:71],a[68:71]
v_add_f32 v43,v43,v27
v_exp_f32 v22,v130
M a[76:79],v[200:203],v[68:71],a[76:79]
v_exp_f32 v23,v131
M a[76:79],v[204:207],v[76:79],a[76:79]
CV v48,v20,v21
v_add_f32 v6,v20,v21
M a[72:75],v[204:207],v[72:75],a[72:75]
v_exp_f32 v24,v136
M a[72:75],v[200:203],v[64:67],a[72:75]
s_waitcnt lgkmcnt(4)
v_exp_f32 v25,v137
CV v49,v22,v23
M a[80:83],v[208:211],v[64:67],a[80:83]
ds_read_b128 v[240:243],v3 offset:14336
ds_read_b128 v[244:247],v3 offset:30720
M a[80:83],v[212:215],v[72:75],a[80:83]
ds_read_b128 v[248:251],v3 offset:15360
ds_read_b128 v[252:255],v3 offset:31744
v_add_f32 v6,v6,v22
M a[84:87],v[212:215],v[76:79],a[84:87]
buffer_load_dwordx4 v115,s[16:19],s56 offen offset:3072 lds
M a[84:87],v[208:211],v[68:71],a[84:87]
v_add_f32 v6,v6,v23
v_exp_f32 v26,v138
M a[92:95],v[216:219],v[68:71],a[92:95]
v_exp_f32 v27,v139
M a[92:95],v[220:223],v[76:79],a[92:95]
CV v50,v24,v25
v_add_f32 v6,v6,v24
v_add_f32 v6,v6,v25
M a[88:91],v[220:223],v[72:75],a[88:91]
v_add_f32 v6,v6,v26
CV v51,v26,v27
M a[88:91],v[216:219],v[64:67],a[88:91]
v_add_f32 v6,v6,v27
s_waitcnt vmcnt(19) lgkmcnt(0)
s_barrier
M a[96:99],v[224:227],v[64:67],a[96:99]
ds_read_b128 v[192:195],v3 offset:32768
ds_read_b128 v[196:199],v3 offset:33792
M a[96:99],v[228:231],v[72:75],a[96:99]
ds_read_b128 v[200:203],v3 offset:34816
ds_read_b128 v[204:207],v3 offset:35840
v_cmp_le_i32 s[44:45],32,v7
M a[100:103],v[228:231],v[76:79],a[100:103]
v_cmp_le_i32 s[46:47],33,v7
v_cmp_le_i32 s[48:49],34,v7
M a[100:103],v[224:227],v[68:71],a[100:103]
s_add_u32 m0,s21,65536
v_cmp_le_i32 s[50:51],35,v7
v_cndmask_b32 v144,v30,v144,s[44:45]
v_cndmask_b32 v145,v30,v145,s[46:47]
M a[108:111],v[232:235],v[68:71],a[108:111]
buffer_load_dwordx4 v4,s[8:11],s23 offen sc1 lds
M a[108:111],v[236:239],v[76:79],a[108:111]
v_cndmask_b32 v146,v30,v146,s[48:49]
v_cndmask_b32 v147,v30,v147,s[50:51]
v_cmp_le_i32 s[44:45],48,v7
M a[104:107],v[236:239],v[72:75],a[104:107]
v_cmp_le_i32 s[46:47],49,v7
v_cmp_le_i32 s[48:49],50,v7
M a[104:107],v[232:235],v[64:67],a[104:107]
v_cmp_le_i32 s[50:51],51,v7
v_cndmask_b32 v152,v30,v152,s[44:45]
v_cndmask_b32 v153,v30,v153,s[46:47]
M a[112:115],v[240:243],v[64:67],a[112:115]
ds_read_b128 v[208:211],v3 offset:36864
ds_read_b128 v[212:215],v3 offset:37888
M a[112:115],v[244:247],v[72:75],a[112:115]
ds_read_b128 v[216:219],v3 offset:38912
ds_read_b128 v[220:223],v3 offset:39936
v_cndmask_b32 v154,v30,v154,s[48:49]
M a[116:119],v[244:247],v[76:79],a[116:119]
v_cndmask_b32 v155,v30,v155,s[50:51]
M a[116:119],v[240:243],v[68:71],a[116:119]
M a[124:127],v[248:251],v[68:71],a[124:127]
buffer_load_dwordx4 v4,s[8:11],s23 offen offset:1024 sc1 lds
M a[124:127],v[252:255],v[76:79],a[124:127]
M a[120:123],v[252:255],v[72:75],a[120:123]
s_waitcnt lgkmcnt(4)
M a[120:123],v[248:251],v[64:67],a[120:123]
K2_LAST:
M v[164:167],v[192:195],a[224:227],v[12:15]
ds_read_b128 v[224:227],v3 offset:40960
ds_read_b128 v[228:231],v3 offset:41984
M v[164:167],v[196:199],a[228:231],v[164:167]
ds_read_b128 v[232:235],v3 offset:43008
ds_read_b128 v[236:239],v3 offset:44032
v_exp_f32 v20,v144
M v[164:167],v[200:203],a[232:235],v[164:167]
buffer_load_dwordx4 v4,s[8:11],s23 offen offset:2048 sc1 lds
M v[164:167],v[204:207],a[236:239],v[164:167]
s_waitcnt lgkmcnt(4)
v_exp_f32 v21,v145
v_exp_f32 v22,v146
M v[164:167],v[208:211],a[240:243],v[164:167]
ds_read_b128 v[240:243],v3 offset:45056
ds_read_b128 v[244:247],v3 offset:46080
v_exp_f32 v23,v147
M v[164:167],v[212:215],a[244:247],v[164:167]
ds_read_b128 v[248:251],v3 offset:47104
ds_read_b128 v[252:255],v3 offset:48128
CV v56,v20,v21
M v[164:167],v[216:219],a[248:251],v[164:167]
buffer_load_dwordx4 v4,s[8:11],s23 offen offset:3072 sc1 lds
v_add_f32 v6,v6,v20
v_add_f32 v6,v6,v21
M v[164:167],v[220:223],a[252:255],v[164:167]
s_waitcnt lgkmcnt(4)
v_exp_f32 v24,v152
v_exp_f32 v25,v153
M v[172:175],v[224:227],a[224:227],v[12:15]
ds_read_b128 v[192:195],v3 offset:49152
ds_read_b128 v[196:199],v3 offset:50176
CV v57,v22,v23
M v[172:175],v[228:231],a[228:231],v[172:175]
ds_read_b128 v[200:203],v3 offset:51200
ds_read_b128 v[204:207],v3 offset:52224
s_add_u32 m0,s21,69632
v_add_f32 v6,v6,v22
v_add_f32 v6,v6,v23
M v[172:175],v[232:235],a[232:235],v[172:175]
buffer_load_dwordx4 v5,s[8:11],s23 offen sc1 lds
M v[172:175],v[236:239],a[236:239],v[172:175]
s_waitcnt lgkmcnt(4)
v_exp_f32 v26,v154
v_exp_f32 v27,v155
M v[172:175],v[240:243],a[240:243],v[172:175]
ds_read_b128 v[208:211],v3 offset:53248
ds_read_b128 v[212:215],v3 offset:54272
CV v58,v24,v25
v_add_f32 v6,v6,v24
M v[172:175],v[244:247],a[244:247],v[172:175]
ds_read_b128 v[216:219],v3 offset:55296
ds_read_b128 v[220:223],v3 offset:56320
v_add_f32 v6,v6,v25
M v[172:175],v[248:251],a[248:251],v[172:175]
buffer_load_dwordx4 v5,s[8:11],s23 offen offset:1024 sc1 lds
v_exp_f32 v20,v148
M v[172:175],v[252:255],a[252:255],v[172:175]
s_waitcnt lgkmcnt(4)
v_exp_f32 v21,v149
CV v59,v26,v27
v_add_f32 v6,v6,v26
M v[180:183],v[192:195],a[224:227],v[12:15]
ds_read_b128 v[224:227],v3 offset:57344
ds_read_b128 v[228:231],v3 offset:58368
v_add_f32 v6,v6,v27
M v[180:183],v[196:199],a[228:231],v[180:183]
ds_read_b128 v[232:235],v3 offset:59392
ds_read_b128 v[236:239],v3 offset:60416
v_exp_f32 v22,v150
M v[180:183],v[200:203],a[232:235],v[180:183]
buffer_load_dwordx4 v5,s[8:11],s23 offen offset:2048 sc1 lds
M v[180:183],v[204:207],a[236:239],v[180:183]
s_waitcnt lgkmcnt(4)
v_exp_f32 v23,v151
CV v60,v20,v21
v_add_f32 v43,v43,v20
M v[180:183],v[208:211],a[240:243],v[180:183]
ds_read_b128 v[240:243],v3 offset:61440
ds_read_b128 v[244:247],v3 offset:62464
v_add_f32 v43,v43,v21
M v[180:183],v[212:215],a[244:247],v[180:183]
ds_read_b128 v[248:251],v3 offset:63488
ds_read_b128 v[252:255],v3 offset:64512
M v[180:183],v[216:219],a[248:251],v[180:183]
buffer_load_dwordx4 v5,s[8:11],s23 offen offset:3072 sc1 lds
v_exp_f32 v24,v156
M v[180:183],v[220:223],a[252:255],v[180:183]
v_exp_f32 v25,v157
s_waitcnt vmcnt(16) lgkmcnt(0)
s_barrier
M v[188:191],v[224:227],a[224:227],v[12:15]
ds_read_b128 v[192:195],v2 offset:0
ds_read_b128 v[196:199],v2 offset:16384
CV v61,v22,v23
M v[188:191],v[228:231],a[228:231],v[188:191]
ds_read_b128 v[200:203],v2 offset:1024
ds_read_b128 v[204:207],v2 offset:17408
v_add_f32 v43,v43,v22
v_add_f32 v43,v43,v23
s_add_u32 s61,s61,128
s_add_u32 s56,s56,128
s_add_u32 m0,s21,98304
M v[188:191],v[232:235],a[232:235],v[188:191]
buffer_load_dwordx4 v112,s[16:19],s61 offen lds
M v[188:191],v[236:239],a[236:239],v[188:191]
s_add_u32 s23,s23,32768
v_exp_f32 v26,v158
v_exp_f32 v27,v159
M v[188:191],v[240:243],a[240:243],v[188:191]
ds_read_b128 v[208:211],v2 offset:2048
ds_read_b128 v[212:215],v2 offset:18432
CV v62,v24,v25
v_add_f32 v43,v43,v24
v_cmp_ne_u32 s[54:55],0,v41
M v[188:191],v[244:247],a[244:247],v[188:191]
s_cmp_eq_u32 s23,s42
s_cselect_b32 s23,s43,s23
ds_read_b128 v[216:219],v2 offset:3072
ds_read_b128 v[220:223],v2 offset:19456
v_add_f32 v43,v43,v25
M v[188:191],v[248:251],a[248:251],v[188:191]
buffer_load_dwordx4 v113,s[16:19],s61 offen offset:1024 lds
v_add_f32 v43,v43,v26
CV v63,v26,v27
s_waitcnt lgkmcnt(4)
M v[188:191],v[252:255],a[252:255],v[188:191]
v_add_f32 v43,v43,v27
v_add_f32 v30,v6,v43
v_cmp_ngt_f32 vcc,1.0,v30
s_andn2_b32 s30,s28,s54
s_cbranch_scc1 K2_PCK
K2_PCKR:
s_cbranch_vccnz CK_6
CK_6R:
M a[0:3],v[192:195],v[48:51],a[0:3]
ds_read_b128 v[224:227],v2 offset:4096
ds_read_b128 v[228:231],v2 offset:20480
v_add_f32 v127,v127,v6
M a[0:3],v[196:199],v[56:59],a[0:3]
ds_read_b128 v[232:235],v2 offset:5120
ds_read_b128 v[236:239],v2 offset:21504
v_add_f32 v46,v46,v43
s_add_u32 s32,s37,16384
M a[4:7],v[196:199],v[60:63],a[4:7]
buffer_load_dwordx4 v[108:111],v28,s[80:83],s32 offen sc1
v_mov_b32 v6,0
M a[4:7],v[192:195],v[52:55],a[4:7]
s_add_u32 s32,s37,0
v_mov_b32 v30,0xff800000
v_cmp_le_i32 s[44:45],0,v7
v_cmp_le_i32 s[46:47],1,v7
M a[12:15],v[200:203],v[52:55],a[12:15]
buffer_load_dwordx4 v[128:131],v28,s[80:83],s32 offen sc1
v_cmp_le_i32 s[48:49],2,v7
M a[12:15],v[204:207],v[60:63],a[12:15]
v_cmp_le_i32 s[50:51],3,v7
v_cndmask_b32 v164,v30,v164,s[44:45]
v_cndmask_b32 v165,v30,v165,s[46:47]
M a[8:11],v[204:207],v[56:59],a[8:11]
buffer_load_dwordx4 v[136:139],v28,s[80:83],s32 offen offset:1024 sc1
v_cndmask_b32 v166,v30,v166,s[48:49]
M a[8:11],v[200:203],v[48:51],a[8:11]
s_waitcnt lgkmcnt(4)
v_cndmask_b32 v167,v30,v167,s[50:51]
v_cmp_le_i32 s[44:45],16,v7
v_cmp_le_i32 s[46:47],17,v7
v_cmp_le_i32 s[48:49],18,v7
M a[16:19],v[208:211],v[48:51],a[16:19]
ds_read_b128 v[240:243],v2 offset:6144
ds_read_b128 v[244:247],v2 offset:22528
v_cmp_le_i32 s[50:51],19,v7
M a[16:19],v[212:215],v[56:59],a[16:19]
ds_read_b128 v[248:251],v2 offset:7168
ds_read_b128 v[252:255],v2 offset:23552
v_cndmask_b32 v172,v30,v172,s[44:45]
M a[20:23],v[212:215],v[60:63],a[20:23]
buffer_load_dwordx4 v[144:147],v28,s[80:83],s32 offen offset:2048 sc1
v_cndmask_b32 v173,v30,v173,s[46:47]
M a[20:23],v[208:211],v[52:55],a[20:23]
v_cndmask_b32 v174,v30,v174,s[48:49]
v_cndmask_b32 v175,v30,v175,s[50:51]
v_cmp_le_i32 s[44:45],32,v7
M a[28:31],v[216:219],v[52:55],a[28:31]
buffer_load_dwordx4 v[152:155],v28,s[80:83],s32 offen offset:3072 sc1
v_cmp_le_i32 s[46:47],33,v7
M a[28:31],v[220:223],v[60:63],a[28:31]
s_add_u32 s32,s37,4096
v_cmp_le_i32 s[48:49],34,v7
v_cmp_le_i32 s[50:51],35,v7
v_cndmask_b32 v180,v30,v180,s[44:45]
M a[24:27],v[220:223],v[56:59],a[24:27]
buffer_load_dwordx4 v[160:163],v28,s[80:83],s32 offen sc1
v_cndmask_b32 v181,v30,v181,s[46:47]
M a[24:27],v[216:219],v[48:51],a[24:27]
s_waitcnt lgkmcnt(4)
v_cndmask_b32 v182,v30,v182,s[48:49]
v_cndmask_b32 v183,v30,v183,s[50:51]
v_cmp_le_i32 s[44:45],48,v7
v_cmp_le_i32 s[46:47],49,v7
M a[32:35],v[224:227],v[48:51],a[32:35]
ds_read_b128 v[192:195],v2 offset:8192
ds_read_b128 v[196:199],v2 offset:24576
v_cmp_le_i32 s[48:49],50,v7
M a[32:35],v[228:231],v[56:59],a[32:35]
ds_read_b128 v[200:203],v2 offset:9216
ds_read_b128 v[204:207],v2 offset:25600
v_cmp_le_i32 s[50:51],51,v7
M a[36:39],v[228:231],v[60:63],a[36:39]
buffer_load_dwordx4 v[168:171],v28,s[80:83],s32 offen offset:1024 sc1
v_cndmask_b32 v188,v30,v188,s[44:45]
M a[36:39],v[224:227],v[52:55],a[36:39]
v_cndmask_b32 v189,v30,v189,s[46:47]
v_cndmask_b32 v190,v30,v190,s[48:49]
v_cndmask_b32 v191,v30,v191,s[50:51]
M a[44:47],v[232:235],v[52:55],a[44:47]
v_exp_f32 v20,v164
M a[44:47],v[236:239],v[60:63],a[44:47]
v_exp_f32 v21,v165
M a[40:43],v[236:239],v[56:59],a[40:43]
buffer_load_dwordx4 v[176:179],v28,s[80:83],s32 offen offset:2048 sc1
M a[40:43],v[232:235],v[48:51],a[40:43]
s_waitcnt lgkmcnt(4)
v_exp_f32 v22,v166
v_exp_f32 v23,v167
M a[48:51],v[240:243],v[48:51],a[48:51]
ds_read_b128 v[208:211],v2 offset:10240
ds_read_b128 v[212:215],v2 offset:26624
CV v68,v20,v21
M a[48:51],v[244:247],v[56:59],a[48:51]
ds_read_b128 v[216:219],v2 offset:11264
ds_read_b128 v[220:223],v2 offset:27648
v_add_f32 v43,v20,v21
M a[52:55],v[244:247],v[60:63],a[52:55]
buffer_load_dwordx4 v[184:187],v28,s[80:83],s32 offen offset:3072 sc1
M a[52:55],v[240:243],v[52:55],a[52:55]
s_add_u32 s32,s37,8192
v_exp_f32 v24,v172
M a[60:63],v[248:251],v[52:55],a[60:63]
buffer_load_dwordx4 v[80:83],v28,s[80:83],s32 offen sc1
M a[60:63],v[252:255],v[60:63],a[60:63]
v_exp_f32 v25,v173
CV v69,v22,v23
M a[56:59],v[252:255],v[56:59],a[56:59]
buffer_load_dwordx4 v[84:87],v28,s[80:83],s32 offen offset:1024 sc1
v_add_f32 v43,v43,v22
M a[56:59],v[248:251],v[48:51],a[56:59]
s_waitcnt lgkmcnt(4)
v_add_f32 v43,v43,v23
v_exp_f32 v26,v174
M a[64:67],v[192:195],v[48:51],a[64:67]
ds_read_b128 v[224:227],v2 offset:12288
ds_read_b128 v[228:231],v2 offset:28672
M a[64:67],v[196:199],v[56:59],a[64:67]
ds_read_b128 v[232:235],v2 offset:13312
ds_read_b128 v[236:239],v2 offset:29696
M a[68:71],v[196:199],v[60:63],a[68:71]
buffer_load_dwordx4 v[88:91],v28,s[80:83],s32 offen offset:2048 sc1
M a[68:71],v[192:195],v[52:55],a[68:71]
v_exp_f32 v27,v175
CV v70,v24,v25
M a[76:79],v[200:203],v[52:55],a[76:79]
v_add_f32 v43,v43,v24
v_add_f32 v43,v43,v25
M a[76:79],v[204:207],v[60:63],a[76:79]
v_exp_f32 v20,v180
M a[72:75],v[204:207],v[56:59],a[72:75]
buffer_load_dwordx4 v[92:95],v28,s[80:83],s32 offen offset:3072 sc1
M a[72:75],v[200:203],v[48:51],a[72:75]
s_waitcnt lgkmcnt(4)
v_exp_f32 v21,v181
CV v71,v26,v27
v_add_f32 v43,v43,v26
M a[80:83],v[208:211],v[48:51],a[80:83]
ds_read_b128 v[240:243],v2 offset:14336
ds_read_b128 v[244:247],v2 offset:30720
v_add_f32 v43,v43,v27
M a[80:83],v[212:215],v[56:59],a[80:83]
ds_read_b128 v[248:251],v2 offset:15360
ds_read_b128 v[252:255],v2 offset:31744
s_add_u32 s32,s37,12288
M a[84:87],v[212:215],v[60:63],a[84:87]
buffer_load_dwordx4 v[96:99],v28,s[80:83],s32 offen sc1
M a[84:87],v[208:211],v[52:55],a[84:87]
v_exp_f32 v22,v182
M a[92:95],v[216:219],v[52:55],a[92:95]
buffer_load_dwordx4 v[100:103],v28,s[80:83],s32 offen offset:1024 sc1
M a[92:95],v[220:223],v[60:63],a[92:95]
v_exp_f32 v23,v183
CV v76,v20,v21
M a[88:91],v[220:223],v[56:59],a[88:91]
buffer_load_dwordx4 v[104:107],v28,s[80:83],s32 offen offset:2048 sc1
v_add_f32 v43,v43,v20
M a[88:91],v[216:219],v[48:51],a[88:91]
v_add_f32 v43,v43,v21
s_waitcnt vmcnt(18) lgkmcnt(0)
s_barrier
M a[96:99],v[224:227],v[48:51],a[96:99]
ds_read_b128 v[192:195],v3 offset:0
ds_read_b128 v[196:199],v3 offset:16384
M a[96:99],v[228:231],v[56:59],a[96:99]
ds_read_b128 v[200:203],v3 offset:1024
ds_read_b128 v[204:207],v3 offset:17408
M a[100:103],v[228:231],v[60:63],a[100:103]
buffer_load_dwordx4 v[16:19],v28,s[80:83],s32 offen offset:3072 sc1
M a[100:103],v[224:227],v[52:55],a[100:103]
v_exp_f32 v24,v188
M a[108:111],v[232:235],v[52:55],a[108:111]
v_exp_f32 v25,v189
CV v77,v22,v23
M a[108:111],v[236:239],v[60:63],a[108:111]
v_add_f32 v43,v43,v22
v_add_f32 v43,v43,v23
M a[104:107],v[236:239],v[56:59],a[104:107]
buffer_load_dwordx4 v114,s[16:19],s61 offen offset:2048 lds
M a[104:107],v[232:235],v[48:51],a[104:107]
v_exp_f32 v26,v190
v_exp_f32 v27,v191
M a[112:115],v[240:243],v[48:51],a[112:115]
ds_read_b128 v[208:211],v3 offset:2048
ds_read_b128 v[212:215],v3 offset:18432
CV v78,v24,v25
M a[112:115],v[244:247],v[56:59],a[112:115]
ds_read_b128 v[216:219],v3 offset:3072
ds_read_b128 v[220:223],v3 offset:19456
v_add_f32 v43,v43,v24
M a[116:119],v[244:247],v[60:63],a[116:119]
buffer_load_dwordx4 v115,s[16:19],s61 offen offset:3072 lds
v_add_f32 v43,v43,v25
M a[116:119],v[240:243],v[52:55],a[116:119]
s_add_u32 m0,s21,102400
v_add_f32 v43,v43,v26
CV v79,v26,v27
v_add_f32 v43,v43,v27
M a[124:127],v[248:251],v[52:55],a[124:127]
buffer_load_dwordx4 v112,s[16:19],s56 offen lds
v_add_f32 v30,v6,v43
M a[124:127],v[252:255],v[60:63],a[124:127]
v_cmp_ngt_f32 vcc,1.0,v30
M a[120:123],v[252:255],v[56:59],a[120:123]
buffer_load_dwordx4 v113,s[16:19],s56 offen offset:1024 lds
s_waitcnt lgkmcnt(4)
M a[120:123],v[248:251],v[48:51],a[120:123]
s_nop 0
s_cbranch_vccnz CK_7
CK_7R:
M a[4:7],v[192:195],v[68:71],a[4:7]
ds_read_b128 v[224:227],v3 offset:4096
ds_read_b128 v[228:231],v3 offset:20480
M a[4:7],v[196:199],v[76:79],a[4:7]
ds_read_b128 v[232:235],v3 offset:5120
ds_read_b128 v[236:239],v3 offset:21504
M a[12:15],v[200:203],v[68:71],a[12:15]
buffer_load_dwordx4 v114,s[16:19],s56 offen offset:2048 lds
M a[12:15],v[204:207],v[76:79],a[12:15]
s_waitcnt lgkmcnt(4)
v_add_f32 v127,v127,v6
v_add_f32 v46,v46,v43
M a[20:23],v[208:211],v[68:71],a[20:23]
ds_read_b128 v[240:243],v3 offset:6144
ds_read_b128 v[244:247],v3 offset:22528
M a[20:23],v[212:215],v[76:79],a[20:23]
ds_read_b128 v[248:251],v3 offset:7168
ds_read_b128 v[252:255],v3 offset:23552
M a[28:31],v[216:219],v[68:71],a[28:31]
buffer_load_dwordx4 v115,s[16:19],s56 offen offset:3072 lds
M a[28:31],v[220:223],v[76:79],a[28:31]
s_waitcnt lgkmcnt(4)
M a[36:39],v[224:227],v[68:71],a[36:39]
ds_read_b128 v[192:195],v3 offset:8192
ds_read_b128 v[196:199],v3 offset:24576
M a[36:39],v[228:231],v[76:79],a[36:39]
ds_read_b128 v[200:203],v3 offset:9216
ds_read_b128 v[204:207],v3 offset:25600
s_add_u32 s61,s61,128
s_add_u32 s56,s56,128
s_add_u32 m0,s21,32768
M a[44:47],v[232:235],v[68:71],a[44:47]
buffer_load_dwordx4 v112,s[16:19],s61 offen lds
M a[44:47],v[236:239],v[76:79],a[44:47]
s_waitcnt lgkmcnt(4)
M a[52:55],v[240:243],v[68:71],a[52:55]
ds_read_b128 v[208:211],v3 offset:10240
ds_read_b128 v[212:215],v3 offset:26624
M a[52:55],v[244:247],v[76:79],a[52:55]
ds_read_b128 v[216:219],v3 offset:11264
ds_read_b128 v[220:223],v3 offset:27648
M a[60:63],v[248:251],v[68:71],a[60:63]
buffer_load_dwordx4 v113,s[16:19],s61 offen offset:1024 lds
M a[60:63],v[252:255],v[76:79],a[60:63]
s_waitcnt lgkmcnt(4)
M a[68:71],v[192:195],v[68:71],a[68:71]
ds_read_b128 v[224:227],v3 offset:12288
ds_read_b128 v[228:231],v3 offset:28672
M a[68:71],v[196:199],v[76:79],a[68:71]
ds_read_b128 v[232:235],v3 offset:13312
ds_read_b128 v[236:239],v3 offset:29696
M a[76:79],v[200:203],v[68:71],a[76:79]
buffer_load_dwordx4 v114,s[16:19],s61 offen offset:2048 lds
M a[76:79],v[204:207],v[76:79],a[76:79]
s_waitcnt lgkmcnt(4)
M a[84:87],v[208:211],v[68:71],a[84:87]
ds_read_b128 v[240:243],v3 offset:14336
ds_read_b128 v[244:247],v3 offset:30720
M a[84:87],v[212:215],v[76:79],a[84:87]
ds_read_b128 v[248:251],v3 offset:15360
ds_read_b128 v[252:255],v3 offset:31744
M a[92:95],v[216:219],v[68:71],a[92:95]
buffer_load_dwordx4 v115,s[16:19],s61 offen offset:3072 lds
M a[92:95],v[220:223],v[76:79],a[92:95]
s_waitcnt lgkmcnt(4)
M a[100:103],v[224:227],v[68:71],a[100:103]
M a[100:103],v[228:231],v[76:79],a[100:103]
s_add_u32 m0,s21,36864
M a[108:111],v[232:235],v[68:71],a[108:111]
buffer_load_dwordx4 v112,s[16:19],s56 offen lds
M a[108:111],v[236:239],v[76:79],a[108:111]
s_waitcnt lgkmcnt(0)
M a[116:119],v[240:243],v[68:71],a[116:119]
M a[116:119],v[244:247],v[76:79],a[116:119]
M a[124:127],v[248:251],v[68:71],a[124:127]
buffer_load_dwordx4 v113,s[16:19],s56 offen offset:1024 lds
M a[124:127],v[252:255],v[76:79],a[124:127]
K2_FINISH:
v_mov_b32 v34,v127
v_mov_b32 v35,v46
s_nop 0
v_permlane32_swap_b32 v34,v127
v_permlane32_swap_b32 v35,v46
s_nop 0
v_add_f32 v127,v34,v127
v_add_f32 v46,v35,v46
v_mov_b32 v34,v127
v_mov_b32 v35,v46
s_nop 0
v_permlane16_swap_b32 v34,v127
v_permlane16_swap_b32 v35,v46
s_nop 0
v_add_f32 v127,v34,v127
v_add_f32_e64 v46,v35,v46
s_lshl_b32 s30,s35,7
s_lshl_b32 s31,s74,3
s_add_u32 s30,s30,s31
s_add_u32 s30,s30,s20
s_mul_i32 s57,s30,14336
s_add_u32 s57,s57,104857600
s_cmp_eq_u32 s36,2
s_cbranch_scc0 K2_NORM
s_waitcnt vmcnt(12)
v_mov_b32 v35,0xffff0000
v_min_f32 v36,v8,v108
v_sub_f32 v37,v36,v8
v_sub_f32 v38,v36,v108
v_exp_f32 v37,v37
v_exp_f32 v38,v38
s_nop 0
v_mul_f32 v36,v37,v127
v_fmac_f32 v36,v38,v110
v_rcp_f32 v36,v36
s_nop 0
v_mul_f32 v30,v37,v36
v_mul_f32 v32,v38,v36
v_min_f32 v36,v12,v109
v_sub_f32 v37,v36,v12
v_sub_f32 v38,v36,v109
v_exp_f32 v37,v37
v_exp_f32 v38,v38
s_nop 0
v_mul_f32 v36,v37,v46
v_fmac_f32 v36,v38,v111
v_rcp_f32 v36,v36
s_nop 0
v_mul_f32 v31,v37,v36
v_mul_f32_e64 v33,v38,v36
AR v48,a0
AR v49,a1
AR v50,a2
AR v51,a3
AR v52,a8
AR v53,a9
AR v54,a10
AR v55,a11
v_pk_mul_f32 v[48:49],v[48:49],v[30:31] op_sel:[0,0] op_sel_hi:[1,0]
v_pk_mul_f32 v[50:51],v[50:51],v[30:31] op_sel:[0,0] op_sel_hi:[1,0]
v_pk_mul_f32 v[52:53],v[52:53],v[30:31] op_sel:[0,0] op_sel_hi:[1,0]
v_pk_mul_f32 v[54:55],v[54:55],v[30:31] op_sel:[0,0] op_sel_hi:[1,0]
v_lshlrev_b32 v56,16,v128
v_and_b32 v57,v35,v128
v_lshlrev_b32 v58,16,v129
v_and_b32 v59,v35,v129
v_lshlrev_b32 v60,16,v130
v_and_b32 v61,v35,v130
v_lshlrev_b32 v62,16,v131
v_and_b32 v63,v35,v131
v_pk_fma_f32 v[48:49],v[56:57],v[32:33],v[48:49] op_sel:[0,0,0] op_sel_hi:[1,0,1]
v_pk_fma_f32 v[50:51],v[58:59],v[32:33],v[50:51] op_sel:[0,0,0] op_sel_hi:[1,0,1]
v_pk_fma_f32 v[52:53],v[60:61],v[32:33],v[52:53] op_sel:[0,0,0] op_sel_hi:[1,0,1]
v_pk_fma_f32 v[54:55],v[62:63],v[32:33],v[54:55] op_sel:[0,0,0] op_sel_hi:[1,0,1]
CV v128,v48,v49
CV v129,v50,v51
CV v130,v52,v53
CV v131,v54,v55
buffer_load_dwordx4 v114,s[16:19],s56 offen offset:2048 lds
AR v48,a4
AR v49,a5
AR v50,a6
AR v51,a7
AR v52,a12
AR v53,a13
AR v54,a14
AR v55,a15
v_pk_mul_f32 v[48:49],v[48:49],v[30:31] op_sel:[0,1] op_sel_hi:[1,1]
v_pk_mul_f32 v[50:51],v[50:51],v[30:31] op_sel:[0,1] op_sel_hi:[1,1]
v_pk_mul_f32 v[52:53],v[52:53],v[30:31] op_sel:[0,1] op_sel_hi:[1,1]
v_pk_mul_f32 v[54:55],v[54:55],v[30:31] op_sel:[0,1] op_sel_hi:[1,1]
v_lshlrev_b32 v56,16,v136
v_and_b32 v57,v35,v136
v_lshlrev_b32 v58,16,v137
v_and_b32 v59,v35,v137
v_lshlrev_b32 v60,16,v138
v_and_b32 v61,v35,v138
v_lshlrev_b32 v62,16,v139
v_and_b32 v63,v35,v139
v_pk_fma_f32 v[48:49],v[56:57],v[32:33],v[48:49] op_sel:[0,1,0] op_sel_hi:[1,1,1]
v_pk_fma_f32 v[50:51],v[58:59],v[32:33],v[50:51] op_sel:[0,1,0] op_sel_hi:[1,1,1]
v_pk_fma_f32 v[52:53],v[60:61],v[32:33],v[52:53] op_sel:[0,1,0] op_sel_hi:[1,1,1]
v_pk_fma_f32 v[54:55],v[62:63],v[32:33],v[54:55] op_sel:[0,1,0] op_sel_hi:[1,1,1]
CV v132,v48,v49
CV v133,v50,v51
CV v134,v52,v53
CV v135,v54,v55
buffer_load_dwordx4 v115,s[16:19],s56 offen offset:3072 lds
AR v48,a16
AR v49,a17
AR v50,a18
AR v51,a19
AR v52,a24
AR v53,a25
AR v54,a26
AR v55,a27
v_pk_mul_f32 v[48:49],v[48:49],v[30:31] op_sel:[0,0] op_sel_hi:[1,0]
v_pk_mul_f32 v[50:51],v[50:51],v[30:31] op_sel:[0,0] op_sel_hi:[1,0]
v_pk_mul_f32 v[52:53],v[52:53],v[30:31] op_sel:[0,0] op_sel_hi:[1,0]
v_pk_mul_f32 v[54:55],v[54:55],v[30:31] op_sel:[0,0] op_sel_hi:[1,0]
v_lshlrev_b32 v56,16,v144
v_and_b32 v57,v35,v144
v_lshlrev_b32 v58,16,v145
v_and_b32 v59,v35,v145
v_lshlrev_b32 v60,16,v146
v_and_b32 v61,v35,v146
v_lshlrev_b32 v62,16,v147
v_and_b32 v63,v35,v147
v_pk_fma_f32 v[48:49],v[56:57],v[32:33],v[48:49] op_sel:[0,0,0] op_sel_hi:[1,0,1]
v_pk_fma_f32 v[50:51],v[58:59],v[32:33],v[50:51] op_sel:[0,0,0] op_sel_hi:[1,0,1]
v_pk_fma_f32 v[52:53],v[60:61],v[32:33],v[52:53] op_sel:[0,0,0] op_sel_hi:[1,0,1]
v_pk_fma_f32 v[54:55],v[62:63],v[32:33],v[54:55] op_sel:[0,0,0] op_sel_hi:[1,0,1]
CV v144,v48,v49
CV v145,v50,v51
CV v146,v52,v53
CV v147,v54,v55
AR v48,a20
AR v49,a21
AR v50,a22
AR v51,a23
AR v52,a28
AR v53,a29
AR v54,a30
AR v55,a31
v_pk_mul_f32 v[48:49],v[48:49],v[30:31] op_sel:[0,1] op_sel_hi:[1,1]
v_pk_mul_f32 v[50:51],v[50:51],v[30:31] op_sel:[0,1] op_sel_hi:[1,1]
v_pk_mul_f32 v[52:53],v[52:53],v[30:31] op_sel:[0,1] op_sel_hi:[1,1]
v_pk_mul_f32 v[54:55],v[54:55],v[30:31] op_sel:[0,1] op_sel_hi:[1,1]
v_lshlrev_b32 v56,16,v152
v_and_b32 v57,v35,v152
v_lshlrev_b32 v58,16,v153
v_and_b32 v59,v35,v153
v_lshlrev_b32 v60,16,v154
v_and_b32 v61,v35,v154
v_lshlrev_b32 v62,16,v155
v_and_b32 v63,v35,v155
v_pk_fma_f32 v[48:49],v[56:57],v[32:33],v[48:49] op_sel:[0,1,0] op_sel_hi:[1,1,1]
v_pk_fma_f32 v[50:51],v[58:59],v[32:33],v[50:51] op_sel:[0,1,0] op_sel_hi:[1,1,1]
v_pk_fma_f32 v[52:53],v[60:61],v[32:33],v[52:53] op_sel:[0,1,0] op_sel_hi:[1,1,1]
v_pk_fma_f32 v[54:55],v[62:63],v[32:33],v[54:55] op_sel:[0,1,0] op_sel_hi:[1,1,1]
CV v148,v48,v49
CV v149,v50,v51
CV v150,v52,v53
CV v151,v54,v55
AR v48,a32
AR v49,a33
AR v50,a34
AR v51,a35
AR v52,a40
AR v53,a41
AR v54,a42
AR v55,a43
v_pk_mul_f32 v[48:49],v[48:49],v[30:31] op_sel:[0,0] op_sel_hi:[1,0]
v_pk_mul_f32 v[50:51],v[50:51],v[30:31] op_sel:[0,0] op_sel_hi:[1,0]
v_pk_mul_f32 v[52:53],v[52:53],v[30:31] op_sel:[0,0] op_sel_hi:[1,0]
v_pk_mul_f32 v[54:55],v[54:55],v[30:31] op_sel:[0,0] op_sel_hi:[1,0]
v_lshlrev_b32 v56,16,v160
v_and_b32 v57,v35,v160
v_lshlrev_b32 v58,16,v161
v_and_b32 v59,v35,v161
v_lshlrev_b32 v60,16,v162
v_and_b32 v61,v35,v162
v_lshlrev_b32 v62,16,v163
v_and_b32 v63,v35,v163
v_pk_fma_f32 v[48:49],v[56:57],v[32:33],v[48:49] op_sel:[0,0,0] op_sel_hi:[1,0,1]
v_pk_fma_f32 v[50:51],v[58:59],v[32:33],v[50:51] op_sel:[0,0,0] op_sel_hi:[1,0,1]
v_pk_fma_f32 v[52:53],v[60:61],v[32:33],v[52:53] op_sel:[0,0,0] op_sel_hi:[1,0,1]
v_pk_fma_f32 v[54:55],v[62:63],v[32:33],v[54:55] op_sel:[0,0,0] op_sel_hi:[1,0,1]
CV v160,v48,v49
CV v161,v50,v51
CV v162,v52,v53
CV v163,v54,v55
AR v48,a36
AR v49,a37
AR v50,a38
AR v51,a39
AR v52,a44
AR v53,a45
AR v54,a46
AR v55,a47
v_pk_mul_f32 v[48:49],v[48:49],v[30:31] op_sel:[0,1] op_sel_hi:[1,1]
v_pk_mul_f32 v[50:51],v[50:51],v[30:31] op_sel:[0,1] op_sel_hi:[1,1]
v_pk_mul_f32 v[52:53],v[52:53],v[30:31] op_sel:[0,1] op_sel_hi:[1,1]
v_pk_mul_f32 v[54:55],v[54:55],v[30:31] op_sel:[0,1] op_sel_hi:[1,1]
v_lshlrev_b32 v56,16,v168
v_and_b32 v57,v35,v168
v_lshlrev_b32 v58,16,v169
v_and_b32 v59,v35,v169
v_lshlrev_b32 v60,16,v170
v_and_b32 v61,v35,v170
v_lshlrev_b32 v62,16,v171
v_and_b32 v63,v35,v171
v_pk_fma_f32 v[48:49],v[56:57],v[32:33],v[48:49] op_sel:[0,1,0] op_sel_hi:[1,1,1]
v_pk_fma_f32 v[50:51],v[58:59],v[32:33],v[50:51] op_sel:[0,1,0] op_sel_hi:[1,1,1]
v_pk_fma_f32 v[52:53],v[60:61],v[32:33],v[52:53] op_sel:[0,1,0] op_sel_hi:[1,1,1]
v_pk_fma_f32 v[54:55],v[62:63],v[32:33],v[54:55] op_sel:[0,1,0] op_sel_hi:[1,1,1]
CV v164,v48,v49
CV v165,v50,v51
CV v166,v52,v53
CV v167,v54,v55
AR v48,a48
AR v49,a49
AR v50,a50
AR v51,a51
AR v52,a56
AR v53,a57
AR v54,a58
AR v55,a59
v_pk_mul_f32 v[48:49],v[48:49],v[30:31] op_sel:[0,0] op_sel_hi:[1,0]
v_pk_mul_f32 v[50:51],v[50:51],v[30:31] op_sel:[0,0] op_sel_hi:[1,0]
v_pk_mul_f32 v[52:53],v[52:53],v[30:31] op_sel:[0,0] op_sel_hi:[1,0]
v_pk_mul_f32 v[54:55],v[54:55],v[30:31] op_sel:[0,0] op_sel_hi:[1,0]
v_lshlrev_b32 v56,16,v176
v_and_b32 v57,v35,v176
v_lshlrev_b32 v58,16,v177
v_and_b32 v59,v35,v177
v_lshlrev_b32 v60,16,v178
v_and_b32 v61,v35,v178
v_lshlrev_b32 v62,16,v179
v_and_b32 v63,v35,v179
v_pk_fma_f32 v[48:49],v[56:57],v[32:33],v[48:49] op_sel:[0,0,0] op_sel_hi:[1,0,1]
v_pk_fma_f32 v[50:51],v[58:59],v[32:33],v[50:51] op_sel:[0,0,0] op_sel_hi:[1,0,1]
v_pk_fma_f32 v[52:53],v[60:61],v[32:33],v[52:53] op_sel:[0,0,0] op_sel_hi:[1,0,1]
v_pk_fma_f32 v[54:55],v[62:63],v[32:33],v[54:55] op_sel:[0,0,0] op_sel_hi:[1,0,1]
CV v176,v48,v49
CV v177,v50,v51
CV v178,v52,v53
CV v179,v54,v55
AR v48,a52
AR v49,a53
AR v50,a54
AR v51,a55
AR v52,a60
AR v53,a61
AR v54,a62
AR v55,a63
v_pk_mul_f32 v[48:49],v[48:49],v[30:31] op_sel:[0,1] op_sel_hi:[1,1]
v_pk_mul_f32 v[50:51],v[50:51],v[30:31] op_sel:[0,1] op_sel_hi:[1,1]
v_pk_mul_f32 v[52:53],v[52:53],v[30:31] op_sel:[0,1] op_sel_hi:[1,1]
v_pk_mul_f32 v[54:55],v[54:55],v[30:31] op_sel:[0,1] op_sel_hi:[1,1]
v_lshlrev_b32 v56,16,v184
v_and_b32 v57,v35,v184
v_lshlrev_b32 v58,16,v185
v_and_b32 v59,v35,v185
v_lshlrev_b32 v60,16,v186
v_and_b32 v61,v35,v186
v_lshlrev_b32 v62,16,v187
v_and_b32 v63,v35,v187
v_pk_fma_f32 v[48:49],v[56:57],v[32:33],v[48:49] op_sel:[0,1,0] op_sel_hi:[1,1,1]
v_pk_fma_f32 v[50:51],v[58:59],v[32:33],v[50:51] op_sel:[0,1,0] op_sel_hi:[1,1,1]
v_pk_fma_f32 v[52:53],v[60:61],v[32:33],v[52:53] op_sel:[0,1,0] op_sel_hi:[1,1,1]
v_pk_fma_f32 v[54:55],v[62:63],v[32:33],v[54:55] op_sel:[0,1,0] op_sel_hi:[1,1,1]
CV v180,v48,v49
CV v181,v50,v51
CV v182,v52,v53
CV v183,v54,v55
AR v48,a64
AR v49,a65
AR v50,a66
AR v51,a67
AR v52,a72
AR v53,a73
AR v54,a74
AR v55,a75
v_pk_mul_f32 v[48:49],v[48:49],v[30:31] op_sel:[0,0] op_sel_hi:[1,0]
v_pk_mul_f32 v[50:51],v[50:51],v[30:31] op_sel:[0,0] op_sel_hi:[1,0]
v_pk_mul_f32 v[52:53],v[52:53],v[30:31] op_sel:[0,0] op_sel_hi:[1,0]
v_pk_mul_f32 v[54:55],v[54:55],v[30:31] op_sel:[0,0] op_sel_hi:[1,0]
v_lshlrev_b32 v56,16,v80
v_and_b32 v57,v35,v80
v_lshlrev_b32 v58,16,v81
v_and_b32 v59,v35,v81
v_lshlrev_b32 v60,16,v82
v_and_b32 v61,v35,v82
v_lshlrev_b32 v62,16,v83
v_and_b32 v63,v35,v83
v_pk_fma_f32 v[48:49],v[56:57],v[32:33],v[48:49] op_sel:[0,0,0] op_sel_hi:[1,0,1]
v_pk_fma_f32 v[50:51],v[58:59],v[32:33],v[50:51] op_sel:[0,0,0] op_sel_hi:[1,0,1]
v_pk_fma_f32 v[52:53],v[60:61],v[32:33],v[52:53] op_sel:[0,0,0] op_sel_hi:[1,0,1]
v_pk_fma_f32 v[54:55],v[62:63],v[32:33],v[54:55] op_sel:[0,0,0] op_sel_hi:[1,0,1]
CV v192,v48,v49
CV v193,v50,v51
CV v194,v52,v53
CV v195,v54,v55
AR v48,a68
AR v49,a69
AR v50,a70
AR v51,a71
AR v52,a76
AR v53,a77
AR v54,a78
AR v55,a79
v_pk_mul_f32 v[48:49],v[48:49],v[30:31] op_sel:[0,1] op_sel_hi:[1,1]
v_pk_mul_f32 v[50:51],v[50:51],v[30:31] op_sel:[0,1] op_sel_hi:[1,1]
v_pk_mul_f32 v[52:53],v[52:53],v[30:31] op_sel:[0,1] op_sel_hi:[1,1]
v_pk_mul_f32 v[54:55],v[54:55],v[30:31] op_sel:[0,1] op_sel_hi:[1,1]
v_lshlrev_b32 v56,16,v84
v_and_b32 v57,v35,v84
v_lshlrev_b32 v58,16,v85
v_and_b32 v59,v35,v85
v_lshlrev_b32 v60,16,v86
v_and_b32 v61,v35,v86
v_lshlrev_b32 v62,16,v87
v_and_b32 v63,v35,v87
v_pk_fma_f32 v[48:49],v[56:57],v[32:33],v[48:49] op_sel:[0,1,0] op_sel_hi:[1,1,1]
v_pk_fma_f32 v[50:51],v[58:59],v[32:33],v[50:51] op_sel:[0,1,0] op_sel_hi:[1,1,1]
v_pk_fma_f32 v[52:53],v[60:61],v[32:33],v[52:53] op_sel:[0,1,0] op_sel_hi:[1,1,1]
v_pk_fma_f32 v[54:55],v[62:63],v[32:33],v[54:55] op_sel:[0,1,0] op_sel_hi:[1,1,1]
CV v196,v48,v49
CV v197,v50,v51
CV v198,v52,v53
CV v199,v54,v55
AR v48,a80
AR v49,a81
AR v50,a82
AR v51,a83
AR v52,a88
AR v53,a89
AR v54,a90
AR v55,a91
v_pk_mul_f32 v[48:49],v[48:49],v[30:31] op_sel:[0,0] op_sel_hi:[1,0]
v_pk_mul_f32 v[50:51],v[50:51],v[30:31] op_sel:[0,0] op_sel_hi:[1,0]
v_pk_mul_f32 v[52:53],v[52:53],v[30:31] op_sel:[0,0] op_sel_hi:[1,0]
v_pk_mul_f32 v[54:55],v[54:55],v[30:31] op_sel:[0,0] op_sel_hi:[1,0]
v_lshlrev_b32 v56,16,v88
v_and_b32 v57,v35,v88
v_lshlrev_b32 v58,16,v89
v_and_b32 v59,v35,v89
v_lshlrev_b32 v60,16,v90
v_and_b32 v61,v35,v90
v_lshlrev_b32 v62,16,v91
v_and_b32 v63,v35,v91
v_pk_fma_f32 v[48:49],v[56:57],v[32:33],v[48:49] op_sel:[0,0,0] op_sel_hi:[1,0,1]
v_pk_fma_f32 v[50:51],v[58:59],v[32:33],v[50:51] op_sel:[0,0,0] op_sel_hi:[1,0,1]
v_pk_fma_f32 v[52:53],v[60:61],v[32:33],v[52:53] op_sel:[0,0,0] op_sel_hi:[1,0,1]
v_pk_fma_f32 v[54:55],v[62:63],v[32:33],v[54:55] op_sel:[0,0,0] op_sel_hi:[1,0,1]
CV v208,v48,v49
CV v209,v50,v51
CV v210,v52,v53
CV v211,v54,v55
AR v48,a84
AR v49,a85
AR v50,a86
AR v51,a87
AR v52,a92
AR v53,a93
AR v54,a94
AR v55,a95
v_pk_mul_f32 v[48:49],v[48:49],v[30:31] op_sel:[0,1] op_sel_hi:[1,1]
v_pk_mul_f32 v[50:51],v[50:51],v[30:31] op_sel:[0,1] op_sel_hi:[1,1]
v_pk_mul_f32 v[52:53],v[52:53],v[30:31] op_sel:[0,1] op_sel_hi:[1,1]
v_pk_mul_f32 v[54:55],v[54:55],v[30:31] op_sel:[0,1] op_sel_hi:[1,1]
v_lshlrev_b32 v56,16,v92
v_and_b32 v57,v35,v92
v_lshlrev_b32 v58,16,v93
v_and_b32 v59,v35,v93
v_lshlrev_b32 v60,16,v94
v_and_b32 v61,v35,v94
v_lshlrev_b32 v62,16,v95
v_and_b32 v63,v35,v95
v_pk_fma_f32 v[48:49],v[56:57],v[32:33],v[48:49] op_sel:[0,1,0] op_sel_hi:[1,1,1]
v_pk_fma_f32 v[50:51],v[58:59],v[32:33],v[50:51] op_sel:[0,1,0] op_sel_hi:[1,1,1]
v_pk_fma_f32 v[52:53],v[60:61],v[32:33],v[52:53] op_sel:[0,1,0] op_sel_hi:[1,1,1]
v_pk_fma_f32 v[54:55],v[62:63],v[32:33],v[54:55] op_sel:[0,1,0] op_sel_hi:[1,1,1]
CV v212,v48,v49
CV v213,v50,v51
CV v214,v52,v53
CV v215,v54,v55
s_waitcnt vmcnt(39)
s_barrier
ds_read_b64_tr_b16 v[136:137],v124 offset:0
ds_read_b64_tr_b16 v[138:139],v124 offset:2048
ds_read_b64_tr_b16 v[140:141],v124 offset:4096
ds_read_b64_tr_b16 v[142:143],v124 offset:6144
AR v48,a96
AR v49,a97
AR v50,a98
AR v51,a99
AR v52,a104
AR v53,a105
AR v54,a106
AR v55,a107
v_pk_mul_f32 v[48:49],v[48:49],v[30:31] op_sel:[0,0] op_sel_hi:[1,0]
v_pk_mul_f32 v[50:51],v[50:51],v[30:31] op_sel:[0,0] op_sel_hi:[1,0]
v_pk_mul_f32 v[52:53],v[52:53],v[30:31] op_sel:[0,0] op_sel_hi:[1,0]
v_pk_mul_f32 v[54:55],v[54:55],v[30:31] op_sel:[0,0] op_sel_hi:[1,0]
v_lshlrev_b32 v56,16,v96
v_and_b32 v57,v35,v96
v_lshlrev_b32 v58,16,v97
v_and_b32 v59,v35,v97
v_lshlrev_b32 v60,16,v98
v_and_b32 v61,v35,v98
v_lshlrev_b32 v62,16,v99
v_and_b32 v63,v35,v99
v_pk_fma_f32 v[48:49],v[56:57],v[32:33],v[48:49] op_sel:[0,0,0] op_sel_hi:[1,0,1]
v_pk_fma_f32 v[50:51],v[58:59],v[32:33],v[50:51] op_sel:[0,0,0] op_sel_hi:[1,0,1]
v_pk_fma_f32 v[52:53],v[60:61],v[32:33],v[52:53] op_sel:[0,0,0] op_sel_hi:[1,0,1]
v_pk_fma_f32 v[54:55],v[62:63],v[32:33],v[54:55] op_sel:[0,0,0] op_sel_hi:[1,0,1]
CV v224,v48,v49
CV v225,v50,v51
CV v226,v52,v53
CV v227,v54,v55
ds_read_b64_tr_b16 v[152:153],v124 offset:8192
ds_read_b64_tr_b16 v[154:155],v124 offset:10240
ds_read_b64_tr_b16 v[156:157],v124 offset:12288
ds_read_b64_tr_b16 v[158:159],v124 offset:14336
AR v48,a100
AR v49,a101
AR v50,a102
AR v51,a103
AR v52,a108
AR v53,a109
AR v54,a110
AR v55,a111
v_pk_mul_f32 v[48:49],v[48:49],v[30:31] op_sel:[0,1] op_sel_hi:[1,1]
v_pk_mul_f32 v[50:51],v[50:51],v[30:31] op_sel:[0,1] op_sel_hi:[1,1]
v_pk_mul_f32 v[52:53],v[52:53],v[30:31] op_sel:[0,1] op_sel_hi:[1,1]
v_pk_mul_f32 v[54:55],v[54:55],v[30:31] op_sel:[0,1] op_sel_hi:[1,1]
v_lshlrev_b32 v56,16,v100
v_and_b32 v57,v35,v100
v_lshlrev_b32 v58,16,v101
v_and_b32 v59,v35,v101
v_lshlrev_b32 v60,16,v102
v_and_b32 v61,v35,v102
v_lshlrev_b32 v62,16,v103
v_and_b32 v63,v35,v103
v_pk_fma_f32 v[48:49],v[56:57],v[32:33],v[48:49] op_sel:[0,1,0] op_sel_hi:[1,1,1]
v_pk_fma_f32 v[50:51],v[58:59],v[32:33],v[50:51] op_sel:[0,1,0] op_sel_hi:[1,1,1]
v_pk_fma_f32 v[52:53],v[60:61],v[32:33],v[52:53] op_sel:[0,1,0] op_sel_hi:[1,1,1]
v_pk_fma_f32 v[54:55],v[62:63],v[32:33],v[54:55] op_sel:[0,1,0] op_sel_hi:[1,1,1]
CV v228,v48,v49
CV v229,v50,v51
CV v230,v52,v53
CV v231,v54,v55
ds_read_b64_tr_b16 v[168:169],v124 offset:16384
ds_read_b64_tr_b16 v[170:171],v124 offset:18432
ds_read_b64_tr_b16 v[172:173],v124 offset:20480
ds_read_b64_tr_b16 v[174:175],v124 offset:22528
AR v48,a112
AR v49,a113
AR v50,a114
AR v51,a115
AR v52,a120
AR v53,a121
AR v54,a122
AR v55,a123
v_pk_mul_f32 v[48:49],v[48:49],v[30:31] op_sel:[0,0] op_sel_hi:[1,0]
v_pk_mul_f32 v[50:51],v[50:51],v[30:31] op_sel:[0,0] op_sel_hi:[1,0]
v_pk_mul_f32 v[52:53],v[52:53],v[30:31] op_sel:[0,0] op_sel_hi:[1,0]
v_pk_mul_f32 v[54:55],v[54:55],v[30:31] op_sel:[0,0] op_sel_hi:[1,0]
v_lshlrev_b32 v56,16,v104
v_and_b32 v57,v35,v104
v_lshlrev_b32 v58,16,v105
v_and_b32 v59,v35,v105
v_lshlrev_b32 v60,16,v106
v_and_b32 v61,v35,v106
v_lshlrev_b32 v62,16,v107
v_and_b32 v63,v35,v107
v_pk_fma_f32 v[48:49],v[56:57],v[32:33],v[48:49] op_sel:[0,0,0] op_sel_hi:[1,0,1]
v_pk_fma_f32 v[50:51],v[58:59],v[32:33],v[50:51] op_sel:[0,0,0] op_sel_hi:[1,0,1]
v_pk_fma_f32 v[52:53],v[60:61],v[32:33],v[52:53] op_sel:[0,0,0] op_sel_hi:[1,0,1]
v_pk_fma_f32 v[54:55],v[62:63],v[32:33],v[54:55] op_sel:[0,0,0] op_sel_hi:[1,0,1]
CV v240,v48,v49
CV v241,v50,v51
CV v242,v52,v53
CV v243,v54,v55
ds_read_b64_tr_b16 v[184:185],v124 offset:24576
ds_read_b64_tr_b16 v[186:187],v124 offset:26624
ds_read_b64_tr_b16 v[188:189],v124 offset:28672
ds_read_b64_tr_b16 v[190:191],v124 offset:30720
AR v48,a116
AR v49,a117
AR v50,a118
AR v51,a119
AR v52,a124
AR v53,a125
AR v54,a126
AR v55,a127
v_pk_mul_f32 v[48:49],v[48:49],v[30:31] op_sel:[0,1] op_sel_hi:[1,1]
v_pk_mul_f32 v[50:51],v[50:51],v[30:31] op_sel:[0,1] op_sel_hi:[1,1]
v_pk_mul_f32 v[52:53],v[52:53],v[30:31] op_sel:[0,1] op_sel_hi:[1,1]
v_pk_mul_f32 v[54:55],v[54:55],v[30:31] op_sel:[0,1] op_sel_hi:[1,1]
v_lshlrev_b32 v56,16,v16
v_and_b32 v57,v35,v16
v_lshlrev_b32 v58,16,v17
v_and_b32 v59,v35,v17
v_lshlrev_b32 v60,16,v18
v_and_b32 v61,v35,v18
v_lshlrev_b32 v62,16,v19
v_and_b32 v63,v35,v19
v_pk_fma_f32 v[48:49],v[56:57],v[32:33],v[48:49] op_sel:[0,1,0] op_sel_hi:[1,1,1]
v_pk_fma_f32 v[50:51],v[58:59],v[32:33],v[50:51] op_sel:[0,1,0] op_sel_hi:[1,1,1]
v_pk_fma_f32 v[52:53],v[60:61],v[32:33],v[52:53] op_sel:[0,1,0] op_sel_hi:[1,1,1]
v_pk_fma_f32 v[54:55],v[62:63],v[32:33],v[54:55] op_sel:[0,1,0] op_sel_hi:[1,1,1]
CV v244,v48,v49
CV v245,v50,v51
CV v246,v52,v53
CV v247,v54,v55
s_add_u32 s61,s61,128
s_add_u32 s56,s56,128
K2_OPROJ:
s_mov_b32 s22,0x11340213
s_add_u32 s23,s21,65536
s_add_u32 s24,s57,57344
s_mov_b32 s25,3
v_mov_b32 v120,v124
v_mov_b32 v121,v125
v_mov_b32 v122,v126
v_mov_b32 v123,v44
s_waitcnt lgkmcnt(8)
M v[48:51],v[136:139],v[128:131],0
ds_read_b64_tr_b16 v[200:201],v121 offset:0
ds_read_b64_tr_b16 v[202:203],v121 offset:2048
M v[48:51],v[140:143],v[144:147],v[48:51]
s_mov_b32 m0,s23
ds_read_b64_tr_b16 v[204:205],v121 offset:4096
ds_read_b64_tr_b16 v[206:207],v121 offset:6144
M v[48:51],v[152:155],v[160:163],v[48:51]
buffer_load_dwordx4 v112,s[16:19],s61 offen lds
M v[48:51],v[156:159],v[176:179],v[48:51]
ds_read_b64_tr_b16 v[216:217],v121 offset:8192
ds_read_b64_tr_b16 v[218:219],v121 offset:10240
M v[52:55],v[156:159],v[180:183],0
ds_read_b64_tr_b16 v[220:221],v121 offset:12288
ds_read_b64_tr_b16 v[222:223],v121 offset:14336
M v[52:55],v[152:155],v[164:167],v[52:55]
s_lshl_b32 s85,s74,11
s_add_u32 s85,s85,136323072
s_lshl_b32 s84,s35,2
M v[52:55],v[140:143],v[148:151],v[52:55]
s_add_u32 s84,s84,s85
s_lshl_b32 s30,s35,7
s_add_u32 s85,s85,s30
M v[52:55],v[136:139],v[132:135],v[52:55]
s_waitcnt lgkmcnt(8)
v_and_b32 v14,60,v40
v_lshrrev_b32 v18,6,v40
v_cmp_gt_u32 vcc,16,v0
v_mov_b32 v12,0x40000000
M v[52:55],v[168:171],v[196:199],v[52:55]
ds_read_b64_tr_b16 v[232:233],v121 offset:16384
ds_read_b64_tr_b16 v[234:235],v121 offset:18432
M v[52:55],v[172:175],v[212:215],v[52:55]
ds_read_b64_tr_b16 v[236:237],v121 offset:20480
ds_read_b64_tr_b16 v[238:239],v121 offset:22528
M v[52:55],v[184:187],v[228:231],v[52:55]
buffer_load_dwordx4 v113,s[16:19],s61 offen offset:1024 lds
M v[52:55],v[188:191],v[244:247],v[52:55]
ds_read_b64_tr_b16 v[248:249],v121 offset:24576
ds_read_b64_tr_b16 v[250:251],v121 offset:26624
M v[48:51],v[188:191],v[240:243],v[48:51]
ds_read_b64_tr_b16 v[252:253],v121 offset:28672
ds_read_b64_tr_b16 v[254:255],v121 offset:30720
M v[48:51],v[184:187],v[224:227],v[48:51]
v_lshlrev_b32 v16,7,v0
v_cndmask_b32 v12,v12,v16,vcc
v_mov_b32 v16,0
M v[48:51],v[172:175],v[208:211],v[48:51]
s_mov_b32 s30,1835008
v_mul_lo_u32 v30,v18,s30
v_and_b32 v31,28,v14
M v[48:51],v[168:171],v[192:195],v[48:51]
s_waitcnt lgkmcnt(8)
v_lshl_add_u32 v30,v31,2,v30
v_mul_u32_u24 v17,448,v31
v_and_b32 v31,32,v14
v_lshl_add_u32 v8,v31,5,v30
M v[56:59],v[200:203],v[128:131],0
ds_read_b64_tr_b16 v[136:137],v122 offset:0
ds_read_b64_tr_b16 v[138:139],v122 offset:2048
M v[56:59],v[204:207],v[144:147],v[56:59]
ds_read_b64_tr_b16 v[140:141],v122 offset:4096
ds_read_b64_tr_b16 v[142:143],v122 offset:6144
M v[56:59],v[216:219],v[160:163],v[56:59]
buffer_load_dwordx4 v114,s[16:19],s61 offen offset:2048 lds
M v[56:59],v[220:223],v[176:179],v[56:59]
ds_read_b64_tr_b16 v[152:153],v122 offset:8192
ds_read_b64_tr_b16 v[154:155],v122 offset:10240
M v[60:63],v[220:223],v[180:183],0
ds_read_b64_tr_b16 v[156:157],v122 offset:12288
ds_read_b64_tr_b16 v[158:159],v122 offset:14336
M v[60:63],v[216:219],v[164:167],v[60:63]
v_add_u32 v9,7340032,v8
v_add_u32 v10,14680064,v8
v_add_u32 v11,22020096,v8
M v[60:63],v[204:207],v[148:151],v[60:63]
v_lshl_add_u32 v17,v31,1,v17
v_lshrrev_b32 v31,1,v18
v_lshl_add_u32 v17,v31,4,v17
v_and_b32 v31,1,v18
M v[60:63],v[200:203],v[132:135],v[60:63]
s_waitcnt lgkmcnt(8)
v_lshl_add_u32 v17,v31,5,v17
s_lshl_b32 s32,s74,3
s_lshr_b32 s30,s35,1
M v[60:63],v[232:235],v[196:199],v[60:63]
ds_read_b64_tr_b16 v[168:169],v122 offset:16384
ds_read_b64_tr_b16 v[170:171],v122 offset:18432
M v[60:63],v[236:239],v[212:215],v[60:63]
ds_read_b64_tr_b16 v[172:173],v122 offset:20480
ds_read_b64_tr_b16 v[174:175],v122 offset:22528
M v[60:63],v[248:251],v[228:231],v[60:63]
buffer_load_dwordx4 v115,s[16:19],s61 offen offset:3072 lds
M v[60:63],v[252:255],v[244:247],v[60:63]
ds_read_b64_tr_b16 v[184:185],v122 offset:24576
ds_read_b64_tr_b16 v[186:187],v122 offset:26624
M v[56:59],v[252:255],v[240:243],v[56:59]
ds_read_b64_tr_b16 v[188:189],v122 offset:28672
ds_read_b64_tr_b16 v[190:191],v122 offset:30720
M v[56:59],v[248:251],v[224:227],v[56:59]
s_add_u32 s32,s32,s30
s_and_b32 s51,s35,1
s_mul_i32 s44,s32,14336
M v[56:59],v[236:239],v[208:211],v[56:59]
s_lshl_b32 s30,s51,7
s_add_u32 s44,s44,s30
s_lshl_b32 s30,s20,11
s_add_u32 s44,s44,s30
M v[56:59],v[232:235],v[192:195],v[56:59]
s_waitcnt lgkmcnt(8)
s_add_u32 s44,s44,104857600
s_add_u32 s45,s44,8192
s_add_u32 s46,s20,4
M v[64:67],v[136:139],v[128:131],0
ds_read_b64_tr_b16 v[200:201],v123 offset:0
ds_read_b64_tr_b16 v[202:203],v123 offset:2048
M v[64:67],v[140:143],v[144:147],v[64:67]
s_add_u32 m0,s23,4096
ds_read_b64_tr_b16 v[204:205],v123 offset:4096
ds_read_b64_tr_b16 v[206:207],v123 offset:6144
M v[64:67],v[152:155],v[160:163],v[64:67]
buffer_load_dwordx4 v112,s[16:19],s56 offen lds
M v[64:67],v[156:159],v[176:179],v[64:67]
ds_read_b64_tr_b16 v[216:217],v123 offset:8192
ds_read_b64_tr_b16 v[218:219],v123 offset:10240
M v[68:71],v[156:159],v[180:183],0
ds_read_b64_tr_b16 v[220:221],v123 offset:12288
ds_read_b64_tr_b16 v[222:223],v123 offset:14336
M v[68:71],v[152:155],v[164:167],v[68:71]
s_and_b32 s31,s22,15
s_lshl_b32 s32,s32,1
s_add_u32 s32,s32,s51
s_mul_i32 s50,s32,14336
M v[68:71],v[140:143],v[148:151],v[68:71]
s_lshl_b32 s31,s31,15
s_lshl_b32 s30,s20,7
s_add_u32 s50,s50,s30
s_add_u32 s50,s50,896
s_add_u32 s30,s20,1
M v[68:71],v[136:139],v[132:135],v[68:71]
s_waitcnt lgkmcnt(8)
s_lshr_b32 s30,s30,2
s_mul_i32 s48,s30,0x2222
v_lshrrev_b32 v30,3,v14
M v[68:71],v[168:171],v[196:199],v[68:71]
ds_read_b64_tr_b16 v[232:233],v123 offset:16384
ds_read_b64_tr_b16 v[234:235],v123 offset:18432
M v[68:71],v[172:175],v[212:215],v[68:71]
ds_read_b64_tr_b16 v[236:237],v123 offset:20480
ds_read_b64_tr_b16 v[238:239],v123 offset:22528
M v[68:71],v[184:187],v[228:231],v[68:71]
buffer_load_dwordx4 v113,s[16:19],s56 offen offset:1024 lds
M v[68:71],v[188:191],v[244:247],v[68:71]
ds_read_b64_tr_b16 v[248:249],v123 offset:24576
ds_read_b64_tr_b16 v[250:251],v123 offset:26624
M v[64:67],v[188:191],v[240:243],v[64:67]
ds_read_b64_tr_b16 v[252:253],v123 offset:28672
ds_read_b64_tr_b16 v[254:255],v123 offset:30720
M v[64:67],v[184:187],v[224:227],v[64:67]
v_add_u32 v120,s31,v116
v_add_u32 v121,s31,v117
M v[64:67],v[172:175],v[208:211],v[64:67]
v_add_u32 v122,s31,v118
v_add_u32 v123,s31,v119
M v[64:67],v[168:171],v[192:195],v[64:67]
s_waitcnt vmcnt(6) lgkmcnt(0)
s_barrier
M v[72:75],v[200:203],v[128:131],0
s_lshr_b32 s22,s22,4
ds_read_b64_tr_b16 v[136:137],v120 offset:0
ds_read_b64_tr_b16 v[138:139],v120 offset:2048
M v[72:75],v[204:207],v[144:147],v[72:75]
s_bfe_u32 s23,s22,0x40008
ds_read_b64_tr_b16 v[140:141],v120 offset:4096
ds_read_b64_tr_b16 v[142:143],v120 offset:6144
M v[72:75],v[216:219],v[160:163],v[72:75]
buffer_load_dwordx4 v114,s[16:19],s56 offen offset:2048 lds
M v[72:75],v[220:223],v[176:179],v[72:75]
s_lshl_b32 s23,s23,15
ds_read_b64_tr_b16 v[152:153],v120 offset:8192
ds_read_b64_tr_b16 v[154:155],v120 offset:10240
M v[76:79],v[220:223],v[180:183],0
s_add_u32 s23,s23,s21
ds_read_b64_tr_b16 v[156:157],v120 offset:12288
ds_read_b64_tr_b16 v[158:159],v120 offset:14336
M v[76:79],v[216:219],v[164:167],v[76:79]
v_and_b32 v31,4,v14
v_lshlrev_b32_e64 v31,2,v31
v_mov_b32 v18,0x3f80
v_lshlrev_b32 v31,v31,v18
M v[76:79],v[204:207],v[148:151],v[76:79]
v_cmp_eq_u32 s[54:55],0,v30
v_cmp_eq_u32 s[86:87],1,v30
v_cmp_eq_u32 s[88:89],2,v30
M v[76:79],v[200:203],v[132:135],v[76:79]
v_cmp_eq_u32 s[90:91],3,v30
v_cndmask_b32 v32,0,v31,s[54:55]
v_cndmask_b32 v33,0,v31,s[86:87]
M v[76:79],v[232:235],v[196:199],v[76:79]
ds_read_b64_tr_b16 v[168:169],v120 offset:16384
ds_read_b64_tr_b16 v[170:171],v120 offset:18432
M v[76:79],v[236:239],v[212:215],v[76:79]
ds_read_b64_tr_b16 v[172:173],v120 offset:20480
ds_read_b64_tr_b16 v[174:175],v120 offset:22528
M v[76:79],v[248:251],v[228:231],v[76:79]
buffer_load_dwordx4 v115,s[16:19],s56 offen offset:3072 lds
M v[76:79],v[252:255],v[244:247],v[76:79]
s_add_u32 s61,s61,128
ds_read_b64_tr_b16 v[184:185],v120 offset:24576
ds_read_b64_tr_b16 v[186:187],v120 offset:26624
M v[72:75],v[252:255],v[240:243],v[72:75]
s_add_u32 s56,s56,128
ds_read_b64_tr_b16 v[188:189],v120 offset:28672
ds_read_b64_tr_b16 v[190:191],v120 offset:30720
M v[72:75],v[248:251],v[224:227],v[72:75]
v_cndmask_b32 v34,0,v31,s[88:89]
v_cndmask_b32 v35,0,v31,s[90:91]
v_cmp_eq_u32 s[54:55],4,v30
v_cmp_eq_u32 s[86:87],5,v30
M v[72:75],v[236:239],v[208:211],v[72:75]
v_cmp_eq_u32 s[88:89],6,v30
v_cmp_eq_u32 s[90:91],7,v30
v_cndmask_b32 v36,0,v31,s[54:55]
M v[72:75],v[232:235],v[192:195],v[72:75]
s_waitcnt lgkmcnt(8)
v_cndmask_b32 v37,0,v31,s[86:87]
v_cndmask_b32 v38,0,v31,s[88:89]
v_cndmask_b32 v39,0,v31,s[90:91]
v_mov_b32 v13,3
.p2align 6
K2_OL:
M v[80:83],v[136:139],v[128:131],0
ds_read_b64_tr_b16 v[200:201],v121 offset:0
ds_read_b64_tr_b16 v[202:203],v121 offset:2048
M v[80:83],v[140:143],v[144:147],v[80:83]
s_mov_b32 m0,s23
ds_read_b64_tr_b16 v[204:205],v121 offset:4096
ds_read_b64_tr_b16 v[206:207],v121 offset:6144
M v[80:83],v[152:155],v[160:163],v[80:83]
buffer_load_dwordx4 v112,s[16:19],s61 offen lds
M v[80:83],v[156:159],v[176:179],v[80:83]
ds_read_b64_tr_b16 v[216:217],v121 offset:8192
ds_read_b64_tr_b16 v[218:219],v121 offset:10240
M v[84:87],v[156:159],v[180:183],0
ds_read_b64_tr_b16 v[220:221],v121 offset:12288
ds_read_b64_tr_b16 v[222:223],v121 offset:14336
M v[84:87],v[152:155],v[164:167],v[84:87]
CV v20,v48,v49
CV v21,v50,v51
M v[84:87],v[140:143],v[148:151],v[84:87]
CV v22,v56,v57
CV v23,v58,v59
M v[84:87],v[136:139],v[132:135],v[84:87]
s_waitcnt lgkmcnt(8)
buffer_store_dwordx4 v[20:23],v28,s[12:15],s57 offen sc1
M v[84:87],v[168:171],v[196:199],v[84:87]
ds_read_b64_tr_b16 v[232:233],v121 offset:16384
ds_read_b64_tr_b16 v[234:235],v121 offset:18432
M v[84:87],v[172:175],v[212:215],v[84:87]
ds_read_b64_tr_b16 v[236:237],v121 offset:20480
ds_read_b64_tr_b16 v[238:239],v121 offset:22528
M v[84:87],v[184:187],v[228:231],v[84:87]
buffer_load_dwordx4 v113,s[16:19],s61 offen offset:1024 lds
M v[84:87],v[188:191],v[244:247],v[84:87]
ds_read_b64_tr_b16 v[248:249],v121 offset:24576
ds_read_b64_tr_b16 v[250:251],v121 offset:26624
M v[80:83],v[188:191],v[240:243],v[80:83]
ds_read_b64_tr_b16 v[252:253],v121 offset:28672
ds_read_b64_tr_b16 v[254:255],v121 offset:30720
M v[80:83],v[184:187],v[224:227],v[80:83]
CV v24,v52,v53
CV v25,v54,v55
M v[80:83],v[172:175],v[208:211],v[80:83]
CV v26,v60,v61
CV v27,v62,v63
M v[80:83],v[168:171],v[192:195],v[80:83]
s_waitcnt lgkmcnt(8)
buffer_store_dwordx4 v[24:27],v28,s[12:15],s24 offen sc1
M v[88:91],v[200:203],v[128:131],0
ds_read_b64_tr_b16 v[136:137],v122 offset:0
ds_read_b64_tr_b16 v[138:139],v122 offset:2048
M v[88:91],v[204:207],v[144:147],v[88:91]
ds_read_b64_tr_b16 v[140:141],v122 offset:4096
ds_read_b64_tr_b16 v[142:143],v122 offset:6144
M v[88:91],v[216:219],v[160:163],v[88:91]
buffer_load_dwordx4 v114,s[16:19],s61 offen offset:2048 lds
M v[88:91],v[220:223],v[176:179],v[88:91]
ds_read_b64_tr_b16 v[152:153],v122 offset:8192
ds_read_b64_tr_b16 v[154:155],v122 offset:10240
M v[92:95],v[220:223],v[180:183],0
ds_read_b64_tr_b16 v[156:157],v122 offset:12288
ds_read_b64_tr_b16 v[158:159],v122 offset:14336
M v[92:95],v[216:219],v[164:167],v[92:95]
CV v20,v64,v65
CV v21,v66,v67
M v[92:95],v[204:207],v[148:151],v[92:95]
CV v22,v72,v73
CV v23,v74,v75
M v[92:95],v[200:203],v[132:135],v[92:95]
s_waitcnt lgkmcnt(8)
buffer_store_dwordx4 v[20:23],v28,s[12:15],s57 offen offset:1024 sc1
M v[92:95],v[232:235],v[196:199],v[92:95]
ds_read_b64_tr_b16 v[168:169],v122 offset:16384
ds_read_b64_tr_b16 v[170:171],v122 offset:18432
M v[92:95],v[236:239],v[212:215],v[92:95]
ds_read_b64_tr_b16 v[172:173],v122 offset:20480
ds_read_b64_tr_b16 v[174:175],v122 offset:22528
M v[92:95],v[248:251],v[228:231],v[92:95]
buffer_load_dwordx4 v115,s[16:19],s61 offen offset:3072 lds
M v[92:95],v[252:255],v[244:247],v[92:95]
ds_read_b64_tr_b16 v[184:185],v122 offset:24576
ds_read_b64_tr_b16 v[186:187],v122 offset:26624
M v[88:91],v[252:255],v[240:243],v[88:91]
ds_read_b64_tr_b16 v[188:189],v122 offset:28672
ds_read_b64_tr_b16 v[190:191],v122 offset:30720
M v[88:91],v[248:251],v[224:227],v[88:91]
CV v24,v68,v69
CV v25,v70,v71
M v[88:91],v[236:239],v[208:211],v[88:91]
CV v26,v76,v77
CV v27,v78,v79
M v[88:91],v[232:235],v[192:195],v[88:91]
s_waitcnt lgkmcnt(8)
buffer_store_dwordx4 v[24:27],v28,s[12:15],s24 offen offset:1024 sc1
M v[96:99],v[136:139],v[128:131],0
ds_read_b64_tr_b16 v[200:201],v123 offset:0
ds_read_b64_tr_b16 v[202:203],v123 offset:2048
M v[96:99],v[140:143],v[144:147],v[96:99]
s_add_u32 m0,s23,4096
ds_read_b64_tr_b16 v[204:205],v123 offset:4096
ds_read_b64_tr_b16 v[206:207],v123 offset:6144
M v[96:99],v[152:155],v[160:163],v[96:99]
buffer_load_dwordx4 v112,s[16:19],s56 offen lds
M v[96:99],v[156:159],v[176:179],v[96:99]
s_add_u32 s57,s57,2048
ds_read_b64_tr_b16 v[216:217],v123 offset:8192
ds_read_b64_tr_b16 v[218:219],v123 offset:10240
M v[100:103],v[156:159],v[180:183],0
s_add_u32 s24,s24,2048
ds_read_b64_tr_b16 v[220:221],v123 offset:12288
ds_read_b64_tr_b16 v[222:223],v123 offset:14336
M v[100:103],v[152:155],v[164:167],v[100:103]
s_and_b32 s31,s22,15
M v[100:103],v[140:143],v[148:151],v[100:103]
s_lshl_b32 s31,s31,15
M v[100:103],v[136:139],v[132:135],v[100:103]
s_waitcnt lgkmcnt(8)
M v[100:103],v[168:171],v[196:199],v[100:103]
ds_read_b64_tr_b16 v[232:233],v123 offset:16384
ds_read_b64_tr_b16 v[234:235],v123 offset:18432
M v[100:103],v[172:175],v[212:215],v[100:103]
ds_read_b64_tr_b16 v[236:237],v123 offset:20480
ds_read_b64_tr_b16 v[238:239],v123 offset:22528
M v[100:103],v[184:187],v[228:231],v[100:103]
buffer_load_dwordx4 v113,s[16:19],s56 offen offset:1024 lds
M v[100:103],v[188:191],v[244:247],v[100:103]
ds_read_b64_tr_b16 v[248:249],v123 offset:24576
ds_read_b64_tr_b16 v[250:251],v123 offset:26624
M v[96:99],v[188:191],v[240:243],v[96:99]
ds_read_b64_tr_b16 v[252:253],v123 offset:28672
ds_read_b64_tr_b16 v[254:255],v123 offset:30720
M v[96:99],v[184:187],v[224:227],v[96:99]
v_add_u32 v120,s31,v116
v_add_u32 v121,s31,v117
M v[96:99],v[172:175],v[208:211],v[96:99]
v_add_u32 v122,s31,v118
v_add_u32 v123,s31,v119
M v[96:99],v[168:171],v[192:195],v[96:99]
s_waitcnt vmcnt(22) lgkmcnt(0)
s_barrier
M v[104:107],v[200:203],v[128:131],0
s_lshr_b32 s22,s22,4
ds_read_b64_tr_b16 v[136:137],v120 offset:0
ds_read_b64_tr_b16 v[138:139],v120 offset:2048
M v[104:107],v[204:207],v[144:147],v[104:107]
s_bfe_u32 s23,s22,0x40008
ds_read_b64_tr_b16 v[140:141],v120 offset:4096
ds_read_b64_tr_b16 v[142:143],v120 offset:6144
M v[104:107],v[216:219],v[160:163],v[104:107]
buffer_load_dwordx4 v114,s[16:19],s56 offen offset:2048 lds
M v[104:107],v[220:223],v[176:179],v[104:107]
s_lshl_b32 s23,s23,15
ds_read_b64_tr_b16 v[152:153],v120 offset:8192
ds_read_b64_tr_b16 v[154:155],v120 offset:10240
M v[108:111],v[220:223],v[180:183],0
s_add_u32 s23,s23,s21
ds_read_b64_tr_b16 v[156:157],v120 offset:12288
ds_read_b64_tr_b16 v[158:159],v120 offset:14336
M v[108:111],v[216:219],v[164:167],v[108:111]
M v[108:111],v[204:207],v[148:151],v[108:111]
M v[108:111],v[200:203],v[132:135],v[108:111]
M v[108:111],v[232:235],v[196:199],v[108:111]
ds_read_b64_tr_b16 v[168:169],v120 offset:16384
ds_read_b64_tr_b16 v[170:171],v120 offset:18432
M v[108:111],v[236:239],v[212:215],v[108:111]
ds_read_b64_tr_b16 v[172:173],v120 offset:20480
ds_read_b64_tr_b16 v[174:175],v120 offset:22528
M v[108:111],v[248:251],v[228:231],v[108:111]
buffer_load_dwordx4 v115,s[16:19],s56 offen offset:3072 lds
M v[108:111],v[252:255],v[244:247],v[108:111]
s_add_u32 s61,s61,128
ds_read_b64_tr_b16 v[184:185],v120 offset:24576
ds_read_b64_tr_b16 v[186:187],v120 offset:26624
M v[104:107],v[252:255],v[240:243],v[104:107]
s_add_u32 s56,s56,128
ds_read_b64_tr_b16 v[188:189],v120 offset:28672
ds_read_b64_tr_b16 v[190:191],v120 offset:30720
M v[104:107],v[248:251],v[224:227],v[104:107]
s_cmp_eq_u32 s25,2
s_cselect_b32 s18,0,s18
M v[104:107],v[236:239],v[208:211],v[104:107]
M v[104:107],v[232:235],v[192:195],v[104:107]
s_waitcnt lgkmcnt(8)
M v[48:51],v[136:139],v[128:131],0
ds_read_b64_tr_b16 v[200:201],v121 offset:0
ds_read_b64_tr_b16 v[202:203],v121 offset:2048
M v[48:51],v[140:143],v[144:147],v[48:51]
s_mov_b32 m0,s23
ds_read_b64_tr_b16 v[204:205],v121 offset:4096
ds_read_b64_tr_b16 v[206:207],v121 offset:6144
M v[48:51],v[152:155],v[160:163],v[48:51]
buffer_load_dwordx4 v112,s[16:19],s61 offen lds
M v[48:51],v[156:159],v[176:179],v[48:51]
ds_read_b64_tr_b16 v[216:217],v121 offset:8192
ds_read_b64_tr_b16 v[218:219],v121 offset:10240
M v[52:55],v[156:159],v[180:183],0
ds_read_b64_tr_b16 v[220:221],v121 offset:12288
ds_read_b64_tr_b16 v[222:223],v121 offset:14336
M v[52:55],v[152:155],v[164:167],v[52:55]
CV v20,v80,v81
CV v21,v82,v83
M v[52:55],v[140:143],v[148:151],v[52:55]
CV v22,v88,v89
CV v23,v90,v91
M v[52:55],v[136:139],v[132:135],v[52:55]
s_waitcnt lgkmcnt(8)
buffer_store_dwordx4 v[20:23],v28,s[12:15],s57 offen sc1
M v[52:55],v[168:171],v[196:199],v[52:55]
ds_read_b64_tr_b16 v[232:233],v121 offset:16384
ds_read_b64_tr_b16 v[234:235],v121 offset:18432
M v[52:55],v[172:175],v[212:215],v[52:55]
ds_read_b64_tr_b16 v[236:237],v121 offset:20480
ds_read_b64_tr_b16 v[238:239],v121 offset:22528
M v[52:55],v[184:187],v[228:231],v[52:55]
buffer_load_dwordx4 v113,s[16:19],s61 offen offset:1024 lds
M v[52:55],v[188:191],v[244:247],v[52:55]
ds_read_b64_tr_b16 v[248:249],v121 offset:24576
ds_read_b64_tr_b16 v[250:251],v121 offset:26624
M v[48:51],v[188:191],v[240:243],v[48:51]
ds_read_b64_tr_b16 v[252:253],v121 offset:28672
ds_read_b64_tr_b16 v[254:255],v121 offset:30720
M v[48:51],v[184:187],v[224:227],v[48:51]
CV v24,v84,v85
CV v25,v86,v87
M v[48:51],v[172:175],v[208:211],v[48:51]
CV v26,v92,v93
CV v27,v94,v95
M v[48:51],v[168:171],v[192:195],v[48:51]
s_waitcnt lgkmcnt(8)
buffer_store_dwordx4 v[24:27],v28,s[12:15],s24 offen sc1
M v[56:59],v[200:203],v[128:131],0
ds_read_b64_tr_b16 v[136:137],v122 offset:0
ds_read_b64_tr_b16 v[138:139],v122 offset:2048
M v[56:59],v[204:207],v[144:147],v[56:59]
ds_read_b64_tr_b16 v[140:141],v122 offset:4096
ds_read_b64_tr_b16 v[142:143],v122 offset:6144
M v[56:59],v[216:219],v[160:163],v[56:59]
buffer_load_dwordx4 v114,s[16:19],s61 offen offset:2048 lds
M v[56:59],v[220:223],v[176:179],v[56:59]
ds_read_b64_tr_b16 v[152:153],v122 offset:8192
ds_read_b64_tr_b16 v[154:155],v122 offset:10240
M v[60:63],v[220:223],v[180:183],0
ds_read_b64_tr_b16 v[156:157],v122 offset:12288
ds_read_b64_tr_b16 v[158:159],v122 offset:14336
M v[60:63],v[216:219],v[164:167],v[60:63]
CV v20,v96,v97
CV v21,v98,v99
M v[60:63],v[204:207],v[148:151],v[60:63]
CV v22,v104,v105
CV v23,v106,v107
M v[60:63],v[200:203],v[132:135],v[60:63]
s_waitcnt lgkmcnt(8)
buffer_store_dwordx4 v[20:23],v28,s[12:15],s57 offen offset:1024 sc1
M v[60:63],v[232:235],v[196:199],v[60:63]
ds_read_b64_tr_b16 v[168:169],v122 offset:16384
ds_read_b64_tr_b16 v[170:171],v122 offset:18432
M v[60:63],v[236:239],v[212:215],v[60:63]
ds_read_b64_tr_b16 v[172:173],v122 offset:20480
ds_read_b64_tr_b16 v[174:175],v122 offset:22528
M v[60:63],v[248:251],v[228:231],v[60:63]
buffer_load_dwordx4 v115,s[16:19],s61 offen offset:3072 lds
M v[60:63],v[252:255],v[244:247],v[60:63]
ds_read_b64_tr_b16 v[184:185],v122 offset:24576
ds_read_b64_tr_b16 v[186:187],v122 offset:26624
M v[56:59],v[252:255],v[240:243],v[56:59]
ds_read_b64_tr_b16 v[188:189],v122 offset:28672
ds_read_b64_tr_b16 v[190:191],v122 offset:30720
M v[56:59],v[248:251],v[224:227],v[56:59]
CV v24,v100,v101
CV v25,v102,v103
M v[56:59],v[236:239],v[208:211],v[56:59]
CV v26,v108,v109
CV v27,v110,v111
M v[56:59],v[232:235],v[192:195],v[56:59]
s_waitcnt lgkmcnt(8)
buffer_store_dwordx4 v[24:27],v28,s[12:15],s24 offen offset:1024 sc1
M v[64:67],v[136:139],v[128:131],0
ds_read_b64_tr_b16 v[200:201],v123 offset:0
ds_read_b64_tr_b16 v[202:203],v123 offset:2048
M v[64:67],v[140:143],v[144:147],v[64:67]
s_add_u32 m0,s23,4096
ds_read_b64_tr_b16 v[204:205],v123 offset:4096
ds_read_b64_tr_b16 v[206:207],v123 offset:6144
M v[64:67],v[152:155],v[160:163],v[64:67]
buffer_load_dwordx4 v112,s[16:19],s56 offen lds
M v[64:67],v[156:159],v[176:179],v[64:67]
s_add_u32 s57,s57,2048
ds_read_b64_tr_b16 v[216:217],v123 offset:8192
ds_read_b64_tr_b16 v[218:219],v123 offset:10240
M v[68:71],v[156:159],v[180:183],0
s_add_u32 s24,s24,2048
ds_read_b64_tr_b16 v[220:221],v123 offset:12288
ds_read_b64_tr_b16 v[222:223],v123 offset:14336
M v[68:71],v[152:155],v[164:167],v[68:71]
s_and_b32 s31,s22,15
M v[68:71],v[140:143],v[148:151],v[68:71]
s_lshl_b32 s31,s31,15
M v[68:71],v[136:139],v[132:135],v[68:71]
s_waitcnt lgkmcnt(8)
M v[68:71],v[168:171],v[196:199],v[68:71]
ds_read_b64_tr_b16 v[232:233],v123 offset:16384
ds_read_b64_tr_b16 v[234:235],v123 offset:18432
M v[68:71],v[172:175],v[212:215],v[68:71]
ds_read_b64_tr_b16 v[236:237],v123 offset:20480
ds_read_b64_tr_b16 v[238:239],v123 offset:22528
M v[68:71],v[184:187],v[228:231],v[68:71]
buffer_load_dwordx4 v113,s[16:19],s56 offen offset:1024 lds
M v[68:71],v[188:191],v[244:247],v[68:71]
ds_read_b64_tr_b16 v[248:249],v123 offset:24576
ds_read_b64_tr_b16 v[250:251],v123 offset:26624
M v[64:67],v[188:191],v[240:243],v[64:67]
ds_read_b64_tr_b16 v[252:253],v123 offset:28672
ds_read_b64_tr_b16 v[254:255],v123 offset:30720
M v[64:67],v[184:187],v[224:227],v[64:67]
v_add_u32 v120,s31,v116
v_add_u32 v121,s31,v117
M v[64:67],v[172:175],v[208:211],v[64:67]
v_add_u32_e64 v122,s31,v118
v_add_u32 v123,s31,v119
M v[64:67],v[168:171],v[192:195],v[64:67]
s_cmp_eq_u32 s25,2
s_cselect_b32 s82,138412032,0
s_cbranch_scc0 K2_OW
s_waitcnt vmcnt(14)
K2_OW:
s_waitcnt vmcnt(22) lgkmcnt(0)
s_barrier
M v[72:75],v[200:203],v[128:131],0
s_lshr_b32 s22,s22,4
ds_read_b64_tr_b16 v[136:137],v120 offset:0
ds_read_b64_tr_b16 v[138:139],v120 offset:2048
M v[72:75],v[204:207],v[144:147],v[72:75]
s_bfe_u32 s23,s22,0x40008
ds_read_b64_tr_b16 v[140:141],v120 offset:4096
ds_read_b64_tr_b16 v[142:143],v120 offset:6144
M v[72:75],v[216:219],v[160:163],v[72:75]
buffer_load_dwordx4 v114,s[16:19],s56 offen offset:2048 lds
M v[72:75],v[220:223],v[176:179],v[72:75]
s_lshl_b32 s23,s23,15
ds_read_b64_tr_b16 v[152:153],v120 offset:8192
ds_read_b64_tr_b16 v[154:155],v120 offset:10240
M v[76:79],v[220:223],v[180:183],0
s_add_u32 s23,s23,s21
ds_read_b64_tr_b16 v[156:157],v120 offset:12288
ds_read_b64_tr_b16 v[158:159],v120 offset:14336
M v[76:79],v[216:219],v[164:167],v[76:79]
M v[76:79],v[204:207],v[148:151],v[76:79]
buffer_store_dword v13,v12,s[80:83],s84 offen sc1
M v[76:79],v[200:203],v[132:135],v[76:79]
M v[76:79],v[232:235],v[196:199],v[76:79]
ds_read_b64_tr_b16 v[168:169],v120 offset:16384
ds_read_b64_tr_b16 v[170:171],v120 offset:18432
M v[76:79],v[236:239],v[212:215],v[76:79]
ds_read_b64_tr_b16 v[172:173],v120 offset:20480
ds_read_b64_tr_b16 v[174:175],v120 offset:22528
M v[76:79],v[248:251],v[228:231],v[76:79]
buffer_load_dwordx4 v115,s[16:19],s56 offen offset:3072 lds
M v[76:79],v[252:255],v[244:247],v[76:79]
s_add_u32 s61,s61,128
ds_read_b64_tr_b16 v[184:185],v120 offset:24576
ds_read_b64_tr_b16 v[186:187],v120 offset:26624
M v[72:75],v[252:255],v[240:243],v[72:75]
s_add_u32 s56,s56,128
ds_read_b64_tr_b16 v[188:189],v120 offset:28672
ds_read_b64_tr_b16 v[190:191],v120 offset:30720
M v[72:75],v[248:251],v[224:227],v[72:75]
s_sub_u32 s25,s25,1
M v[72:75],v[236:239],v[208:211],v[72:75]
s_cmp_lg_u32 s25,0
M v[72:75],v[232:235],v[192:195],v[72:75]
s_waitcnt lgkmcnt(8)
s_cbranch_scc1 K2_OL
s_nop 5
CV v20,v48,v49
CV v21,v50,v51
CV v22,v56,v57
CV v23,v58,v59
buffer_store_dwordx4 v[20:23],v28,s[12:15],s57 offen sc1
CV v24,v52,v53
CV v25,v54,v55
CV v26,v60,v61
CV v27,v62,v63
buffer_store_dwordx4 v[24:27],v28,s[12:15],s24 offen sc1
CV v20,v64,v65
CV v21,v66,v67
CV v22,v72,v73
CV v23,v74,v75
buffer_store_dwordx4 v[20:23],v28,s[12:15],s57 offen offset:1024 sc1
CV v24,v68,v69
CV v25,v70,v71
CV v26,v76,v77
CV v27,v78,v79
buffer_store_dwordx4 v[24:27],v28,s[12:15],s24 offen offset:1024 sc1
buffer_load_dword v15,v14,s[12:15],s85 offen sc1
s_load_dwordx2 s[16:17],s[0:1],72
s_mov_b32 s18,3670016
v_mov_b32 v13,7
v_lshrrev_b32 v30,2,v14
v_cmp_eq_u32_e64 vcc,s35,v30
s_mov_b32 s33,0x80000
s_nop 0
v_cndmask_b32 v16,v16,v13,vcc
s_waitcnt vmcnt(0) lgkmcnt(0)
s_barrier
buffer_store_dword v13,v12,s[12:15],s84 offen sc1
s_mov_b32 s54,0x1111
K2_RL:
s_and_b32 s55,s48,s54
v_max_u32 v15,v15,v16
s_nop 1
v_min_u32_dpp v15,v15,v15 quad_perm:[1,0,3,2] row_mask:0xf bank_mask:0xf
s_nop 1
v_min_u32_dpp v15,v15,v15 quad_perm:[2,3,0,1] row_mask:0xf bank_mask:0xf
v_cmp_lt_u32_e64 vcc,s20,v15
v_cmp_lt_u32 s[52:53],s46,v15
s_nop 0
s_and_b32 s49,vcc_lo,0x1111
s_and_b32 s52,s52,0x2222
s_or_b32 s49,s49,s52
s_andn2_b32 s49,s49,s48
s_or_b32 s30,s49,s48
s_bcnt1_i32_b32 s30,s30
s_cmp_ge_u32 s30,8
s_cbranch_scc1 K2_RNL
s_mov_b32 s31,s49
s_sub_u32 s30,s31,1
s_and_b32 s31,s31,s30
s_sub_u32 s30,s31,1
s_and_b32 s31,s31,s30
s_andn2_b32 s49,s49,s31
K2_RNL:
s_or_b32 s48,s48,s49
s_bitcmp1_b32 s49,0
s_cbranch_scc0 K2_RS00
buffer_load_dwordx4 a[0:3],v8,s[12:15],s44 offen sc1
buffer_load_dwordx4 a[16:19],v8,s[12:15],s44 offen offset:256 sc1
buffer_load_dwordx4 a[32:35],v8,s[12:15],s44 offen offset:512 sc1
buffer_load_dwordx4 a[48:51],v8,s[12:15],s44 offen offset:768 sc1
K2_RS00:
s_bitcmp1_b32 s49,4
s_cbranch_scc0 K2_RS01
buffer_load_dwordx4 a[4:7],v9,s[12:15],s44 offen sc1
buffer_load_dwordx4 a[20:23],v9,s[12:15],s44 offen offset:256 sc1
buffer_load_dwordx4 a[36:39],v9,s[12:15],s44 offen offset:512 sc1
buffer_load_dwordx4 a[52:55],v9,s[12:15],s44 offen offset:768 sc1
K2_RS01:
s_bitcmp1_b32 s49,8
s_cbranch_scc0 K2_RS02
buffer_load_dwordx4 a[8:11],v10,s[12:15],s44 offen sc1
buffer_load_dwordx4 a[24:27],v10,s[12:15],s44 offen offset:256 sc1
buffer_load_dwordx4 a[40:43],v10,s[12:15],s44 offen offset:512 sc1
buffer_load_dwordx4 a[56:59],v10,s[12:15],s44 offen offset:768 sc1
K2_RS02:
s_bitcmp1_b32 s49,12
s_cbranch_scc0 K2_RS03
buffer_load_dwordx4 a[12:15],v11,s[12:15],s44 offen sc1
buffer_load_dwordx4 a[28:31],v11,s[12:15],s44 offen offset:256 sc1
buffer_load_dwordx4 a[44:47],v11,s[12:15],s44 offen offset:512 sc1
buffer_load_dwordx4 a[60:63],v11,s[12:15],s44 offen offset:768 sc1
K2_RS03:
s_bitcmp1_b32 s49,1
s_cbranch_scc0 K2_RS10
buffer_load_dwordx4 a[64:67],v8,s[12:15],s45 offen sc1
buffer_load_dwordx4 a[80:83],v8,s[12:15],s45 offen offset:256 sc1
buffer_load_dwordx4 a[96:99],v8,s[12:15],s45 offen offset:512 sc1
buffer_load_dwordx4 a[112:115],v8,s[12:15],s45 offen offset:768 sc1
K2_RS10:
s_bitcmp1_b32 s49,5
s_cbranch_scc0 K2_RS11
buffer_load_dwordx4 a[68:71],v9,s[12:15],s45 offen sc1
buffer_load_dwordx4 a[84:87],v9,s[12:15],s45 offen offset:256 sc1
buffer_load_dwordx4 a[100:103],v9,s[12:15],s45 offen offset:512 sc1
buffer_load_dwordx4 a[116:119],v9,s[12:15],s45 offen offset:768 sc1
K2_RS11:
s_bitcmp1_b32 s49,9
s_cbranch_scc0 K2_RS12
buffer_load_dwordx4 a[72:75],v10,s[12:15],s45 offen sc1
buffer_load_dwordx4 a[88:91],v10,s[12:15],s45 offen offset:256 sc1
buffer_load_dwordx4 a[104:107],v10,s[12:15],s45 offen offset:512 sc1
buffer_load_dwordx4 a[120:123],v10,s[12:15],s45 offen offset:768 sc1
K2_RS12:
s_bitcmp1_b32 s49,13
s_cbranch_scc0 K2_RS13
buffer_load_dwordx4 a[76:79],v11,s[12:15],s45 offen sc1
buffer_load_dwordx4 a[92:95],v11,s[12:15],s45 offen offset:256 sc1
buffer_load_dwordx4 a[108:111],v11,s[12:15],s45 offen offset:512 sc1
buffer_load_dwordx4 a[124:127],v11,s[12:15],s45 offen offset:768 sc1
K2_RS13:
s_cmp_eq_u32 s55,0x1111
s_cbranch_scc0 K2_RE
s_mov_b32 s54,0
M v[48:51],v[32:35],a[0:3],0
M v[52:55],v[32:35],a[16:19],0
M v[48:51],v[36:39],a[32:35],v[48:51]
M v[52:55],v[36:39],a[48:51],v[52:55]
M v[48:51],v[32:35],a[4:7],v[48:51]
M v[52:55],v[32:35],a[20:23],v[52:55]
M v[48:51],v[36:39],a[36:39],v[48:51]
M v[52:55],v[36:39],a[52:55],v[52:55]
M v[48:51],v[32:35],a[8:11],v[48:51]
M v[52:55],v[32:35],a[24:27],v[52:55]
M v[48:51],v[36:39],a[40:43],v[48:51]
M v[52:55],v[36:39],a[56:59],v[52:55]
M v[48:51],v[32:35],a[12:15],v[48:51]
M v[52:55],v[32:35],a[28:31],v[52:55]
M v[48:51],v[36:39],a[44:47],v[48:51]
M v[52:55],v[36:39],a[60:63],v[52:55]
s_nop 7
s_nop 0
CV v64,v48,v49
CV v65,v50,v51
CV v66,v52,v53
CV v67,v54,v55
buffer_store_dwordx4 v[64:67],v17,s[16:19],s50 offen sc1
K2_RE:
s_cmp_eq_u32 s48,0x3333
s_cbranch_scc1 K2_RFIN
s_sub_u32 s33,s33,1
s_cbranch_scc1 K2_RFIN
s_cmp_lg_u32 s49,0
s_cbranch_scc1 K2_RP
s_sleep 8
K2_RP:
buffer_load_dword v15,v14,s[12:15],s85 offen sc1
s_waitcnt vmcnt(0)
s_branch K2_RL
K2_RFIN:
s_waitcnt vmcnt(0)
s_cmp_eq_u32 s54,0
s_cbranch_scc1 K2_RB
M v[48:51],v[32:35],a[0:3],0
M v[52:55],v[32:35],a[16:19],0
M v[48:51],v[36:39],a[32:35],v[48:51]
M v[52:55],v[36:39],a[48:51],v[52:55]
M v[48:51],v[32:35],a[4:7],v[48:51]
M v[52:55],v[32:35],a[20:23],v[52:55]
M v[48:51],v[36:39],a[36:39],v[48:51]
M v[52:55],v[36:39],a[52:55],v[52:55]
M v[48:51],v[32:35],a[8:11],v[48:51]
M v[52:55],v[32:35],a[24:27],v[52:55]
M v[48:51],v[36:39],a[40:43],v[48:51]
M v[52:55],v[36:39],a[56:59],v[52:55]
M v[48:51],v[32:35],a[12:15],v[48:51]
M v[52:55],v[32:35],a[28:31],v[52:55]
M v[48:51],v[36:39],a[44:47],v[48:51]
M v[52:55],v[36:39],a[60:63],v[52:55]
s_nop 7
CV v64,v48,v49
CV v65,v50,v51
CV v66,v52,v53
CV v67,v54,v55
buffer_store_dwordx4 v[64:67],v17,s[16:19],s50 offen sc1
K2_RB:
s_cmp_eq_u32 s20,3
s_cbranch_scc1 K2_DONE
M v[48:51],v[32:35],a[64:67],0
M v[52:55],v[32:35],a[80:83],0
M v[48:51],v[36:39],a[96:99],v[48:51]
M v[52:55],v[36:39],a[112:115],v[52:55]
M v[48:51],v[32:35],a[68:71],v[48:51]
M v[52:55],v[32:35],a[84:87],v[52:55]
M v[48:51],v[36:39],a[100:103],v[48:51]
M v[52:55],v[36:39],a[116:119],v[52:55]
M v[48:51],v[32:35],a[72:75],v[48:51]
M v[52:55],v[32:35],a[88:91],v[52:55]
M v[48:51],v[36:39],a[104:107],v[48:51]
M v[52:55],v[36:39],a[120:123],v[52:55]
M v[48:51],v[32:35],a[76:79],v[48:51]
M v[52:55],v[32:35],a[92:95],v[52:55]
M v[48:51],v[36:39],a[108:111],v[48:51]
M v[52:55],v[36:39],a[124:127],v[52:55]
s_nop 7
CV v68,v48,v49
CV v69,v50,v51
CV v70,v52,v53
CV v71,v54,v55
buffer_store_dwordx4 v[68:71],v17,s[16:19],s50 offen offset:512 sc1
K2_DONE:
s_endpgm
K2_TAILM:
s_cmp_eq_u32 s60,2
s_cbranch_scc0 K2_TM1
s_waitcnt vmcnt(8)
s_mov_b32 s33,s29
s_call_b64 s[100:101],SUB_CHK
K2_TM1:
s_sub_u32 s74,7,s72
s_lshl_b32 s24,s74,1
s_add_u32 s24,s24,2
s_lshl_b32 s6,s24,15
s_mov_b32 s10,s6
s_mov_b32 s22,0
s_mov_b32 s23,0
M a[0:3],v[192:195],v[48:51],a[0:3]
ds_read_b128 v[224:227],v2 offset:4096
ds_read_b128 v[228:231],v2 offset:20480
s_mov_b32 s25,3
M a[0:3],v[196:199],v[56:59],a[0:3]
ds_read_b128 v[232:235],v2 offset:5120
ds_read_b128 v[236:239],v2 offset:21504
s_mov_b32 s36,0
s_mov_b32 s26,2
s_add_u32 m0,s21,131072
M a[4:7],v[196:199],v[60:63],a[4:7]
buffer_load_dwordx4 v4,s[4:7],s22 offen sc1 lds
s_mov_b32 s39,0
M a[4:7],v[192:195],v[52:55],a[4:7]
v_add_u32 v29,0x20000,v28
s_lshl_b32 s30,s35,7
s_lshl_b32 s31,s74,3
s_add_u32 s30,s30,s31
M a[12:15],v[200:203],v[52:55],a[12:15]
s_add_u32 s30,s30,s20
s_lshl_b32 s62,s30,13
v_add_f32 v127,v127,v6
M a[12:15],v[204:207],v[60:63],a[12:15]
v_add_f32 v46,v46,v43
v_exp_f32 v20,v160
M a[8:11],v[204:207],v[56:59],a[8:11]
buffer_load_dwordx4 v4,s[4:7],s22 offen offset:1024 sc1 lds
M a[8:11],v[200:203],v[48:51],a[8:11]
s_waitcnt lgkmcnt(4)
v_exp_f32 v21,v161
v_exp_f32 v22,v162
M a[16:19],v[208:211],v[48:51],a[16:19]
ds_read_b128 v[240:243],v2 offset:6144
ds_read_b128 v[244:247],v2 offset:22528
M a[16:19],v[212:215],v[56:59],a[16:19]
ds_read_b128 v[248:251],v2 offset:7168
ds_read_b128 v[252:255],v2 offset:23552
v_exp_f32 v23,v163
M a[20:23],v[212:215],v[60:63],a[20:23]
buffer_load_dwordx4 v4,s[4:7],s22 offen offset:2048 sc1 lds
CV v64,v20,v21
M a[20:23],v[208:211],v[52:55],a[20:23]
v_add_f32 v6,v20,v21
v_exp_f32 v24,v168
M a[28:31],v[216:219],v[52:55],a[28:31]
buffer_load_dwordx4 v4,s[4:7],s22 offen offset:3072 sc1 lds
M a[28:31],v[220:223],v[60:63],a[28:31]
s_add_u32 m0,s21,135168
v_exp_f32 v25,v169
CV v65,v22,v23
v_add_f32 v6,v6,v22
M a[24:27],v[220:223],v[56:59],a[24:27]
buffer_load_dwordx4 v5,s[4:7],s22 offen sc1 lds
v_add_f32 v6,v6,v23
M a[24:27],v[216:219],v[48:51],a[24:27]
s_waitcnt lgkmcnt(4)
v_exp_f32 v26,v170
v_exp_f32 v27,v171
M a[32:35],v[224:227],v[48:51],a[32:35]
ds_read_b128 v[192:195],v2 offset:8192
ds_read_b128 v[196:199],v2 offset:24576
CV v66,v24,v25
M a[32:35],v[228:231],v[56:59],a[32:35]
ds_read_b128 v[200:203],v2 offset:9216
ds_read_b128 v[204:207],v2 offset:25600
v_add_f32 v6,v6,v24
v_add_f32 v6,v6,v25
M a[36:39],v[228:231],v[60:63],a[36:39]
buffer_load_dwordx4 v5,s[4:7],s22 offen offset:1024 sc1 lds
M a[36:39],v[224:227],v[52:55],a[36:39]
v_exp_f32 v20,v164
v_exp_f32 v21,v165
M a[44:47],v[232:235],v[52:55],a[44:47]
buffer_load_dwordx4 v5,s[4:7],s22 offen offset:2048 sc1 lds
CV v67,v26,v27
M a[44:47],v[236:239],v[60:63],a[44:47]
v_add_f32 v6,v6,v26
v_add_f32 v6,v6,v27
v_exp_f32 v22,v166
M a[40:43],v[236:239],v[56:59],a[40:43]
buffer_load_dwordx4 v5,s[4:7],s22 offen offset:3072 sc1 lds
M a[40:43],v[232:235],v[48:51],a[40:43]
s_waitcnt lgkmcnt(4)
v_exp_f32 v23,v167
CV v68,v20,v21
v_add_f32 v43,v20,v21
M a[48:51],v[240:243],v[48:51],a[48:51]
ds_read_b128 v[208:211],v2 offset:10240
ds_read_b128 v[212:215],v2 offset:26624
M a[48:51],v[244:247],v[56:59],a[48:51]
ds_read_b128 v[216:219],v2 offset:11264
ds_read_b128 v[220:223],v2 offset:27648
v_exp_f32 v24,v172
s_add_u32 s22,s22,32768
s_add_u32 m0,s21,98304
M a[52:55],v[244:247],v[60:63],a[52:55]
buffer_load_dwordx4 v4,s[4:7],s22 offen sc1 lds
M a[52:55],v[240:243],v[52:55],a[52:55]
v_exp_f32 v25,v173
CV v69,v22,v23
v_add_f32 v43,v43,v22
M a[60:63],v[248:251],v[52:55],a[60:63]
buffer_load_dwordx4 v4,s[4:7],s22 offen offset:1024 sc1 lds
v_add_f32 v43,v43,v23
M a[60:63],v[252:255],v[60:63],a[60:63]
v_exp_f32 v26,v174
v_exp_f32 v27,v175
M a[56:59],v[252:255],v[56:59],a[56:59]
buffer_load_dwordx4 v4,s[4:7],s22 offen offset:2048 sc1 lds
CV v70,v24,v25
M a[56:59],v[248:251],v[48:51],a[56:59]
s_waitcnt lgkmcnt(4)
v_add_f32 v43,v43,v24
v_add_f32 v43,v43,v25
v_exp_f32 v20,v176
M a[64:67],v[192:195],v[48:51],a[64:67]
ds_read_b128 v[224:227],v2 offset:12288
ds_read_b128 v[228:231],v2 offset:28672
M a[64:67],v[196:199],v[56:59],a[64:67]
ds_read_b128 v[232:235],v2 offset:13312
ds_read_b128 v[236:239],v2 offset:29696
v_exp_f32 v21,v177
M a[68:71],v[196:199],v[60:63],a[68:71]
buffer_load_dwordx4 v4,s[4:7],s22 offen offset:3072 sc1 lds
CV v71,v26,v27
M a[68:71],v[192:195],v[52:55],a[68:71]
s_add_u32 m0,s21,102400
v_add_f32 v43,v43,v26
v_add_f32 v43,v43,v27
v_exp_f32 v22,v178
M a[76:79],v[200:203],v[52:55],a[76:79]
buffer_load_dwordx4 v5,s[4:7],s22 offen sc1 lds
M a[76:79],v[204:207],v[60:63],a[76:79]
v_exp_f32 v23,v179
CV v72,v20,v21
v_add_f32 v6,v6,v20
M a[72:75],v[204:207],v[56:59],a[72:75]
buffer_load_dwordx4 v5,s[4:7],s22 offen offset:1024 sc1 lds
v_add_f32 v6,v6,v21
M a[72:75],v[200:203],v[48:51],a[72:75]
s_waitcnt lgkmcnt(4)
v_exp_f32 v24,v184
v_exp_f32 v25,v185
M a[80:83],v[208:211],v[48:51],a[80:83]
ds_read_b128 v[240:243],v2 offset:14336
ds_read_b128 v[244:247],v2 offset:30720
CV v73,v22,v23
M a[80:83],v[212:215],v[56:59],a[80:83]
ds_read_b128 v[248:251],v2 offset:15360
ds_read_b128 v[252:255],v2 offset:31744
v_add_f32 v6,v6,v22
v_add_f32 v6,v6,v23
M a[84:87],v[212:215],v[60:63],a[84:87]
buffer_load_dwordx4 v5,s[4:7],s22 offen offset:2048 sc1 lds
M a[84:87],v[208:211],v[52:55],a[84:87]
v_exp_f32 v26,v186
v_exp_f32 v27,v187
M a[92:95],v[216:219],v[52:55],a[92:95]
CV v74,v24,v25
v_add_f32 v6,v6,v24
v_add_f32 v6,v6,v25
M a[92:95],v[220:223],v[60:63],a[92:95]
v_exp_f32 v20,v180
v_exp_f32 v21,v181
M a[88:91],v[220:223],v[56:59],a[88:91]
buffer_load_dwordx4 v5,s[4:7],s22 offen offset:3072 sc1 lds
CV v75,v26,v27
M a[88:91],v[216:219],v[48:51],a[88:91]
v_add_f32 v6,v6,v26
v_add_f32 v6,v6,v27
s_waitcnt vmcnt(18) lgkmcnt(0)
s_barrier
M a[96:99],v[224:227],v[48:51],a[96:99]
ds_read_b128 v[192:195],v3 offset:0
ds_read_b128 v[196:199],v3 offset:16384
M a[96:99],v[228:231],v[56:59],a[96:99]
ds_read_b128 v[200:203],v3 offset:1024
ds_read_b128 v[204:207],v3 offset:17408
v_exp_f32 v22,v182
s_add_u32 s31,s62,0
M a[100:103],v[228:231],v[60:63],a[100:103]
buffer_load_dwordx4 a[192:195],v28,s[12:15],s31 offen sc1
M a[100:103],v[224:227],v[52:55],a[100:103]
v_exp_f32 v23,v183
CV v76,v20,v21
v_add_f32 v43,v43,v20
M a[108:111],v[232:235],v[52:55],a[108:111]
buffer_load_dwordx4 a[196:199],v28,s[12:15],s31 offen offset:1024 sc1
v_add_f32 v43,v43,v21
M a[108:111],v[236:239],v[60:63],a[108:111]
v_exp_f32 v24,v188
v_exp_f32 v25,v189
M a[104:107],v[236:239],v[56:59],a[104:107]
buffer_load_dwordx4 a[200:203],v28,s[12:15],s31 offen offset:2048 sc1
CV v77,v22,v23
M a[104:107],v[232:235],v[48:51],a[104:107]
v_add_f32 v43,v43,v22
v_add_f32 v43,v43,v23
v_exp_f32 v26,v190
M a[112:115],v[240:243],v[48:51],a[112:115]
ds_read_b128 v[208:211],v3 offset:2048
ds_read_b128 v[212:215],v3 offset:18432
M a[112:115],v[244:247],v[56:59],a[112:115]
ds_read_b128 v[216:219],v3 offset:3072
ds_read_b128 v[220:223],v3 offset:19456
v_exp_f32 v27,v191
M a[116:119],v[244:247],v[60:63],a[116:119]
buffer_load_dwordx4 a[204:207],v28,s[12:15],s31 offen offset:3072 sc1
CV v78,v24,v25
M a[116:119],v[240:243],v[52:55],a[116:119]
s_add_u32 s31,s62,4096
v_add_f32 v43,v43,v24
v_add_f32 v43,v43,v25
v_add_f32 v43,v43,v26
CV v79,v26,v27
M a[124:127],v[248:251],v[52:55],a[124:127]
buffer_load_dwordx4 a[208:211],v28,s[12:15],s31 offen sc1
v_add_f32 v43,v43,v27
M a[124:127],v[252:255],v[60:63],a[124:127]
v_add_f32 v30,v6,v43
v_cmp_ngt_f32 vcc,1.0,v30
M a[120:123],v[252:255],v[56:59],a[120:123]
buffer_load_dwordx4 a[212:215],v28,s[12:15],s31 offen offset:1024 sc1
s_waitcnt lgkmcnt(4)
M a[120:123],v[248:251],v[48:51],a[120:123]
s_cmp_eq_u32 s60,0
s_cbranch_vccnz CK_5001
CK_5001R:
s_cbranch_scc0 K2_TM2
v_mov_b32 v34,1
v_mov_b32 v35,0
s_mov_b64 exec,1
buffer_store_dword v34,v35,s[12:15],s79 offen sc1
s_mov_b64 exec,-1
K2_TM2:
s_mov_b32 s60,9
M a[0:3],v[192:195],v[64:67],a[0:3]
ds_read_b128 v[224:227],v3 offset:4096
ds_read_b128 v[228:231],v3 offset:20480
M a[0:3],v[196:199],v[72:75],a[0:3]
ds_read_b128 v[232:235],v3 offset:5120
ds_read_b128 v[236:239],v3 offset:21504
M a[4:7],v[196:199],v[76:79],a[4:7]
buffer_load_dwordx4 a[216:219],v28,s[12:15],s31 offen offset:2048 sc1
M a[4:7],v[192:195],v[68:71],a[4:7]
v_add_f32 v127,v127,v6
v_add_f32 v46,v46,v43
M a[12:15],v[200:203],v[68:71],a[12:15]
buffer_load_dwordx4 a[220:223],v28,s[12:15],s31 offen offset:3072 sc1
M a[12:15],v[204:207],v[76:79],a[12:15]
s_add_u32 s31,s62,32768
M a[8:11],v[204:207],v[72:75],a[8:11]
buffer_load_dwordx4 a[224:227],v28,s[12:15],s31 offen sc1
M a[8:11],v[200:203],v[64:67],a[8:11]
s_waitcnt lgkmcnt(4)
M a[16:19],v[208:211],v[64:67],a[16:19]
ds_read_b128 v[240:243],v3 offset:6144
ds_read_b128 v[244:247],v3 offset:22528
M a[16:19],v[212:215],v[72:75],a[16:19]
ds_read_b128 v[248:251],v3 offset:7168
ds_read_b128 v[252:255],v3 offset:23552
M a[20:23],v[212:215],v[76:79],a[20:23]
buffer_load_dwordx4 a[228:231],v28,s[12:15],s31 offen offset:1024 sc1
M a[20:23],v[208:211],v[68:71],a[20:23]
M a[28:31],v[216:219],v[68:71],a[28:31]
buffer_load_dwordx4 a[232:235],v28,s[12:15],s31 offen offset:2048 sc1
M a[28:31],v[220:223],v[76:79],a[28:31]
M a[24:27],v[220:223],v[72:75],a[24:27]
buffer_load_dwordx4 a[236:239],v28,s[12:15],s31 offen offset:3072 sc1
M a[24:27],v[216:219],v[64:67],a[24:27]
s_waitcnt lgkmcnt(4)
M a[32:35],v[224:227],v[64:67],a[32:35]
ds_read_b128 v[192:195],v3 offset:8192
ds_read_b128 v[196:199],v3 offset:24576
M a[32:35],v[228:231],v[72:75],a[32:35]
ds_read_b128 v[200:203],v3 offset:9216
ds_read_b128 v[204:207],v3 offset:25600
s_add_u32 s31,s62,36864
M a[36:39],v[228:231],v[76:79],a[36:39]
buffer_load_dwordx4 a[240:243],v28,s[12:15],s31 offen sc1
M a[36:39],v[224:227],v[68:71],a[36:39]
M a[44:47],v[232:235],v[68:71],a[44:47]
buffer_load_dwordx4 a[244:247],v28,s[12:15],s31 offen offset:1024 sc1
M a[44:47],v[236:239],v[76:79],a[44:47]
M a[40:43],v[236:239],v[72:75],a[40:43]
buffer_load_dwordx4 a[248:251],v28,s[12:15],s31 offen offset:2048 sc1
M a[40:43],v[232:235],v[64:67],a[40:43]
s_waitcnt lgkmcnt(4)
M a[48:51],v[240:243],v[64:67],a[48:51]
ds_read_b128 v[208:211],v3 offset:10240
ds_read_b128 v[212:215],v3 offset:26624
M a[48:51],v[244:247],v[72:75],a[48:51]
ds_read_b128 v[216:219],v3 offset:11264
ds_read_b128 v[220:223],v3 offset:27648
M a[52:55],v[244:247],v[76:79],a[52:55]
buffer_load_dwordx4 a[252:255],v28,s[12:15],s31 offen offset:3072 sc1
M a[52:55],v[240:243],v[68:71],a[52:55]
s_add_u32 m0,s21,0
M a[60:63],v[248:251],v[68:71],a[60:63]
buffer_load_dwordx4 v4,s[8:11],s23 offen sc1 lds
M a[60:63],v[252:255],v[76:79],a[60:63]
M a[56:59],v[252:255],v[72:75],a[56:59]
buffer_load_dwordx4 v4,s[8:11],s23 offen offset:1024 sc1 lds
M a[56:59],v[248:251],v[64:67],a[56:59]
s_waitcnt lgkmcnt(4)
M a[64:67],v[192:195],v[64:67],a[64:67]
ds_read_b128 v[224:227],v3 offset:12288
ds_read_b128 v[228:231],v3 offset:28672
M a[64:67],v[196:199],v[72:75],a[64:67]
ds_read_b128 v[232:235],v3 offset:13312
ds_read_b128 v[236:239],v3 offset:29696
M a[68:71],v[196:199],v[76:79],a[68:71]
buffer_load_dwordx4 v4,s[8:11],s23 offen offset:2048 sc1 lds
M a[68:71],v[192:195],v[68:71],a[68:71]
M a[76:79],v[200:203],v[68:71],a[76:79]
M a[76:79],v[204:207],v[76:79],a[76:79]
M a[72:75],v[204:207],v[72:75],a[72:75]
buffer_load_dwordx4 v4,s[8:11],s23 offen offset:3072 sc1 lds
M a[72:75],v[200:203],v[64:67],a[72:75]
s_waitcnt lgkmcnt(4)
M a[80:83],v[208:211],v[64:67],a[80:83]
ds_read_b128 v[240:243],v3 offset:14336
ds_read_b128 v[244:247],v3 offset:30720
M a[80:83],v[212:215],v[72:75],a[80:83]
ds_read_b128 v[248:251],v3 offset:15360
ds_read_b128 v[252:255],v3 offset:31744
s_add_u32 m0,s21,4096
M a[84:87],v[212:215],v[76:79],a[84:87]
buffer_load_dwordx4 v5,s[8:11],s23 offen sc1 lds
M a[84:87],v[208:211],v[68:71],a[84:87]
M a[92:95],v[216:219],v[68:71],a[92:95]
M a[92:95],v[220:223],v[76:79],a[92:95]
M a[88:91],v[220:223],v[72:75],a[88:91]
buffer_load_dwordx4 v5,s[8:11],s23 offen offset:1024 sc1 lds
M a[88:91],v[216:219],v[64:67],a[88:91]
s_waitcnt lgkmcnt(4)
M a[96:99],v[224:227],v[64:67],a[96:99]
M a[96:99],v[228:231],v[72:75],a[96:99]
M a[100:103],v[228:231],v[76:79],a[100:103]
buffer_load_dwordx4 v5,s[8:11],s23 offen offset:2048 sc1 lds
M a[100:103],v[224:227],v[68:71],a[100:103]
M a[108:111],v[232:235],v[68:71],a[108:111]
M a[108:111],v[236:239],v[76:79],a[108:111]
M a[104:107],v[236:239],v[72:75],a[104:107]
buffer_load_dwordx4 v5,s[8:11],s23 offen offset:3072 sc1 lds
M a[104:107],v[232:235],v[64:67],a[104:107]
s_waitcnt lgkmcnt(0)
M a[112:115],v[240:243],v[64:67],a[112:115]
M a[112:115],v[244:247],v[72:75],a[112:115]
s_add_u32 s22,s22,32768
s_add_u32 s23,s23,32768
s_add_u32 m0,s21,32768
M a[116:119],v[244:247],v[76:79],a[116:119]
buffer_load_dwordx4 v4,s[4:7],s22 offen sc1 lds
M a[116:119],v[240:243],v[68:71],a[116:119]
M a[124:127],v[248:251],v[68:71],a[124:127]
M a[124:127],v[252:255],v[76:79],a[124:127]
M a[120:123],v[252:255],v[72:75],a[120:123]
buffer_load_dwordx4 v4,s[4:7],s22 offen offset:1024 sc1 lds
M a[120:123],v[248:251],v[64:67],a[120:123]
v_mov_b32 v30,v127
v_mov_b32 v31,v46
s_nop 0
v_permlane32_swap_b32 v30,v127
v_permlane32_swap_b32 v31,v46
s_nop 0
v_add_f32 v127,v30,v127
v_add_f32 v46,v31,v46
v_mov_b32 v30,v127
v_mov_b32 v31,v46
s_nop 0
v_permlane16_swap_b32 v30,v127
v_permlane16_swap_b32 v31,v46
s_nop 0
v_add_f32 v127,v30,v127
v_add_f32 v46,v31,v46
v_mov_b32 v108,v8
v_mov_b32 v110,v127
v_mov_b32 v109,v12
v_mov_b32 v111,v46
AR v48,a0
AR v49,a1
AR v50,a2
AR v51,a3
AR v52,a8
AR v53,a9
AR v54,a10
AR v55,a11
CV v64,v48,v49
CV v65,v50,v51
CV v66,v52,v53
CV v67,v54,v55
s_add_u32 s32,s37,0
s_nop 0
buffer_store_dwordx4 v[64:67],v28,s[12:15],s32 offen sc1
AW a0,0
AW a1,0
AW a2,0
AW a3,0
AW a8,0
AW a9,0
AW a10,0
AW a11,0
AR v56,a4
AR v57,a5
AR v58,a6
AR v59,a7
AR v60,a12
AR v61,a13
AR v62,a14
AR v63,a15
CV v68,v56,v57
CV v69,v58,v59
CV v70,v60,v61
CV v71,v62,v63
buffer_store_dwordx4 v[68:71],v28,s[12:15],s32 offen offset:1024 sc1
AW a4,0
AW a5,0
AW a6,0
AW a7,0
AW a12,0
AW a13,0
AW a14,0
AW a15,0
AR v48,a16
AR v49,a17
AR v50,a18
AR v51,a19
AR v52,a24
AR v53,a25
AR v54,a26
AR v55,a27
CV v72,v48,v49
CV v73,v50,v51
CV v74,v52,v53
CV v75,v54,v55
buffer_store_dwordx4 v[72:75],v28,s[12:15],s32 offen offset:2048 sc1
AW a16,0
AW a17,0
AW a18,0
AW a19,0
AW a24,0
AW a25,0
AW a26,0
AW a27,0
AR v56,a20
AR v57,a21
AR v58,a22
AR v59,a23
AR v60,a28
AR v61,a29
AR v62,a30
AR v63,a31
CV v76,v56,v57
CV v77,v58,v59
CV v78,v60,v61
CV v79,v62,v63
buffer_store_dwordx4 v[76:79],v28,s[12:15],s32 offen offset:3072 sc1
AW a20,0
AW a21,0
AW a22,0
AW a23,0
AW a28,0
AW a29,0
AW a30,0
AW a31,0
AR v48,a32
AR v49,a33
AR v50,a34
AR v51,a35
AR v52,a40
AR v53,a41
AR v54,a42
AR v55,a43
CV v64,v48,v49
CV v65,v50,v51
CV v66,v52,v53
CV v67,v54,v55
s_add_u32 s32,s37,4096
buffer_store_dwordx4 v[64:67],v28,s[12:15],s32 offen sc1
AW a32,0
AW a33,0
AW a34,0
AW a35,0
AW a40,0
AW a41,0
AW a42,0
AW a43,0
AR v56,a36
AR v57,a37
AR v58,a38
AR v59,a39
AR v60,a44
AR v61,a45
AR v62,a46
AR v63,a47
CV v68,v56,v57
CV v69,v58,v59
CV v70,v60,v61
CV v71,v62,v63
buffer_store_dwordx4 v[68:71],v28,s[12:15],s32 offen offset:1024 sc1
AW a36,0
AW a37,0
AW a38,0
AW a39,0
AW a44,0
AW a45,0
AW a46,0
AW a47,0
AR v48,a48
AR v49,a49
AR v50,a50
AR v51,a51
AR v52,a56
AR v53,a57
AR v54,a58
AR v55,a59
CV v72,v48,v49
CV v73,v50,v51
CV v74,v52,v53
CV v75,v54,v55
buffer_store_dwordx4 v[72:75],v28,s[12:15],s32 offen offset:2048 sc1
AW a48,0
AW a49,0
AW a50,0
AW a51,0
AW a56,0
AW a57,0
AW a58,0
AW a59,0
AR v56,a52
AR v57,a53
AR v58,a54
AR v59,a55
AR v60,a60
AR v61,a61
AR v62,a62
AR v63,a63
CV v76,v56,v57
CV v77,v58,v59
CV v78,v60,v61
CV v79,v62,v63
buffer_store_dwordx4 v[76:79],v28,s[12:15],s32 offen offset:3072 sc1
AW a52,0
AW a53,0
AW a54,0
AW a55,0
AW a60,0
AW a61,0
AW a62,0
AW a63,0
AR v48,a64
AR v49,a65
AR v50,a66
AR v51,a67
AR v52,a72
AR v53,a73
AR v54,a74
AR v55,a75
CV v64,v48,v49
CV v65,v50,v51
CV v66,v52,v53
CV v67,v54,v55
s_add_u32 s32,s37,8192
buffer_store_dwordx4 v[64:67],v28,s[12:15],s32 offen sc1
AW a64,0
AW a65,0
AW a66,0
AW a67,0
AW a72,0
AW a73,0
AW a74,0
AW a75,0
AR v56,a68
AR v57,a69
AR v58,a70
AR v59,a71
AR v60,a76
AR v61,a77
AR v62,a78
AR v63,a79
CV v68,v56,v57
CV v69,v58,v59
CV v70,v60,v61
CV v71,v62,v63
buffer_store_dwordx4 v[68:71],v28,s[12:15],s32 offen offset:1024 sc1
AW a68,0
AW a69,0
AW a70,0
AW a71,0
AW a76,0
AW a77,0
AW a78,0
AW a79,0
AR v48,a80
AR v49,a81
AR v50,a82
AR v51,a83
AR v52,a88
AR v53,a89
AR v54,a90
AR v55,a91
CV v72,v48,v49
CV v73,v50,v51
CV v74,v52,v53
CV v75,v54,v55
buffer_store_dwordx4 v[72:75],v28,s[12:15],s32 offen offset:2048 sc1
AW a80,0
AW a81,0
AW a82,0
AW a83,0
AW a88,0
AW a89,0
AW a90,0
AW a91,0
AR v56,a84
AR v57,a85
AR v58,a86
AR v59,a87
AR v60,a92
AR v61,a93
AR v62,a94
AR v63,a95
CV v76,v56,v57
CV v77,v58,v59
CV v78,v60,v61
CV v79,v62,v63
buffer_store_dwordx4 v[76:79],v28,s[12:15],s32 offen offset:3072 sc1
AW a84,0
AW a85,0
AW a86,0
AW a87,0
AW a92,0
AW a93,0
AW a94,0
AW a95,0
AR v48,a96
AR v49,a97
AR v50,a98
AR v51,a99
AR v52,a104
AR v53,a105
AR v54,a106
AR v55,a107
CV v64,v48,v49
CV v65,v50,v51
CV v66,v52,v53
CV v67,v54,v55
s_add_u32 s32,s37,12288
buffer_store_dwordx4 v[64:67],v28,s[12:15],s32 offen sc1
AW a96,0
AW a97,0
AW a98,0
AW a99,0
AW a104,0
AW a105,0
AW a106,0
AW a107,0
AR v56,a100
AR v57,a101
AR v58,a102
AR v59,a103
AR v60,a108
AR v61,a109
AR v62,a110
AR v63,a111
CV v68,v56,v57
CV v69,v58,v59
CV v70,v60,v61
CV v71,v62,v63
buffer_store_dwordx4 v[68:71],v28,s[12:15],s32 offen offset:1024 sc1
AW a100,0
AW a101,0
AW a102,0
AW a103,0
AW a108,0
AW a109,0
AW a110,0
AW a111,0
AR v48,a112
AR v49,a113
AR v50,a114
AR v51,a115
AR v52,a120
AR v53,a121
AR v54,a122
AR v55,a123
CV v72,v48,v49
CV v73,v50,v51
CV v74,v52,v53
CV v75,v54,v55
buffer_store_dwordx4 v[72:75],v28,s[12:15],s32 offen offset:2048 sc1
AW a112,0
AW a113,0
AW a114,0
AW a115,0
AW a120,0
AW a121,0
AW a122,0
AW a123,0
AR v56,a116
AR v57,a117
AR v58,a118
AR v59,a119
AR v60,a124
AR v61,a125
AR v62,a126
AR v63,a127
CV v76,v56,v57
CV v77,v58,v59
CV v78,v60,v61
CV v79,v62,v63
buffer_store_dwordx4 v[76:79],v28,s[12:15],s32 offen offset:3072 sc1
AW a116,0
AW a117,0
AW a118,0
AW a119,0
AW a124,0
AW a125,0
AW a126,0
AW a127,0
s_add_u32 s32,s37,16384
buffer_store_dwordx4 v[108:111],v28,s[12:15],s32 offen sc1
s_lshl_b32 s31,s35,7
s_lshl_b32 s30,s72,2
s_add_u32 s31,s31,s30
s_add_u32 s31,s31,136314976
s_mov_b32 s77,s31
s_cmp_eq_u32 s20,0
s_cselect_b32 s38,3,2
s_waitcnt vmcnt(27)
s_branch K2_SEG
.p2align 6
K2_HK1:
s_lshl_b32 s31,s35,7
s_add_u32 s31,s31,136314880
buffer_load_dword v41,v40,s[12:15],s31 offen sc1
s_mov_b32 s60,2
s_sub_u32 s39,s24,1
s_branch K2_HK1R
K2_HK0:
s_cmp_eq_u32 s60,0
s_cbranch_scc0 K2_EV2
v_mov_b32_e64 v34,1
v_mov_b32 v35,0
s_mov_b64 exec,1
buffer_store_dword v34,v35,s[12:15],s79 offen sc1
s_mov_b64 exec,-1
s_mov_b32 s60,1
s_sub_u32 s39,s24,1
s_branch K2_HK0R
K2_EV2:
s_mov_b32 s39,0
s_mov_b32 s60,3
s_waitcnt vmcnt(16)
v_cmp_ne_u32 vcc,0,v41
s_mov_b32 s33,s29
s_nop 0
s_andn2_b32 s30,s33,vcc_lo
s_cbranch_scc0 K2_HK0R
s_call_b64 s[100:101],SUB_CHK
s_branch K2_HK0R
K2_NORM:
v_rcp_f32_e64 v30,v127
v_rcp_f32 v31,v46
s_waitcnt vmcnt(12)
AR v48,a0
AR v49,a1
AR v50,a2
AR v51,a3
AR v52,a8
AR v53,a9
AR v54,a10
AR v55,a11
v_pk_mul_f32 v[48:49],v[48:49],v[30:31] op_sel:[0,0] op_sel_hi:[1,0]
v_pk_mul_f32 v[50:51],v[50:51],v[30:31] op_sel:[0,0] op_sel_hi:[1,0]
v_pk_mul_f32 v[52:53],v[52:53],v[30:31] op_sel:[0,0] op_sel_hi:[1,0]
v_pk_mul_f32 v[54:55],v[54:55],v[30:31] op_sel:[0,0] op_sel_hi:[1,0]
CV v128,v48,v49
CV v129,v50,v51
CV v130,v52,v53
CV v131,v54,v55
buffer_load_dwordx4 v114,s[16:19],s56 offen offset:2048 lds
AR v48,a4
AR v49,a5
AR v50,a6
AR v51,a7
AR v52,a12
AR v53,a13
AR v54,a14
AR v55,a15
v_pk_mul_f32 v[48:49],v[48:49],v[30:31] op_sel:[0,1] op_sel_hi:[1,1]
v_pk_mul_f32 v[50:51],v[50:51],v[30:31] op_sel:[0,1] op_sel_hi:[1,1]
v_pk_mul_f32 v[52:53],v[52:53],v[30:31] op_sel:[0,1] op_sel_hi:[1,1]
v_pk_mul_f32 v[54:55],v[54:55],v[30:31] op_sel:[0,1] op_sel_hi:[1,1]
CV v132,v48,v49
CV v133,v50,v51
CV v134,v52,v53
CV v135,v54,v55
buffer_load_dwordx4 v115,s[16:19],s56 offen offset:3072 lds
AR v48,a16
AR v49,a17
AR v50,a18
AR v51,a19
AR v52,a24
AR v53,a25
AR v54,a26
AR v55,a27
v_pk_mul_f32 v[48:49],v[48:49],v[30:31] op_sel:[0,0] op_sel_hi:[1,0]
v_pk_mul_f32 v[50:51],v[50:51],v[30:31] op_sel:[0,0] op_sel_hi:[1,0]
v_pk_mul_f32 v[52:53],v[52:53],v[30:31] op_sel:[0,0] op_sel_hi:[1,0]
v_pk_mul_f32 v[54:55],v[54:55],v[30:31] op_sel:[0,0] op_sel_hi:[1,0]
CV v144,v48,v49
CV v145,v50,v51
CV v146,v52,v53
CV v147,v54,v55
AR v48,a20
AR v49,a21
AR v50,a22
AR v51,a23
AR v52,a28
AR v53,a29
AR v54,a30
AR v55,a31
v_pk_mul_f32 v[48:49],v[48:49],v[30:31] op_sel:[0,1] op_sel_hi:[1,1]
v_pk_mul_f32 v[50:51],v[50:51],v[30:31] op_sel:[0,1] op_sel_hi:[1,1]
v_pk_mul_f32 v[52:53],v[52:53],v[30:31] op_sel:[0,1] op_sel_hi:[1,1]
v_pk_mul_f32 v[54:55],v[54:55],v[30:31] op_sel:[0,1] op_sel_hi:[1,1]
CV v148,v48,v49
CV v149,v50,v51
CV v150,v52,v53
CV v151,v54,v55
AR v48,a32
AR v49,a33
AR v50,a34
AR v51,a35
AR v52,a40
AR v53,a41
AR v54,a42
AR v55,a43
v_pk_mul_f32 v[48:49],v[48:49],v[30:31] op_sel:[0,0] op_sel_hi:[1,0]
v_pk_mul_f32 v[50:51],v[50:51],v[30:31] op_sel:[0,0] op_sel_hi:[1,0]
v_pk_mul_f32 v[52:53],v[52:53],v[30:31] op_sel:[0,0] op_sel_hi:[1,0]
v_pk_mul_f32 v[54:55],v[54:55],v[30:31] op_sel:[0,0] op_sel_hi:[1,0]
CV v160,v48,v49
CV v161,v50,v51
CV v162,v52,v53
CV v163,v54,v55
AR v48,a36
AR v49,a37
AR v50,a38
AR v51,a39
AR v52,a44
AR v53,a45
AR v54,a46
AR v55,a47
v_pk_mul_f32 v[48:49],v[48:49],v[30:31] op_sel:[0,1] op_sel_hi:[1,1]
v_pk_mul_f32 v[50:51],v[50:51],v[30:31] op_sel:[0,1] op_sel_hi:[1,1]
v_pk_mul_f32 v[52:53],v[52:53],v[30:31] op_sel:[0,1] op_sel_hi:[1,1]
v_pk_mul_f32 v[54:55],v[54:55],v[30:31] op_sel:[0,1] op_sel_hi:[1,1]
CV v164,v48,v49
CV v165,v50,v51
CV v166,v52,v53
CV v167,v54,v55
AR v48,a48
AR v49,a49
AR v50,a50
AR v51,a51
AR v52,a56
AR v53,a57
AR v54,a58
AR v55,a59
v_pk_mul_f32 v[48:49],v[48:49],v[30:31] op_sel:[0,0] op_sel_hi:[1,0]
v_pk_mul_f32 v[50:51],v[50:51],v[30:31] op_sel:[0,0] op_sel_hi:[1,0]
v_pk_mul_f32 v[52:53],v[52:53],v[30:31] op_sel:[0,0] op_sel_hi:[1,0]
v_pk_mul_f32 v[54:55],v[54:55],v[30:31] op_sel:[0,0] op_sel_hi:[1,0]
CV v176,v48,v49
CV v177,v50,v51
CV v178,v52,v53
CV v179,v54,v55
AR v48,a52
AR v49,a53
AR v50,a54
AR v51,a55
AR v52,a60
AR v53,a61
AR v54,a62
AR v55,a63
v_pk_mul_f32 v[48:49],v[48:49],v[30:31] op_sel:[0,1] op_sel_hi:[1,1]
v_pk_mul_f32 v[50:51],v[50:51],v[30:31] op_sel:[0,1] op_sel_hi:[1,1]
v_pk_mul_f32 v[52:53],v[52:53],v[30:31] op_sel:[0,1] op_sel_hi:[1,1]
v_pk_mul_f32 v[54:55],v[54:55],v[30:31] op_sel:[0,1] op_sel_hi:[1,1]
CV v180,v48,v49
CV v181,v50,v51
CV v182,v52,v53
CV v183,v54,v55
AR v48,a64
AR v49,a65
AR v50,a66
AR v51,a67
AR v52,a72
AR v53,a73
AR v54,a74
AR v55,a75
v_pk_mul_f32 v[48:49],v[48:49],v[30:31] op_sel:[0,0] op_sel_hi:[1,0]
v_pk_mul_f32 v[50:51],v[50:51],v[30:31] op_sel:[0,0] op_sel_hi:[1,0]
v_pk_mul_f32 v[52:53],v[52:53],v[30:31] op_sel:[0,0] op_sel_hi:[1,0]
v_pk_mul_f32 v[54:55],v[54:55],v[30:31] op_sel:[0,0] op_sel_hi:[1,0]
CV v192,v48,v49
CV v193,v50,v51
CV v194,v52,v53
CV v195,v54,v55
AR v48,a68
AR v49,a69
AR v50,a70
AR v51,a71
AR v52,a76
AR v53,a77
AR v54,a78
AR v55,a79
v_pk_mul_f32 v[48:49],v[48:49],v[30:31] op_sel:[0,1] op_sel_hi:[1,1]
v_pk_mul_f32 v[50:51],v[50:51],v[30:31] op_sel:[0,1] op_sel_hi:[1,1]
v_pk_mul_f32 v[52:53],v[52:53],v[30:31] op_sel:[0,1] op_sel_hi:[1,1]
v_pk_mul_f32 v[54:55],v[54:55],v[30:31] op_sel:[0,1] op_sel_hi:[1,1]
CV v196,v48,v49
CV v197,v50,v51
CV v198,v52,v53
CV v199,v54,v55
AR v48,a80
AR v49,a81
AR v50,a82
AR v51,a83
AR v52,a88
AR v53,a89
AR v54,a90
AR v55,a91
v_pk_mul_f32 v[48:49],v[48:49],v[30:31] op_sel:[0,0] op_sel_hi:[1,0]
v_pk_mul_f32 v[50:51],v[50:51],v[30:31] op_sel:[0,0] op_sel_hi:[1,0]
v_pk_mul_f32 v[52:53],v[52:53],v[30:31] op_sel:[0,0] op_sel_hi:[1,0]
v_pk_mul_f32 v[54:55],v[54:55],v[30:31] op_sel:[0,0] op_sel_hi:[1,0]
CV v208,v48,v49
CV v209,v50,v51
CV v210,v52,v53
CV v211,v54,v55
AR v48,a84
AR v49,a85
AR v50,a86
AR v51,a87
AR v52,a92
AR v53,a93
AR v54,a94
AR v55,a95
v_pk_mul_f32 v[48:49],v[48:49],v[30:31] op_sel:[0,1] op_sel_hi:[1,1]
v_pk_mul_f32 v[50:51],v[50:51],v[30:31] op_sel:[0,1] op_sel_hi:[1,1]
v_pk_mul_f32 v[52:53],v[52:53],v[30:31] op_sel:[0,1] op_sel_hi:[1,1]
v_pk_mul_f32 v[54:55],v[54:55],v[30:31] op_sel:[0,1] op_sel_hi:[1,1]
CV v212,v48,v49
CV v213,v50,v51
CV v214,v52,v53
CV v215,v54,v55
s_waitcnt vmcnt(39)
s_barrier
ds_read_b64_tr_b16 v[136:137],v124 offset:0
ds_read_b64_tr_b16 v[138:139],v124 offset:2048
ds_read_b64_tr_b16 v[140:141],v124 offset:4096
ds_read_b64_tr_b16 v[142:143],v124 offset:6144
AR v48,a96
AR v49,a97
AR v50,a98
AR v51,a99
AR v52,a104
AR v53,a105
AR v54,a106
AR v55,a107
v_pk_mul_f32 v[48:49],v[48:49],v[30:31] op_sel:[0,0] op_sel_hi:[1,0]
v_pk_mul_f32 v[50:51],v[50:51],v[30:31] op_sel:[0,0] op_sel_hi:[1,0]
v_pk_mul_f32 v[52:53],v[52:53],v[30:31] op_sel:[0,0] op_sel_hi:[1,0]
v_pk_mul_f32 v[54:55],v[54:55],v[30:31] op_sel:[0,0] op_sel_hi:[1,0]
CV v224,v48,v49
CV v225,v50,v51
CV v226,v52,v53
CV v227,v54,v55
ds_read_b64_tr_b16 v[152:153],v124 offset:8192
ds_read_b64_tr_b16 v[154:155],v124 offset:10240
ds_read_b64_tr_b16 v[156:157],v124 offset:12288
ds_read_b64_tr_b16 v[158:159],v124 offset:14336
AR v48,a100
AR v49,a101
AR v50,a102
AR v51,a103
AR v52,a108
AR v53,a109
AR v54,a110
AR v55,a111
v_pk_mul_f32 v[48:49],v[48:49],v[30:31] op_sel:[0,1] op_sel_hi:[1,1]
v_pk_mul_f32 v[50:51],v[50:51],v[30:31] op_sel:[0,1] op_sel_hi:[1,1]
v_pk_mul_f32 v[52:53],v[52:53],v[30:31] op_sel:[0,1] op_sel_hi:[1,1]
v_pk_mul_f32 v[54:55],v[54:55],v[30:31] op_sel:[0,1] op_sel_hi:[1,1]
CV v228,v48,v49
CV v229,v50,v51
CV v230,v52,v53
CV v231,v54,v55
ds_read_b64_tr_b16 v[168:169],v124 offset:16384
ds_read_b64_tr_b16 v[170:171],v124 offset:18432
ds_read_b64_tr_b16 v[172:173],v124 offset:20480
ds_read_b64_tr_b16 v[174:175],v124 offset:22528
AR v48,a112
AR v49,a113
AR v50,a114
AR v51,a115
AR v52,a120
AR v53,a121
AR v54,a122
AR v55,a123
v_pk_mul_f32 v[48:49],v[48:49],v[30:31] op_sel:[0,0] op_sel_hi:[1,0]
v_pk_mul_f32 v[50:51],v[50:51],v[30:31] op_sel:[0,0] op_sel_hi:[1,0]
v_pk_mul_f32 v[52:53],v[52:53],v[30:31] op_sel:[0,0] op_sel_hi:[1,0]
v_pk_mul_f32 v[54:55],v[54:55],v[30:31] op_sel:[0,0] op_sel_hi:[1,0]
CV v240,v48,v49
CV v241,v50,v51
CV v242,v52,v53
CV v243,v54,v55
ds_read_b64_tr_b16 v[184:185],v124 offset:24576
ds_read_b64_tr_b16 v[186:187],v124 offset:26624
ds_read_b64_tr_b16 v[188:189],v124 offset:28672
ds_read_b64_tr_b16 v[190:191],v124 offset:30720
AR v48,a116
AR v49,a117
AR v50,a118
AR v51,a119
AR v52,a124
AR v53,a125
AR v54,a126
AR v55,a127
v_pk_mul_f32 v[48:49],v[48:49],v[30:31] op_sel:[0,1] op_sel_hi:[1,1]
v_pk_mul_f32 v[50:51],v[50:51],v[30:31] op_sel:[0,1] op_sel_hi:[1,1]
v_pk_mul_f32 v[52:53],v[52:53],v[30:31] op_sel:[0,1] op_sel_hi:[1,1]
v_pk_mul_f32 v[54:55],v[54:55],v[30:31] op_sel:[0,1] op_sel_hi:[1,1]
CV v244,v48,v49
CV v245,v50,v51
CV v246,v52,v53
CV v247,v54,v55
s_add_u32 s61,s61,128
s_add_u32 s56,s56,128
s_branch K2_OPROJ
K2_RARE0:
s_nop 7
v_max3_f32 v30,v128,v129,v130
v_max3_f32 v30,v131,v136,v30
v_max3_f32 v30,v137,v138,v30
v_max3_f32 v30,v139,v144,v30
v_max3_f32 v30,v145,v146,v30
v_max3_f32 v30,v147,v152,v30
v_max3_f32 v30,v153,v154,v30
v_max_f32 v30,v155,v30
v_mov_b32 v34,v30
s_nop 1
v_permlane32_swap_b32 v34,v30
s_nop 1
v_max_f32 v30,v34,v30
v_mov_b32 v34,v30
s_nop 1
v_permlane16_swap_b32 v34,v30
s_nop 1
v_max_f32_e64 v30,v34,v30
v_add_f32 v30,0x42000000,v30
v_max_f32_e64 v30,0,v30
v_exp_f32 v32,-v30
v_sub_f32 v8,v8,v30
v_sub_f32 v9,v9,v30
v_sub_f32 v10,v10,v30
v_sub_f32 v11,v11,v30
v_mul_f32 v127,v127,v32
v_sub_f32 v128,v128,v30
v_sub_f32 v129,v129,v30
v_sub_f32 v130,v130,v30
v_sub_f32 v131,v131,v30
v_sub_f32 v136,v136,v30
v_sub_f32 v137,v137,v30
v_sub_f32 v138,v138,v30
v_sub_f32 v139,v139,v30
v_sub_f32 v144,v144,v30
v_sub_f32 v145,v145,v30
v_sub_f32 v146,v146,v30
v_sub_f32 v147,v147,v30
v_sub_f32 v152,v152,v30
v_sub_f32 v153,v153,v30
v_sub_f32 v154,v154,v30
v_sub_f32 v155,v155,v30
v_sub_f32 v160,v160,v30
v_sub_f32 v161,v161,v30
v_sub_f32 v162,v162,v30
v_sub_f32 v163,v163,v30
v_sub_f32 v168,v168,v30
v_sub_f32 v169,v169,v30
v_sub_f32 v170,v170,v30
v_sub_f32 v171,v171,v30
v_sub_f32 v176,v176,v30
v_sub_f32 v177,v177,v30
v_sub_f32 v178,v178,v30
v_sub_f32 v179,v179,v30
v_sub_f32 v184,v184,v30
v_sub_f32 v185,v185,v30
v_sub_f32 v186,v186,v30
v_sub_f32_e64 v187,v187,v30
v_max3_f32 v31,v132,v133,v134
v_max3_f32 v31,v135,v140,v31
v_max3_f32 v31,v141,v142,v31
v_max3_f32 v31,v143,v148,v31
v_max3_f32 v31,v149,v150,v31
v_max3_f32 v31,v151,v156,v31
v_max3_f32 v31,v157,v158,v31
v_max_f32 v31,v159,v31
v_mov_b32 v34,v31
s_nop 1
v_permlane32_swap_b32 v34,v31
s_nop 1
v_max_f32 v31,v34,v31
v_mov_b32 v34,v31
s_nop 1
v_permlane16_swap_b32 v34,v31
s_nop 1
v_max_f32_e64 v31,v34,v31
v_add_f32 v31,0x42000000,v31
v_max_f32_e64 v31,0,v31
v_exp_f32 v33,-v31
v_sub_f32 v12,v12,v31
v_sub_f32 v13,v13,v31
v_sub_f32 v14,v14,v31
v_sub_f32 v15,v15,v31
v_mul_f32 v46,v46,v33
v_sub_f32 v132,v132,v31
v_sub_f32 v133,v133,v31
v_sub_f32 v134,v134,v31
v_sub_f32 v135,v135,v31
v_sub_f32 v140,v140,v31
v_sub_f32 v141,v141,v31
v_sub_f32 v142,v142,v31
v_sub_f32 v143,v143,v31
v_sub_f32 v148,v148,v31
v_sub_f32 v149,v149,v31
v_sub_f32 v150,v150,v31
v_sub_f32 v151,v151,v31
v_sub_f32 v156,v156,v31
v_sub_f32 v157,v157,v31
v_sub_f32 v158,v158,v31
v_sub_f32 v159,v159,v31
v_sub_f32 v164,v164,v31
v_sub_f32 v165,v165,v31
v_sub_f32 v166,v166,v31
v_sub_f32 v167,v167,v31
v_sub_f32 v172,v172,v31
v_sub_f32 v173,v173,v31
v_sub_f32 v174,v174,v31
v_sub_f32 v175,v175,v31
v_sub_f32 v180,v180,v31
v_sub_f32 v181,v181,v31
v_sub_f32 v182,v182,v31
v_sub_f32 v183,v183,v31
v_sub_f32 v188,v188,v31
v_sub_f32 v189,v189,v31
v_sub_f32 v190,v190,v31
v_sub_f32 v191,v191,v31
v_exp_f32 v20,v128
v_exp_f32 v21,v129
v_exp_f32 v22,v130
v_exp_f32_e64 v23,v131
CV v48,v20,v21
v_add_f32 v6,v20,v21
v_exp_f32 v24,v136
v_exp_f32_e64 v25,v137
CV v49,v22,v23
v_add_f32 v6,v6,v22
v_add_f32 v6,v6,v23
v_exp_f32 v26,v138
v_exp_f32 v27,v139
CV v50,v24,v25
v_add_f32 v6,v6,v24
v_add_f32 v6,v6,v25
v_exp_f32 v20,v144
v_exp_f32 v21,v145
CV v51,v26,v27
v_add_f32 v6,v6,v26
v_add_f32 v6,v6,v27
v_exp_f32 v22,v146
v_exp_f32 v23,v147
CV v56,v20,v21
v_add_f32 v6,v6,v20
v_add_f32 v6,v6,v21
v_exp_f32 v24,v152
v_exp_f32 v25,v153
CV v57,v22,v23
v_add_f32 v6,v6,v22
v_add_f32 v6,v6,v23
v_exp_f32 v26,v154
v_exp_f32 v27,v155
CV v58,v24,v25
v_add_f32 v6,v6,v24
v_add_f32 v6,v6,v25
v_exp_f32 v20,v132
v_exp_f32 v21,v133
CV v59,v26,v27
v_add_f32 v6,v6,v26
v_add_f32 v6,v6,v27
v_exp_f32 v22,v134
v_exp_f32 v23,v135
CV v52,v20,v21
v_add_f32 v43,v20,v21
v_exp_f32 v24,v140
v_exp_f32_e64 v25,v141
CV v53,v22,v23
v_add_f32 v43,v43,v22
v_add_f32 v43,v43,v23
v_exp_f32 v26,v142
v_exp_f32 v27,v143
CV v54,v24,v25
v_add_f32 v43,v43,v24
v_add_f32 v43,v43,v25
v_exp_f32 v20,v148
v_exp_f32 v21,v149
CV v55,v26,v27
v_add_f32 v43,v43,v26
v_add_f32 v43,v43,v27
v_exp_f32 v22,v150
v_exp_f32 v23,v151
CV v60,v20,v21
v_add_f32 v43,v43,v20
v_add_f32 v43,v43,v21
v_exp_f32 v24,v156
v_exp_f32 v25,v157
CV v61,v22,v23
v_add_f32 v43,v43,v22
v_add_f32 v43,v43,v23
v_exp_f32 v26,v158
v_exp_f32 v27,v159
CV v62,v24,v25
v_add_f32 v43,v43,v24
v_add_f32 v43,v43,v25
v_add_f32_e64 v43,v43,v26
CV v63,v26,v27
v_add_f32_e64 v43,v43,v27
AR v20,a0
AR v21,a1
AR v22,a2
AR v23,a3
AR v24,a4
AR v25,a5
AR v26,a6
AR v27,a7
v_mul_f32 v20,v32,v20
v_mul_f32 v21,v32,v21
v_mul_f32 v22,v32,v22
v_mul_f32 v23,v32,v23
v_mul_f32 v24,v33,v24
v_mul_f32 v25,v33,v25
v_mul_f32 v26,v33,v26
v_mul_f32 v27,v33,v27
AW a0,v20
AW a1,v21
AW a2,v22
AW a3,v23
AW a4,v24
AW a5,v25
AW a6,v26
AW a7,v27
AR v20,a8
AR v21,a9
AR v22,a10
AR v23,a11
AR v24,a12
AR v25,a13
AR v26,a14
AR v27,a15
v_mul_f32 v20,v32,v20
v_mul_f32 v21,v32,v21
v_mul_f32 v22,v32,v22
v_mul_f32 v23,v32,v23
v_mul_f32 v24,v33,v24
v_mul_f32 v25,v33,v25
v_mul_f32 v26,v33,v26
v_mul_f32 v27,v33,v27
AW a8,v20
AW a9,v21
AW a10,v22
AW a11,v23
AW a12,v24
AW a13,v25
AW a14,v26
AW a15,v27
AR v20,a16
AR v21,a17
AR v22,a18
AR v23,a19
AR v24,a20
AR v25,a21
AR v26,a22
AR v27,a23
v_mul_f32 v20,v32,v20
v_mul_f32 v21,v32,v21
v_mul_f32 v22,v32,v22
v_mul_f32 v23,v32,v23
v_mul_f32 v24,v33,v24
v_mul_f32 v25,v33,v25
v_mul_f32 v26,v33,v26
v_mul_f32 v27,v33,v27
AW a16,v20
AW a17,v21
AW a18,v22
AW a19,v23
AW a20,v24
AW a21,v25
AW a22,v26
AW a23,v27
AR v20,a24
AR v21,a25
AR v22,a26
AR v23,a27
AR v24,a28
AR v25,a29
AR v26,a30
AR v27,a31
v_mul_f32 v20,v32,v20
v_mul_f32 v21,v32,v21
v_mul_f32 v22,v32,v22
v_mul_f32 v23,v32,v23
v_mul_f32 v24,v33,v24
v_mul_f32 v25,v33,v25
v_mul_f32 v26,v33,v26
v_mul_f32 v27,v33,v27
AW a24,v20
AW a25,v21
AW a26,v22
AW a27,v23
AW a28,v24
AW a29,v25
AW a30,v26
AW a31,v27
AR v20,a32
AR v21,a33
AR v22,a34
AR v23,a35
AR v24,a36
AR v25,a37
AR v26,a38
AR v27,a39
v_mul_f32 v20,v32,v20
v_mul_f32 v21,v32,v21
v_mul_f32 v22,v32,v22
v_mul_f32 v23,v32,v23
v_mul_f32 v24,v33,v24
v_mul_f32 v25,v33,v25
v_mul_f32 v26,v33,v26
v_mul_f32 v27,v33,v27
AW a32,v20
AW a33,v21
AW a34,v22
AW a35,v23
AW a36,v24
AW a37,v25
AW a38,v26
AW a39,v27
AR v20,a40
AR v21,a41
AR v22,a42
AR v23,a43
AR v24,a44
AR v25,a45
AR v26,a46
AR v27,a47
v_mul_f32 v20,v32,v20
v_mul_f32 v21,v32,v21
v_mul_f32 v22,v32,v22
v_mul_f32 v23,v32,v23
v_mul_f32 v24,v33,v24
v_mul_f32 v25,v33,v25
v_mul_f32 v26,v33,v26
v_mul_f32 v27,v33,v27
AW a40,v20
AW a41,v21
AW a42,v22
AW a43,v23
AW a44,v24
AW a45,v25
AW a46,v26
AW a47,v27
AR v20,a48
AR v21,a49
AR v22,a50
AR v23,a51
AR v24,a52
AR v25,a53
AR v26,a54
AR v27,a55
v_mul_f32 v20,v32,v20
v_mul_f32 v21,v32,v21
v_mul_f32 v22,v32,v22
v_mul_f32 v23,v32,v23
v_mul_f32 v24,v33,v24
v_mul_f32 v25,v33,v25
v_mul_f32 v26,v33,v26
v_mul_f32 v27,v33,v27
AW a48,v20
AW a49,v21
AW a50,v22
AW a51,v23
AW a52,v24
AW a53,v25
AW a54,v26
AW a55,v27
AR v20,a56
AR v21,a57
AR v22,a58
AR v23,a59
AR v24,a60
AR v25,a61
AR v26,a62
AR v27,a63
v_mul_f32 v20,v32,v20
v_mul_f32 v21,v32,v21
v_mul_f32 v22,v32,v22
v_mul_f32 v23,v32,v23
v_mul_f32 v24,v33,v24
v_mul_f32 v25,v33,v25
v_mul_f32 v26,v33,v26
v_mul_f32 v27,v33,v27
AW a56,v20
AW a57,v21
AW a58,v22
AW a59,v23
AW a60,v24
AW a61,v25
AW a62,v26
AW a63,v27
AR v20,a64
AR v21,a65
AR v22,a66
AR v23,a67
AR v24,a68
AR v25,a69
AR v26,a70
AR v27,a71
v_mul_f32 v20,v32,v20
v_mul_f32 v21,v32,v21
v_mul_f32 v22,v32,v22
v_mul_f32 v23,v32,v23
v_mul_f32 v24,v33,v24
v_mul_f32 v25,v33,v25
v_mul_f32 v26,v33,v26
v_mul_f32 v27,v33,v27
AW a64,v20
AW a65,v21
AW a66,v22
AW a67,v23
AW a68,v24
AW a69,v25
AW a70,v26
AW a71,v27
AR v20,a72
AR v21,a73
AR v22,a74
AR v23,a75
AR v24,a76
AR v25,a77
AR v26,a78
AR v27,a79
v_mul_f32 v20,v32,v20
v_mul_f32 v21,v32,v21
v_mul_f32 v22,v32,v22
v_mul_f32 v23,v32,v23
v_mul_f32 v24,v33,v24
v_mul_f32 v25,v33,v25
v_mul_f32 v26,v33,v26
v_mul_f32 v27,v33,v27
AW a72,v20
AW a73,v21
AW a74,v22
AW a75,v23
AW a76,v24
AW a77,v25
AW a78,v26
AW a79,v27
AR v20,a80
AR v21,a81
AR v22,a82
AR v23,a83
AR v24,a84
AR v25,a85
AR v26,a86
AR v27,a87
v_mul_f32 v20,v32,v20
v_mul_f32 v21,v32,v21
v_mul_f32 v22,v32,v22
v_mul_f32 v23,v32,v23
v_mul_f32 v24,v33,v24
v_mul_f32 v25,v33,v25
v_mul_f32 v26,v33,v26
v_mul_f32 v27,v33,v27
AW a80,v20
AW a81,v21
AW a82,v22
AW a83,v23
AW a84,v24
AW a85,v25
AW a86,v26
AW a87,v27
AR v20,a88
AR v21,a89
AR v22,a90
AR v23,a91
AR v24,a92
AR v25,a93
AR v26,a94
AR v27,a95
v_mul_f32 v20,v32,v20
v_mul_f32 v21,v32,v21
v_mul_f32 v22,v32,v22
v_mul_f32 v23,v32,v23
v_mul_f32 v24,v33,v24
v_mul_f32 v25,v33,v25
v_mul_f32 v26,v33,v26
v_mul_f32 v27,v33,v27
AW a88,v20
AW a89,v21
AW a90,v22
AW a91,v23
AW a92,v24
AW a93,v25
AW a94,v26
AW a95,v27
AR v20,a96
AR v21,a97
AR v22,a98
AR v23,a99
AR v24,a100
AR v25,a101
AR v26,a102
AR v27,a103
v_mul_f32 v20,v32,v20
v_mul_f32 v21,v32,v21
v_mul_f32 v22,v32,v22
v_mul_f32 v23,v32,v23
v_mul_f32 v24,v33,v24
v_mul_f32 v25,v33,v25
v_mul_f32 v26,v33,v26
v_mul_f32 v27,v33,v27
AW a96,v20
AW a97,v21
AW a98,v22
AW a99,v23
AW a100,v24
AW a101,v25
AW a102,v26
AW a103,v27
AR v20,a104
AR v21,a105
AR v22,a106
AR v23,a107
AR v24,a108
AR v25,a109
AR v26,a110
AR v27,a111
v_mul_f32 v20,v32,v20
v_mul_f32 v21,v32,v21
v_mul_f32 v22,v32,v22
v_mul_f32 v23,v32,v23
v_mul_f32 v24,v33,v24
v_mul_f32 v25,v33,v25
v_mul_f32 v26,v33,v26
v_mul_f32 v27,v33,v27
AW a104,v20
AW a105,v21
AW a106,v22
AW a107,v23
AW a108,v24
AW a109,v25
AW a110,v26
AW a111,v27
AR v20,a112
AR v21,a113
AR v22,a114
AR v23,a115
AR v24,a116
AR v25,a117
AR v26,a118
AR v27,a119
v_mul_f32 v20,v32,v20
v_mul_f32 v21,v32,v21
v_mul_f32 v22,v32,v22
v_mul_f32 v23,v32,v23
v_mul_f32 v24,v33,v24
v_mul_f32 v25,v33,v25
v_mul_f32 v26,v33,v26
v_mul_f32 v27,v33,v27
AW a112,v20
AW a113,v21
AW a114,v22
AW a115,v23
AW a116,v24
AW a117,v25
AW a118,v26
AW a119,v27
AR v20,a120
AR v21,a121
AR v22,a122
AR v23,a123
AR v24,a124
AR v25,a125
AR v26,a126
AR v27,a127
v_mul_f32 v20,v32,v20
v_mul_f32 v21,v32,v21
v_mul_f32 v22,v32,v22
v_mul_f32 v23,v32,v23
v_mul_f32 v24,v33,v24
v_mul_f32 v25,v33,v25
v_mul_f32 v26,v33,v26
v_mul_f32 v27,v33,v27
AW a120,v20
AW a121,v21
AW a122,v22
AW a123,v23
AW a124,v24
AW a125,v25
AW a126,v26
AW a127,v27
s_nop 1
s_setpc_b64 s[100:101]
K2_RARE1:
s_nop 7
s_nop 0
v_max3_f32 v30,v160,v161,v162
v_max3_f32 v30,v163,v168,v30
v_max3_f32 v30,v169,v170,v30
v_max3_f32 v30,v171,v176,v30
v_max3_f32 v30,v177,v178,v30
v_max3_f32 v30,v179,v184,v30
v_max3_f32 v30,v185,v186,v30
v_max_f32 v30,v187,v30
v_mov_b32 v34,v30
s_nop 1
v_permlane32_swap_b32 v34,v30
s_nop 1
v_max_f32 v30,v34,v30
v_mov_b32 v34,v30
s_nop 1
v_permlane16_swap_b32 v34,v30
s_nop 1
v_max_f32_e64 v30,v34,v30
v_add_f32 v30,0x42000000,v30
v_max_f32_e64 v30,0,v30
v_exp_f32 v32,-v30
v_sub_f32 v8,v8,v30
v_sub_f32 v9,v9,v30
v_sub_f32 v10,v10,v30
v_sub_f32 v11,v11,v30
v_mul_f32 v127,v127,v32
v_sub_f32 v128,v128,v30
v_sub_f32 v129,v129,v30
v_sub_f32 v130,v130,v30
v_sub_f32 v131,v131,v30
v_sub_f32 v136,v136,v30
v_sub_f32 v137,v137,v30
v_sub_f32 v138,v138,v30
v_sub_f32 v139,v139,v30
v_sub_f32 v144,v144,v30
v_sub_f32 v145,v145,v30
v_sub_f32 v146,v146,v30
v_sub_f32 v147,v147,v30
v_sub_f32 v152,v152,v30
v_sub_f32 v153,v153,v30
v_sub_f32 v154,v154,v30
v_sub_f32 v155,v155,v30
v_sub_f32 v160,v160,v30
v_sub_f32 v161,v161,v30
v_sub_f32 v162,v162,v30
v_sub_f32 v163,v163,v30
v_sub_f32 v168,v168,v30
v_sub_f32 v169,v169,v30
v_sub_f32 v170,v170,v30
v_sub_f32 v171,v171,v30
v_sub_f32 v176,v176,v30
v_sub_f32 v177,v177,v30
v_sub_f32 v178,v178,v30
v_sub_f32 v179,v179,v30
v_sub_f32 v184,v184,v30
v_sub_f32 v185,v185,v30
v_sub_f32 v186,v186,v30
v_sub_f32_e64 v187,v187,v30
v_max3_f32 v31,v164,v165,v166
v_max3_f32 v31,v167,v172,v31
v_max3_f32 v31,v173,v174,v31
v_max3_f32 v31,v175,v180,v31
v_max3_f32 v31,v181,v182,v31
v_max3_f32 v31,v183,v188,v31
v_max3_f32 v31,v189,v190,v31
v_max_f32 v31,v191,v31
v_mov_b32 v34,v31
s_nop 1
v_permlane32_swap_b32 v34,v31
s_nop 1
v_max_f32 v31,v34,v31
v_mov_b32 v34,v31
s_nop 1
v_permlane16_swap_b32 v34,v31
s_nop 1
v_max_f32_e64 v31,v34,v31
v_add_f32 v31,0x42000000,v31
v_max_f32_e64 v31,0,v31
v_exp_f32 v33,-v31
v_sub_f32 v12,v12,v31
v_sub_f32 v13,v13,v31
v_sub_f32 v14,v14,v31
v_sub_f32 v15,v15,v31
v_mul_f32 v46,v46,v33
v_sub_f32 v132,v132,v31
v_sub_f32 v133,v133,v31
v_sub_f32 v134,v134,v31
v_sub_f32 v135,v135,v31
v_sub_f32 v140,v140,v31
v_sub_f32 v141,v141,v31
v_sub_f32 v142,v142,v31
v_sub_f32 v143,v143,v31
v_sub_f32 v148,v148,v31
v_sub_f32 v149,v149,v31
v_sub_f32 v150,v150,v31
v_sub_f32 v151,v151,v31
v_sub_f32 v156,v156,v31
v_sub_f32 v157,v157,v31
v_sub_f32 v158,v158,v31
v_sub_f32 v159,v159,v31
v_sub_f32 v164,v164,v31
v_sub_f32 v165,v165,v31
v_sub_f32 v166,v166,v31
v_sub_f32 v167,v167,v31
v_sub_f32 v172,v172,v31
v_sub_f32 v173,v173,v31
v_sub_f32 v174,v174,v31
v_sub_f32 v175,v175,v31
v_sub_f32 v180,v180,v31
v_sub_f32 v181,v181,v31
v_sub_f32 v182,v182,v31
v_sub_f32 v183,v183,v31
v_sub_f32 v188,v188,v31
v_sub_f32 v189,v189,v31
v_sub_f32 v190,v190,v31
v_sub_f32 v191,v191,v31
v_exp_f32 v20,v160
v_exp_f32 v21,v161
v_exp_f32 v22,v162
v_exp_f32_e64 v23,v163
CV v64,v20,v21
v_add_f32 v6,v20,v21
v_exp_f32 v24,v168
v_exp_f32_e64 v25,v169
CV v65,v22,v23
v_add_f32 v6,v6,v22
v_add_f32 v6,v6,v23
v_exp_f32 v26,v170
v_exp_f32 v27,v171
CV v66,v24,v25
v_add_f32 v6,v6,v24
v_add_f32 v6,v6,v25
v_exp_f32 v20,v176
v_exp_f32 v21,v177
CV v67,v26,v27
v_add_f32 v6,v6,v26
v_add_f32 v6,v6,v27
v_exp_f32 v22,v178
v_exp_f32 v23,v179
CV v72,v20,v21
v_add_f32 v6,v6,v20
v_add_f32 v6,v6,v21
v_exp_f32 v24,v184
v_exp_f32 v25,v185
CV v73,v22,v23
v_add_f32 v6,v6,v22
v_add_f32 v6,v6,v23
v_exp_f32 v26,v186
v_exp_f32 v27,v187
CV v74,v24,v25
v_add_f32 v6,v6,v24
v_add_f32 v6,v6,v25
v_exp_f32 v20,v164
v_exp_f32 v21,v165
CV v75,v26,v27
v_add_f32 v6,v6,v26
v_add_f32 v6,v6,v27
v_exp_f32 v22,v166
v_exp_f32 v23,v167
CV v68,v20,v21
v_add_f32 v43,v20,v21
v_exp_f32 v24,v172
v_exp_f32_e64 v25,v173
CV v69,v22,v23
v_add_f32 v43,v43,v22
v_add_f32 v43,v43,v23
v_exp_f32 v26,v174
v_exp_f32 v27,v175
CV v70,v24,v25
v_add_f32 v43,v43,v24
v_add_f32 v43,v43,v25
v_exp_f32 v20,v180
v_exp_f32 v21,v181
CV v71,v26,v27
v_add_f32 v43,v43,v26
v_add_f32 v43,v43,v27
v_exp_f32 v22,v182
v_exp_f32 v23,v183
CV v76,v20,v21
v_add_f32 v43,v43,v20
v_add_f32 v43,v43,v21
v_exp_f32 v24,v188
v_exp_f32 v25,v189
CV v77,v22,v23
v_add_f32 v43,v43,v22
v_add_f32 v43,v43,v23
v_exp_f32 v26,v190
v_exp_f32 v27,v191
CV v78,v24,v25
v_add_f32 v43,v43,v24
v_add_f32 v43,v43,v25
v_add_f32_e64 v43,v43,v26
CV v79,v26,v27
v_add_f32_e64 v43,v43,v27
AR v20,a0
AR v21,a1
AR v22,a2
AR v23,a3
AR v24,a4
AR v25,a5
AR v26,a6
AR v27,a7
v_mul_f32 v20,v32,v20
v_mul_f32 v21,v32,v21
v_mul_f32 v22,v32,v22
v_mul_f32 v23,v32,v23
v_mul_f32 v24,v33,v24
v_mul_f32 v25,v33,v25
v_mul_f32 v26,v33,v26
v_mul_f32 v27,v33,v27
AW a0,v20
AW a1,v21
AW a2,v22
AW a3,v23
AW a4,v24
AW a5,v25
AW a6,v26
AW a7,v27
AR v20,a8
AR v21,a9
AR v22,a10
AR v23,a11
AR v24,a12
AR v25,a13
AR v26,a14
AR v27,a15
v_mul_f32 v20,v32,v20
v_mul_f32 v21,v32,v21
v_mul_f32 v22,v32,v22
v_mul_f32 v23,v32,v23
v_mul_f32 v24,v33,v24
v_mul_f32 v25,v33,v25
v_mul_f32 v26,v33,v26
v_mul_f32 v27,v33,v27
AW a8,v20
AW a9,v21
AW a10,v22
AW a11,v23
AW a12,v24
AW a13,v25
AW a14,v26
AW a15,v27
AR v20,a16
AR v21,a17
AR v22,a18
AR v23,a19
AR v24,a20
AR v25,a21
AR v26,a22
AR v27,a23
v_mul_f32 v20,v32,v20
v_mul_f32 v21,v32,v21
v_mul_f32 v22,v32,v22
v_mul_f32 v23,v32,v23
v_mul_f32 v24,v33,v24
v_mul_f32 v25,v33,v25
v_mul_f32 v26,v33,v26
v_mul_f32 v27,v33,v27
AW a16,v20
AW a17,v21
AW a18,v22
AW a19,v23
AW a20,v24
AW a21,v25
AW a22,v26
AW a23,v27
AR v20,a24
AR v21,a25
AR v22,a26
AR v23,a27
AR v24,a28
AR v25,a29
AR v26,a30
AR v27,a31
v_mul_f32 v20,v32,v20
v_mul_f32 v21,v32,v21
v_mul_f32 v22,v32,v22
v_mul_f32 v23,v32,v23
v_mul_f32 v24,v33,v24
v_mul_f32 v25,v33,v25
v_mul_f32 v26,v33,v26
v_mul_f32 v27,v33,v27
AW a24,v20
AW a25,v21
AW a26,v22
AW a27,v23
AW a28,v24
AW a29,v25
AW a30,v26
AW a31,v27
AR v20,a32
AR v21,a33
AR v22,a34
AR v23,a35
AR v24,a36
AR v25,a37
AR v26,a38
AR v27,a39
v_mul_f32 v20,v32,v20
v_mul_f32 v21,v32,v21
v_mul_f32 v22,v32,v22
v_mul_f32 v23,v32,v23
v_mul_f32 v24,v33,v24
v_mul_f32 v25,v33,v25
v_mul_f32 v26,v33,v26
v_mul_f32 v27,v33,v27
AW a32,v20
AW a33,v21
AW a34,v22
AW a35,v23
AW a36,v24
AW a37,v25
AW a38,v26
AW a39,v27
AR v20,a40
AR v21,a41
AR v22,a42
AR v23,a43
AR v24,a44
AR v25,a45
AR v26,a46
AR v27,a47
v_mul_f32 v20,v32,v20
v_mul_f32 v21,v32,v21
v_mul_f32 v22,v32,v22
v_mul_f32 v23,v32,v23
v_mul_f32 v24,v33,v24
v_mul_f32 v25,v33,v25
v_mul_f32 v26,v33,v26
v_mul_f32 v27,v33,v27
AW a40,v20
AW a41,v21
AW a42,v22
AW a43,v23
AW a44,v24
AW a45,v25
AW a46,v26
AW a47,v27
AR v20,a48
AR v21,a49
AR v22,a50
AR v23,a51
AR v24,a52
AR v25,a53
AR v26,a54
AR v27,a55
v_mul_f32 v20,v32,v20
v_mul_f32 v21,v32,v21
v_mul_f32 v22,v32,v22
v_mul_f32 v23,v32,v23
v_mul_f32 v24,v33,v24
v_mul_f32 v25,v33,v25
v_mul_f32 v26,v33,v26
v_mul_f32 v27,v33,v27
AW a48,v20
AW a49,v21
AW a50,v22
AW a51,v23
AW a52,v24
AW a53,v25
AW a54,v26
AW a55,v27
AR v20,a56
AR v21,a57
AR v22,a58
AR v23,a59
AR v24,a60
AR v25,a61
AR v26,a62
AR v27,a63
v_mul_f32 v20,v32,v20
v_mul_f32 v21,v32,v21
v_mul_f32 v22,v32,v22
v_mul_f32 v23,v32,v23
v_mul_f32 v24,v33,v24
v_mul_f32 v25,v33,v25
v_mul_f32 v26,v33,v26
v_mul_f32 v27,v33,v27
AW a56,v20
AW a57,v21
AW a58,v22
AW a59,v23
AW a60,v24
AW a61,v25
AW a62,v26
AW a63,v27
AR v20,a64
AR v21,a65
AR v22,a66
AR v23,a67
AR v24,a68
AR v25,a69
AR v26,a70
AR v27,a71
v_mul_f32 v20,v32,v20
v_mul_f32 v21,v32,v21
v_mul_f32 v22,v32,v22
v_mul_f32 v23,v32,v23
v_mul_f32 v24,v33,v24
v_mul_f32 v25,v33,v25
v_mul_f32 v26,v33,v26
v_mul_f32 v27,v33,v27
AW a64,v20
AW a65,v21
AW a66,v22
AW a67,v23
AW a68,v24
AW a69,v25
AW a70,v26
AW a71,v27
AR v20,a72
AR v21,a73
AR v22,a74
AR v23,a75
AR v24,a76
AR v25,a77
AR v26,a78
AR v27,a79
v_mul_f32 v20,v32,v20
v_mul_f32 v21,v32,v21
v_mul_f32 v22,v32,v22
v_mul_f32 v23,v32,v23
v_mul_f32 v24,v33,v24
v_mul_f32 v25,v33,v25
v_mul_f32 v26,v33,v26
v_mul_f32 v27,v33,v27
AW a72,v20
AW a73,v21
AW a74,v22
AW a75,v23
AW a76,v24
AW a77,v25
AW a78,v26
AW a79,v27
AR v20,a80
AR v21,a81
AR v22,a82
AR v23,a83
AR v24,a84
AR v25,a85
AR v26,a86
AR v27,a87
v_mul_f32 v20,v32,v20
v_mul_f32 v21,v32,v21
v_mul_f32 v22,v32,v22
v_mul_f32 v23,v32,v23
v_mul_f32 v24,v33,v24
v_mul_f32 v25,v33,v25
v_mul_f32 v26,v33,v26
v_mul_f32 v27,v33,v27
AW a80,v20
AW a81,v21
AW a82,v22
AW a83,v23
AW a84,v24
AW a85,v25
AW a86,v26
AW a87,v27
AR v20,a88
AR v21,a89
AR v22,a90
AR v23,a91
AR v24,a92
AR v25,a93
AR v26,a94
AR v27,a95
v_mul_f32 v20,v32,v20
v_mul_f32 v21,v32,v21
v_mul_f32 v22,v32,v22
v_mul_f32 v23,v32,v23
v_mul_f32 v24,v33,v24
v_mul_f32 v25,v33,v25
v_mul_f32 v26,v33,v26
v_mul_f32 v27,v33,v27
AW a88,v20
AW a89,v21
AW a90,v22
AW a91,v23
AW a92,v24
AW a93,v25
AW a94,v26
AW a95,v27
AR v20,a96
AR v21,a97
AR v22,a98
AR v23,a99
AR v24,a100
AR v25,a101
AR v26,a102
AR v27,a103
v_mul_f32 v20,v32,v20
v_mul_f32 v21,v32,v21
v_mul_f32 v22,v32,v22
v_mul_f32 v23,v32,v23
v_mul_f32 v24,v33,v24
v_mul_f32 v25,v33,v25
v_mul_f32 v26,v33,v26
v_mul_f32 v27,v33,v27
AW a96,v20
AW a97,v21
AW a98,v22
AW a99,v23
AW a100,v24
AW a101,v25
AW a102,v26
AW a103,v27
AR v20,a104
AR v21,a105
AR v22,a106
AR v23,a107
AR v24,a108
AR v25,a109
AR v26,a110
AR v27,a111
v_mul_f32 v20,v32,v20
v_mul_f32 v21,v32,v21
v_mul_f32 v22,v32,v22
v_mul_f32 v23,v32,v23
v_mul_f32 v24,v33,v24
v_mul_f32 v25,v33,v25
v_mul_f32 v26,v33,v26
v_mul_f32 v27,v33,v27
AW a104,v20
AW a105,v21
AW a106,v22
AW a107,v23
AW a108,v24
AW a109,v25
AW a110,v26
AW a111,v27
AR v20,a112
AR v21,a113
AR v22,a114
AR v23,a115
AR v24,a116
AR v25,a117
AR v26,a118
AR v27,a119
v_mul_f32 v20,v32,v20
v_mul_f32 v21,v32,v21
v_mul_f32 v22,v32,v22
v_mul_f32 v23,v32,v23
v_mul_f32 v24,v33,v24
v_mul_f32 v25,v33,v25
v_mul_f32 v26,v33,v26
v_mul_f32 v27,v33,v27
AW a112,v20
AW a113,v21
AW a114,v22
AW a115,v23
AW a116,v24
AW a117,v25
AW a118,v26
AW a119,v27
AR v20,a120
AR v21,a121
AR v22,a122
AR v23,a123
AR v24,a124
AR v25,a125
AR v26,a126
AR v27,a127
v_mul_f32 v20,v32,v20
v_mul_f32 v21,v32,v21
v_mul_f32 v22,v32,v22
v_mul_f32 v23,v32,v23
v_mul_f32 v24,v33,v24
v_mul_f32 v25,v33,v25
v_mul_f32 v26,v33,v26
v_mul_f32 v27,v33,v27
AW a120,v20
AW a121,v21
AW a122,v22
AW a123,v23
AW a124,v24
AW a125,v25
AW a126,v26
AW a127,v27
s_nop 1
s_setpc_b64 s[100:101]
K2_RAREL1:
s_nop 7
s_nop 0
v_max3_f32 v31,v164,v165,v166
v_max3_f32 v31,v167,v172,v31
v_max3_f32 v31,v173,v174,v31
v_max3_f32 v31,v175,v180,v31
v_max3_f32 v31,v181,v182,v31
v_max3_f32 v31,v183,v188,v31
v_max3_f32 v31,v189,v190,v31
v_max_f32 v31,v191,v31
v_mov_b32 v34,v31
s_nop 1
v_permlane32_swap_b32 v34,v31
s_nop 1
v_max_f32 v31,v34,v31
v_mov_b32 v34,v31
s_nop 1
v_permlane16_swap_b32 v34,v31
s_nop 1
v_max_f32_e64 v31,v34,v31
v_add_f32 v31,0x42000000,v31
v_max_f32_e64 v31,0,v31
v_exp_f32 v33,-v31
v_sub_f32 v12,v12,v31
v_sub_f32 v13,v13,v31
v_sub_f32 v14,v14,v31
v_sub_f32 v15,v15,v31
v_mul_f32 v46,v46,v33
v_sub_f32 v164,v164,v31
v_sub_f32 v165,v165,v31
v_sub_f32 v166,v166,v31
v_sub_f32 v167,v167,v31
v_sub_f32 v172,v172,v31
v_sub_f32 v173,v173,v31
v_sub_f32 v174,v174,v31
v_sub_f32 v175,v175,v31
v_sub_f32 v180,v180,v31
v_sub_f32 v181,v181,v31
v_sub_f32 v182,v182,v31
v_sub_f32 v183,v183,v31
v_sub_f32 v188,v188,v31
v_sub_f32 v189,v189,v31
v_sub_f32 v190,v190,v31
v_sub_f32 v191,v191,v31
v_exp_f32 v20,v164
v_exp_f32 v21,v165
v_exp_f32 v22,v166
v_exp_f32_e64 v23,v167
CV v68,v20,v21
v_add_f32 v43,v20,v21
v_exp_f32 v24,v172
v_exp_f32_e64 v25,v173
CV v69,v22,v23
v_add_f32 v43,v43,v22
v_add_f32 v43,v43,v23
v_exp_f32 v26,v174
v_exp_f32 v27,v175
CV v70,v24,v25
v_add_f32 v43,v43,v24
v_add_f32 v43,v43,v25
v_exp_f32 v20,v180
v_exp_f32 v21,v181
CV v71,v26,v27
v_add_f32 v43,v43,v26
v_add_f32 v43,v43,v27
v_exp_f32 v22,v182
v_exp_f32 v23,v183
CV v76,v20,v21
v_add_f32 v43,v43,v20
v_add_f32 v43,v43,v21
v_exp_f32 v24,v188
v_exp_f32 v25,v189
CV v77,v22,v23
v_add_f32 v43,v43,v22
v_add_f32 v43,v43,v23
v_exp_f32 v26,v190
v_exp_f32 v27,v191
CV v78,v24,v25
v_add_f32 v43,v43,v24
v_add_f32 v43,v43,v25
v_add_f32_e64 v43,v43,v26
CV v79,v26,v27
v_add_f32_e64 v43,v43,v27
AR v20,a4
AR v21,a5
AR v22,a6
AR v23,a7
AR v24,a12
AR v25,a13
AR v26,a14
AR v27,a15
v_mul_f32 v20,v33,v20
v_mul_f32 v21,v33,v21
v_mul_f32 v22,v33,v22
v_mul_f32 v23,v33,v23
v_mul_f32 v24,v33,v24
v_mul_f32 v25,v33,v25
v_mul_f32 v26,v33,v26
v_mul_f32 v27,v33,v27
AW a4,v20
AW a5,v21
AW a6,v22
AW a7,v23
AW a12,v24
AW a13,v25
AW a14,v26
AW a15,v27
AR v20,a20
AR v21,a21
AR v22,a22
AR v23,a23
AR v24,a28
AR v25,a29
AR v26,a30
AR v27,a31
v_mul_f32 v20,v33,v20
v_mul_f32 v21,v33,v21
v_mul_f32 v22,v33,v22
v_mul_f32 v23,v33,v23
v_mul_f32 v24,v33,v24
v_mul_f32 v25,v33,v25
v_mul_f32 v26,v33,v26
v_mul_f32 v27,v33,v27
AW a20,v20
AW a21,v21
AW a22,v22
AW a23,v23
AW a28,v24
AW a29,v25
AW a30,v26
AW a31,v27
AR v20,a36
AR v21,a37
AR v22,a38
AR v23,a39
AR v24,a44
AR v25,a45
AR v26,a46
AR v27,a47
v_mul_f32 v20,v33,v20
v_mul_f32 v21,v33,v21
v_mul_f32 v22,v33,v22
v_mul_f32 v23,v33,v23
v_mul_f32 v24,v33,v24
v_mul_f32 v25,v33,v25
v_mul_f32 v26,v33,v26
v_mul_f32 v27,v33,v27
AW a36,v20
AW a37,v21
AW a38,v22
AW a39,v23
AW a44,v24
AW a45,v25
AW a46,v26
AW a47,v27
AR v20,a52
AR v21,a53
AR v22,a54
AR v23,a55
AR v24,a60
AR v25,a61
AR v26,a62
AR v27,a63
v_mul_f32 v20,v33,v20
v_mul_f32 v21,v33,v21
v_mul_f32 v22,v33,v22
v_mul_f32 v23,v33,v23
v_mul_f32 v24,v33,v24
v_mul_f32 v25,v33,v25
v_mul_f32 v26,v33,v26
v_mul_f32 v27,v33,v27
AW a52,v20
AW a53,v21
AW a54,v22
AW a55,v23
AW a60,v24
AW a61,v25
AW a62,v26
AW a63,v27
AR v20,a68
AR v21,a69
AR v22,a70
AR v23,a71
AR v24,a76
AR v25,a77
AR v26,a78
AR v27,a79
v_mul_f32 v20,v33,v20
v_mul_f32 v21,v33,v21
v_mul_f32 v22,v33,v22
v_mul_f32 v23,v33,v23
v_mul_f32 v24,v33,v24
v_mul_f32 v25,v33,v25
v_mul_f32 v26,v33,v26
v_mul_f32 v27,v33,v27
AW a68,v20
AW a69,v21
AW a70,v22
AW a71,v23
AW a76,v24
AW a77,v25
AW a78,v26
AW a79,v27
AR v20,a84
AR v21,a85
AR v22,a86
AR v23,a87
AR v24,a92
AR v25,a93
AR v26,a94
AR v27,a95
v_mul_f32 v20,v33,v20
v_mul_f32 v21,v33,v21
v_mul_f32 v22,v33,v22
v_mul_f32 v23,v33,v23
v_mul_f32 v24,v33,v24
v_mul_f32 v25,v33,v25
v_mul_f32 v26,v33,v26
v_mul_f32 v27,v33,v27
AW a84,v20
AW a85,v21
AW a86,v22
AW a87,v23
AW a92,v24
AW a93,v25
AW a94,v26
AW a95,v27
AR v20,a100
AR v21,a101
AR v22,a102
AR v23,a103
AR v24,a108
AR v25,a109
AR v26,a110
AR v27,a111
v_mul_f32 v20,v33,v20
v_mul_f32 v21,v33,v21
v_mul_f32 v22,v33,v22
v_mul_f32 v23,v33,v23
v_mul_f32 v24,v33,v24
v_mul_f32 v25,v33,v25
v_mul_f32 v26,v33,v26
v_mul_f32 v27,v33,v27
AW a100,v20
AW a101,v21
AW a102,v22
AW a103,v23
AW a108,v24
AW a109,v25
AW a110,v26
AW a111,v27
AR v20,a116
AR v21,a117
AR v22,a118
AR v23,a119
AR v24,a124
AR v25,a125
AR v26,a126
AR v27,a127
v_mul_f32 v20,v33,v20
v_mul_f32 v21,v33,v21
v_mul_f32 v22,v33,v22
v_mul_f32 v23,v33,v23
v_mul_f32 v24,v33,v24
v_mul_f32 v25,v33,v25
v_mul_f32 v26,v33,v26
v_mul_f32 v27,v33,v27
AW a116,v20
AW a117,v21
AW a118,v22
AW a119,v23
AW a124,v24
AW a125,v25
AW a126,v26
AW a127,v27
s_nop 1
s_setpc_b64 s[100:101]
CK_2:
s_call_b64 s[100:101],K2_RARE0
s_branch CK_2R
CK_3:
s_call_b64 s[100:101],K2_RARE1
s_branch CK_3R
CK_4:
s_call_b64 s[100:101],K2_RARE0
s_branch CK_4R
CK_5:
s_call_b64 s[100:101],K2_RARE1
s_branch CK_5R
K2_LAST2:
s_add_u32 m0,s21,131072
s_nop 0
buffer_load_dwordx4 v112,s[16:19],s61 offen lds
buffer_load_dwordx4 v113,s[16:19],s61 offen offset:1024 lds
buffer_load_dwordx4 v114,s[16:19],s61 offen offset:2048 lds
buffer_load_dwordx4 v115,s[16:19],s61 offen offset:3072 lds
s_add_u32 m0,s21,135168
s_nop 0
buffer_load_dwordx4 v112,s[16:19],s56 offen lds
buffer_load_dwordx4 v113,s[16:19],s56 offen offset:1024 lds
buffer_load_dwordx4 v114,s[16:19],s56 offen offset:2048 lds
buffer_load_dwordx4 v115,s[16:19],s56 offen offset:3072 lds
s_add_u32 m0,s21,65536
s_branch K2_LAST
K2_PCK:
s_mov_b64 s[54:55],vcc
s_mov_b32 s33,s28
s_call_b64 s[100:101],SUB_CHK
s_mov_b64 vcc,s[54:55]
s_branch K2_PCKR
CK_6:
s_call_b64 s[100:101],K2_RARE0
s_branch CK_6R
CK_7:
s_call_b64 s[100:101],K2_RAREL1
s_branch CK_7R
CK_5001:
s_call_b64 s[100:101],K2_RARE1
s_branch CK_5001R
HSUB_PF_F0V0:
s_call_b64 s[100:101],SUB_PF
s_branch HSUB_PF_F0V0_R
HSUB_X_V0:
s_mov_b64 s[4:5],s[46:47]
s_mov_b32 s6,s48
s_mov_b32 s22,0
s_mov_b32 s23,s16
AR v22,a192
AR v23,a193
AR v24,a194
AR v25,a195
s_branch HSUB_X_V0_R
HSUB_S_V0:
s_call_b64 s[100:101],SUB_S
s_branch HSUB_S_V0_R
HSUB_W_V0:
s_mov_b64 s[8:9],s[50:51]
s_mov_b32 s10,s49
s_mov_b32 s24,0
s_mov_b32 s25,s52
AR v26,a196
AR v27,a197
AR v28,a198
AR v29,a199
v_readfirstlane_b32 s30,v38
s_nop 0
s_cmp_lg_u32 s30,0
s_cbranch_scc1 HSUB_W_V0_R
s_cmp_eq_u32 s20,0
s_cbranch_scc0 HSUB_W_V0_R
s_call_b64 s[100:101],SUB_W
s_branch HSUB_W_V0_R
HSUB_PF_V0:
s_call_b64 s[100:101],SUB_PF
s_branch HSUB_PF_V0_R
HSUB_X_V1:
s_mov_b64 s[4:5],s[46:47]
s_mov_b32 s6,s48
s_mov_b32 s22,0
s_mov_b32 s23,s16
AR v22,a192
AR v23,a193
AR v24,a194
AR v25,a195
s_branch HSUB_X_V1_R
HSUB_S_V1:
s_call_b64 s[100:101],SUB_S
s_branch HSUB_S_V1_R
HSUB_W_V1:
s_mov_b64 s[8:9],s[50:51]
s_mov_b32 s10,s49
s_mov_b32 s24,0
s_mov_b32 s25,s52
AR v26,a196
AR v27,a197
AR v28,a198
AR v29,a199
v_readfirstlane_b32 s30,v38
s_nop 0
s_cmp_lg_u32 s30,0
s_cbranch_scc1 HSUB_W_V1_R
s_cmp_eq_u32 s20,0
s_cbranch_scc0 HSUB_W_V1_R
s_call_b64 s[100:101],SUB_W
s_branch HSUB_W_V1_R
HSUB_PF_V1:
s_call_b64 s[100:101],SUB_PF
s_branch HSUB_PF_V1_R
TLC_V:
s_call_b64 s[100:101],SUB_CHK
s_branch TLC_VR
.section .rodata,"a"
.p2align 6
.amdhsa_kernel concat_heads__sliding_local_dilated__compressed_kv_cla__prompt_kernel
      .amdhsa_next_free_vgpr 512
      .amdhsa_next_free_sgpr 102
      .amdhsa_accum_offset 256
      .amdhsa_group_segment_fixed_size 0
      .amdhsa_kernarg_size 96
      .amdhsa_user_sgpr_count 2
      .amdhsa_user_sgpr_kernarg_segment_ptr 1
      .amdhsa_system_sgpr_workgroup_id_x 1
.end_amdhsa_kernel
.text
.text
CODE_END:
```
